```python
import torch

def _softmax(x, axis=-1):
    return torch.softmax(x, dim=axis)

def _gelu(x):
    return torch.nn.functional.gelu(x, approximate='tanh')

def _silu(x):
    return torch.nn.functional.silu(x)

def _sigmoid(x):
    return torch.sigmoid(x)

def _layernorm(x, axis=-1, eps=1e-05):
    m = x.mean(dim=axis, keepdim=True)
    v = x.var(dim=axis, keepdim=True, unbiased=False)
    return (x - m) / torch.sqrt(v + eps)

def _scatter_add(tgt, idx, src, axis=0):
    return tgt.clone().index_add_(axis, idx, src)

def _segment_sum(src, seg, n):
    out = torch.zeros((n,) + src.shape[1:], dtype=src.dtype)
    return out.index_add_(0, seg, src)

def _pad(x, pw):
    flat = tuple((v for pair in reversed(pw) for v in pair))
    return torch.nn.functional.pad(x, flat)
kernel_name = 'adaLN_cond__mha_block_cached__glu_gated_geglu__prompt'

def setup_inputs():

    _w = lambda a: (lambda t: t.to(torch.bfloat16) if t.is_floating_point() else t)(torch.as_tensor(a))

    def _A_setup():
        B, Sq, D = (1, 2048, 448)
        H, Sk, Dh = (16, 2048, 256)
        return {'x': _w((lambda *s: torch.randn(*s, dtype=torch.bfloat16) * 0.05)(B, Sq, D)), 'k_cache': _w((lambda *s: torch.randn(*s, dtype=torch.bfloat16) * 0.8)(B, H, Sk, Dh)), 'v_cache': _w((lambda *s: torch.randn(*s, dtype=torch.bfloat16) * 3.2)(B, H, Sk, Dh)), 'wq': _w((lambda *s: torch.randn(*s, dtype=torch.bfloat16) * 0.8)(D, H * Dh) * D ** (-0.5)), 'wo': _w((lambda *s: torch.randn(*s, dtype=torch.bfloat16) * 3.2)(H * Dh, D) * (H * Dh) ** (-0.5))}
    _A_in = _A_setup()

    def _B_setup():
        B, S, Dm, Df = (1, 2048, 448, 1792)
        return {'x': _w((lambda *s: torch.randn(*s, dtype=torch.bfloat16) * 0.05)(B, S, Dm)), 'w_gate': _w((lambda *s: torch.randn(*s, dtype=torch.bfloat16) * 3.2)(Dm, Df) * Dm ** (-0.5)), 'w_up': _w((lambda *s: torch.randn(*s, dtype=torch.bfloat16) * 3.2)(Dm, Df) * Dm ** (-0.5)), 'w_down': _w((lambda *s: torch.randn(*s, dtype=torch.bfloat16) * 3.2)(Df, Dm) * Df ** (-0.5))}
    _B_in = _B_setup()
    return {'A_x': _A_in['x'], 'A_k_cache': _A_in['k_cache'], 'A_v_cache': _A_in['v_cache'], 'A_wq': _A_in['wq'], 'A_wo': _A_in['wo'], 'B_x': _B_in['x'], 'B_w_gate': _B_in['w_gate'], 'B_w_up': _B_in['w_up'], 'B_w_down': _B_in['w_down'], 'c': _w((lambda *s: torch.randn(*s, dtype=torch.bfloat16) * 0.4)(1, 448) * 8.0), 'w_mod': _w((lambda *s: torch.randn(*s, dtype=torch.bfloat16) * 0.4)(448, 6 * 448) * 448 ** (-0.5) * 8.0)}

def reference(A_x, A_k_cache, A_v_cache, A_wq, A_wo, B_x, B_w_gate, B_w_up, B_w_down, c, w_mod):

    def _A_ref(x, k_cache, v_cache, wq, wo):
        B, Sq, D = x.shape
        H, Dh = (16, 256)
        q = (lambda x, *d: x.permute(*d))((x @ wq).reshape(B, Sq, H, Dh), 0, 2, 1, 3)
        scores = torch.einsum('bhqd,bhkd->bhqk', q, k_cache) * Dh ** (-0.5)
        p = _softmax(scores, axis=-1)
        o = torch.einsum('bhqk,bhkd->bhqd', p, v_cache)
        return (lambda x, *d: x.permute(*d))(o, 0, 2, 1, 3).reshape(B, Sq, H * Dh) @ wo

    def _B_ref(x, w_gate, w_up, w_down):
        g = torch.einsum('bsd,df->bsf', x, w_gate)
        u = torch.einsum('bsd,df->bsf', x, w_up)
        h = _gelu(g) * u
        return torch.einsum('bsf,fd->bsd', h, w_down)
    x = A_x
    mod = (_silu(c) @ w_mod).reshape(c.shape[0], 6, 1, -1)
    sa, ca, ga, sb, cb, gb = (mod[:, 0].clone(), mod[:, 1].clone(), mod[:, 2].clone(), mod[:, 3].clone(), mod[:, 4].clone(), mod[:, 5].clone())
    h = _layernorm(x, axis=-1) * (1 + ca) + sa
    x = x + ga * _A_ref(h, A_k_cache, A_v_cache, A_wq, A_wo)
    h = _layernorm(x, axis=-1) * (1 + cb) + sb
    x = x + gb * _B_ref(h, B_w_gate, B_w_up, B_w_down)
    return x
```

```asm
; @launch grid=(256,1,1) block=(256,1,1) lds=163840
.amdgcn_target "amdgcn-amd-amdhsa--gfx950"
.text
.globl adaLN_cond__mha_block_cached__glu_gated_geglu__prompt_kernel
.p2align 8
.type adaLN_cond__mha_block_cached__glu_gated_geglu__prompt_kernel,@function
adaLN_cond__mha_block_cached__glu_gated_geglu__prompt_kernel:
s_cmp_ge_u32 s2, 256
s_cbranch_scc1 K_END
s_load_dwordx8 s[80:87], s[0:1], 64
s_load_dwordx16 s[64:79], s[0:1], 0
s_load_dwordx4 s[88:91], s[0:1], 96
v_lshrrev_b32 v29, 6, v0
v_and_b32 v30, 63, v0
v_readfirstlane_b32 s56, v29
s_getpc_b64 s[20:21]
K_PC:
s_lshr_b32 s59, s2, 3
v_min_u32 v252, 4, v30
s_lshl2_add_u32 s59, s59, s56
v_lshlrev_b32 v252, 14, v252
v_lshl_add_u32 v252, s59, 7, v252
v_min_u32 v252, K_STUB1-K_PC, v252
v_mov_b32 v253, s21
v_add_co_u32 v252, vcc, s20, v252
s_nop 1
v_addc_co_u32 v253, vcc, 0, v253, vcc
global_load_dword v254, v[252:253], off
s_bfe_u32 s57, s2, 131073
s_bfe_u32 s59, s2, 131075
s_lshl_b32 s57, s57, 2
s_lshr_b32 s58, s2, 5
s_add_u32 s57, s57, s59
s_and_b32 s59, s2, 1
s_lshl_b32 s59, s59, 3
s_add_u32 s58, s58, s59
s_lshl2_add_u32 s60, s57, s58
s_mul_i32 s59, s60, 37
s_lshr_b32 s59, s59, 8
s_mul_i32 s59, s59, 7
s_sub_u32 s60, s60, s59
s_mul_i32 s92, s60, 128
v_lshrrev_b32 v96, 2, v0
v_and_b32 v97, 3, v0
v_mul_u32_u24 v120, 43008, v96
v_lshl_add_u32 v120, v97, 4, v120
v_lshlrev_b32 v99, 4, v96
v_lshrrev_b32 v96, 3, v30
v_mul_u32_u24 v104, 896, v96
v_lshrrev_b32 v96, 4, v30
v_xor_b32 v96, v96, v30
v_and_b32 v96, 7, v96
v_lshl_add_u32 v104, v96, 4, v104
v_xor_b32 v105, 64, v104
v_add_u32 v105, 6144, v105
v_add_u32 v106, 12288, v104
v_add_u32 v107, 12288, v105
v_and_b32 v98, 15, v30
v_lshlrev_b32 v98, 3, v98
v_lshrrev_b32 v96, 4, v30
v_lshl_add_u32 v123, v96, 12, v98
s_lshl_b32 s24, s56, 13
s_lshl2_add_u32 s59, s58, s56
s_mul_i32 s33, s59, 28672
s_add_u32 s93, s92, 128
s_cmp_eq_u32 s93, 896
s_cselect_b32 s93, 0, s93
s_add_u32 s94, s93, 128
s_cmp_eq_u32 s94, 896
s_cselect_b32 s94, 0, s94
s_add_u32 s95, s94, 128
s_cmp_eq_u32 s95, 896
s_cselect_b32 s95, 0, s95
s_add_u32 s100, s95, 128
s_cmp_eq_u32 s100, 896
s_cselect_b32 s100, 0, s100
s_add_u32 s101, s100, 128
s_cmp_eq_u32 s101, 896
s_cselect_b32 s101, 0, s101
s_add_u32 s35, s101, 128
s_cmp_eq_u32 s35, 896
s_cselect_b32 s35, 0, s35
s_lshl_b32 s62, s2, 7
s_cmp_ge_u32 s2, 84
s_waitcnt lgkmcnt(0)
s_mov_b32 s36, s64
s_mov_b32 s37, s65
s_mov_b32 s38, 1835008
s_mov_b32 s39, 0x20000
s_mov_b32 s52, s82
s_mov_b32 s53, s83
s_mov_b32 s54, 896
s_mov_b32 s55, 0x20000
s_mov_b32 s48, s84
s_mov_b32 s49, s85
s_mov_b32 s50, 2408448
s_mov_b32 s51, 0x20000
s_cbranch_scc1 PRO_A
buffer_load_dwordx4 v[124:127], v99, s[52:55], 0 offen
s_cmp_ge_u32 s2, 28
s_cbranch_scc1 PRO_A
s_mov_b32 s20, s90
s_mov_b32 s21, s91
s_mov_b32 s22, 268435456
s_mov_b32 s23, 0x20000
s_add_u32 s62, s62, 32768
buffer_load_dword v122, v123, s[20:23], s62 offen offset:4 sc1
s_lshl_b32 s61, s2, 6
buffer_load_dwordx4 v[32:35], v120, s[48:51], s61 offen
s_add_u32 s61, s61, 5376
buffer_load_dwordx4 v[36:39], v120, s[48:51], s61 offen
s_add_u32 s61, s61, 5376
buffer_load_dwordx4 v[40:43], v120, s[48:51], s61 offen
s_add_u32 s61, s61, 5376
buffer_load_dwordx4 v[44:47], v120, s[48:51], s61 offen
s_add_u32 s61, s61, 5376
buffer_load_dwordx4 v[48:51], v120, s[48:51], s61 offen
s_add_u32 s61, s61, 5376
buffer_load_dwordx4 v[52:55], v120, s[48:51], s61 offen
s_add_u32 s61, s61, 5376
buffer_load_dwordx4 v[56:59], v120, s[48:51], s61 offen
s_add_u32 s61, s61, 5376
buffer_load_dwordx4 v[60:63], v120, s[48:51], s61 offen
PRO_A:
s_add_u32 m0, s24, 65536
s_add_u32 s29, s33, s92
buffer_load_dwordx4 v104, s[36:39], s29 offen lds
buffer_load_dwordx4 v105, s[36:39], s29 offen offset:1024 lds
buffer_load_dwordx4 v106, s[36:39], s29 offen offset:2048 lds
buffer_load_dwordx4 v107, s[36:39], s29 offen offset:3072 lds
s_add_u32 m0, s24, 69632
s_add_u32 s29, s33, s93
buffer_load_dwordx4 v104, s[36:39], s29 offen lds
buffer_load_dwordx4 v105, s[36:39], s29 offen offset:1024 lds
buffer_load_dwordx4 v106, s[36:39], s29 offen offset:2048 lds
buffer_load_dwordx4 v107, s[36:39], s29 offen offset:3072 lds
s_mov_b32 s20, s90
s_mov_b32 s21, s91
s_mov_b32 s22, 268435456
s_mov_b32 s23, 0x20000
s_mov_b32 s40, s88
s_mov_b32 s41, s89
s_mov_b32 s42, 256
s_mov_b32 s43, 0x20000
s_lshl_b32 s61, s57, 9
s_add_u32 s12, s70, s61
s_addc_u32 s13, s71, 0
s_sub_u32 s14, 3670016, s61
s_mov_b32 s15, 0x20000
s_mov_b32 s25, 0
s_mov_b32 s26, 0
s_mov_b32 s28, 0x5f800000
s_lshl2_add_u32 s59, s58, s56
s_mul_i32 s59, s59, 4096
s_mul_i32 s60, s57, 262144
s_add_u32 s32, s59, s60
s_add_u32 s32, s32, 16777216
s_lshl_b32 s61, s57, 20
s_add_u32 s4, s66, s61
s_addc_u32 s5, s67, 0
s_mov_b32 s6, 1048576
s_mov_b32 s7, 0x20000
s_add_u32 s8, s68, s61
s_addc_u32 s9, s69, 0
s_mov_b32 s10, 1048576
s_mov_b32 s11, 0x20000

s_mul_i32 s61, s57, 229376
s_add_u32 s16, s72, s61
s_addc_u32 s17, s73, 0
s_mov_b32 s18, 229376
s_mov_b32 s19, 0x20000
s_and_b32 s59, s56, 1
s_mul_i32 s61, s59, 114688
s_mul_i32 s60, s57, 224
s_add_u32 s61, s61, s60
s_mul_i32 s34, s59, 7168
s_cmp_lt_u32 s56, 2
s_cselect_b32 s44, s76, s78
s_cselect_b32 s45, s77, s79
s_cselect_b32 s59, 0, 14464
s_add_u32 s34, s34, s59
s_add_u32 s44, s44, s61
s_addc_u32 s45, s45, 0
s_sub_u32 s46, 1605632, s61
s_mov_b32 s47, 0x20000
s_lshl2_add_u32 s63, s58, s56
s_lshl4_add_u32 s63, s63, s57
s_lshl_b32 s63, s63, 7
s_add_u32 s63, s63, 262144
s_lshl1_add_u32 s59, s92, 131072
v_lshrrev_b32 v96, 5, v30
v_and_b32 v97, 31, v30
v_lshl_add_u32 v250, v96, 5, s59
v_lshl_add_u32 v98, v29, 4, v96
v_lshlrev_b32 v98, 13, v98
v_lshlrev_b32 v100, 2, v96
v_xor_b32 v100, v100, v97
v_lshl_add_u32 v248, v100, 4, v98
v_xor_b32 v249, 128, v248
v_and_b32 v98, 15, v30
v_lshrrev_b32 v99, 4, v30
v_xor_b32 v99, v99, v98
v_lshlrev_b32 v98, 9, v98
v_lshl_add_u32 v99, v99, 4, v98
v_add_u32 v99, 98304, v99
v_xor_b32 v1, 0, v99
v_xor_b32 v2, 64, v99
v_xor_b32 v3, 128, v99
v_xor_b32 v4, 192, v99
v_lshrrev_b32 v98, 2, v30
v_lshlrev_b32 v99, 9, v98
v_and_b32 v98, 7, v98
v_lshl_add_u32 v99, v98, 5, v99
v_and_b32 v98, 3, v30
v_lshl_add_u32 v99, v98, 3, v99
v_xor_b32 v5, 65536, v99
v_xor_b32 v6, 65568, v99
v_xor_b32 v7, 65600, v99
v_xor_b32 v8, 65632, v99
v_xor_b32 v9, 65664, v99
v_xor_b32 v10, 65696, v99
v_xor_b32 v11, 65728, v99
v_xor_b32 v12, 65760, v99
v_bfe_u32 v98, v30, 2, 2
v_mul_u32_u24 v99, 576, v98
v_lshl_add_u32 v99, v96, 12, v99
v_and_b32 v98, 1, v30
v_lshl_add_u32 v99, v98, 5, v99
v_and_b32 v98, 16, v30
v_add_u32 v99, v99, v98
v_and_b32 v98, 2, v30
v_lshl_add_u32 v99, v98, 2, v99
v_xor_b32 v240, 0, v99
v_xor_b32 v241, 64, v99
v_xor_b32 v242, 128, v99
v_xor_b32 v243, 192, v99
v_xor_b32 v244, 65536, v99
v_xor_b32 v245, 65600, v99
v_xor_b32 v246, 65664, v99
v_xor_b32 v247, 65728, v99
v_lshlrev_b32 v98, 13, v29
v_lshl_add_u32 v98, v96, 9, v98
v_xor_b32 v99, v97, v96
v_lshl_add_u32 v99, v99, 4, v98
v_xor_b32 v13, 0, v99
v_xor_b32 v14, 32, v99
v_xor_b32 v15, 64, v99
v_xor_b32 v16, 96, v99
v_xor_b32 v17, 4224, v99
v_xor_b32 v18, 4256, v99
v_xor_b32 v19, 4288, v99
v_xor_b32 v20, 4320, v99
v_lshlrev_b32 v100, 1, v96
v_xor_b32 v100, v100, v97
v_lshl_add_u32 v99, v100, 4, v98
v_xor_b32 v21, 0, v99
v_xor_b32 v22, 64, v99
v_xor_b32 v23, 128, v99
v_xor_b32 v24, 192, v99
v_xor_b32 v25, 4096, v99
v_xor_b32 v26, 4160, v99
v_xor_b32 v27, 4224, v99
v_xor_b32 v28, 4288, v99
v_bfe_u32 v98, v30, 1, 3
v_xor_b32 v98, v98, v96
v_lshlrev_b32 v99, 7, v97
v_lshl_add_u32 v99, v98, 4, v99
s_add_u32 s59, s24, 32768
v_add_u32 v108, s59, v99
v_xor_b32 v109, 32, v108
v_xor_b32 v110, 64, v108
v_xor_b32 v111, 96, v108
v_mov_b32 v112, 0
v_mov_b32 v113, 0
v_mov_b32 v114, 0
v_mov_b32 v115, 0
s_cmp_lt_u32 s2, 84
s_cbranch_scc1 PROD
PRO_B:
s_mov_b32 s59, 0x3f803f80
s_add_u32 m0, s24, 32768
s_add_u32 s29, s33, s94
buffer_load_dwordx4 v104, s[36:39], s29 offen lds
buffer_load_dwordx4 v105, s[36:39], s29 offen offset:1024 lds
buffer_load_dwordx4 v106, s[36:39], s29 offen offset:2048 lds
buffer_load_dwordx4 v107, s[36:39], s29 offen offset:3072 lds
s_add_u32 m0, s24, 36864
s_add_u32 s29, s33, s95
buffer_load_dwordx4 v104, s[36:39], s29 offen lds
buffer_load_dwordx4 v105, s[36:39], s29 offen offset:1024 lds
buffer_load_dwordx4 v106, s[36:39], s29 offen offset:2048 lds
buffer_load_dwordx4 v107, s[36:39], s29 offen offset:3072 lds
s_add_u32 m0, s24, 98304
s_add_u32 s29, s33, s100
buffer_load_dwordx4 v104, s[36:39], s29 offen lds
buffer_load_dwordx4 v105, s[36:39], s29 offen offset:1024 lds
buffer_load_dwordx4 v106, s[36:39], s29 offen offset:2048 lds
buffer_load_dwordx4 v107, s[36:39], s29 offen offset:3072 lds
s_waitcnt vmcnt(16)
ds_read_b128 v[128:131], v108 offset:32768
ds_read_b128 v[132:135], v109 offset:32768
ds_read_b128 v[136:139], v110 offset:32768
ds_read_b128 v[140:143], v111 offset:32768
s_add_u32 m0, s24, 102400
s_add_u32 s29, s33, s101
buffer_load_dwordx4 v104, s[36:39], s29 offen lds
buffer_load_dwordx4 v105, s[36:39], s29 offen offset:1024 lds
buffer_load_dwordx4 v106, s[36:39], s29 offen offset:2048 lds
buffer_load_dwordx4 v107, s[36:39], s29 offen offset:3072 lds
s_waitcnt vmcnt(16)
ds_read_b128 v[144:147], v108 offset:36864
ds_read_b128 v[148:151], v109 offset:36864
ds_read_b128 v[152:155], v110 offset:36864
ds_read_b128 v[156:159], v111 offset:36864
s_waitcnt lgkmcnt(7)
v_dot2c_f32_bf16 v112, s59, v128
v_dot2c_f32_bf16 v114, v128, v128
v_dot2c_f32_bf16 v113, s59, v129
v_dot2c_f32_bf16 v115, v129, v129
v_dot2c_f32_bf16 v112, s59, v130
v_dot2c_f32_bf16 v114, v130, v130
v_dot2c_f32_bf16 v113, s59, v131
v_dot2c_f32_bf16 v115, v131, v131
s_waitcnt lgkmcnt(6)
v_dot2c_f32_bf16 v112, s59, v132
v_dot2c_f32_bf16 v114, v132, v132
v_dot2c_f32_bf16 v113, s59, v133
v_dot2c_f32_bf16 v115, v133, v133
v_dot2c_f32_bf16 v112, s59, v134
v_dot2c_f32_bf16 v114, v134, v134
v_dot2c_f32_bf16 v113, s59, v135
v_dot2c_f32_bf16 v115, v135, v135
s_waitcnt lgkmcnt(5)
v_dot2c_f32_bf16 v112, s59, v136
v_dot2c_f32_bf16 v114, v136, v136
v_dot2c_f32_bf16 v113, s59, v137
v_dot2c_f32_bf16 v115, v137, v137
v_dot2c_f32_bf16 v112, s59, v138
v_dot2c_f32_bf16 v114, v138, v138
v_dot2c_f32_bf16 v113, s59, v139
v_dot2c_f32_bf16 v115, v139, v139
s_waitcnt lgkmcnt(4)
v_dot2c_f32_bf16 v112, s59, v140
v_dot2c_f32_bf16 v114, v140, v140
v_dot2c_f32_bf16 v113, s59, v141
v_dot2c_f32_bf16 v115, v141, v141
v_dot2c_f32_bf16 v112, s59, v142
v_dot2c_f32_bf16 v114, v142, v142
v_dot2c_f32_bf16 v113, s59, v143
v_dot2c_f32_bf16 v115, v143, v143
s_add_u32 m0, s24, 135168
s_add_u32 s29, s33, s35
buffer_load_dwordx4 v104, s[36:39], s29 offen lds
buffer_load_dwordx4 v105, s[36:39], s29 offen offset:1024 lds
buffer_load_dwordx4 v106, s[36:39], s29 offen offset:2048 lds
buffer_load_dwordx4 v107, s[36:39], s29 offen offset:3072 lds
s_waitcnt vmcnt(16)
ds_read_b128 v[160:163], v108 offset:0
ds_read_b128 v[164:167], v109 offset:0
ds_read_b128 v[168:171], v110 offset:0
ds_read_b128 v[172:175], v111 offset:0
s_waitcnt lgkmcnt(7)
v_dot2c_f32_bf16 v112, s59, v144
v_dot2c_f32_bf16 v114, v144, v144
v_dot2c_f32_bf16 v113, s59, v145
v_dot2c_f32_bf16 v115, v145, v145
v_dot2c_f32_bf16 v112, s59, v146
v_dot2c_f32_bf16 v114, v146, v146
v_dot2c_f32_bf16 v113, s59, v147
v_dot2c_f32_bf16 v115, v147, v147
s_waitcnt lgkmcnt(6)
v_dot2c_f32_bf16 v112, s59, v148
v_dot2c_f32_bf16 v114, v148, v148
v_dot2c_f32_bf16 v113, s59, v149
v_dot2c_f32_bf16 v115, v149, v149
v_dot2c_f32_bf16 v112, s59, v150
v_dot2c_f32_bf16 v114, v150, v150
v_dot2c_f32_bf16 v113, s59, v151
v_dot2c_f32_bf16 v115, v151, v151
s_waitcnt lgkmcnt(5)
v_dot2c_f32_bf16 v112, s59, v152
v_dot2c_f32_bf16 v114, v152, v152
v_dot2c_f32_bf16 v113, s59, v153
v_dot2c_f32_bf16 v115, v153, v153
v_dot2c_f32_bf16 v112, s59, v154
v_dot2c_f32_bf16 v114, v154, v154
v_dot2c_f32_bf16 v113, s59, v155
v_dot2c_f32_bf16 v115, v155, v155
s_waitcnt lgkmcnt(4)
v_dot2c_f32_bf16 v112, s59, v156
v_dot2c_f32_bf16 v114, v156, v156
v_dot2c_f32_bf16 v113, s59, v157
v_dot2c_f32_bf16 v115, v157, v157
v_dot2c_f32_bf16 v112, s59, v158
v_dot2c_f32_bf16 v114, v158, v158
v_dot2c_f32_bf16 v113, s59, v159
v_dot2c_f32_bf16 v115, v159, v159
s_lshl_b32 s92, s92, 12
s_lshl_b32 s93, s93, 12
s_lshl_b32 s94, s94, 12
s_lshl_b32 s95, s95, 12
s_lshl_b32 s100, s100, 12
s_lshl_b32 s101, s101, 12
s_lshl_b32 s35, s35, 12
s_add_u32 m0, s24, 0
s_mov_b32 s29, s92
buffer_load_dwordx4 v248, s[12:15], s29 offen lds
s_add_u32 s29, s92, 15360
buffer_load_dwordx4 v249, s[12:15], s29 offen offset:1024 lds
s_add_u32 s29, s92, 30720
buffer_load_dwordx4 v248, s[12:15], s29 offen offset:2048 lds
s_add_u32 s29, s92, 46080
buffer_load_dwordx4 v249, s[12:15], s29 offen offset:3072 lds
s_add_u32 m0, s24, 4096
s_add_u32 s29, s92, 65536
buffer_load_dwordx4 v248, s[12:15], s29 offen lds
s_add_u32 s29, s92, 80896
buffer_load_dwordx4 v249, s[12:15], s29 offen offset:1024 lds
s_add_u32 s29, s92, 96256
buffer_load_dwordx4 v248, s[12:15], s29 offen offset:2048 lds
s_add_u32 s29, s92, 111616
buffer_load_dwordx4 v249, s[12:15], s29 offen offset:3072 lds
s_waitcnt vmcnt(20)
ds_read_b128 v[176:179], v108 offset:4096
ds_read_b128 v[180:183], v109 offset:4096
ds_read_b128 v[184:187], v110 offset:4096
ds_read_b128 v[188:191], v111 offset:4096
s_waitcnt lgkmcnt(7)
v_dot2c_f32_bf16 v112, s59, v160
v_dot2c_f32_bf16 v114, v160, v160
v_dot2c_f32_bf16 v113, s59, v161
v_dot2c_f32_bf16 v115, v161, v161
v_dot2c_f32_bf16 v112, s59, v162
v_dot2c_f32_bf16 v114, v162, v162
v_dot2c_f32_bf16 v113, s59, v163
v_dot2c_f32_bf16 v115, v163, v163
s_waitcnt lgkmcnt(6)
v_dot2c_f32_bf16 v112, s59, v164
v_dot2c_f32_bf16 v114, v164, v164
v_dot2c_f32_bf16 v113, s59, v165
v_dot2c_f32_bf16 v115, v165, v165
v_dot2c_f32_bf16 v112, s59, v166
v_dot2c_f32_bf16 v114, v166, v166
v_dot2c_f32_bf16 v113, s59, v167
v_dot2c_f32_bf16 v115, v167, v167
s_waitcnt lgkmcnt(5)
v_dot2c_f32_bf16 v112, s59, v168
v_dot2c_f32_bf16 v114, v168, v168
v_dot2c_f32_bf16 v113, s59, v169
v_dot2c_f32_bf16 v115, v169, v169
v_dot2c_f32_bf16 v112, s59, v170
v_dot2c_f32_bf16 v114, v170, v170
v_dot2c_f32_bf16 v113, s59, v171
v_dot2c_f32_bf16 v115, v171, v171
s_waitcnt lgkmcnt(4)
v_dot2c_f32_bf16 v112, s59, v172
v_dot2c_f32_bf16 v114, v172, v172
v_dot2c_f32_bf16 v113, s59, v173
v_dot2c_f32_bf16 v115, v173, v173
v_dot2c_f32_bf16 v112, s59, v174
v_dot2c_f32_bf16 v114, v174, v174
v_dot2c_f32_bf16 v113, s59, v175
v_dot2c_f32_bf16 v115, v175, v175
v_add_u32 v108, 0x10000, v108
v_add_u32 v109, 0x10000, v109
v_add_u32 v110, 0x10000, v110
v_add_u32 v111, 0x10000, v111
s_waitcnt vmcnt(16)
ds_read_b128 v[192:195], v108 offset:0
ds_read_b128 v[196:199], v109 offset:0
ds_read_b128 v[200:203], v110 offset:0
ds_read_b128 v[204:207], v111 offset:0
s_waitcnt lgkmcnt(7)
v_dot2c_f32_bf16 v112, s59, v176
v_dot2c_f32_bf16 v114, v176, v176
v_dot2c_f32_bf16 v113, s59, v177
v_dot2c_f32_bf16 v115, v177, v177
v_dot2c_f32_bf16 v112, s59, v178
v_dot2c_f32_bf16 v114, v178, v178
v_dot2c_f32_bf16 v113, s59, v179
v_dot2c_f32_bf16 v115, v179, v179
s_waitcnt lgkmcnt(6)
v_dot2c_f32_bf16 v112, s59, v180
v_dot2c_f32_bf16 v114, v180, v180
v_dot2c_f32_bf16 v113, s59, v181
v_dot2c_f32_bf16 v115, v181, v181
v_dot2c_f32_bf16 v112, s59, v182
v_dot2c_f32_bf16 v114, v182, v182
v_dot2c_f32_bf16 v113, s59, v183
v_dot2c_f32_bf16 v115, v183, v183
s_waitcnt lgkmcnt(5)
v_dot2c_f32_bf16 v112, s59, v184
v_dot2c_f32_bf16 v114, v184, v184
v_dot2c_f32_bf16 v113, s59, v185
v_dot2c_f32_bf16 v115, v185, v185
v_dot2c_f32_bf16 v112, s59, v186
v_dot2c_f32_bf16 v114, v186, v186
v_dot2c_f32_bf16 v113, s59, v187
v_dot2c_f32_bf16 v115, v187, v187
s_waitcnt lgkmcnt(4)
v_dot2c_f32_bf16 v112, s59, v188
v_dot2c_f32_bf16 v114, v188, v188
v_dot2c_f32_bf16 v113, s59, v189
v_dot2c_f32_bf16 v115, v189, v189
v_dot2c_f32_bf16 v112, s59, v190
v_dot2c_f32_bf16 v114, v190, v190
v_dot2c_f32_bf16 v113, s59, v191
v_dot2c_f32_bf16 v115, v191, v191
s_waitcnt vmcnt(12)
ds_read_b128 v[208:211], v108 offset:4096
ds_read_b128 v[212:215], v109 offset:4096
ds_read_b128 v[216:219], v110 offset:4096
ds_read_b128 v[220:223], v111 offset:4096
s_waitcnt lgkmcnt(7)
v_dot2c_f32_bf16 v112, s59, v192
v_dot2c_f32_bf16 v114, v192, v192
v_dot2c_f32_bf16 v113, s59, v193
v_dot2c_f32_bf16 v115, v193, v193
v_dot2c_f32_bf16 v112, s59, v194
v_dot2c_f32_bf16 v114, v194, v194
v_dot2c_f32_bf16 v113, s59, v195
v_dot2c_f32_bf16 v115, v195, v195
s_waitcnt lgkmcnt(6)
v_dot2c_f32_bf16 v112, s59, v196
v_dot2c_f32_bf16 v114, v196, v196
v_dot2c_f32_bf16 v113, s59, v197
v_dot2c_f32_bf16 v115, v197, v197
v_dot2c_f32_bf16 v112, s59, v198
v_dot2c_f32_bf16 v114, v198, v198
v_dot2c_f32_bf16 v113, s59, v199
v_dot2c_f32_bf16 v115, v199, v199
s_waitcnt lgkmcnt(5)
v_dot2c_f32_bf16 v112, s59, v200
v_dot2c_f32_bf16 v114, v200, v200
v_dot2c_f32_bf16 v113, s59, v201
v_dot2c_f32_bf16 v115, v201, v201
v_dot2c_f32_bf16 v112, s59, v202
v_dot2c_f32_bf16 v114, v202, v202
v_dot2c_f32_bf16 v113, s59, v203
v_dot2c_f32_bf16 v115, v203, v203
s_waitcnt lgkmcnt(4)
v_dot2c_f32_bf16 v112, s59, v204
v_dot2c_f32_bf16 v114, v204, v204
v_dot2c_f32_bf16 v113, s59, v205
v_dot2c_f32_bf16 v115, v205, v205
v_dot2c_f32_bf16 v112, s59, v206
v_dot2c_f32_bf16 v114, v206, v206
v_dot2c_f32_bf16 v113, s59, v207
v_dot2c_f32_bf16 v115, v207, v207
s_waitcnt vmcnt(8)
ds_read_b128 v[224:227], v108 offset:36864
ds_read_b128 v[228:231], v109 offset:36864
ds_read_b128 v[232:235], v110 offset:36864
ds_read_b128 v[236:239], v111 offset:36864
s_waitcnt lgkmcnt(7)
v_dot2c_f32_bf16 v112, s59, v208
v_dot2c_f32_bf16 v114, v208, v208
v_dot2c_f32_bf16 v113, s59, v209
v_dot2c_f32_bf16 v115, v209, v209
v_dot2c_f32_bf16 v112, s59, v210
v_dot2c_f32_bf16 v114, v210, v210
v_dot2c_f32_bf16 v113, s59, v211
v_dot2c_f32_bf16 v115, v211, v211
s_waitcnt lgkmcnt(6)
v_dot2c_f32_bf16 v112, s59, v212
v_dot2c_f32_bf16 v114, v212, v212
v_dot2c_f32_bf16 v113, s59, v213
v_dot2c_f32_bf16 v115, v213, v213
v_dot2c_f32_bf16 v112, s59, v214
v_dot2c_f32_bf16 v114, v214, v214
v_dot2c_f32_bf16 v113, s59, v215
v_dot2c_f32_bf16 v115, v215, v215
s_waitcnt lgkmcnt(5)
v_dot2c_f32_bf16 v112, s59, v216
v_dot2c_f32_bf16 v114, v216, v216
v_dot2c_f32_bf16 v113, s59, v217
v_dot2c_f32_bf16 v115, v217, v217
v_dot2c_f32_bf16 v112, s59, v218
v_dot2c_f32_bf16 v114, v218, v218
v_dot2c_f32_bf16 v113, s59, v219
v_dot2c_f32_bf16 v115, v219, v219
s_waitcnt lgkmcnt(4)
v_dot2c_f32_bf16 v112, s59, v220
v_dot2c_f32_bf16 v114, v220, v220
v_dot2c_f32_bf16 v113, s59, v221
v_dot2c_f32_bf16 v115, v221, v221
v_dot2c_f32_bf16 v112, s59, v222
v_dot2c_f32_bf16 v114, v222, v222
v_dot2c_f32_bf16 v113, s59, v223
v_dot2c_f32_bf16 v115, v223, v223
s_sub_u32 m0, s2, 28
s_cmp_ge_u32 m0, 56
s_cbranch_scc1 PRO_D
s_lshl_b32 s61, s2, 6
buffer_load_dwordx4 v[32:35], v120, s[48:51], s61 offen
s_add_u32 s61, s61, 5376
buffer_load_dwordx4 v[36:39], v120, s[48:51], s61 offen
s_add_u32 s61, s61, 5376
buffer_load_dwordx4 v[40:43], v120, s[48:51], s61 offen
s_add_u32 s61, s61, 5376
buffer_load_dwordx4 v[44:47], v120, s[48:51], s61 offen
s_add_u32 s61, s61, 5376
buffer_load_dwordx4 v[48:51], v120, s[48:51], s61 offen
s_add_u32 s61, s61, 5376
buffer_load_dwordx4 v[52:55], v120, s[48:51], s61 offen
s_add_u32 s61, s61, 5376
buffer_load_dwordx4 v[56:59], v120, s[48:51], s61 offen
s_add_u32 s61, s61, 5376
buffer_load_dwordx4 v[60:63], v120, s[48:51], s61 offen
PRO_D:
v_min_u32 v95, 55, v30
s_mul_i32 s60, s56, 56
v_add_u32 v93, s60, v95
s_bfe_u32 s62, s2, 0x20003
v_lshrrev_b32 v94, 3, v93
v_lshlrev_b32 v93, 4, v93
v_lshl_add_u32 v94, v94, 2, s62
s_cmp_lt_u32 s56, 2
s_cselect_b32 s60, 0, 6400
s_add_u32 s60, s60, 131072
s_lshl_b32 s62, s62, 12
v_add_u32 v95, s60, v93
s_add_u32 s62, s62, 32768
v_add_u32 v93, s62, v93
s_waitcnt lgkmcnt(3)
v_dot2c_f32_bf16 v112, s59, v224
v_dot2c_f32_bf16 v114, v224, v224
v_dot2c_f32_bf16 v113, s59, v225
v_dot2c_f32_bf16 v115, v225, v225
v_dot2c_f32_bf16 v112, s59, v226
v_dot2c_f32_bf16 v114, v226, v226
v_dot2c_f32_bf16 v113, s59, v227
v_dot2c_f32_bf16 v115, v227, v227
s_waitcnt lgkmcnt(2)
v_dot2c_f32_bf16 v112, s59, v228
v_dot2c_f32_bf16 v114, v228, v228
v_dot2c_f32_bf16 v113, s59, v229
v_dot2c_f32_bf16 v115, v229, v229
v_dot2c_f32_bf16 v112, s59, v230
v_dot2c_f32_bf16 v114, v230, v230
v_dot2c_f32_bf16 v113, s59, v231
v_dot2c_f32_bf16 v115, v231, v231
s_waitcnt lgkmcnt(1)
v_dot2c_f32_bf16 v112, s59, v232
v_dot2c_f32_bf16 v114, v232, v232
v_dot2c_f32_bf16 v113, s59, v233
v_dot2c_f32_bf16 v115, v233, v233
v_dot2c_f32_bf16 v112, s59, v234
v_dot2c_f32_bf16 v114, v234, v234
v_dot2c_f32_bf16 v113, s59, v235
v_dot2c_f32_bf16 v115, v235, v235
s_waitcnt lgkmcnt(0)
v_dot2c_f32_bf16 v112, s59, v236
v_dot2c_f32_bf16 v114, v236, v236
v_dot2c_f32_bf16 v113, s59, v237
v_dot2c_f32_bf16 v115, v237, v237
v_dot2c_f32_bf16 v112, s59, v238
v_dot2c_f32_bf16 v114, v238, v238
v_dot2c_f32_bf16 v113, s59, v239
v_dot2c_f32_bf16 v115, v239, v239
s_mov_b32 s60, 0x3b124925
s_mov_b32 s61, 0xffff0000
s_nop 0
v_add_f32 v112, v112, v113
v_add_f32 v114, v114, v115
v_mov_b32 v116, v112
v_mov_b32 v117, v114
s_nop 0
v_permlane32_swap_b32 v112, v116
v_permlane32_swap_b32 v114, v117
v_add_f32 v112, v112, v116
v_add_f32 v114, v114, v117
v_mul_f32 v112, s60, v112
v_mul_f32 v114, s60, v114
v_fma_f32 v114, -v112, v112, v114
v_max_f32 v114, 0, v114
v_add_f32 v114, 0x3727c5ac, v114
v_rsq_f32 v251, v114
v_mov_b32 v252, v121
v_mul_f32 v31, -v112, v251
v_lshlrev_b32 v96, 16, v144
v_and_b32 v97, s61, v144
v_lshlrev_b32 v98, 16, v145
v_and_b32 v99, s61, v145
v_lshlrev_b32 v100, 16, v146
v_and_b32 v101, s61, v146
v_lshlrev_b32 v102, 16, v147
v_and_b32 v103, s61, v147
v_fma_f32 v96, v96, v251, v31
v_fma_f32 v97, v97, v251, v31
v_fma_f32 v98, v98, v251, v31
v_fma_f32 v99, v99, v251, v31
v_fma_f32 v100, v100, v251, v31
v_fma_f32 v101, v101, v251, v31
v_fma_f32 v102, v102, v251, v31
v_fma_f32 v103, v103, v251, v31
v_cvt_pk_bf16_f32 v144, v96, v97
v_cvt_pk_bf16_f32 v145, v98, v99
v_cvt_pk_bf16_f32 v146, v100, v101
v_cvt_pk_bf16_f32 v147, v102, v103
v_lshlrev_b32 v104, 16, v148
v_and_b32 v105, s61, v148
v_lshlrev_b32 v106, 16, v149
v_and_b32 v107, s61, v149
v_lshlrev_b32 v108, 16, v150
v_and_b32 v109, s61, v150
v_lshlrev_b32 v110, 16, v151
v_and_b32 v111, s61, v151
v_fma_f32 v104, v104, v251, v31
v_fma_f32 v105, v105, v251, v31
v_fma_f32 v106, v106, v251, v31
v_fma_f32 v107, v107, v251, v31
v_fma_f32 v108, v108, v251, v31
v_fma_f32 v109, v109, v251, v31
v_fma_f32 v110, v110, v251, v31
v_fma_f32 v111, v111, v251, v31
v_cvt_pk_bf16_f32 v148, v104, v105
v_cvt_pk_bf16_f32 v149, v106, v107
v_cvt_pk_bf16_f32 v150, v108, v109
v_cvt_pk_bf16_f32 v151, v110, v111
v_lshlrev_b32 v112, 16, v152
v_and_b32 v113, s61, v152
v_lshlrev_b32 v114, 16, v153
v_and_b32 v115, s61, v153
v_lshlrev_b32 v116, 16, v154
v_and_b32 v117, s61, v154
v_lshlrev_b32 v118, 16, v155
v_and_b32 v119, s61, v155
v_fma_f32 v112, v112, v251, v31
v_fma_f32 v113, v113, v251, v31
v_fma_f32 v114, v114, v251, v31
v_fma_f32 v115, v115, v251, v31
v_fma_f32 v116, v116, v251, v31
v_fma_f32 v117, v117, v251, v31
v_fma_f32 v118, v118, v251, v31
v_fma_f32 v119, v119, v251, v31
v_cvt_pk_bf16_f32 v152, v112, v113
v_cvt_pk_bf16_f32 v153, v114, v115
v_cvt_pk_bf16_f32 v154, v116, v117
v_cvt_pk_bf16_f32 v155, v118, v119
v_lshlrev_b32 v120, 16, v156
v_and_b32 v121, s61, v156
v_lshlrev_b32 v122, 16, v157
v_and_b32 v123, s61, v157
v_lshlrev_b32 v124, 16, v158
v_and_b32 v125, s61, v158
v_lshlrev_b32 v126, 16, v159
v_and_b32 v127, s61, v159
v_fma_f32 v120, v120, v251, v31
v_fma_f32 v121, v121, v251, v31
v_fma_f32 v122, v122, v251, v31
v_fma_f32 v123, v123, v251, v31
v_fma_f32 v124, v124, v251, v31
v_fma_f32 v125, v125, v251, v31
v_fma_f32 v126, v126, v251, v31
v_fma_f32 v127, v127, v251, v31
v_cvt_pk_bf16_f32 v156, v120, v121
v_cvt_pk_bf16_f32 v157, v122, v123
v_cvt_pk_bf16_f32 v158, v124, v125
v_cvt_pk_bf16_f32 v159, v126, v127
v_lshlrev_b32 v96, 16, v160
v_and_b32 v97, s61, v160
v_lshlrev_b32 v98, 16, v161
v_and_b32 v99, s61, v161
v_lshlrev_b32 v100, 16, v162
v_and_b32 v101, s61, v162
v_lshlrev_b32 v102, 16, v163
v_and_b32 v103, s61, v163
v_fma_f32 v96, v96, v251, v31
v_fma_f32 v97, v97, v251, v31
v_fma_f32 v98, v98, v251, v31
v_fma_f32 v99, v99, v251, v31
v_fma_f32 v100, v100, v251, v31
v_fma_f32 v101, v101, v251, v31
v_fma_f32 v102, v102, v251, v31
v_fma_f32 v103, v103, v251, v31
v_cvt_pk_bf16_f32 v160, v96, v97
v_cvt_pk_bf16_f32 v161, v98, v99
v_cvt_pk_bf16_f32 v162, v100, v101
v_cvt_pk_bf16_f32 v163, v102, v103
v_lshlrev_b32 v104, 16, v164
v_and_b32 v105, s61, v164
v_lshlrev_b32 v106, 16, v165
v_and_b32 v107, s61, v165
v_lshlrev_b32 v108, 16, v166
v_and_b32 v109, s61, v166
v_lshlrev_b32 v110, 16, v167
v_and_b32 v111, s61, v167
v_fma_f32 v104, v104, v251, v31
v_fma_f32 v105, v105, v251, v31
v_fma_f32 v106, v106, v251, v31
v_fma_f32 v107, v107, v251, v31
v_fma_f32 v108, v108, v251, v31
v_fma_f32 v109, v109, v251, v31
v_fma_f32 v110, v110, v251, v31
v_fma_f32 v111, v111, v251, v31
v_cvt_pk_bf16_f32 v164, v104, v105
v_cvt_pk_bf16_f32 v165, v106, v107
v_cvt_pk_bf16_f32 v166, v108, v109
v_cvt_pk_bf16_f32 v167, v110, v111
v_lshlrev_b32 v112, 16, v168
v_and_b32 v113, s61, v168
v_lshlrev_b32 v114, 16, v169
v_and_b32 v115, s61, v169
v_lshlrev_b32 v116, 16, v170
v_and_b32 v117, s61, v170
v_lshlrev_b32 v118, 16, v171
v_and_b32 v119, s61, v171
v_fma_f32 v112, v112, v251, v31
v_fma_f32 v113, v113, v251, v31
v_fma_f32 v114, v114, v251, v31
v_fma_f32 v115, v115, v251, v31
v_fma_f32 v116, v116, v251, v31
v_fma_f32 v117, v117, v251, v31
v_fma_f32 v118, v118, v251, v31
v_fma_f32 v119, v119, v251, v31
v_cvt_pk_bf16_f32 v168, v112, v113
v_cvt_pk_bf16_f32 v169, v114, v115
v_cvt_pk_bf16_f32 v170, v116, v117
v_cvt_pk_bf16_f32 v171, v118, v119
v_lshlrev_b32 v120, 16, v172
v_and_b32 v121, s61, v172
v_lshlrev_b32 v122, 16, v173
v_and_b32 v123, s61, v173
v_lshlrev_b32 v124, 16, v174
v_and_b32 v125, s61, v174
v_lshlrev_b32 v126, 16, v175
v_and_b32 v127, s61, v175
v_fma_f32 v120, v120, v251, v31
v_fma_f32 v121, v121, v251, v31
v_fma_f32 v122, v122, v251, v31
v_fma_f32 v123, v123, v251, v31
v_fma_f32 v124, v124, v251, v31
v_fma_f32 v125, v125, v251, v31
v_fma_f32 v126, v126, v251, v31
v_fma_f32 v127, v127, v251, v31
v_cvt_pk_bf16_f32 v172, v120, v121
v_cvt_pk_bf16_f32 v173, v122, v123
v_cvt_pk_bf16_f32 v174, v124, v125
v_cvt_pk_bf16_f32 v175, v126, v127
v_lshlrev_b32 v96, 16, v176
v_and_b32 v97, s61, v176
v_lshlrev_b32 v98, 16, v177
v_and_b32 v99, s61, v177
v_lshlrev_b32 v100, 16, v178
v_and_b32 v101, s61, v178
v_lshlrev_b32 v102, 16, v179
v_and_b32 v103, s61, v179
v_fma_f32 v96, v96, v251, v31
v_fma_f32 v97, v97, v251, v31
v_fma_f32 v98, v98, v251, v31
v_fma_f32 v99, v99, v251, v31
v_fma_f32 v100, v100, v251, v31
v_fma_f32 v101, v101, v251, v31
v_fma_f32 v102, v102, v251, v31
v_fma_f32 v103, v103, v251, v31
v_cvt_pk_bf16_f32 v176, v96, v97
v_cvt_pk_bf16_f32 v177, v98, v99
v_cvt_pk_bf16_f32 v178, v100, v101
v_cvt_pk_bf16_f32 v179, v102, v103
v_lshlrev_b32 v104, 16, v180
v_and_b32 v105, s61, v180
v_lshlrev_b32 v106, 16, v181
v_and_b32 v107, s61, v181
v_lshlrev_b32 v108, 16, v182
v_and_b32 v109, s61, v182
v_lshlrev_b32 v110, 16, v183
v_and_b32 v111, s61, v183
v_fma_f32 v104, v104, v251, v31
v_fma_f32 v105, v105, v251, v31
v_fma_f32 v106, v106, v251, v31
v_fma_f32 v107, v107, v251, v31
v_fma_f32 v108, v108, v251, v31
v_fma_f32 v109, v109, v251, v31
v_fma_f32 v110, v110, v251, v31
v_fma_f32 v111, v111, v251, v31
v_cvt_pk_bf16_f32 v180, v104, v105
v_cvt_pk_bf16_f32 v181, v106, v107
v_cvt_pk_bf16_f32 v182, v108, v109
v_cvt_pk_bf16_f32 v183, v110, v111
v_lshlrev_b32 v112, 16, v184
v_and_b32 v113, s61, v184
v_lshlrev_b32 v114, 16, v185
v_and_b32 v115, s61, v185
v_lshlrev_b32 v116, 16, v186
v_and_b32 v117, s61, v186
v_lshlrev_b32 v118, 16, v187
v_and_b32 v119, s61, v187
v_fma_f32 v112, v112, v251, v31
v_fma_f32 v113, v113, v251, v31
v_fma_f32 v114, v114, v251, v31
v_fma_f32 v115, v115, v251, v31
v_fma_f32 v116, v116, v251, v31
v_fma_f32 v117, v117, v251, v31
v_fma_f32 v118, v118, v251, v31
v_fma_f32 v119, v119, v251, v31
v_cvt_pk_bf16_f32 v184, v112, v113
v_cvt_pk_bf16_f32 v185, v114, v115
v_cvt_pk_bf16_f32 v186, v116, v117
v_cvt_pk_bf16_f32 v187, v118, v119
v_lshlrev_b32 v120, 16, v188
v_and_b32 v121, s61, v188
v_lshlrev_b32 v122, 16, v189
v_and_b32 v123, s61, v189
v_lshlrev_b32 v124, 16, v190
v_and_b32 v125, s61, v190
v_lshlrev_b32 v126, 16, v191
v_and_b32 v127, s61, v191
v_fma_f32 v120, v120, v251, v31
v_fma_f32 v121, v121, v251, v31
v_fma_f32 v122, v122, v251, v31
v_fma_f32 v123, v123, v251, v31
v_fma_f32 v124, v124, v251, v31
v_fma_f32 v125, v125, v251, v31
v_fma_f32 v126, v126, v251, v31
v_fma_f32 v127, v127, v251, v31
v_cvt_pk_bf16_f32 v188, v120, v121
v_cvt_pk_bf16_f32 v189, v122, v123
v_cvt_pk_bf16_f32 v190, v124, v125
v_cvt_pk_bf16_f32 v191, v126, v127
v_lshlrev_b32 v96, 16, v192
v_and_b32 v97, s61, v192
v_lshlrev_b32 v98, 16, v193
v_and_b32 v99, s61, v193
v_lshlrev_b32 v100, 16, v194
v_and_b32 v101, s61, v194
v_lshlrev_b32 v102, 16, v195
v_and_b32 v103, s61, v195
v_fma_f32 v96, v96, v251, v31
v_fma_f32 v97, v97, v251, v31
v_fma_f32 v98, v98, v251, v31
v_fma_f32 v99, v99, v251, v31
v_fma_f32 v100, v100, v251, v31
v_fma_f32 v101, v101, v251, v31
v_fma_f32 v102, v102, v251, v31
v_fma_f32 v103, v103, v251, v31
v_cvt_pk_bf16_f32 v192, v96, v97
v_cvt_pk_bf16_f32 v193, v98, v99
v_cvt_pk_bf16_f32 v194, v100, v101
v_cvt_pk_bf16_f32 v195, v102, v103
v_lshlrev_b32 v104, 16, v196
v_and_b32 v105, s61, v196
v_lshlrev_b32 v106, 16, v197
v_and_b32 v107, s61, v197
v_lshlrev_b32 v108, 16, v198
v_and_b32 v109, s61, v198
v_lshlrev_b32 v110, 16, v199
v_and_b32 v111, s61, v199
v_fma_f32 v104, v104, v251, v31
v_fma_f32 v105, v105, v251, v31
v_fma_f32 v106, v106, v251, v31
v_fma_f32 v107, v107, v251, v31
v_fma_f32 v108, v108, v251, v31
v_fma_f32 v109, v109, v251, v31
v_fma_f32 v110, v110, v251, v31
v_fma_f32 v111, v111, v251, v31
v_cvt_pk_bf16_f32 v196, v104, v105
v_cvt_pk_bf16_f32 v197, v106, v107
v_cvt_pk_bf16_f32 v198, v108, v109
v_cvt_pk_bf16_f32 v199, v110, v111
v_lshlrev_b32 v112, 16, v200
v_and_b32 v113, s61, v200
v_lshlrev_b32 v114, 16, v201
v_and_b32 v115, s61, v201
v_lshlrev_b32 v116, 16, v202
v_and_b32 v117, s61, v202
v_lshlrev_b32 v118, 16, v203
v_and_b32 v119, s61, v203
v_fma_f32 v112, v112, v251, v31
v_fma_f32 v113, v113, v251, v31
v_fma_f32 v114, v114, v251, v31
v_fma_f32 v115, v115, v251, v31
v_fma_f32 v116, v116, v251, v31
v_fma_f32 v117, v117, v251, v31
v_fma_f32 v118, v118, v251, v31
v_fma_f32 v119, v119, v251, v31
v_cvt_pk_bf16_f32 v200, v112, v113
v_cvt_pk_bf16_f32 v201, v114, v115
v_cvt_pk_bf16_f32 v202, v116, v117
v_cvt_pk_bf16_f32 v203, v118, v119
v_lshlrev_b32 v120, 16, v204
v_and_b32 v121, s61, v204
v_lshlrev_b32 v122, 16, v205
v_and_b32 v123, s61, v205
v_lshlrev_b32 v124, 16, v206
v_and_b32 v125, s61, v206
v_lshlrev_b32 v126, 16, v207
v_and_b32 v127, s61, v207
v_fma_f32 v120, v120, v251, v31
v_fma_f32 v121, v121, v251, v31
v_fma_f32 v122, v122, v251, v31
v_fma_f32 v123, v123, v251, v31
v_fma_f32 v124, v124, v251, v31
v_fma_f32 v125, v125, v251, v31
v_fma_f32 v126, v126, v251, v31
v_fma_f32 v127, v127, v251, v31
v_cvt_pk_bf16_f32 v204, v120, v121
v_cvt_pk_bf16_f32 v205, v122, v123
v_cvt_pk_bf16_f32 v206, v124, v125
v_cvt_pk_bf16_f32 v207, v126, v127
v_lshlrev_b32 v96, 16, v208
v_and_b32 v97, s61, v208
v_lshlrev_b32 v98, 16, v209
v_and_b32 v99, s61, v209
v_lshlrev_b32 v100, 16, v210
v_and_b32 v101, s61, v210
v_lshlrev_b32 v102, 16, v211
v_and_b32 v103, s61, v211
v_fma_f32 v96, v96, v251, v31
v_fma_f32 v97, v97, v251, v31
v_fma_f32 v98, v98, v251, v31
v_fma_f32 v99, v99, v251, v31
v_fma_f32 v100, v100, v251, v31
v_fma_f32 v101, v101, v251, v31
v_fma_f32 v102, v102, v251, v31
v_fma_f32 v103, v103, v251, v31
v_cvt_pk_bf16_f32 v208, v96, v97
v_cvt_pk_bf16_f32 v209, v98, v99
v_cvt_pk_bf16_f32 v210, v100, v101
v_cvt_pk_bf16_f32 v211, v102, v103
v_lshlrev_b32 v104, 16, v212
v_and_b32 v105, s61, v212
v_lshlrev_b32 v106, 16, v213
v_and_b32 v107, s61, v213
v_lshlrev_b32 v108, 16, v214
v_and_b32 v109, s61, v214
v_lshlrev_b32 v110, 16, v215
v_and_b32 v111, s61, v215
v_fma_f32 v104, v104, v251, v31
v_fma_f32 v105, v105, v251, v31
v_fma_f32 v106, v106, v251, v31
v_fma_f32 v107, v107, v251, v31
v_fma_f32 v108, v108, v251, v31
v_fma_f32 v109, v109, v251, v31
v_fma_f32 v110, v110, v251, v31
v_fma_f32 v111, v111, v251, v31
v_cvt_pk_bf16_f32 v212, v104, v105
v_cvt_pk_bf16_f32 v213, v106, v107
v_cvt_pk_bf16_f32 v214, v108, v109
v_cvt_pk_bf16_f32 v215, v110, v111
buffer_load_ubyte v92, v94, s[40:43], 0 offen
buffer_load_dwordx4 v[88:91], v93, s[20:23], 0 offen sc1
v_lshlrev_b32 v112, 16, v216
v_and_b32 v113, s61, v216
v_lshlrev_b32 v114, 16, v217
v_and_b32 v115, s61, v217
v_lshlrev_b32 v116, 16, v218
v_and_b32 v117, s61, v218
v_lshlrev_b32 v118, 16, v219
v_and_b32 v119, s61, v219
v_fma_f32 v112, v112, v251, v31
v_fma_f32 v113, v113, v251, v31
v_fma_f32 v114, v114, v251, v31
v_fma_f32 v115, v115, v251, v31
v_fma_f32 v116, v116, v251, v31
v_fma_f32 v117, v117, v251, v31
v_fma_f32 v118, v118, v251, v31
v_fma_f32 v119, v119, v251, v31
v_cvt_pk_bf16_f32 v216, v112, v113
v_cvt_pk_bf16_f32 v217, v114, v115
v_cvt_pk_bf16_f32 v218, v116, v117
v_cvt_pk_bf16_f32 v219, v118, v119
v_lshlrev_b32 v120, 16, v220
v_and_b32 v121, s61, v220
v_lshlrev_b32 v122, 16, v221
v_and_b32 v123, s61, v221
v_lshlrev_b32 v124, 16, v222
v_and_b32 v125, s61, v222
v_lshlrev_b32 v126, 16, v223
v_and_b32 v127, s61, v223
v_fma_f32 v120, v120, v251, v31
v_fma_f32 v121, v121, v251, v31
v_fma_f32 v122, v122, v251, v31
v_fma_f32 v123, v123, v251, v31
v_fma_f32 v124, v124, v251, v31
v_fma_f32 v125, v125, v251, v31
v_fma_f32 v126, v126, v251, v31
v_fma_f32 v127, v127, v251, v31
v_cvt_pk_bf16_f32 v220, v120, v121
v_cvt_pk_bf16_f32 v221, v122, v123
v_cvt_pk_bf16_f32 v222, v124, v125
v_cvt_pk_bf16_f32 v223, v126, v127
v_lshlrev_b32 v96, 16, v224
v_and_b32 v97, s61, v224
v_lshlrev_b32 v98, 16, v225
v_and_b32 v99, s61, v225
v_lshlrev_b32 v100, 16, v226
v_and_b32 v101, s61, v226
v_lshlrev_b32 v102, 16, v227
v_and_b32 v103, s61, v227
v_fma_f32 v96, v96, v251, v31
v_fma_f32 v97, v97, v251, v31
v_fma_f32 v98, v98, v251, v31
v_fma_f32 v99, v99, v251, v31
v_fma_f32 v100, v100, v251, v31
v_fma_f32 v101, v101, v251, v31
v_fma_f32 v102, v102, v251, v31
v_fma_f32 v103, v103, v251, v31
v_cvt_pk_bf16_f32 v224, v96, v97
v_cvt_pk_bf16_f32 v225, v98, v99
v_cvt_pk_bf16_f32 v226, v100, v101
v_cvt_pk_bf16_f32 v227, v102, v103
v_lshlrev_b32 v104, 16, v228
v_and_b32 v105, s61, v228
v_lshlrev_b32 v106, 16, v229
v_and_b32 v107, s61, v229
v_lshlrev_b32 v108, 16, v230
v_and_b32 v109, s61, v230
v_lshlrev_b32 v110, 16, v231
v_and_b32 v111, s61, v231
v_fma_f32 v104, v104, v251, v31
v_fma_f32 v105, v105, v251, v31
v_fma_f32 v106, v106, v251, v31
v_fma_f32 v107, v107, v251, v31
v_fma_f32 v108, v108, v251, v31
v_fma_f32 v109, v109, v251, v31
v_fma_f32 v110, v110, v251, v31
v_fma_f32 v111, v111, v251, v31
v_cvt_pk_bf16_f32 v228, v104, v105
v_cvt_pk_bf16_f32 v229, v106, v107
v_cvt_pk_bf16_f32 v230, v108, v109
v_cvt_pk_bf16_f32 v231, v110, v111
v_lshlrev_b32 v112, 16, v232
v_and_b32 v113, s61, v232
v_lshlrev_b32 v114, 16, v233
v_and_b32 v115, s61, v233
v_lshlrev_b32 v116, 16, v234
v_and_b32 v117, s61, v234
v_lshlrev_b32 v118, 16, v235
v_and_b32 v119, s61, v235
v_fma_f32 v112, v112, v251, v31
v_fma_f32 v113, v113, v251, v31
v_fma_f32 v114, v114, v251, v31
v_fma_f32 v115, v115, v251, v31
v_fma_f32 v116, v116, v251, v31
v_fma_f32 v117, v117, v251, v31
v_fma_f32 v118, v118, v251, v31
v_fma_f32 v119, v119, v251, v31
v_cvt_pk_bf16_f32 v232, v112, v113
v_cvt_pk_bf16_f32 v233, v114, v115
v_cvt_pk_bf16_f32 v234, v116, v117
v_cvt_pk_bf16_f32 v235, v118, v119
v_lshlrev_b32 v120, 16, v236
v_and_b32 v121, s61, v236
v_lshlrev_b32 v122, 16, v237
v_and_b32 v123, s61, v237
v_lshlrev_b32 v124, 16, v238
v_and_b32 v125, s61, v238
v_lshlrev_b32 v126, 16, v239
v_and_b32 v127, s61, v239
v_fma_f32 v120, v120, v251, v31
v_fma_f32 v121, v121, v251, v31
v_fma_f32 v122, v122, v251, v31
v_fma_f32 v123, v123, v251, v31
v_fma_f32 v124, v124, v251, v31
v_fma_f32 v125, v125, v251, v31
v_fma_f32 v126, v126, v251, v31
v_fma_f32 v127, v127, v251, v31
v_cvt_pk_bf16_f32 v236, v120, v121
v_cvt_pk_bf16_f32 v237, v122, v123
v_cvt_pk_bf16_f32 v238, v124, v125
v_cvt_pk_bf16_f32 v239, v126, v127
v_lshlrev_b32 v96, 16, v128
v_and_b32 v97, s61, v128
v_lshlrev_b32 v98, 16, v129
v_and_b32 v99, s61, v129
v_lshlrev_b32 v100, 16, v130
v_and_b32 v101, s61, v130
v_lshlrev_b32 v102, 16, v131
v_and_b32 v103, s61, v131
v_fma_f32 v96, v96, v251, v31
v_fma_f32 v97, v97, v251, v31
v_fma_f32 v98, v98, v251, v31
v_fma_f32 v99, v99, v251, v31
v_fma_f32 v100, v100, v251, v31
v_fma_f32 v101, v101, v251, v31
v_fma_f32 v102, v102, v251, v31
v_fma_f32 v103, v103, v251, v31
v_lshlrev_b32 v104, 16, v132
v_and_b32 v105, s61, v132
v_lshlrev_b32 v106, 16, v133
v_and_b32 v107, s61, v133
v_lshlrev_b32 v108, 16, v134
v_and_b32 v109, s61, v134
v_lshlrev_b32 v110, 16, v135
v_and_b32 v111, s61, v135
v_fma_f32 v104, v104, v251, v31
v_fma_f32 v105, v105, v251, v31
v_fma_f32 v106, v106, v251, v31
v_fma_f32 v107, v107, v251, v31
v_fma_f32 v108, v108, v251, v31
v_fma_f32 v109, v109, v251, v31
v_fma_f32 v110, v110, v251, v31
v_fma_f32 v111, v111, v251, v31
v_lshlrev_b32 v112, 16, v136
v_and_b32 v113, s61, v136
v_lshlrev_b32 v114, 16, v137
v_and_b32 v115, s61, v137
v_lshlrev_b32 v116, 16, v138
v_and_b32 v117, s61, v138
v_lshlrev_b32 v118, 16, v139
v_and_b32 v119, s61, v139
v_fma_f32 v112, v112, v251, v31
v_fma_f32 v113, v113, v251, v31
v_fma_f32 v114, v114, v251, v31
v_fma_f32 v115, v115, v251, v31
v_fma_f32 v116, v116, v251, v31
v_fma_f32 v117, v117, v251, v31
v_fma_f32 v118, v118, v251, v31
v_fma_f32 v119, v119, v251, v31
v_lshlrev_b32 v120, 16, v140
v_and_b32 v121, s61, v140
v_lshlrev_b32 v122, 16, v141
v_and_b32 v123, s61, v141
v_lshlrev_b32 v124, 16, v142
v_and_b32 v125, s61, v142
v_lshlrev_b32 v126, 16, v143
v_and_b32 v127, s61, v143
v_fma_f32 v120, v120, v251, v31
v_fma_f32 v121, v121, v251, v31
v_fma_f32 v122, v122, v251, v31
v_fma_f32 v123, v123, v251, v31
v_fma_f32 v124, v124, v251, v31
v_fma_f32 v125, v125, v251, v31
v_fma_f32 v126, v126, v251, v31
v_fma_f32 v127, v127, v251, v31
s_cmp_lt_u32 m0, 56
s_cbranch_scc1 LATE
PRO_E:
s_mov_b32 s62, 16384
s_mov_b32 s60, 0x3db8aa3b
POLL0_L:
s_waitcnt vmcnt(0)
v_cmp_eq_u32 vcc, v89, v92
v_cmp_eq_u32 s[96:97], v91, v92
v_cmp_ne_u32 s[98:99], 0, v92
v_lshlrev_b32 v80, 16, v88
s_and_b64 vcc, vcc, s[96:97]
s_and_b64 vcc, vcc, s[98:99]
s_cmp_eq_u64 vcc, -1
s_cbranch_scc1 POLL0_D
s_sub_u32 s62, s62, 1
s_cbranch_scc1 POLL0_D
s_sleep 6
buffer_load_dwordx4 v[88:91], v93, s[20:23], 0 offen sc1
buffer_load_ubyte v92, v94, s[40:43], 0 offen sc1
s_branch POLL0_L
POLL0_D:
v_and_b32 v81, s61, v88
v_lshlrev_b32 v82, 16, v90
v_and_b32 v83, s61, v90
v_mul_f32 v80, s60, v80
v_mul_f32 v81, s60, v81
v_mul_f32 v82, s60, v82
v_mul_f32 v83, s60, v83
s_cmp_lt_u32 m0, 56
ds_write_b128 v95, v[80:83]
ds_write_b128 v95, v[80:83] offset:1792
s_cselect_b32 s59, s56, 1
s_cmp_eq_u32 s59, 0
s_waitcnt lgkmcnt(0)
s_barrier
s_cbranch_scc1 LATE_F
LATE_FB:
ds_read_b128 v[64:67], v250 offset:8192
ds_read_b128 v[68:71], v250 offset:8208
ds_read_b128 v[72:75], v250 offset:0
ds_read_b128 v[76:79], v250 offset:16
ds_read_b128 v[80:83], v250 offset:8256
ds_read_b128 v[84:87], v250 offset:8272
ds_read_b128 v[88:91], v250 offset:64
ds_read_b128 v[92:95], v250 offset:80
ds_read_b64_tr_b16 a[128:129], v240 offset:0
ds_read_b64_tr_b16 a[130:131], v240 offset:2048
ds_read_b64_tr_b16 a[132:133], v241 offset:0
ds_read_b64_tr_b16 a[134:135], v241 offset:2048
s_add_u32 m0, s24, 65536
ds_read_b64_tr_b16 a[136:137], v242 offset:0
s_mov_b32 s29, s93
ds_read_b64_tr_b16 a[138:139], v242 offset:2048
buffer_load_dwordx4 v248, s[12:15], s29 offen lds
ds_read_b64_tr_b16 a[140:141], v243 offset:0
s_add_u32 s29, s93, 15360
ds_read_b64_tr_b16 a[142:143], v243 offset:2048
buffer_load_dwordx4 v249, s[12:15], s29 offen offset:1024 lds
s_waitcnt lgkmcnt(6)
v_fmac_f32 v72, v96, v64
v_fmac_f32 v73, v97, v65
v_fmac_f32 v74, v98, v66
ds_read_b64_tr_b16 a[144:145], v240 offset:256
s_add_u32 s29, s93, 30720
v_fmac_f32 v75, v99, v67
v_fmac_f32 v76, v100, v68
v_fmac_f32 v77, v101, v69
ds_read_b64_tr_b16 a[146:147], v240 offset:2304
buffer_load_dwordx4 v248, s[12:15], s29 offen offset:2048 lds
v_fmac_f32 v78, v102, v70
v_fmac_f32 v79, v103, v71
ds_read_b64_tr_b16 a[148:149], v241 offset:256
s_add_u32 s29, s93, 46080
v_cvt_pk_bf16_f32 v32, v72, v73
v_cvt_pk_bf16_f32 v33, v74, v75
v_cvt_pk_bf16_f32 v34, v76, v77
ds_read_b64_tr_b16 a[150:151], v241 offset:2304
buffer_load_dwordx4 v249, s[12:15], s29 offen offset:3072 lds
s_add_u32 m0, s24, 69632
v_cvt_pk_bf16_f32 v35, v78, v79
s_nop 0
ds_read_b64_tr_b16 a[152:153], v242 offset:256
ds_read_b64_tr_b16 a[154:155], v242 offset:2304
s_add_u32 s29, s93, 65536
v_mfma_f32_32x32x16_bf16 a[0:15], a[128:131], v[32:35], 0
ds_read_b64_tr_b16 a[156:157], v243 offset:256
buffer_load_dwordx4 v248, s[12:15], s29 offen lds
ds_read_b64_tr_b16 a[158:159], v243 offset:2304
s_add_u32 s29, s93, 80896
v_fmac_f32 v88, v104, v80
v_fmac_f32 v89, v105, v81
s_waitcnt lgkmcnt(6)
v_mfma_f32_32x32x16_bf16 a[16:31], a[132:135], v[32:35], 0
ds_read_b64_tr_b16 a[160:161], v240 offset:8192
buffer_load_dwordx4 v249, s[12:15], s29 offen offset:1024 lds
ds_read_b64_tr_b16 a[162:163], v240 offset:10240
s_add_u32 s29, s93, 96256
v_fmac_f32 v90, v106, v82
v_fmac_f32 v91, v107, v83
v_mfma_f32_32x32x16_bf16 a[32:47], a[136:139], v[32:35], 0
ds_read_b64_tr_b16 a[164:165], v241 offset:8192
buffer_load_dwordx4 v248, s[12:15], s29 offen offset:2048 lds
ds_read_b64_tr_b16 a[166:167], v241 offset:10240
s_add_u32 s29, s93, 111616
ds_read_b128 v[64:67], v250 offset:8320
v_fmac_f32 v92, v108, v84
v_mfma_f32_32x32x16_bf16 a[48:63], a[140:143], v[32:35], 0
ds_read_b64_tr_b16 a[168:169], v242 offset:8192
buffer_load_dwordx4 v249, s[12:15], s29 offen offset:3072 lds
ds_read_b64_tr_b16 a[170:171], v242 offset:10240
ds_read_b128 v[68:71], v250 offset:8336
v_fmac_f32 v93, v109, v85
v_fmac_f32 v94, v110, v86
v_mfma_f32_32x32x16_bf16 a[64:79], a[144:147], v[32:35], 0
ds_read_b64_tr_b16 a[172:173], v243 offset:8192
s_add_u32 m0, s24, 32768
ds_read_b64_tr_b16 a[174:175], v243 offset:10240
s_mov_b32 s29, s94
ds_read_b128 v[72:75], v250 offset:128
v_fmac_f32 v95, v111, v87
s_waitcnt lgkmcnt(6)
v_mfma_f32_32x32x16_bf16 a[80:95], a[148:151], v[32:35], 0
ds_read_b64_tr_b16 a[176:177], v240 offset:8448
buffer_load_dwordx4 v248, s[12:15], s29 offen lds
ds_read_b64_tr_b16 a[178:179], v240 offset:10496
ds_read_b64_tr_b16 a[180:181], v241 offset:8448
v_cvt_pk_bf16_f32 v36, v88, v89
v_cvt_pk_bf16_f32 v37, v90, v91
v_mfma_f32_32x32x16_bf16 a[96:111], a[152:155], v[32:35], 0
ds_read_b64_tr_b16 a[182:183], v241 offset:10496
ds_read_b64_tr_b16 a[184:185], v242 offset:8448
s_add_u32 s29, s94, 15360
ds_read_b128 v[76:79], v250 offset:144
v_cvt_pk_bf16_f32 v38, v92, v93
v_cvt_pk_bf16_f32 v39, v94, v95
v_mfma_f32_32x32x16_bf16 a[112:127], a[156:159], v[32:35], 0
ds_read_b64_tr_b16 a[186:187], v242 offset:10496
buffer_load_dwordx4 v249, s[12:15], s29 offen offset:1024 lds
ds_read_b64_tr_b16 a[188:189], v243 offset:8448
s_waitcnt lgkmcnt(2)
v_fmac_f32 v72, v112, v64
v_fmac_f32 v73, v113, v65
v_mfma_f32_32x32x16_bf16 a[0:15], a[160:163], v[36:39], a[0:15]
ds_read_b64_tr_b16 a[190:191], v243 offset:10496
ds_read_b64_tr_b16 a[192:193], v240 offset:16384
s_add_u32 s29, s94, 30720
ds_read_b128 v[80:83], v250 offset:8384
v_fmac_f32 v74, v114, v66
v_fmac_f32 v75, v115, v67
v_mfma_f32_32x32x16_bf16 a[16:31], a[164:167], v[36:39], a[16:31]
ds_read_b64_tr_b16 a[194:195], v240 offset:18432
buffer_load_dwordx4 v248, s[12:15], s29 offen offset:2048 lds
ds_read_b64_tr_b16 a[196:197], v241 offset:16384
v_fmac_f32 v76, v116, v68
v_fmac_f32 v77, v117, v69
v_mfma_f32_32x32x16_bf16 a[32:47], a[168:171], v[36:39], a[32:47]
ds_read_b64_tr_b16 a[198:199], v241 offset:18432
ds_read_b64_tr_b16 a[200:201], v242 offset:16384
s_add_u32 s29, s94, 46080
ds_read_b128 v[84:87], v250 offset:8400
v_fmac_f32 v78, v118, v70
v_mfma_f32_32x32x16_bf16 a[48:63], a[172:175], v[36:39], a[48:63]
ds_read_b64_tr_b16 a[202:203], v242 offset:18432
buffer_load_dwordx4 v249, s[12:15], s29 offen offset:3072 lds
ds_read_b64_tr_b16 a[204:205], v243 offset:16384
ds_read_b64_tr_b16 a[206:207], v243 offset:18432
v_fmac_f32 v79, v119, v71
v_mfma_f32_32x32x16_bf16 a[64:79], a[176:179], v[36:39], a[64:79]
ds_read_b64_tr_b16 a[208:209], v240 offset:16640
s_add_u32 m0, s24, 36864
ds_read_b64_tr_b16 a[210:211], v240 offset:18688
s_add_u32 s29, s94, 65536
ds_read_b128 v[88:91], v250 offset:192
v_cvt_pk_bf16_f32 v40, v72, v73
v_mfma_f32_32x32x16_bf16 a[80:95], a[180:183], v[36:39], a[80:95]
ds_read_b64_tr_b16 a[212:213], v241 offset:16640
buffer_load_dwordx4 v248, s[12:15], s29 offen lds
ds_read_b64_tr_b16 a[214:215], v241 offset:18688
ds_read_b128 v[92:95], v250 offset:208
v_cvt_pk_bf16_f32 v41, v74, v75
s_waitcnt lgkmcnt(6)
v_mfma_f32_32x32x16_bf16 a[96:111], a[184:187], v[36:39], a[96:111]
ds_read_b64_tr_b16 a[216:217], v242 offset:16640
ds_read_b64_tr_b16 a[218:219], v242 offset:18688
s_add_u32 s29, s94, 80896
v_cvt_pk_bf16_f32 v42, v76, v77
v_cvt_pk_bf16_f32 v43, v78, v79
v_mfma_f32_32x32x16_bf16 a[112:127], a[188:191], v[36:39], a[112:127]
ds_read_b64_tr_b16 a[220:221], v243 offset:16640
buffer_load_dwordx4 v249, s[12:15], s29 offen offset:1024 lds
ds_read_b64_tr_b16 a[222:223], v243 offset:18688
s_waitcnt lgkmcnt(4)
v_fmac_f32 v88, v120, v80
v_fmac_f32 v89, v121, v81
v_mfma_f32_32x32x16_bf16 a[0:15], a[192:195], v[40:43], a[0:15]
ds_read_b64_tr_b16 a[224:225], v240 offset:24576
ds_read_b64_tr_b16 a[226:227], v240 offset:26624
s_add_u32 s29, s94, 96256
v_fmac_f32 v90, v122, v82
v_fmac_f32 v91, v123, v83
v_mfma_f32_32x32x16_bf16 a[16:31], a[196:199], v[40:43], a[16:31]
ds_read_b64_tr_b16 a[228:229], v241 offset:24576
buffer_load_dwordx4 v248, s[12:15], s29 offen offset:2048 lds
ds_read_b64_tr_b16 a[230:231], v241 offset:26624
ds_read_b64_tr_b16 a[232:233], v242 offset:24576
ds_read_b128 v[64:67], v250 offset:8448
v_mfma_f32_32x32x16_bf16 a[32:47], a[200:203], v[40:43], a[32:47]
ds_read_b64_tr_b16 a[234:235], v242 offset:26624
ds_read_b64_tr_b16 a[236:237], v243 offset:24576
s_add_u32 s29, s94, 111616
ds_read_b128 v[68:71], v250 offset:8464
v_fmac_f32 v92, v124, v84
v_fmac_f32 v93, v125, v85
v_mfma_f32_32x32x16_bf16 a[48:63], a[204:207], v[40:43], a[48:63]
ds_read_b64_tr_b16 a[238:239], v243 offset:26624
buffer_load_dwordx4 v249, s[12:15], s29 offen offset:3072 lds
ds_read_b64_tr_b16 a[240:241], v240 offset:24832
v_fmac_f32 v94, v126, v86
v_fmac_f32 v95, v127, v87
v_mfma_f32_32x32x16_bf16 a[64:79], a[208:211], v[40:43], a[64:79]
ds_read_b64_tr_b16 a[242:243], v240 offset:26880
ds_read_b64_tr_b16 a[244:245], v241 offset:24832
ds_read_b128 v[72:75], v250 offset:256
v_cvt_pk_bf16_f32 v44, v88, v89
v_cvt_pk_bf16_f32 v45, v90, v91
v_mfma_f32_32x32x16_bf16 a[80:95], a[212:215], v[40:43], a[80:95]
ds_read_b64_tr_b16 a[246:247], v241 offset:26880
s_add_u32 m0, s24, 98304
ds_read_b64_tr_b16 a[248:249], v242 offset:24832
s_mov_b32 s29, s95
ds_read_b128 v[76:79], v250 offset:272
s_waitcnt lgkmcnt(6)
v_mfma_f32_32x32x16_bf16 a[96:111], a[216:219], v[40:43], a[96:111]
ds_read_b64_tr_b16 a[250:251], v242 offset:26880
buffer_load_dwordx4 v248, s[12:15], s29 offen lds
ds_read_b64_tr_b16 a[252:253], v243 offset:24832
v_cvt_pk_bf16_f32 v46, v92, v93
v_cvt_pk_bf16_f32 v47, v94, v95
v_mfma_f32_32x32x16_bf16 a[112:127], a[220:223], v[40:43], a[112:127]
ds_read_b64_tr_b16 a[254:255], v243 offset:26880
s_add_u32 s29, s95, 15360
v_lshlrev_b32 v96, 16, v144
v_and_b32 v97, s61, v144
v_lshlrev_b32 v98, 16, v145
v_and_b32 v99, s61, v145
v_mfma_f32_32x32x16_bf16 a[0:15], a[224:227], v[44:47], a[0:15]
buffer_load_dwordx4 v249, s[12:15], s29 offen offset:1024 lds
ds_read_b128 v[80:83], v250 offset:8512
v_lshlrev_b32 v100, 16, v146
v_and_b32 v101, s61, v146
v_lshlrev_b32 v102, 16, v147
v_mfma_f32_32x32x16_bf16 a[16:31], a[228:231], v[44:47], a[16:31]
s_add_u32 s29, s95, 30720
ds_read_b128 v[84:87], v250 offset:8528
v_and_b32 v103, s61, v147
s_waitcnt lgkmcnt(3)
v_fmac_f32 v72, v96, v64
v_fmac_f32 v73, v97, v65
v_fmac_f32 v74, v98, v66
v_mfma_f32_32x32x16_bf16 a[32:47], a[232:235], v[44:47], a[32:47]
s_waitcnt vmcnt(10) lgkmcnt(2)
s_barrier
ds_read_b64_tr_b16 a[128:129], v244 offset:0
ds_read_b64_tr_b16 a[130:131], v244 offset:2048
buffer_load_dwordx4 v248, s[12:15], s29 offen offset:2048 lds
ds_read_b64_tr_b16 a[132:133], v245 offset:0
ds_read_b128 v[88:91], v250 offset:320
v_fmac_f32 v75, v99, v67
v_mfma_f32_32x32x16_bf16 a[48:63], a[236:239], v[44:47], a[48:63]
ds_read_b64_tr_b16 a[134:135], v245 offset:2048
ds_read_b64_tr_b16 a[136:137], v246 offset:0
s_add_u32 s29, s95, 46080
v_fmac_f32 v76, v100, v68
v_fmac_f32 v77, v101, v69
v_mfma_f32_32x32x16_bf16 a[64:79], a[240:243], v[44:47], a[64:79]
ds_read_b64_tr_b16 a[138:139], v246 offset:2048
buffer_load_dwordx4 v249, s[12:15], s29 offen offset:3072 lds
ds_read_b64_tr_b16 a[140:141], v247 offset:0
ds_read_b128 v[92:95], v250 offset:336
v_fmac_f32 v78, v102, v70
v_fmac_f32 v79, v103, v71
v_mfma_f32_32x32x16_bf16 a[80:95], a[244:247], v[44:47], a[80:95]
ds_read_b64_tr_b16 a[142:143], v247 offset:2048
s_add_u32 m0, s24, 102400
ds_read_b64_tr_b16 a[144:145], v244 offset:256
s_add_u32 s29, s95, 65536
v_cvt_pk_bf16_f32 v48, v72, v73
v_mfma_f32_32x32x16_bf16 a[96:111], a[248:251], v[44:47], a[96:111]
ds_read_b64_tr_b16 a[146:147], v244 offset:2304
buffer_load_dwordx4 v248, s[12:15], s29 offen lds
ds_read_b64_tr_b16 a[148:149], v245 offset:256
v_cvt_pk_bf16_f32 v49, v74, v75
v_cvt_pk_bf16_f32 v50, v76, v77
v_cvt_pk_bf16_f32 v51, v78, v79
v_mfma_f32_32x32x16_bf16 a[112:127], a[252:255], v[44:47], a[112:127]
ds_read_b64_tr_b16 a[150:151], v245 offset:2304
ds_read_b64_tr_b16 a[152:153], v246 offset:256
ds_read_b64_tr_b16 a[154:155], v246 offset:2304
s_add_u32 s29, s95, 80896
v_lshlrev_b32 v104, 16, v148
v_and_b32 v105, s61, v148
s_waitcnt lgkmcnt(5)
v_mfma_f32_32x32x16_bf16 a[0:15], a[128:131], v[48:51], a[0:15]
ds_read_b64_tr_b16 a[156:157], v247 offset:256
buffer_load_dwordx4 v249, s[12:15], s29 offen offset:1024 lds
ds_read_b64_tr_b16 a[158:159], v247 offset:2304
ds_read_b128 v[64:67], v250 offset:8576
v_lshlrev_b32 v106, 16, v149
v_and_b32 v107, s61, v149
v_lshlrev_b32 v108, 16, v150
v_mfma_f32_32x32x16_bf16 a[16:31], a[132:135], v[48:51], a[16:31]
ds_read_b64_tr_b16 a[160:161], v244 offset:8192
ds_read_b64_tr_b16 a[162:163], v244 offset:10240
s_add_u32 s29, s95, 96256
v_and_b32 v109, s61, v150
v_lshlrev_b32 v110, 16, v151
v_and_b32 v111, s61, v151
v_mfma_f32_32x32x16_bf16 a[32:47], a[136:139], v[48:51], a[32:47]
ds_read_b64_tr_b16 a[164:165], v245 offset:8192
buffer_load_dwordx4 v248, s[12:15], s29 offen offset:2048 lds
ds_read_b64_tr_b16 a[166:167], v245 offset:10240
ds_read_b128 v[68:71], v250 offset:8592
v_fmac_f32 v88, v104, v80
v_fmac_f32 v89, v105, v81
v_mfma_f32_32x32x16_bf16 a[48:63], a[140:143], v[48:51], a[48:63]
ds_read_b64_tr_b16 a[168:169], v246 offset:8192
ds_read_b64_tr_b16 a[170:171], v246 offset:10240
s_add_u32 s29, s95, 111616
ds_read_b128 v[72:75], v250 offset:384
v_fmac_f32 v90, v106, v82
v_fmac_f32 v91, v107, v83
s_waitcnt lgkmcnt(6)
v_mfma_f32_32x32x16_bf16 a[64:79], a[144:147], v[48:51], a[64:79]
ds_read_b64_tr_b16 a[172:173], v247 offset:8192
buffer_load_dwordx4 v249, s[12:15], s29 offen offset:3072 lds
ds_read_b64_tr_b16 a[174:175], v247 offset:10240
v_fmac_f32 v92, v108, v84
v_fmac_f32 v93, v109, v85
v_fmac_f32 v94, v110, v86
v_fmac_f32 v95, v111, v87
v_mfma_f32_32x32x16_bf16 a[80:95], a[148:151], v[48:51], a[80:95]
ds_read_b64_tr_b16 a[176:177], v244 offset:8448
ds_read_b64_tr_b16 a[178:179], v244 offset:10496
ds_read_b64_tr_b16 a[180:181], v245 offset:8448
ds_read_b128 v[76:79], v250 offset:400
v_cvt_pk_bf16_f32 v52, v88, v89
v_cvt_pk_bf16_f32 v53, v90, v91
v_mfma_f32_32x32x16_bf16 a[96:111], a[152:155], v[48:51], a[96:111]
ds_read_b64_tr_b16 a[182:183], v245 offset:10496
s_add_u32 m0, s24, 0
ds_read_b64_tr_b16 a[184:185], v246 offset:8448
s_mov_b32 s29, s100
v_cvt_pk_bf16_f32 v54, v92, v93
v_cvt_pk_bf16_f32 v55, v94, v95
v_mfma_f32_32x32x16_bf16 a[112:127], a[156:159], v[48:51], a[112:127]
ds_read_b64_tr_b16 a[186:187], v246 offset:10496
buffer_load_dwordx4 v248, s[12:15], s29 offen lds
ds_read_b64_tr_b16 a[188:189], v247 offset:8448
v_lshlrev_b32 v112, 16, v152
v_and_b32 v113, s61, v152
v_lshlrev_b32 v114, 16, v153
v_mfma_f32_32x32x16_bf16 a[0:15], a[160:163], v[52:55], a[0:15]
ds_read_b64_tr_b16 a[190:191], v247 offset:10496
ds_read_b64_tr_b16 a[192:193], v244 offset:16384
s_add_u32 s29, s100, 15360
ds_read_b128 v[80:83], v250 offset:8640
v_and_b32 v115, s61, v153
v_lshlrev_b32 v116, 16, v154
v_and_b32 v117, s61, v154
s_waitcnt lgkmcnt(5)
v_mfma_f32_32x32x16_bf16 a[16:31], a[164:167], v[52:55], a[16:31]
ds_read_b64_tr_b16 a[194:195], v244 offset:18432
buffer_load_dwordx4 v249, s[12:15], s29 offen offset:1024 lds
ds_read_b64_tr_b16 a[196:197], v245 offset:16384
ds_read_b128 v[84:87], v250 offset:8656
v_lshlrev_b32 v118, 16, v155
v_and_b32 v119, s61, v155
v_mfma_f32_32x32x16_bf16 a[32:47], a[168:171], v[52:55], a[32:47]
ds_read_b64_tr_b16 a[198:199], v245 offset:18432
ds_read_b64_tr_b16 a[200:201], v246 offset:16384
s_add_u32 s29, s100, 30720
v_fmac_f32 v72, v112, v64
v_fmac_f32 v73, v113, v65
v_fmac_f32 v74, v114, v66
v_mfma_f32_32x32x16_bf16 a[48:63], a[172:175], v[52:55], a[48:63]
ds_read_b64_tr_b16 a[202:203], v246 offset:18432
buffer_load_dwordx4 v248, s[12:15], s29 offen offset:2048 lds
ds_read_b64_tr_b16 a[204:205], v247 offset:16384
ds_read_b64_tr_b16 a[206:207], v247 offset:18432
ds_read_b128 v[88:91], v250 offset:448
v_fmac_f32 v75, v115, v67
v_mfma_f32_32x32x16_bf16 a[64:79], a[176:179], v[52:55], a[64:79]
ds_read_b64_tr_b16 a[208:209], v244 offset:16640
ds_read_b64_tr_b16 a[210:211], v244 offset:18688
s_add_u32 s29, s100, 46080
v_fmac_f32 v76, v116, v68
v_fmac_f32 v77, v117, v69
v_fmac_f32 v78, v118, v70
v_fmac_f32 v79, v119, v71
v_mfma_f32_32x32x16_bf16 a[80:95], a[180:183], v[52:55], a[80:95]
ds_read_b64_tr_b16 a[212:213], v245 offset:16640
buffer_load_dwordx4 v249, s[12:15], s29 offen offset:3072 lds
ds_read_b64_tr_b16 a[214:215], v245 offset:18688
ds_read_b128 v[92:95], v250 offset:464
v_cvt_pk_bf16_f32 v56, v72, v73
v_cvt_pk_bf16_f32 v57, v74, v75
s_waitcnt lgkmcnt(5)
v_mfma_f32_32x32x16_bf16 a[96:111], a[184:187], v[52:55], a[96:111]
ds_read_b64_tr_b16 a[216:217], v246 offset:16640
s_add_u32 m0, s24, 4096
ds_read_b64_tr_b16 a[218:219], v246 offset:18688
s_add_u32 s29, s100, 65536
v_cvt_pk_bf16_f32 v58, v76, v77
v_cvt_pk_bf16_f32 v59, v78, v79
v_mfma_f32_32x32x16_bf16 a[112:127], a[188:191], v[52:55], a[112:127]
ds_read_b64_tr_b16 a[220:221], v247 offset:16640
buffer_load_dwordx4 v248, s[12:15], s29 offen lds
ds_read_b64_tr_b16 a[222:223], v247 offset:18688
v_lshlrev_b32 v120, 16, v156
v_and_b32 v121, s61, v156
v_lshlrev_b32 v122, 16, v157
v_mfma_f32_32x32x16_bf16 a[0:15], a[192:195], v[56:59], a[0:15]
ds_read_b64_tr_b16 a[224:225], v244 offset:24576
ds_read_b64_tr_b16 a[226:227], v244 offset:26624
s_add_u32 s29, s100, 80896
ds_read_b128 v[64:67], v250 offset:8704
v_and_b32 v123, s61, v157
v_lshlrev_b32 v124, 16, v158
v_mfma_f32_32x32x16_bf16 a[16:31], a[196:199], v[56:59], a[16:31]
ds_read_b64_tr_b16 a[228:229], v245 offset:24576
buffer_load_dwordx4 v249, s[12:15], s29 offen offset:1024 lds
ds_read_b64_tr_b16 a[230:231], v245 offset:26624
ds_read_b64_tr_b16 a[232:233], v246 offset:24576
v_and_b32 v125, s61, v158
v_lshlrev_b32 v126, 16, v159
v_mfma_f32_32x32x16_bf16 a[32:47], a[200:203], v[56:59], a[32:47]
ds_read_b64_tr_b16 a[234:235], v246 offset:26624
ds_read_b64_tr_b16 a[236:237], v247 offset:24576
s_add_u32 s29, s100, 96256
ds_read_b128 v[68:71], v250 offset:8720
v_and_b32 v127, s61, v159
s_waitcnt lgkmcnt(9)
v_fmac_f32 v88, v120, v80
v_mfma_f32_32x32x16_bf16 a[48:63], a[204:207], v[56:59], a[48:63]
ds_read_b64_tr_b16 a[238:239], v247 offset:26624
buffer_load_dwordx4 v248, s[12:15], s29 offen offset:2048 lds
ds_read_b64_tr_b16 a[240:241], v244 offset:24832
v_fmac_f32 v89, v121, v81
v_fmac_f32 v90, v122, v82
v_fmac_f32 v91, v123, v83
v_mfma_f32_32x32x16_bf16 a[64:79], a[208:211], v[56:59], a[64:79]
ds_read_b64_tr_b16 a[242:243], v244 offset:26880
ds_read_b64_tr_b16 a[244:245], v245 offset:24832
s_add_u32 s29, s100, 111616
ds_read_b128 v[72:75], v250 offset:512
v_fmac_f32 v92, v124, v84
v_fmac_f32 v93, v125, v85
v_mfma_f32_32x32x16_bf16 a[80:95], a[212:215], v[56:59], a[80:95]
ds_read_b64_tr_b16 a[246:247], v245 offset:26880
buffer_load_dwordx4 v249, s[12:15], s29 offen offset:3072 lds
ds_read_b64_tr_b16 a[248:249], v246 offset:24832
ds_read_b128 v[76:79], v250 offset:528
v_fmac_f32 v94, v126, v86
v_fmac_f32 v95, v127, v87
v_mfma_f32_32x32x16_bf16 a[96:111], a[216:219], v[56:59], a[96:111]
ds_read_b64_tr_b16 a[250:251], v246 offset:26880
ds_read_b64_tr_b16 a[252:253], v247 offset:24832
v_cvt_pk_bf16_f32 v60, v88, v89
v_cvt_pk_bf16_f32 v61, v90, v91
v_cvt_pk_bf16_f32 v62, v92, v93
v_cvt_pk_bf16_f32 v63, v94, v95
v_mfma_f32_32x32x16_bf16 a[112:127], a[220:223], v[56:59], a[112:127]
ds_read_b64_tr_b16 a[254:255], v247 offset:26880
ds_read_b128 v[80:83], v250 offset:8768
v_lshlrev_b32 v96, 16, v160
v_and_b32 v97, s61, v160
v_lshlrev_b32 v98, 16, v161
v_and_b32 v99, s61, v161
s_waitcnt lgkmcnt(4)
v_mfma_f32_32x32x16_bf16 a[0:15], a[224:227], v[60:63], a[0:15]
ds_read_b128 v[84:87], v250 offset:8784
v_lshlrev_b32 v100, 16, v162
v_and_b32 v101, s61, v162
v_lshlrev_b32 v102, 16, v163
v_and_b32 v103, s61, v163
v_fmac_f32 v72, v96, v64
v_mfma_f32_32x32x16_bf16 a[16:31], a[228:231], v[60:63], a[16:31]
ds_read_b128 v[88:91], v250 offset:576
v_fmac_f32 v73, v97, v65
v_fmac_f32 v74, v98, v66
v_fmac_f32 v75, v99, v67
v_fmac_f32 v76, v100, v68
v_fmac_f32 v77, v101, v69
v_mfma_f32_32x32x16_bf16 a[32:47], a[232:235], v[60:63], a[32:47]
s_waitcnt vmcnt(16) lgkmcnt(3)
s_barrier
ds_read_b64_tr_b16 a[128:129], v240 offset:32768
ds_read_b64_tr_b16 a[130:131], v240 offset:34816
ds_read_b64_tr_b16 a[132:133], v241 offset:32768
v_fmac_f32 v78, v102, v70
v_fmac_f32 v79, v103, v71
v_mfma_f32_32x32x16_bf16 a[48:63], a[236:239], v[60:63], a[48:63]
ds_read_b64_tr_b16 a[134:135], v241 offset:34816
ds_read_b64_tr_b16 a[136:137], v242 offset:32768
s_add_u32 m0, s24, 65536
ds_read_b128 v[92:95], v250 offset:592
v_cvt_pk_bf16_f32 v32, v72, v73
v_mfma_f32_32x32x16_bf16 a[64:79], a[240:243], v[60:63], a[64:79]
ds_read_b64_tr_b16 a[138:139], v242 offset:34816
s_mov_b32 s29, s101
ds_read_b64_tr_b16 a[140:141], v243 offset:32768
buffer_load_dwordx4 v248, s[12:15], s29 offen lds
v_cvt_pk_bf16_f32 v33, v74, v75
v_cvt_pk_bf16_f32 v34, v76, v77
v_mfma_f32_32x32x16_bf16 a[80:95], a[244:247], v[60:63], a[80:95]
ds_read_b64_tr_b16 a[142:143], v243 offset:34816
ds_read_b64_tr_b16 a[144:145], v240 offset:33024
v_cvt_pk_bf16_f32 v35, v78, v79
v_lshlrev_b32 v104, 16, v164
v_and_b32 v105, s61, v164
v_lshlrev_b32 v106, 16, v165
v_mfma_f32_32x32x16_bf16 a[96:111], a[248:251], v[60:63], a[96:111]
ds_read_b64_tr_b16 a[146:147], v240 offset:35072
ds_read_b64_tr_b16 a[148:149], v241 offset:33024
ds_read_b128 v[64:67], v250 offset:8832
v_and_b32 v107, s61, v165
v_lshlrev_b32 v108, 16, v166
v_and_b32 v109, s61, v166
v_mfma_f32_32x32x16_bf16 a[112:127], a[252:255], v[60:63], a[112:127]
ds_read_b64_tr_b16 a[150:151], v241 offset:35072
s_add_u32 s29, s101, 15360
ds_read_b64_tr_b16 a[152:153], v242 offset:33024
ds_read_b64_tr_b16 a[154:155], v242 offset:35072
buffer_load_dwordx4 v249, s[12:15], s29 offen offset:1024 lds
v_lshlrev_b32 v110, 16, v167
s_waitcnt lgkmcnt(6)
v_mfma_f32_32x32x16_bf16 a[0:15], a[128:131], v[32:35], a[0:15]
ds_read_b64_tr_b16 a[156:157], v243 offset:33024
ds_read_b64_tr_b16 a[158:159], v243 offset:35072
ds_read_b128 v[68:71], v250 offset:8848
v_and_b32 v111, s61, v167
v_fmac_f32 v88, v104, v80
v_fmac_f32 v89, v105, v81
v_mfma_f32_32x32x16_bf16 a[16:31], a[132:135], v[32:35], a[16:31]
ds_read_b64_tr_b16 a[160:161], v240 offset:40960
ds_read_b64_tr_b16 a[162:163], v240 offset:43008
ds_read_b128 v[72:75], v250 offset:640
v_fmac_f32 v90, v106, v82
v_fmac_f32 v91, v107, v83
v_fmac_f32 v92, v108, v84
v_mfma_f32_32x32x16_bf16 a[32:47], a[136:139], v[32:35], a[32:47]
ds_read_b64_tr_b16 a[164:165], v241 offset:40960
s_add_u32 s29, s101, 30720
ds_read_b64_tr_b16 a[166:167], v241 offset:43008
buffer_load_dwordx4 v248, s[12:15], s29 offen offset:2048 lds
v_fmac_f32 v93, v109, v85
v_fmac_f32 v94, v110, v86
v_mfma_f32_32x32x16_bf16 a[48:63], a[140:143], v[32:35], a[48:63]
ds_read_b64_tr_b16 a[168:169], v242 offset:40960
ds_read_b64_tr_b16 a[170:171], v242 offset:43008
ds_read_b128 v[76:79], v250 offset:656
v_fmac_f32 v95, v111, v87
v_cvt_pk_bf16_f32 v36, v88, v89
s_waitcnt lgkmcnt(5)
v_mfma_f32_32x32x16_bf16 a[64:79], a[144:147], v[32:35], a[64:79]
ds_read_b64_tr_b16 a[172:173], v243 offset:40960
ds_read_b64_tr_b16 a[174:175], v243 offset:43008
v_cvt_pk_bf16_f32 v37, v90, v91
v_cvt_pk_bf16_f32 v38, v92, v93
v_cvt_pk_bf16_f32 v39, v94, v95
v_lshlrev_b32 v112, 16, v168
v_mfma_f32_32x32x16_bf16 a[80:95], a[148:151], v[32:35], a[80:95]
ds_read_b64_tr_b16 a[176:177], v240 offset:41216
s_add_u32 s29, s101, 46080
ds_read_b64_tr_b16 a[178:179], v240 offset:43264
ds_read_b64_tr_b16 a[180:181], v241 offset:41216
buffer_load_dwordx4 v249, s[12:15], s29 offen offset:3072 lds
v_and_b32 v113, s61, v168
v_mfma_f32_32x32x16_bf16 a[96:111], a[152:155], v[32:35], a[96:111]
ds_read_b64_tr_b16 a[182:183], v241 offset:43264
ds_read_b64_tr_b16 a[184:185], v242 offset:41216
ds_read_b128 v[80:83], v250 offset:8896
v_lshlrev_b32 v114, 16, v169
v_and_b32 v115, s61, v169
v_lshlrev_b32 v116, 16, v170
v_mfma_f32_32x32x16_bf16 a[112:127], a[156:159], v[32:35], a[112:127]
ds_read_b64_tr_b16 a[186:187], v242 offset:43264
ds_read_b64_tr_b16 a[188:189], v243 offset:41216
s_add_u32 m0, s24, 69632
v_and_b32 v117, s61, v170
v_lshlrev_b32 v118, 16, v171
v_and_b32 v119, s61, v171
v_mfma_f32_32x32x16_bf16 a[0:15], a[160:163], v[36:39], a[0:15]
ds_read_b64_tr_b16 a[190:191], v243 offset:43264
s_add_u32 s29, s101, 65536
ds_read_b64_tr_b16 a[192:193], v240 offset:49152
buffer_load_dwordx4 v248, s[12:15], s29 offen lds
ds_read_b128 v[84:87], v250 offset:8912
s_waitcnt lgkmcnt(8)
v_fmac_f32 v72, v112, v64
v_mfma_f32_32x32x16_bf16 a[16:31], a[164:167], v[36:39], a[16:31]
ds_read_b64_tr_b16 a[194:195], v240 offset:51200
ds_read_b64_tr_b16 a[196:197], v241 offset:49152
ds_read_b128 v[88:91], v250 offset:704
v_fmac_f32 v73, v113, v65
v_fmac_f32 v74, v114, v66
v_fmac_f32 v75, v115, v67
v_mfma_f32_32x32x16_bf16 a[32:47], a[168:171], v[36:39], a[32:47]
ds_read_b64_tr_b16 a[198:199], v241 offset:51200
ds_read_b64_tr_b16 a[200:201], v242 offset:49152
v_fmac_f32 v76, v116, v68
v_fmac_f32 v77, v117, v69
v_fmac_f32 v78, v118, v70
v_fmac_f32 v79, v119, v71
v_mfma_f32_32x32x16_bf16 a[48:63], a[172:175], v[36:39], a[48:63]
ds_read_b64_tr_b16 a[202:203], v242 offset:51200
s_add_u32 s29, s101, 80896
ds_read_b64_tr_b16 a[204:205], v243 offset:49152
ds_read_b64_tr_b16 a[206:207], v243 offset:51200
buffer_load_dwordx4 v249, s[12:15], s29 offen offset:1024 lds
v_mfma_f32_32x32x16_bf16 a[64:79], a[176:179], v[36:39], a[64:79]
ds_read_b64_tr_b16 a[208:209], v240 offset:49408
ds_read_b64_tr_b16 a[210:211], v240 offset:51456
ds_read_b128 v[92:95], v250 offset:720
v_cvt_pk_bf16_f32 v40, v72, v73
v_cvt_pk_bf16_f32 v41, v74, v75
v_cvt_pk_bf16_f32 v42, v76, v77
s_waitcnt lgkmcnt(6)
v_mfma_f32_32x32x16_bf16 a[80:95], a[180:183], v[36:39], a[80:95]
ds_read_b64_tr_b16 a[212:213], v241 offset:49408
ds_read_b64_tr_b16 a[214:215], v241 offset:51456
v_cvt_pk_bf16_f32 v43, v78, v79
v_lshlrev_b32 v120, 16, v172
v_and_b32 v121, s61, v172
v_lshlrev_b32 v122, 16, v173
v_mfma_f32_32x32x16_bf16 a[96:111], a[184:187], v[36:39], a[96:111]
ds_read_b64_tr_b16 a[216:217], v242 offset:49408
s_add_u32 s29, s101, 96256
ds_read_b64_tr_b16 a[218:219], v242 offset:51456
buffer_load_dwordx4 v248, s[12:15], s29 offen offset:2048 lds
ds_read_b128 v[64:67], v250 offset:8960
v_and_b32 v123, s61, v173
v_mfma_f32_32x32x16_bf16 a[112:127], a[188:191], v[36:39], a[112:127]
ds_read_b64_tr_b16 a[220:221], v243 offset:49408
ds_read_b64_tr_b16 a[222:223], v243 offset:51456
v_lshlrev_b32 v124, 16, v174
v_and_b32 v125, s61, v174
v_lshlrev_b32 v126, 16, v175
v_and_b32 v127, s61, v175
v_mfma_f32_32x32x16_bf16 a[0:15], a[192:195], v[40:43], a[0:15]
ds_read_b64_tr_b16 a[224:225], v240 offset:57344
ds_read_b64_tr_b16 a[226:227], v240 offset:59392
ds_read_b128 v[68:71], v250 offset:8976
s_waitcnt lgkmcnt(8)
v_fmac_f32 v88, v120, v80
v_fmac_f32 v89, v121, v81
v_fmac_f32 v90, v122, v82
v_mfma_f32_32x32x16_bf16 a[16:31], a[196:199], v[40:43], a[16:31]
ds_read_b64_tr_b16 a[228:229], v241 offset:57344
s_add_u32 s29, s101, 111616
ds_read_b64_tr_b16 a[230:231], v241 offset:59392
ds_read_b64_tr_b16 a[232:233], v242 offset:57344
buffer_load_dwordx4 v249, s[12:15], s29 offen offset:3072 lds
v_fmac_f32 v91, v123, v83
v_mfma_f32_32x32x16_bf16 a[32:47], a[200:203], v[40:43], a[32:47]
ds_read_b64_tr_b16 a[234:235], v242 offset:59392
ds_read_b64_tr_b16 a[236:237], v243 offset:57344
ds_read_b128 v[72:75], v250 offset:768
v_fmac_f32 v92, v124, v84
v_fmac_f32 v93, v125, v85
v_fmac_f32 v94, v126, v86
v_mfma_f32_32x32x16_bf16 a[48:63], a[204:207], v[40:43], a[48:63]
ds_read_b64_tr_b16 a[238:239], v243 offset:59392
ds_read_b64_tr_b16 a[240:241], v240 offset:57600
ds_read_b128 v[76:79], v250 offset:784
v_fmac_f32 v95, v127, v87
v_cvt_pk_bf16_f32 v44, v88, v89
v_mfma_f32_32x32x16_bf16 a[64:79], a[208:211], v[40:43], a[64:79]
ds_read_b64_tr_b16 a[242:243], v240 offset:59648
ds_read_b64_tr_b16 a[244:245], v241 offset:57600
v_cvt_pk_bf16_f32 v45, v90, v91
v_cvt_pk_bf16_f32 v46, v92, v93
v_cvt_pk_bf16_f32 v47, v94, v95
v_lshlrev_b32 v96, 16, v176
v_mfma_f32_32x32x16_bf16 a[80:95], a[212:215], v[40:43], a[80:95]
ds_read_b64_tr_b16 a[246:247], v241 offset:59648
ds_read_b64_tr_b16 a[248:249], v242 offset:57600
ds_read_b128 v[80:83], v250 offset:9024
v_and_b32 v97, s61, v176
v_lshlrev_b32 v98, 16, v177
v_and_b32 v99, s61, v177
s_waitcnt lgkmcnt(5)
v_mfma_f32_32x32x16_bf16 a[96:111], a[216:219], v[40:43], a[96:111]
ds_read_b64_tr_b16 a[250:251], v242 offset:59648
ds_read_b64_tr_b16 a[252:253], v243 offset:57600
v_lshlrev_b32 v100, 16, v178
v_and_b32 v101, s61, v178
v_lshlrev_b32 v102, 16, v179
v_and_b32 v103, s61, v179
v_mfma_f32_32x32x16_bf16 a[112:127], a[220:223], v[40:43], a[112:127]
ds_read_b64_tr_b16 a[254:255], v243 offset:59648
ds_read_b128 v[84:87], v250 offset:9040
v_fmac_f32 v72, v96, v64
v_fmac_f32 v73, v97, v65
v_fmac_f32 v74, v98, v66
v_fmac_f32 v75, v99, v67
v_mfma_f32_32x32x16_bf16 a[0:15], a[224:227], v[44:47], a[0:15]
ds_read_b128 v[88:91], v250 offset:832
ds_read_b128 v[92:95], v250 offset:848
v_fmac_f32 v76, v100, v68
v_fmac_f32 v77, v101, v69
v_fmac_f32 v78, v102, v70
v_fmac_f32 v79, v103, v71
v_mfma_f32_32x32x16_bf16 a[16:31], a[228:231], v[44:47], a[16:31]
v_cvt_pk_bf16_f32 v48, v72, v73
v_cvt_pk_bf16_f32 v49, v74, v75
v_cvt_pk_bf16_f32 v50, v76, v77
v_cvt_pk_bf16_f32 v51, v78, v79
v_lshlrev_b32 v104, 16, v180
v_and_b32 v105, s61, v180
v_mfma_f32_32x32x16_bf16 a[32:47], a[232:235], v[44:47], a[32:47]
s_waitcnt vmcnt(16) lgkmcnt(3)
s_barrier
ds_read_b64_tr_b16 a[128:129], v244 offset:32768
ds_read_b64_tr_b16 a[130:131], v244 offset:34816
ds_read_b64_tr_b16 a[132:133], v245 offset:32768
v_lshlrev_b32 v106, 16, v181
v_and_b32 v107, s61, v181
v_mfma_f32_32x32x16_bf16 a[48:63], a[236:239], v[44:47], a[48:63]
ds_read_b64_tr_b16 a[134:135], v245 offset:34816
ds_read_b64_tr_b16 a[136:137], v246 offset:32768
s_add_u32 m0, s24, 32768
ds_read_b128 v[64:67], v250 offset:9088
v_lshlrev_b32 v108, 16, v182
v_mfma_f32_32x32x16_bf16 a[64:79], a[240:243], v[44:47], a[64:79]
ds_read_b64_tr_b16 a[138:139], v246 offset:34816
s_mov_b32 s29, s35
ds_read_b64_tr_b16 a[140:141], v247 offset:32768
buffer_load_dwordx4 v248, s[12:15], s29 offen lds
v_and_b32 v109, s61, v182
v_lshlrev_b32 v110, 16, v183
v_mfma_f32_32x32x16_bf16 a[80:95], a[244:247], v[44:47], a[80:95]
ds_read_b64_tr_b16 a[142:143], v247 offset:34816
ds_read_b64_tr_b16 a[144:145], v244 offset:33024
ds_read_b128 v[68:71], v250 offset:9104
v_and_b32 v111, s61, v183
s_waitcnt lgkmcnt(8)
v_fmac_f32 v88, v104, v80
v_fmac_f32 v89, v105, v81
v_mfma_f32_32x32x16_bf16 a[96:111], a[248:251], v[44:47], a[96:111]
ds_read_b64_tr_b16 a[146:147], v244 offset:35072
ds_read_b64_tr_b16 a[148:149], v245 offset:33024
ds_read_b128 v[72:75], v250 offset:896
v_fmac_f32 v90, v106, v82
v_fmac_f32 v91, v107, v83
v_fmac_f32 v92, v108, v84
v_mfma_f32_32x32x16_bf16 a[112:127], a[252:255], v[44:47], a[112:127]
ds_read_b64_tr_b16 a[150:151], v245 offset:35072
s_add_u32 s29, s35, 15360
ds_read_b64_tr_b16 a[152:153], v246 offset:33024
ds_read_b64_tr_b16 a[154:155], v246 offset:35072
buffer_load_dwordx4 v249, s[12:15], s29 offen offset:1024 lds
v_fmac_f32 v93, v109, v85
v_mfma_f32_32x32x16_bf16 a[0:15], a[128:131], v[48:51], a[0:15]
ds_read_b64_tr_b16 a[156:157], v247 offset:33024
ds_read_b64_tr_b16 a[158:159], v247 offset:35072
ds_read_b128 v[76:79], v250 offset:912
v_fmac_f32 v94, v110, v86
v_fmac_f32 v95, v111, v87
v_cvt_pk_bf16_f32 v52, v88, v89
s_waitcnt lgkmcnt(6)
v_mfma_f32_32x32x16_bf16 a[16:31], a[132:135], v[48:51], a[16:31]
ds_read_b64_tr_b16 a[160:161], v244 offset:40960
ds_read_b64_tr_b16 a[162:163], v244 offset:43008
v_cvt_pk_bf16_f32 v53, v90, v91
v_cvt_pk_bf16_f32 v54, v92, v93
v_cvt_pk_bf16_f32 v55, v94, v95
v_lshlrev_b32 v112, 16, v184
v_mfma_f32_32x32x16_bf16 a[32:47], a[136:139], v[48:51], a[32:47]
ds_read_b64_tr_b16 a[164:165], v245 offset:40960
s_add_u32 s29, s35, 30720
ds_read_b64_tr_b16 a[166:167], v245 offset:43008
buffer_load_dwordx4 v248, s[12:15], s29 offen offset:2048 lds
v_and_b32 v113, s61, v184
v_lshlrev_b32 v114, 16, v185
v_mfma_f32_32x32x16_bf16 a[48:63], a[140:143], v[48:51], a[48:63]
ds_read_b64_tr_b16 a[168:169], v246 offset:40960
ds_read_b64_tr_b16 a[170:171], v246 offset:43008
ds_read_b128 v[80:83], v250 offset:9152
v_and_b32 v115, s61, v185
v_lshlrev_b32 v116, 16, v186
v_mfma_f32_32x32x16_bf16 a[64:79], a[144:147], v[48:51], a[64:79]
ds_read_b64_tr_b16 a[172:173], v247 offset:40960
ds_read_b64_tr_b16 a[174:175], v247 offset:43008
ds_read_b128 v[84:87], v250 offset:9168
v_and_b32 v117, s61, v186
v_lshlrev_b32 v118, 16, v187
v_and_b32 v119, s61, v187
s_waitcnt lgkmcnt(6)
v_mfma_f32_32x32x16_bf16 a[80:95], a[148:151], v[48:51], a[80:95]
ds_read_b64_tr_b16 a[176:177], v244 offset:41216
s_add_u32 s29, s35, 46080
ds_read_b64_tr_b16 a[178:179], v244 offset:43264
ds_read_b64_tr_b16 a[180:181], v245 offset:41216
buffer_load_dwordx4 v249, s[12:15], s29 offen offset:3072 lds
v_fmac_f32 v72, v112, v64
v_mfma_f32_32x32x16_bf16 a[96:111], a[152:155], v[48:51], a[96:111]
ds_read_b64_tr_b16 a[182:183], v245 offset:43264
ds_read_b64_tr_b16 a[184:185], v246 offset:41216
ds_read_b128 v[88:91], v250 offset:960
v_fmac_f32 v73, v113, v65
v_fmac_f32 v74, v114, v66
v_fmac_f32 v75, v115, v67
v_mfma_f32_32x32x16_bf16 a[112:127], a[156:159], v[48:51], a[112:127]
ds_read_b64_tr_b16 a[186:187], v246 offset:43264
ds_read_b64_tr_b16 a[188:189], v247 offset:41216
s_add_u32 m0, s24, 36864
v_fmac_f32 v76, v116, v68
v_fmac_f32 v77, v117, v69
v_fmac_f32 v78, v118, v70
v_mfma_f32_32x32x16_bf16 a[0:15], a[160:163], v[52:55], a[0:15]
ds_read_b64_tr_b16 a[190:191], v247 offset:43264
s_add_u32 s29, s35, 65536
ds_read_b64_tr_b16 a[192:193], v244 offset:49152
buffer_load_dwordx4 v248, s[12:15], s29 offen lds
ds_read_b128 v[92:95], v250 offset:976
v_fmac_f32 v79, v119, v71
v_mfma_f32_32x32x16_bf16 a[16:31], a[164:167], v[52:55], a[16:31]
ds_read_b64_tr_b16 a[194:195], v244 offset:51200
ds_read_b64_tr_b16 a[196:197], v245 offset:49152
v_cvt_pk_bf16_f32 v56, v72, v73
v_cvt_pk_bf16_f32 v57, v74, v75
v_cvt_pk_bf16_f32 v58, v76, v77
v_cvt_pk_bf16_f32 v59, v78, v79
s_waitcnt lgkmcnt(5)
v_mfma_f32_32x32x16_bf16 a[32:47], a[168:171], v[52:55], a[32:47]
ds_read_b64_tr_b16 a[198:199], v245 offset:51200
ds_read_b64_tr_b16 a[200:201], v246 offset:49152
v_lshlrev_b32 v120, 16, v188
v_and_b32 v121, s61, v188
v_lshlrev_b32 v122, 16, v189
v_and_b32 v123, s61, v189
v_mfma_f32_32x32x16_bf16 a[48:63], a[172:175], v[52:55], a[48:63]
ds_read_b64_tr_b16 a[202:203], v246 offset:51200
s_add_u32 s29, s35, 80896
ds_read_b64_tr_b16 a[204:205], v247 offset:49152
ds_read_b64_tr_b16 a[206:207], v247 offset:51200
buffer_load_dwordx4 v249, s[12:15], s29 offen offset:1024 lds
ds_read_b128 v[64:67], v250 offset:9216
v_mfma_f32_32x32x16_bf16 a[64:79], a[176:179], v[52:55], a[64:79]
ds_read_b64_tr_b16 a[208:209], v244 offset:49408
ds_read_b64_tr_b16 a[210:211], v244 offset:51456
v_lshlrev_b32 v124, 16, v190
v_and_b32 v125, s61, v190
v_lshlrev_b32 v126, 16, v191
v_mfma_f32_32x32x16_bf16 a[80:95], a[180:183], v[52:55], a[80:95]
ds_read_b64_tr_b16 a[212:213], v245 offset:49408
ds_read_b64_tr_b16 a[214:215], v245 offset:51456
ds_read_b128 v[68:71], v250 offset:9232
v_and_b32 v127, s61, v191
s_waitcnt lgkmcnt(9)
v_fmac_f32 v88, v120, v80
v_fmac_f32 v89, v121, v81
v_mfma_f32_32x32x16_bf16 a[96:111], a[184:187], v[52:55], a[96:111]
ds_read_b64_tr_b16 a[216:217], v246 offset:49408
s_add_u32 s29, s35, 96256
ds_read_b64_tr_b16 a[218:219], v246 offset:51456
buffer_load_dwordx4 v248, s[12:15], s29 offen offset:2048 lds
v_fmac_f32 v90, v122, v82
v_fmac_f32 v91, v123, v83
v_mfma_f32_32x32x16_bf16 a[112:127], a[188:191], v[52:55], a[112:127]
ds_read_b64_tr_b16 a[220:221], v247 offset:49408
ds_read_b64_tr_b16 a[222:223], v247 offset:51456
ds_read_b128 v[72:75], v250 offset:1024
v_fmac_f32 v92, v124, v84
v_fmac_f32 v93, v125, v85
v_fmac_f32 v94, v126, v86
v_mfma_f32_32x32x16_bf16 a[0:15], a[192:195], v[56:59], a[0:15]
ds_read_b64_tr_b16 a[224:225], v244 offset:57344
ds_read_b64_tr_b16 a[226:227], v244 offset:59392
ds_read_b128 v[76:79], v250 offset:1040
v_fmac_f32 v95, v127, v87
v_cvt_pk_bf16_f32 v60, v88, v89
v_cvt_pk_bf16_f32 v61, v90, v91
v_mfma_f32_32x32x16_bf16 a[16:31], a[196:199], v[56:59], a[16:31]
ds_read_b64_tr_b16 a[228:229], v245 offset:57344
s_add_u32 s29, s35, 111616
ds_read_b64_tr_b16 a[230:231], v245 offset:59392
ds_read_b64_tr_b16 a[232:233], v246 offset:57344
buffer_load_dwordx4 v249, s[12:15], s29 offen offset:3072 lds
v_cvt_pk_bf16_f32 v62, v92, v93
s_waitcnt lgkmcnt(6)
v_mfma_f32_32x32x16_bf16 a[32:47], a[200:203], v[56:59], a[32:47]
ds_read_b64_tr_b16 a[234:235], v246 offset:59392
ds_read_b64_tr_b16 a[236:237], v247 offset:57344
v_cvt_pk_bf16_f32 v63, v94, v95
v_lshlrev_b32 v96, 16, v192
v_and_b32 v97, s61, v192
v_lshlrev_b32 v98, 16, v193
v_mfma_f32_32x32x16_bf16 a[48:63], a[204:207], v[56:59], a[48:63]
ds_read_b64_tr_b16 a[238:239], v247 offset:59392
ds_read_b64_tr_b16 a[240:241], v244 offset:57600
ds_read_b128 v[80:83], v250 offset:9280
v_and_b32 v99, s61, v193
v_lshlrev_b32 v100, 16, v194
v_and_b32 v101, s61, v194
v_mfma_f32_32x32x16_bf16 a[64:79], a[208:211], v[56:59], a[64:79]
ds_read_b64_tr_b16 a[242:243], v244 offset:59648
ds_read_b64_tr_b16 a[244:245], v245 offset:57600
ds_read_b128 v[84:87], v250 offset:9296
v_lshlrev_b32 v102, 16, v195
v_and_b32 v103, s61, v195
v_mfma_f32_32x32x16_bf16 a[80:95], a[212:215], v[56:59], a[80:95]
ds_read_b64_tr_b16 a[246:247], v245 offset:59648
ds_read_b64_tr_b16 a[248:249], v246 offset:57600
s_waitcnt lgkmcnt(8)
v_fmac_f32 v72, v96, v64
v_fmac_f32 v73, v97, v65
v_fmac_f32 v74, v98, v66
v_fmac_f32 v75, v99, v67
v_mfma_f32_32x32x16_bf16 a[96:111], a[216:219], v[56:59], a[96:111]
ds_read_b64_tr_b16 a[250:251], v246 offset:59648
ds_read_b64_tr_b16 a[252:253], v247 offset:57600
ds_read_b128 v[88:91], v250 offset:1088
v_fmac_f32 v76, v100, v68
v_fmac_f32 v77, v101, v69
v_fmac_f32 v78, v102, v70
v_mfma_f32_32x32x16_bf16 a[112:127], a[220:223], v[56:59], a[112:127]
ds_read_b64_tr_b16 a[254:255], v247 offset:59648
ds_read_b128 v[92:95], v250 offset:1104
v_fmac_f32 v79, v103, v71
v_cvt_pk_bf16_f32 v32, v72, v73
v_cvt_pk_bf16_f32 v33, v74, v75
v_cvt_pk_bf16_f32 v34, v76, v77
v_mfma_f32_32x32x16_bf16 a[0:15], a[224:227], v[60:63], a[0:15]
ds_read_b128 v[64:67], v250 offset:9344
v_cvt_pk_bf16_f32 v35, v78, v79
v_lshlrev_b32 v104, 16, v196
v_and_b32 v105, s61, v196
v_lshlrev_b32 v106, 16, v197
v_and_b32 v107, s61, v197
v_mfma_f32_32x32x16_bf16 a[16:31], a[228:231], v[60:63], a[16:31]
ds_read_b128 v[68:71], v250 offset:9360
v_lshlrev_b32 v108, 16, v198
v_and_b32 v109, s61, v198
v_lshlrev_b32 v110, 16, v199
v_and_b32 v111, s61, v199
s_waitcnt lgkmcnt(2)
v_fmac_f32 v88, v104, v80
v_mfma_f32_32x32x16_bf16 a[32:47], a[232:235], v[60:63], a[32:47]
s_waitcnt vmcnt(16)
s_barrier
ds_read_b64_tr_b16 a[128:129], v240 offset:0
ds_read_b64_tr_b16 a[130:131], v240 offset:2048
ds_read_b64_tr_b16 a[132:133], v241 offset:0
v_fmac_f32 v89, v105, v81
v_fmac_f32 v90, v106, v82
v_mfma_f32_32x32x16_bf16 a[48:63], a[236:239], v[60:63], a[48:63]
ds_read_b64_tr_b16 a[134:135], v241 offset:2048
ds_read_b64_tr_b16 a[136:137], v242 offset:0
ds_read_b128 v[72:75], v250 offset:1152
v_fmac_f32 v91, v107, v83
v_fmac_f32 v92, v108, v84
v_fmac_f32 v93, v109, v85
v_mfma_f32_32x32x16_bf16 a[64:79], a[240:243], v[60:63], a[64:79]
ds_read_b64_tr_b16 a[138:139], v242 offset:2048
s_add_u32 m0, s24, 98304
ds_read_b64_tr_b16 a[140:141], v243 offset:0
buffer_load_dwordx4 v13, s[4:7], s25 offen lds
v_fmac_f32 v94, v110, v86
v_mfma_f32_32x32x16_bf16 a[80:95], a[244:247], v[60:63], a[80:95]
ds_read_b64_tr_b16 a[142:143], v243 offset:2048
ds_read_b64_tr_b16 a[144:145], v240 offset:256
ds_read_b128 v[76:79], v250 offset:1168
v_fmac_f32 v95, v111, v87
v_cvt_pk_bf16_f32 v36, v88, v89
v_cvt_pk_bf16_f32 v37, v90, v91
v_mfma_f32_32x32x16_bf16 a[96:111], a[248:251], v[60:63], a[96:111]
ds_read_b64_tr_b16 a[146:147], v240 offset:2304
ds_read_b64_tr_b16 a[148:149], v241 offset:256
v_cvt_pk_bf16_f32 v38, v92, v93
v_cvt_pk_bf16_f32 v39, v94, v95
v_lshlrev_b32 v112, 16, v200
v_and_b32 v113, s61, v200
v_mfma_f32_32x32x16_bf16 a[112:127], a[252:255], v[60:63], a[112:127]
ds_read_b64_tr_b16 a[150:151], v241 offset:2304
ds_read_b64_tr_b16 a[152:153], v242 offset:256
ds_read_b64_tr_b16 a[154:155], v242 offset:2304
buffer_load_dwordx4 v14, s[4:7], s25 offen offset:1024 lds
v_lshlrev_b32 v114, 16, v201
v_and_b32 v115, s61, v201
s_waitcnt lgkmcnt(5)
v_mfma_f32_32x32x16_bf16 a[0:15], a[128:131], v[32:35], a[0:15]
ds_read_b64_tr_b16 a[156:157], v243 offset:256
ds_read_b64_tr_b16 a[158:159], v243 offset:2304
ds_read_b128 v[80:83], v250 offset:9408
v_lshlrev_b32 v116, 16, v202
v_and_b32 v117, s61, v202
v_lshlrev_b32 v118, 16, v203
v_mfma_f32_32x32x16_bf16 a[16:31], a[132:135], v[32:35], a[16:31]
ds_read_b64_tr_b16 a[160:161], v240 offset:8192
ds_read_b64_tr_b16 a[162:163], v240 offset:10240
ds_read_b128 v[84:87], v250 offset:9424
v_and_b32 v119, s61, v203
v_fmac_f32 v72, v112, v64
v_fmac_f32 v73, v113, v65
v_mfma_f32_32x32x16_bf16 a[32:47], a[136:139], v[32:35], a[32:47]
ds_read_b64_tr_b16 a[164:165], v241 offset:8192
ds_read_b64_tr_b16 a[166:167], v241 offset:10240
buffer_load_dwordx4 v15, s[4:7], s25 offen offset:2048 lds
ds_read_b128 v[88:91], v250 offset:1216
v_fmac_f32 v74, v114, v66
v_fmac_f32 v75, v115, v67
v_mfma_f32_32x32x16_bf16 a[48:63], a[140:143], v[32:35], a[48:63]
ds_read_b64_tr_b16 a[168:169], v242 offset:8192
ds_read_b64_tr_b16 a[170:171], v242 offset:10240
v_fmac_f32 v76, v116, v68
v_fmac_f32 v77, v117, v69
v_fmac_f32 v78, v118, v70
v_fmac_f32 v79, v119, v71
s_waitcnt lgkmcnt(5)
v_mfma_f32_32x32x16_bf16 a[64:79], a[144:147], v[32:35], a[64:79]
ds_read_b64_tr_b16 a[172:173], v243 offset:8192
ds_read_b64_tr_b16 a[174:175], v243 offset:10240
ds_read_b128 v[92:95], v250 offset:1232
v_cvt_pk_bf16_f32 v40, v72, v73
v_cvt_pk_bf16_f32 v41, v74, v75
v_mfma_f32_32x32x16_bf16 a[80:95], a[148:151], v[32:35], a[80:95]
ds_read_b64_tr_b16 a[176:177], v240 offset:8448
ds_read_b64_tr_b16 a[178:179], v240 offset:10496
ds_read_b64_tr_b16 a[180:181], v241 offset:8448
buffer_load_dwordx4 v16, s[4:7], s25 offen offset:3072 lds
v_cvt_pk_bf16_f32 v42, v76, v77
v_cvt_pk_bf16_f32 v43, v78, v79
v_mfma_f32_32x32x16_bf16 a[96:111], a[152:155], v[32:35], a[96:111]
ds_read_b64_tr_b16 a[182:183], v241 offset:10496
ds_read_b64_tr_b16 a[184:185], v242 offset:8448
v_lshlrev_b32 v120, 16, v204
v_and_b32 v121, s61, v204
v_lshlrev_b32 v122, 16, v205
v_and_b32 v123, s61, v205
v_mfma_f32_32x32x16_bf16 a[112:127], a[156:159], v[32:35], a[112:127]
ds_read_b64_tr_b16 a[186:187], v242 offset:10496
ds_read_b64_tr_b16 a[188:189], v243 offset:8448
ds_read_b128 v[64:67], v250 offset:9472
v_lshlrev_b32 v124, 16, v206
v_and_b32 v125, s61, v206
v_lshlrev_b32 v126, 16, v207
v_mfma_f32_32x32x16_bf16 a[0:15], a[160:163], v[36:39], a[0:15]
ds_read_b64_tr_b16 a[190:191], v243 offset:10496
s_add_u32 m0, s24, 102400
ds_read_b64_tr_b16 a[192:193], v240 offset:16384
buffer_load_dwordx4 v17, s[4:7], s25 offen lds
ds_read_b128 v[68:71], v250 offset:9488
v_and_b32 v127, s61, v207
s_waitcnt lgkmcnt(6)
v_mfma_f32_32x32x16_bf16 a[16:31], a[164:167], v[36:39], a[16:31]
ds_read_b64_tr_b16 a[194:195], v240 offset:18432
ds_read_b64_tr_b16 a[196:197], v241 offset:16384
v_fmac_f32 v88, v120, v80
v_fmac_f32 v89, v121, v81
v_fmac_f32 v90, v122, v82
v_fmac_f32 v91, v123, v83
v_mfma_f32_32x32x16_bf16 a[32:47], a[168:171], v[36:39], a[32:47]
ds_read_b64_tr_b16 a[198:199], v241 offset:18432
ds_read_b64_tr_b16 a[200:201], v242 offset:16384
ds_read_b128 v[72:75], v250 offset:1280
v_fmac_f32 v92, v124, v84
v_fmac_f32 v93, v125, v85
v_fmac_f32 v94, v126, v86
v_mfma_f32_32x32x16_bf16 a[48:63], a[172:175], v[36:39], a[48:63]
ds_read_b64_tr_b16 a[202:203], v242 offset:18432
ds_read_b64_tr_b16 a[204:205], v243 offset:16384
ds_read_b64_tr_b16 a[206:207], v243 offset:18432
buffer_load_dwordx4 v18, s[4:7], s25 offen offset:1024 lds
ds_read_b128 v[76:79], v250 offset:1296
v_fmac_f32 v95, v127, v87
v_mfma_f32_32x32x16_bf16 a[64:79], a[176:179], v[36:39], a[64:79]
ds_read_b64_tr_b16 a[208:209], v240 offset:16640
ds_read_b64_tr_b16 a[210:211], v240 offset:18688
v_cvt_pk_bf16_f32 v44, v88, v89
v_cvt_pk_bf16_f32 v45, v90, v91
v_cvt_pk_bf16_f32 v46, v92, v93
v_cvt_pk_bf16_f32 v47, v94, v95
v_mfma_f32_32x32x16_bf16 a[80:95], a[180:183], v[36:39], a[80:95]
ds_read_b64_tr_b16 a[212:213], v241 offset:16640
ds_read_b64_tr_b16 a[214:215], v241 offset:18688
v_lshlrev_b32 v96, 16, v208
v_and_b32 v97, s61, v208
v_lshlrev_b32 v98, 16, v209
s_waitcnt lgkmcnt(4)
v_mfma_f32_32x32x16_bf16 a[96:111], a[184:187], v[36:39], a[96:111]
ds_read_b64_tr_b16 a[216:217], v242 offset:16640
ds_read_b64_tr_b16 a[218:219], v242 offset:18688
buffer_load_dwordx4 v19, s[4:7], s25 offen offset:2048 lds
ds_read_b128 v[80:83], v250 offset:9536
v_and_b32 v99, s61, v209
v_lshlrev_b32 v100, 16, v210
v_mfma_f32_32x32x16_bf16 a[112:127], a[188:191], v[36:39], a[112:127]
ds_read_b64_tr_b16 a[220:221], v243 offset:16640
ds_read_b64_tr_b16 a[222:223], v243 offset:18688
ds_read_b128 v[84:87], v250 offset:9552
v_and_b32 v101, s61, v210
v_lshlrev_b32 v102, 16, v211
v_and_b32 v103, s61, v211
v_mfma_f32_32x32x16_bf16 a[0:15], a[192:195], v[40:43], a[0:15]
ds_read_b64_tr_b16 a[224:225], v240 offset:24576
ds_read_b64_tr_b16 a[226:227], v240 offset:26624
v_fmac_f32 v72, v96, v64
v_fmac_f32 v73, v97, v65
v_fmac_f32 v74, v98, v66
v_fmac_f32 v75, v99, v67
v_mfma_f32_32x32x16_bf16 a[16:31], a[196:199], v[40:43], a[16:31]
ds_read_b64_tr_b16 a[228:229], v241 offset:24576
ds_read_b64_tr_b16 a[230:231], v241 offset:26624
ds_read_b64_tr_b16 a[232:233], v242 offset:24576
buffer_load_dwordx4 v20, s[4:7], s25 offen offset:3072 lds
ds_read_b128 v[88:91], v250 offset:1344
v_fmac_f32 v76, v100, v68
v_mfma_f32_32x32x16_bf16 a[32:47], a[200:203], v[40:43], a[32:47]
ds_read_b64_tr_b16 a[234:235], v242 offset:26624
s_add_u32 s25, s25, 32768
ds_read_b64_tr_b16 a[236:237], v243 offset:24576
v_fmac_f32 v77, v101, v69
v_fmac_f32 v78, v102, v70
v_fmac_f32 v79, v103, v71
v_mfma_f32_32x32x16_bf16 a[48:63], a[204:207], v[40:43], a[48:63]
ds_read_b64_tr_b16 a[238:239], v243 offset:26624
ds_read_b64_tr_b16 a[240:241], v240 offset:24832
ds_read_b128 v[92:95], v250 offset:1360
v_cvt_pk_bf16_f32 v48, v72, v73
v_cvt_pk_bf16_f32 v49, v74, v75
v_cvt_pk_bf16_f32 v50, v76, v77
s_waitcnt lgkmcnt(5)
v_mfma_f32_32x32x16_bf16 a[64:79], a[208:211], v[40:43], a[64:79]
ds_read_b64_tr_b16 a[242:243], v240 offset:26880
ds_read_b64_tr_b16 a[244:245], v241 offset:24832
v_cvt_pk_bf16_f32 v51, v78, v79
v_lshlrev_b32 v104, 16, v212
v_and_b32 v105, s61, v212
v_lshlrev_b32 v106, 16, v213
v_mfma_f32_32x32x16_bf16 a[80:95], a[212:215], v[40:43], a[80:95]
ds_read_b64_tr_b16 a[246:247], v241 offset:26880
ds_read_b64_tr_b16 a[248:249], v242 offset:24832
ds_read_b128 v[64:67], v250 offset:9600
v_and_b32 v107, s61, v213
v_lshlrev_b32 v108, 16, v214
v_mfma_f32_32x32x16_bf16 a[96:111], a[216:219], v[40:43], a[96:111]
ds_read_b64_tr_b16 a[250:251], v242 offset:26880
ds_read_b64_tr_b16 a[252:253], v243 offset:24832
ds_read_b128 v[68:71], v250 offset:9616
v_and_b32 v109, s61, v214
v_lshlrev_b32 v110, 16, v215
v_and_b32 v111, s61, v215
v_mfma_f32_32x32x16_bf16 a[112:127], a[220:223], v[40:43], a[112:127]
ds_read_b64_tr_b16 a[254:255], v243 offset:26880
ds_read_b128 v[72:75], v250 offset:1408
s_waitcnt lgkmcnt(8)
v_fmac_f32 v88, v104, v80
v_fmac_f32 v89, v105, v81
v_fmac_f32 v90, v106, v82
v_fmac_f32 v91, v107, v83
v_mfma_f32_32x32x16_bf16 a[0:15], a[224:227], v[44:47], a[0:15]
ds_read_b128 v[76:79], v250 offset:1424
v_fmac_f32 v92, v108, v84
v_fmac_f32 v93, v109, v85
v_fmac_f32 v94, v110, v86
v_fmac_f32 v95, v111, v87
v_cvt_pk_bf16_f32 v52, v88, v89
v_mfma_f32_32x32x16_bf16 a[16:31], a[228:231], v[44:47], a[16:31]
v_cvt_pk_bf16_f32 v53, v90, v91
v_cvt_pk_bf16_f32 v54, v92, v93
v_cvt_pk_bf16_f32 v55, v94, v95
v_lshlrev_b32 v112, 16, v216
v_and_b32 v113, s61, v216
v_lshlrev_b32 v114, 16, v217
v_mfma_f32_32x32x16_bf16 a[32:47], a[232:235], v[44:47], a[32:47]
s_waitcnt vmcnt(16) lgkmcnt(2)
s_barrier
ds_read_b64_tr_b16 a[128:129], v244 offset:0
ds_read_b64_tr_b16 a[130:131], v244 offset:2048
ds_read_b64_tr_b16 a[132:133], v245 offset:0
ds_read_b128 v[80:83], v250 offset:9664
v_and_b32 v115, s61, v217
v_mfma_f32_32x32x16_bf16 a[48:63], a[236:239], v[44:47], a[48:63]
ds_read_b64_tr_b16 a[134:135], v245 offset:2048
ds_read_b64_tr_b16 a[136:137], v246 offset:0
v_lshlrev_b32 v116, 16, v218
v_and_b32 v117, s61, v218
v_lshlrev_b32 v118, 16, v219
v_and_b32 v119, s61, v219
v_mfma_f32_32x32x16_bf16 a[64:79], a[240:243], v[44:47], a[64:79]
ds_read_b64_tr_b16 a[138:139], v246 offset:2048
s_add_u32 m0, s24, 0
ds_read_b64_tr_b16 a[140:141], v247 offset:0
buffer_load_dwordx4 v13, s[4:7], s25 offen lds
ds_read_b128 v[84:87], v250 offset:9680
s_waitcnt lgkmcnt(9)
v_fmac_f32 v72, v112, v64
v_mfma_f32_32x32x16_bf16 a[80:95], a[244:247], v[44:47], a[80:95]
ds_read_b64_tr_b16 a[142:143], v247 offset:2048
ds_read_b64_tr_b16 a[144:145], v244 offset:256
v_fmac_f32 v73, v113, v65
v_fmac_f32 v74, v114, v66
v_fmac_f32 v75, v115, v67
v_mfma_f32_32x32x16_bf16 a[96:111], a[248:251], v[44:47], a[96:111]
ds_read_b64_tr_b16 a[146:147], v244 offset:2304
ds_read_b64_tr_b16 a[148:149], v245 offset:256
ds_read_b128 v[88:91], v250 offset:1472
v_fmac_f32 v76, v116, v68
v_fmac_f32 v77, v117, v69
v_fmac_f32 v78, v118, v70
v_mfma_f32_32x32x16_bf16 a[112:127], a[252:255], v[44:47], a[112:127]
ds_read_b64_tr_b16 a[150:151], v245 offset:2304
ds_read_b64_tr_b16 a[152:153], v246 offset:256
ds_read_b64_tr_b16 a[154:155], v246 offset:2304
buffer_load_dwordx4 v14, s[4:7], s25 offen offset:1024 lds
ds_read_b128 v[92:95], v250 offset:1488
v_fmac_f32 v79, v119, v71
s_waitcnt lgkmcnt(7)
v_mfma_f32_32x32x16_bf16 a[0:15], a[128:131], v[48:51], a[0:15]
ds_read_b64_tr_b16 a[156:157], v247 offset:256
ds_read_b64_tr_b16 a[158:159], v247 offset:2304
v_cvt_pk_bf16_f32 v56, v72, v73
v_cvt_pk_bf16_f32 v57, v74, v75
v_cvt_pk_bf16_f32 v58, v76, v77
v_cvt_pk_bf16_f32 v59, v78, v79
v_mfma_f32_32x32x16_bf16 a[16:31], a[132:135], v[48:51], a[16:31]
ds_read_b64_tr_b16 a[160:161], v244 offset:8192
ds_read_b64_tr_b16 a[162:163], v244 offset:10240
v_lshlrev_b32 v120, 16, v220
v_and_b32 v121, s61, v220
v_lshlrev_b32 v122, 16, v221
v_and_b32 v123, s61, v221
v_mfma_f32_32x32x16_bf16 a[32:47], a[136:139], v[48:51], a[32:47]
ds_read_b64_tr_b16 a[164:165], v245 offset:8192
ds_read_b64_tr_b16 a[166:167], v245 offset:10240
buffer_load_dwordx4 v15, s[4:7], s25 offen offset:2048 lds
ds_read_b128 v[64:67], v250 offset:9728
v_lshlrev_b32 v124, 16, v222
v_and_b32 v125, s61, v222
v_mfma_f32_32x32x16_bf16 a[48:63], a[140:143], v[48:51], a[48:63]
ds_read_b64_tr_b16 a[168:169], v246 offset:8192
ds_read_b64_tr_b16 a[170:171], v246 offset:10240
ds_read_b128 v[68:71], v250 offset:9744
v_lshlrev_b32 v126, 16, v223
v_and_b32 v127, s61, v223
s_waitcnt lgkmcnt(8)
v_fmac_f32 v88, v120, v80
v_mfma_f32_32x32x16_bf16 a[64:79], a[144:147], v[48:51], a[64:79]
ds_read_b64_tr_b16 a[172:173], v247 offset:8192
ds_read_b64_tr_b16 a[174:175], v247 offset:10240
ds_read_b128 v[72:75], v250 offset:1536
v_fmac_f32 v89, v121, v81
v_fmac_f32 v90, v122, v82
v_fmac_f32 v91, v123, v83
v_mfma_f32_32x32x16_bf16 a[80:95], a[148:151], v[48:51], a[80:95]
ds_read_b64_tr_b16 a[176:177], v244 offset:8448
ds_read_b64_tr_b16 a[178:179], v244 offset:10496
ds_read_b64_tr_b16 a[180:181], v245 offset:8448
buffer_load_dwordx4 v16, s[4:7], s25 offen offset:3072 lds
v_fmac_f32 v92, v124, v84
v_mfma_f32_32x32x16_bf16 a[96:111], a[152:155], v[48:51], a[96:111]
ds_read_b64_tr_b16 a[182:183], v245 offset:10496
ds_read_b64_tr_b16 a[184:185], v246 offset:8448
ds_read_b128 v[76:79], v250 offset:1552
v_fmac_f32 v93, v125, v85
v_fmac_f32 v94, v126, v86
v_fmac_f32 v95, v127, v87
v_mfma_f32_32x32x16_bf16 a[112:127], a[156:159], v[48:51], a[112:127]
ds_read_b64_tr_b16 a[186:187], v246 offset:10496
ds_read_b64_tr_b16 a[188:189], v247 offset:8448
v_cvt_pk_bf16_f32 v60, v88, v89
v_cvt_pk_bf16_f32 v61, v90, v91
v_cvt_pk_bf16_f32 v62, v92, v93
v_cvt_pk_bf16_f32 v63, v94, v95
s_waitcnt lgkmcnt(5)
v_mfma_f32_32x32x16_bf16 a[0:15], a[160:163], v[52:55], a[0:15]
ds_read_b64_tr_b16 a[190:191], v247 offset:10496
s_add_u32 m0, s24, 4096
ds_read_b64_tr_b16 a[192:193], v244 offset:16384
buffer_load_dwordx4 v17, s[4:7], s25 offen lds
v_lshlrev_b32 v96, 16, v224
v_and_b32 v97, s61, v224
v_mfma_f32_32x32x16_bf16 a[16:31], a[164:167], v[52:55], a[16:31]
ds_read_b64_tr_b16 a[194:195], v244 offset:18432
ds_read_b64_tr_b16 a[196:197], v245 offset:16384
ds_read_b128 v[80:83], v250 offset:9792
v_lshlrev_b32 v98, 16, v225
v_and_b32 v99, s61, v225
v_lshlrev_b32 v100, 16, v226
v_mfma_f32_32x32x16_bf16 a[32:47], a[168:171], v[52:55], a[32:47]
ds_read_b64_tr_b16 a[198:199], v245 offset:18432
ds_read_b64_tr_b16 a[200:201], v246 offset:16384
ds_read_b128 v[84:87], v250 offset:9808
v_and_b32 v101, s61, v226
v_lshlrev_b32 v102, 16, v227
v_and_b32 v103, s61, v227
v_mfma_f32_32x32x16_bf16 a[48:63], a[172:175], v[52:55], a[48:63]
ds_read_b64_tr_b16 a[202:203], v246 offset:18432
ds_read_b64_tr_b16 a[204:205], v247 offset:16384
ds_read_b64_tr_b16 a[206:207], v247 offset:18432
buffer_load_dwordx4 v18, s[4:7], s25 offen offset:1024 lds
s_waitcnt lgkmcnt(9)
v_fmac_f32 v72, v96, v64
v_fmac_f32 v73, v97, v65
v_mfma_f32_32x32x16_bf16 a[64:79], a[176:179], v[52:55], a[64:79]
ds_read_b64_tr_b16 a[208:209], v244 offset:16640
ds_read_b64_tr_b16 a[210:211], v244 offset:18688
ds_read_b128 v[88:91], v250 offset:1600
v_fmac_f32 v74, v98, v66
v_fmac_f32 v75, v99, v67
v_fmac_f32 v76, v100, v68
v_mfma_f32_32x32x16_bf16 a[80:95], a[180:183], v[52:55], a[80:95]
ds_read_b64_tr_b16 a[212:213], v245 offset:16640
ds_read_b64_tr_b16 a[214:215], v245 offset:18688
v_fmac_f32 v77, v101, v69
v_fmac_f32 v78, v102, v70
v_fmac_f32 v79, v103, v71
v_mfma_f32_32x32x16_bf16 a[96:111], a[184:187], v[52:55], a[96:111]
ds_read_b64_tr_b16 a[216:217], v246 offset:16640
ds_read_b64_tr_b16 a[218:219], v246 offset:18688
buffer_load_dwordx4 v19, s[4:7], s25 offen offset:2048 lds
ds_read_b128 v[92:95], v250 offset:1616
v_cvt_pk_bf16_f32 v32, v72, v73
v_cvt_pk_bf16_f32 v33, v74, v75
v_mfma_f32_32x32x16_bf16 a[112:127], a[188:191], v[52:55], a[112:127]
ds_read_b64_tr_b16 a[220:221], v247 offset:16640
ds_read_b64_tr_b16 a[222:223], v247 offset:18688
v_cvt_pk_bf16_f32 v34, v76, v77
v_cvt_pk_bf16_f32 v35, v78, v79
v_lshlrev_b32 v104, 16, v228
v_and_b32 v105, s61, v228
s_waitcnt lgkmcnt(5)
v_mfma_f32_32x32x16_bf16 a[0:15], a[192:195], v[56:59], a[0:15]
ds_read_b64_tr_b16 a[224:225], v244 offset:24576
ds_read_b64_tr_b16 a[226:227], v244 offset:26624
ds_read_b128 v[64:67], v250 offset:9856
v_lshlrev_b32 v106, 16, v229
v_and_b32 v107, s61, v229
v_lshlrev_b32 v108, 16, v230
v_mfma_f32_32x32x16_bf16 a[16:31], a[196:199], v[56:59], a[16:31]
ds_read_b64_tr_b16 a[228:229], v245 offset:24576
ds_read_b64_tr_b16 a[230:231], v245 offset:26624
ds_read_b64_tr_b16 a[232:233], v246 offset:24576
buffer_load_dwordx4 v20, s[4:7], s25 offen offset:3072 lds
v_and_b32 v109, s61, v230
v_lshlrev_b32 v110, 16, v231
v_mfma_f32_32x32x16_bf16 a[32:47], a[200:203], v[56:59], a[32:47]
ds_read_b64_tr_b16 a[234:235], v246 offset:26624
s_add_u32 s25, s25, 32768
ds_read_b64_tr_b16 a[236:237], v247 offset:24576
ds_read_b128 v[68:71], v250 offset:9872
v_and_b32 v111, s61, v231
s_waitcnt lgkmcnt(9)
v_fmac_f32 v88, v104, v80
v_mfma_f32_32x32x16_bf16 a[48:63], a[204:207], v[56:59], a[48:63]
ds_read_b64_tr_b16 a[238:239], v247 offset:26624
ds_read_b64_tr_b16 a[240:241], v244 offset:24832
ds_read_b128 v[72:75], v250 offset:1664
v_fmac_f32 v89, v105, v81
v_fmac_f32 v90, v106, v82
v_fmac_f32 v91, v107, v83
v_mfma_f32_32x32x16_bf16 a[64:79], a[208:211], v[56:59], a[64:79]
ds_read_b64_tr_b16 a[242:243], v244 offset:26880
ds_read_b64_tr_b16 a[244:245], v245 offset:24832
v_fmac_f32 v92, v108, v84
v_fmac_f32 v93, v109, v85
v_fmac_f32 v94, v110, v86
v_fmac_f32 v95, v111, v87
v_mfma_f32_32x32x16_bf16 a[80:95], a[212:215], v[56:59], a[80:95]
ds_read_b64_tr_b16 a[246:247], v245 offset:26880
ds_read_b64_tr_b16 a[248:249], v246 offset:24832
ds_read_b128 v[76:79], v250 offset:1680
v_cvt_pk_bf16_f32 v36, v88, v89
v_cvt_pk_bf16_f32 v37, v90, v91
v_mfma_f32_32x32x16_bf16 a[96:111], a[216:219], v[56:59], a[96:111]
ds_read_b64_tr_b16 a[250:251], v246 offset:26880
ds_read_b64_tr_b16 a[252:253], v247 offset:24832
v_cvt_pk_bf16_f32 v38, v92, v93
v_cvt_pk_bf16_f32 v39, v94, v95
v_lshlrev_b32 v112, 16, v232
v_and_b32 v113, s61, v232
v_mfma_f32_32x32x16_bf16 a[112:127], a[220:223], v[56:59], a[112:127]
ds_read_b64_tr_b16 a[254:255], v247 offset:26880
ds_read_b128 v[80:83], v250 offset:9920
v_lshlrev_b32 v114, 16, v233
v_and_b32 v115, s61, v233
v_lshlrev_b32 v116, 16, v234
v_and_b32 v117, s61, v234
s_waitcnt lgkmcnt(4)
v_mfma_f32_32x32x16_bf16 a[0:15], a[224:227], v[60:63], a[0:15]
ds_read_b128 v[84:87], v250 offset:9936
v_lshlrev_b32 v118, 16, v235
v_and_b32 v119, s61, v235
v_fmac_f32 v72, v112, v64
v_fmac_f32 v73, v113, v65
v_fmac_f32 v74, v114, v66
v_mfma_f32_32x32x16_bf16 a[16:31], a[228:231], v[60:63], a[16:31]
ds_read_b128 v[88:91], v250 offset:1728
v_fmac_f32 v75, v115, v67
v_fmac_f32 v76, v116, v68
v_fmac_f32 v77, v117, v69
v_fmac_f32 v78, v118, v70
v_fmac_f32 v79, v119, v71
v_mfma_f32_32x32x16_bf16 a[32:47], a[232:235], v[60:63], a[32:47]
s_waitcnt vmcnt(16) lgkmcnt(3)
s_barrier
ds_read_b64_tr_b16 a[128:129], v240 offset:32768
ds_read_b64_tr_b16 a[130:131], v240 offset:34816
ds_read_b64_tr_b16 a[132:133], v240 offset:40960
ds_read_b128 v[92:95], v250 offset:1744
v_cvt_pk_bf16_f32 v40, v72, v73
v_mfma_f32_32x32x16_bf16 a[48:63], a[236:239], v[60:63], a[48:63]
ds_read_b64_tr_b16 a[134:135], v240 offset:43008
ds_read_b64_tr_b16 a[136:137], v240 offset:49152
v_cvt_pk_bf16_f32 v41, v74, v75
v_cvt_pk_bf16_f32 v42, v76, v77
v_cvt_pk_bf16_f32 v43, v78, v79
v_lshlrev_b32 v120, 16, v236
v_mfma_f32_32x32x16_bf16 a[64:79], a[240:243], v[60:63], a[64:79]
ds_read_b64_tr_b16 a[138:139], v240 offset:51200
s_add_u32 m0, s24, 65536
ds_read_b64_tr_b16 a[140:141], v240 offset:57344
buffer_load_dwordx4 v21, s[8:11], s26 offen lds
v_and_b32 v121, s61, v236
v_lshlrev_b32 v122, 16, v237
v_mfma_f32_32x32x16_bf16 a[80:95], a[244:247], v[60:63], a[80:95]
ds_read_b64_tr_b16 a[142:143], v240 offset:59392
ds_read_b64_tr_b16 a[144:145], v241 offset:32768
v_and_b32 v123, s61, v237
v_lshlrev_b32 v124, 16, v238
v_and_b32 v125, s61, v238
v_mfma_f32_32x32x16_bf16 a[96:111], a[248:251], v[60:63], a[96:111]
ds_read_b64_tr_b16 a[146:147], v241 offset:34816
ds_read_b64_tr_b16 a[148:149], v241 offset:40960
v_lshlrev_b32 v126, 16, v239
v_and_b32 v127, s61, v239
s_waitcnt lgkmcnt(6)
v_fmac_f32 v88, v120, v80
v_fmac_f32 v89, v121, v81
v_mfma_f32_32x32x16_bf16 a[112:127], a[252:255], v[60:63], a[112:127]
ds_read_b64_tr_b16 a[150:151], v241 offset:43008
ds_read_b64_tr_b16 a[152:153], v241 offset:49152
ds_read_b64_tr_b16 a[154:155], v241 offset:51200
buffer_load_dwordx4 v22, s[8:11], s26 offen offset:1024 lds
v_fmac_f32 v90, v122, v82
v_fmac_f32 v91, v123, v83
v_mfma_f32_32x32x16_bf16 a[0:15], a[128:131], v[32:35], a[0:15]
ds_read_b64_tr_b16 a[156:157], v241 offset:57344
ds_read_b64_tr_b16 a[158:159], v241 offset:59392
v_fmac_f32 v92, v124, v84
v_fmac_f32 v93, v125, v85
v_fmac_f32 v94, v126, v86
v_fmac_f32 v95, v127, v87
v_mfma_f32_32x32x16_bf16 a[0:15], a[132:135], v[36:39], a[0:15]
ds_read_b64_tr_b16 a[160:161], v242 offset:32768
ds_read_b64_tr_b16 a[162:163], v242 offset:34816
v_cvt_pk_bf16_f32 v44, v88, v89
v_cvt_pk_bf16_f32 v45, v90, v91
v_cvt_pk_bf16_f32 v46, v92, v93
v_cvt_pk_bf16_f32 v47, v94, v95
s_waitcnt lgkmcnt(4)
v_mfma_f32_32x32x16_bf16 a[0:15], a[136:139], v[40:43], a[0:15]
ds_read_b64_tr_b16 a[164:165], v242 offset:40960
ds_read_b64_tr_b16 a[166:167], v242 offset:43008
buffer_load_dwordx4 v23, s[8:11], s26 offen offset:2048 lds
v_mfma_f32_32x32x16_bf16 a[0:15], a[140:143], v[44:47], a[0:15]
ds_read_b64_tr_b16 a[168:169], v242 offset:49152
ds_read_b64_tr_b16 a[170:171], v242 offset:51200
v_mfma_f32_32x32x16_bf16 a[16:31], a[144:147], v[32:35], a[16:31]
ds_read_b64_tr_b16 a[172:173], v242 offset:57344
ds_read_b64_tr_b16 a[174:175], v242 offset:59392
v_mfma_f32_32x32x16_bf16 a[16:31], a[148:151], v[36:39], a[16:31]
ds_read_b64_tr_b16 a[176:177], v243 offset:32768
ds_read_b64_tr_b16 a[178:179], v243 offset:34816
ds_read_b64_tr_b16 a[180:181], v243 offset:40960
buffer_load_dwordx4 v24, s[8:11], s26 offen offset:3072 lds
v_mfma_f32_32x32x16_bf16 a[16:31], a[152:155], v[40:43], a[16:31]
ds_read_b64_tr_b16 a[182:183], v243 offset:43008
ds_read_b64_tr_b16 a[184:185], v243 offset:49152
v_accvgpr_read_b32 v192, a0
v_accvgpr_read_b32 v193, a1
v_accvgpr_read_b32 v194, a2
v_accvgpr_read_b32 v195, a3
v_cvt_pk_bf16_f32 v64, v192, v193
v_accvgpr_read_b32 v196, a4
s_waitcnt lgkmcnt(5)
v_mfma_f32_32x32x16_bf16 a[16:31], a[156:159], v[44:47], a[16:31]
ds_read_b64_tr_b16 a[186:187], v243 offset:51200
ds_read_b64_tr_b16 a[188:189], v243 offset:57344
v_accvgpr_read_b32 v197, a5
v_cvt_pk_bf16_f32 v65, v194, v195
v_accvgpr_read_b32 v198, a6
v_accvgpr_read_b32 v199, a7
v_cvt_pk_bf16_f32 v66, v196, v197
v_accvgpr_read_b32 v200, a8
v_mfma_f32_32x32x16_bf16 a[32:47], a[160:163], v[32:35], a[32:47]
ds_read_b64_tr_b16 a[190:191], v243 offset:59392
s_add_u32 m0, s24, 69632
ds_read_b64_tr_b16 a[192:193], v240 offset:33024
buffer_load_dwordx4 v25, s[8:11], s26 offen lds
v_accvgpr_read_b32 v201, a9
v_cvt_pk_bf16_f32 v67, v198, v199
v_accvgpr_read_b32 v202, a10
v_accvgpr_read_b32 v203, a11
v_mfma_f32_32x32x16_bf16 a[32:47], a[164:167], v[36:39], a[32:47]
ds_read_b64_tr_b16 a[194:195], v240 offset:35072
ds_read_b64_tr_b16 a[196:197], v240 offset:41216
v_cvt_pk_bf16_f32 v68, v200, v201
v_accvgpr_read_b32 v204, a12
v_accvgpr_read_b32 v205, a13
v_cvt_pk_bf16_f32 v69, v202, v203
v_accvgpr_read_b32 v206, a14
v_accvgpr_read_b32 v207, a15
v_mfma_f32_32x32x16_bf16 a[32:47], a[168:171], v[40:43], a[32:47]
ds_read_b64_tr_b16 a[198:199], v240 offset:43264
ds_read_b64_tr_b16 a[200:201], v240 offset:49408
v_cvt_pk_bf16_f32 v70, v204, v205
v_cvt_pk_bf16_f32 v71, v206, v207
v_permlane16_swap_b32 v64, v68
v_permlane16_swap_b32 v65, v69
v_permlane16_swap_b32 v66, v70
v_permlane16_swap_b32 v67, v71
v_mfma_f32_32x32x16_bf16 a[32:47], a[172:175], v[44:47], a[32:47]
ds_read_b64_tr_b16 a[202:203], v240 offset:51456
ds_read_b64_tr_b16 a[204:205], v240 offset:57600
ds_read_b64_tr_b16 a[206:207], v240 offset:59648
buffer_load_dwordx4 v26, s[8:11], s26 offen offset:1024 lds
v_accvgpr_read_b32 v208, a16
v_accvgpr_read_b32 v209, a17
v_accvgpr_read_b32 v210, a18
v_accvgpr_read_b32 v211, a19
s_waitcnt lgkmcnt(5)
v_mfma_f32_32x32x16_bf16 a[48:63], a[176:179], v[32:35], a[48:63]
ds_read_b64_tr_b16 a[208:209], v241 offset:33024
ds_read_b64_tr_b16 a[210:211], v241 offset:35072
v_cvt_pk_bf16_f32 v72, v208, v209
v_accvgpr_read_b32 v212, a20
v_accvgpr_read_b32 v213, a21
v_cvt_pk_bf16_f32 v73, v210, v211
v_accvgpr_read_b32 v214, a22
v_mfma_f32_32x32x16_bf16 a[48:63], a[180:183], v[36:39], a[48:63]
ds_read_b64_tr_b16 a[212:213], v241 offset:41216
ds_read_b64_tr_b16 a[214:215], v241 offset:43264
v_accvgpr_read_b32 v215, a23
v_cvt_pk_bf16_f32 v74, v212, v213
v_accvgpr_read_b32 v216, a24
v_accvgpr_read_b32 v217, a25
v_cvt_pk_bf16_f32 v75, v214, v215
v_accvgpr_read_b32 v218, a26
v_mfma_f32_32x32x16_bf16 a[48:63], a[184:187], v[40:43], a[48:63]
ds_read_b64_tr_b16 a[216:217], v241 offset:49408
ds_read_b64_tr_b16 a[218:219], v241 offset:51456
buffer_load_dwordx4 v27, s[8:11], s26 offen offset:2048 lds
v_accvgpr_read_b32 v219, a27
v_cvt_pk_bf16_f32 v76, v216, v217
v_accvgpr_read_b32 v220, a28
v_accvgpr_read_b32 v221, a29
v_cvt_pk_bf16_f32 v77, v218, v219
v_mfma_f32_32x32x16_bf16 a[48:63], a[188:191], v[44:47], a[48:63]
ds_read_b64_tr_b16 a[220:221], v241 offset:57600
ds_read_b64_tr_b16 a[222:223], v241 offset:59648
v_accvgpr_read_b32 v222, a30
v_accvgpr_read_b32 v223, a31
v_cvt_pk_bf16_f32 v78, v220, v221
v_cvt_pk_bf16_f32 v79, v222, v223
v_permlane16_swap_b32 v72, v76
v_mfma_f32_32x32x16_bf16 a[64:79], a[192:195], v[32:35], a[64:79]
ds_read_b64_tr_b16 a[224:225], v242 offset:33024
ds_read_b64_tr_b16 a[226:227], v242 offset:35072
v_permlane16_swap_b32 v73, v77
v_permlane16_swap_b32 v74, v78
v_permlane16_swap_b32 v75, v79
v_accvgpr_read_b32 v192, a32
v_accvgpr_read_b32 v193, a33
v_accvgpr_read_b32 v194, a34
s_waitcnt lgkmcnt(4)
v_mfma_f32_32x32x16_bf16 a[64:79], a[196:199], v[36:39], a[64:79]
ds_read_b64_tr_b16 a[228:229], v242 offset:41216
ds_read_b64_tr_b16 a[230:231], v242 offset:43264
ds_read_b64_tr_b16 a[232:233], v242 offset:49408
buffer_load_dwordx4 v28, s[8:11], s26 offen offset:3072 lds
v_accvgpr_read_b32 v195, a35
v_cvt_pk_bf16_f32 v80, v192, v193
v_accvgpr_read_b32 v196, a36
v_accvgpr_read_b32 v197, a37
v_mfma_f32_32x32x16_bf16 a[64:79], a[200:203], v[40:43], a[64:79]
ds_read_b64_tr_b16 a[234:235], v242 offset:51456
s_add_u32 s26, s26, 32768
ds_read_b64_tr_b16 a[236:237], v242 offset:57600
v_cvt_pk_bf16_f32 v81, v194, v195
v_accvgpr_read_b32 v198, a38
v_accvgpr_read_b32 v199, a39
v_cvt_pk_bf16_f32 v82, v196, v197
v_accvgpr_read_b32 v200, a40
v_accvgpr_read_b32 v201, a41
v_mfma_f32_32x32x16_bf16 a[64:79], a[204:207], v[44:47], a[64:79]
ds_read_b64_tr_b16 a[238:239], v242 offset:59648
ds_read_b64_tr_b16 a[240:241], v243 offset:33024
v_cvt_pk_bf16_f32 v83, v198, v199
v_accvgpr_read_b32 v202, a42
v_accvgpr_read_b32 v203, a43
v_cvt_pk_bf16_f32 v84, v200, v201
v_accvgpr_read_b32 v204, a44
v_accvgpr_read_b32 v205, a45
v_mfma_f32_32x32x16_bf16 a[80:95], a[208:211], v[32:35], a[80:95]
ds_read_b64_tr_b16 a[242:243], v243 offset:35072
ds_read_b64_tr_b16 a[244:245], v243 offset:41216
v_cvt_pk_bf16_f32 v85, v202, v203
v_accvgpr_read_b32 v206, a46
v_accvgpr_read_b32 v207, a47
v_cvt_pk_bf16_f32 v86, v204, v205
v_cvt_pk_bf16_f32 v87, v206, v207
v_permlane16_swap_b32 v80, v84
v_mfma_f32_32x32x16_bf16 a[80:95], a[212:215], v[36:39], a[80:95]
ds_read_b64_tr_b16 a[246:247], v243 offset:43264
ds_read_b64_tr_b16 a[248:249], v243 offset:49408
v_permlane16_swap_b32 v81, v85
v_permlane16_swap_b32 v82, v86
v_permlane16_swap_b32 v83, v87
v_accvgpr_read_b32 v208, a48
v_accvgpr_read_b32 v209, a49
v_mfma_f32_32x32x16_bf16 a[80:95], a[216:219], v[40:43], a[80:95]
ds_read_b64_tr_b16 a[250:251], v243 offset:51456
ds_read_b64_tr_b16 a[252:253], v243 offset:57600
v_accvgpr_read_b32 v210, a50
v_accvgpr_read_b32 v211, a51
v_cvt_pk_bf16_f32 v88, v208, v209
v_accvgpr_read_b32 v212, a52
v_accvgpr_read_b32 v213, a53
s_waitcnt lgkmcnt(4)
v_mfma_f32_32x32x16_bf16 a[80:95], a[220:223], v[44:47], a[80:95]
ds_read_b64_tr_b16 a[254:255], v243 offset:59648
v_cvt_pk_bf16_f32 v89, v210, v211
v_accvgpr_read_b32 v214, a54
v_accvgpr_read_b32 v215, a55
v_cvt_pk_bf16_f32 v90, v212, v213
v_accvgpr_read_b32 v216, a56
v_mfma_f32_32x32x16_bf16 a[96:111], a[224:227], v[32:35], a[96:111]
v_accvgpr_read_b32 v217, a57
v_cvt_pk_bf16_f32 v91, v214, v215
v_accvgpr_read_b32 v218, a58
v_accvgpr_read_b32 v219, a59
v_cvt_pk_bf16_f32 v92, v216, v217
v_accvgpr_read_b32 v220, a60
v_accvgpr_read_b32 v221, a61
v_mfma_f32_32x32x16_bf16 a[96:111], a[228:231], v[36:39], a[96:111]
v_cvt_pk_bf16_f32 v93, v218, v219
v_accvgpr_read_b32 v222, a62
v_accvgpr_read_b32 v223, a63
v_cvt_pk_bf16_f32 v94, v220, v221
v_cvt_pk_bf16_f32 v95, v222, v223
v_permlane16_swap_b32 v88, v92
v_mfma_f32_32x32x16_bf16 a[96:111], a[232:235], v[40:43], a[96:111]
s_waitcnt vmcnt(16) lgkmcnt(0)
s_barrier
ds_read_b128 a[128:131], v1 offset:0
ds_read_b128 a[132:135], v1 offset:8192
v_permlane16_swap_b32 v89, v93
v_permlane16_swap_b32 v90, v94
v_permlane16_swap_b32 v91, v95
v_mfma_f32_32x32x16_bf16 a[96:111], a[236:239], v[44:47], a[96:111]
ds_read_b128 a[136:139], v1 offset:16384
v_accvgpr_read_b32 v192, a64
v_accvgpr_read_b32 v193, a65
v_accvgpr_read_b32 v194, a66
v_accvgpr_read_b32 v195, a67
v_cvt_pk_bf16_f32 v96, v192, v193
v_accvgpr_read_b32 v196, a68
v_mfma_f32_32x32x16_bf16 a[112:127], a[240:243], v[32:35], a[112:127]
s_add_u32 m0, s24, 32768
ds_read_b128 a[140:143], v1 offset:24576
buffer_load_dwordx4 v13, s[4:7], s25 offen lds
v_accvgpr_read_b32 v197, a69
v_cvt_pk_bf16_f32 v97, v194, v195
v_accvgpr_read_b32 v198, a70
v_mfma_f32_32x32x16_bf16 a[112:127], a[244:247], v[36:39], a[112:127]
ds_read_b128 a[144:147], v2 offset:0
v_accvgpr_read_b32 v199, a71
v_cvt_pk_bf16_f32 v98, v196, v197
v_accvgpr_read_b32 v200, a72
v_accvgpr_read_b32 v201, a73
v_cvt_pk_bf16_f32 v99, v198, v199
v_accvgpr_read_b32 v202, a74
v_mfma_f32_32x32x16_bf16 a[112:127], a[248:251], v[40:43], a[112:127]
ds_read_b128 a[148:151], v2 offset:8192
v_accvgpr_read_b32 v203, a75
v_cvt_pk_bf16_f32 v100, v200, v201
v_accvgpr_read_b32 v204, a76
v_accvgpr_read_b32 v205, a77
v_cvt_pk_bf16_f32 v101, v202, v203
v_accvgpr_read_b32 v206, a78
v_mfma_f32_32x32x16_bf16 a[112:127], a[252:255], v[44:47], a[112:127]
ds_read_b128 a[152:155], v2 offset:16384
buffer_load_dwordx4 v14, s[4:7], s25 offen offset:1024 lds
v_accvgpr_read_b32 v207, a79
v_cvt_pk_bf16_f32 v102, v204, v205
v_cvt_pk_bf16_f32 v103, v206, v207
v_permlane16_swap_b32 v96, v100
v_permlane16_swap_b32 v97, v101
s_waitcnt lgkmcnt(2)
v_mfma_f32_16x16x32_bf16 v[128:131], a[128:131], v[64:67], 0
ds_read_b128 a[156:159], v2 offset:24576
v_permlane16_swap_b32 v98, v102
v_permlane16_swap_b32 v99, v103
v_mfma_f32_16x16x32_bf16 v[132:135], a[128:131], v[68:71], 0
v_accvgpr_read_b32 v208, a80
v_accvgpr_read_b32 v209, a81
v_accvgpr_read_b32 v210, a82
v_mfma_f32_16x16x32_bf16 v[136:139], a[132:135], v[64:67], 0
ds_read_b128 a[160:163], v3 offset:0
v_accvgpr_read_b32 v211, a83
v_cvt_pk_bf16_f32 v104, v208, v209
v_accvgpr_read_b32 v212, a84
v_mfma_f32_16x16x32_bf16 v[140:143], a[132:135], v[68:71], 0
v_accvgpr_read_b32 v213, a85
v_cvt_pk_bf16_f32 v105, v210, v211
v_accvgpr_read_b32 v214, a86
v_mfma_f32_16x16x32_bf16 v[144:147], a[136:139], v[64:67], 0
ds_read_b128 a[164:167], v3 offset:8192
v_accvgpr_read_b32 v215, a87
v_cvt_pk_bf16_f32 v106, v212, v213
v_accvgpr_read_b32 v216, a88
v_mfma_f32_16x16x32_bf16 v[148:151], a[136:139], v[68:71], 0
buffer_load_dwordx4 v15, s[4:7], s25 offen offset:2048 lds
v_accvgpr_read_b32 v217, a89
v_cvt_pk_bf16_f32 v107, v214, v215
v_mfma_f32_16x16x32_bf16 v[152:155], a[140:143], v[64:67], 0
ds_read_b128 a[168:171], v3 offset:16384
v_accvgpr_read_b32 v218, a90
v_accvgpr_read_b32 v219, a91
v_mfma_f32_16x16x32_bf16 v[156:159], a[140:143], v[68:71], 0
v_cvt_pk_bf16_f32 v108, v216, v217
v_accvgpr_read_b32 v220, a92
v_accvgpr_read_b32 v221, a93
v_cvt_pk_bf16_f32 v109, v218, v219
v_mfma_f32_16x16x32_bf16 v[128:131], a[144:147], v[72:75], v[128:131]
ds_read_b128 a[172:175], v3 offset:24576
v_accvgpr_read_b32 v222, a94
v_accvgpr_read_b32 v223, a95
v_mfma_f32_16x16x32_bf16 v[132:135], a[144:147], v[76:79], v[132:135]
v_cvt_pk_bf16_f32 v110, v220, v221
v_cvt_pk_bf16_f32 v111, v222, v223
v_permlane16_swap_b32 v104, v108
v_permlane16_swap_b32 v105, v109
s_waitcnt lgkmcnt(2)
v_mfma_f32_16x16x32_bf16 v[136:139], a[148:151], v[72:75], v[136:139]
ds_read_b128 a[176:179], v4 offset:0
v_permlane16_swap_b32 v106, v110
v_permlane16_swap_b32 v107, v111
v_mfma_f32_16x16x32_bf16 v[140:143], a[148:151], v[76:79], v[140:143]
ds_read_b128 a[180:183], v4 offset:8192
buffer_load_dwordx4 v16, s[4:7], s25 offen offset:3072 lds
v_accvgpr_read_b32 v192, a96
v_mfma_f32_16x16x32_bf16 v[144:147], a[152:155], v[72:75], v[144:147]
v_accvgpr_read_b32 v193, a97
v_accvgpr_read_b32 v194, a98
v_accvgpr_read_b32 v195, a99
v_cvt_pk_bf16_f32 v112, v192, v193
v_mfma_f32_16x16x32_bf16 v[148:151], a[152:155], v[76:79], v[148:151]
ds_read_b128 a[184:187], v4 offset:16384
v_accvgpr_read_b32 v196, a100
v_accvgpr_read_b32 v197, a101
v_mfma_f32_16x16x32_bf16 v[152:155], a[156:159], v[72:75], v[152:155]
v_cvt_pk_bf16_f32 v113, v194, v195
v_accvgpr_read_b32 v198, a102
v_accvgpr_read_b32 v199, a103
v_mfma_f32_16x16x32_bf16 v[156:159], a[156:159], v[76:79], v[156:159]
ds_read_b128 a[188:191], v4 offset:24576
v_cvt_pk_bf16_f32 v114, v196, v197
v_accvgpr_read_b32 v200, a104
v_accvgpr_read_b32 v201, a105
v_mfma_f32_16x16x32_bf16 v[128:131], a[160:163], v[80:83], v[128:131]
s_add_u32 m0, s24, 36864
v_cvt_pk_bf16_f32 v115, v198, v199
v_accvgpr_read_b32 v202, a106
v_mfma_f32_16x16x32_bf16 v[132:135], a[160:163], v[84:87], v[132:135]
ds_read_b128 a[192:195], v1 offset:256
buffer_load_dwordx4 v17, s[4:7], s25 offen lds
v_accvgpr_read_b32 v203, a107
v_cvt_pk_bf16_f32 v116, v200, v201
v_mfma_f32_16x16x32_bf16 v[136:139], a[164:167], v[80:83], v[136:139]
v_accvgpr_read_b32 v204, a108
v_accvgpr_read_b32 v205, a109
v_cvt_pk_bf16_f32 v117, v202, v203
v_mfma_f32_16x16x32_bf16 v[140:143], a[164:167], v[84:87], v[140:143]
ds_read_b128 a[196:199], v2 offset:256
v_accvgpr_read_b32 v206, a110
v_accvgpr_read_b32 v207, a111
s_waitcnt lgkmcnt(3)
v_mfma_f32_16x16x32_bf16 v[144:147], a[168:171], v[80:83], v[144:147]
v_cvt_pk_bf16_f32 v118, v204, v205
v_cvt_pk_bf16_f32 v119, v206, v207
v_permlane16_swap_b32 v112, v116
v_permlane16_swap_b32 v113, v117
v_mfma_f32_16x16x32_bf16 v[148:151], a[168:171], v[84:87], v[148:151]
ds_read_b128 a[200:203], v3 offset:256
v_permlane16_swap_b32 v114, v118
v_permlane16_swap_b32 v115, v119
v_mfma_f32_16x16x32_bf16 v[152:155], a[172:175], v[80:83], v[152:155]
v_accvgpr_read_b32 v208, a112
v_accvgpr_read_b32 v209, a113
v_accvgpr_read_b32 v210, a114
v_mfma_f32_16x16x32_bf16 v[156:159], a[172:175], v[84:87], v[156:159]
ds_read_b128 a[204:207], v4 offset:256
buffer_load_dwordx4 v18, s[4:7], s25 offen offset:1024 lds
v_accvgpr_read_b32 v211, a115
v_cvt_pk_bf16_f32 v120, v208, v209
v_mfma_f32_16x16x32_bf16 v[128:131], a[176:179], v[88:91], v[128:131]
ds_read_b128 a[208:211], v1 offset:8448
v_accvgpr_read_b32 v212, a116
v_accvgpr_read_b32 v213, a117
v_mfma_f32_16x16x32_bf16 v[132:135], a[176:179], v[92:95], v[132:135]
v_cvt_pk_bf16_f32 v121, v210, v211
v_accvgpr_read_b32 v214, a118
v_accvgpr_read_b32 v215, a119
v_mfma_f32_16x16x32_bf16 v[136:139], a[180:183], v[88:91], v[136:139]
ds_read_b128 a[212:215], v2 offset:8448
v_cvt_pk_bf16_f32 v122, v212, v213
v_accvgpr_read_b32 v216, a120
v_mfma_f32_16x16x32_bf16 v[140:143], a[180:183], v[92:95], v[140:143]
v_accvgpr_read_b32 v217, a121
v_cvt_pk_bf16_f32 v123, v214, v215
v_accvgpr_read_b32 v218, a122
v_accvgpr_read_b32 v219, a123
v_mfma_f32_16x16x32_bf16 v[144:147], a[184:187], v[88:91], v[144:147]
ds_read_b128 a[216:219], v3 offset:8448
v_cvt_pk_bf16_f32 v124, v216, v217
v_accvgpr_read_b32 v220, a124
v_mfma_f32_16x16x32_bf16 v[148:151], a[184:187], v[92:95], v[148:151]
buffer_load_dwordx4 v19, s[4:7], s25 offen offset:2048 lds
v_accvgpr_read_b32 v221, a125
v_cvt_pk_bf16_f32 v125, v218, v219
s_waitcnt lgkmcnt(2)
v_mfma_f32_16x16x32_bf16 v[152:155], a[188:191], v[88:91], v[152:155]
ds_read_b128 a[220:223], v4 offset:8448
v_accvgpr_read_b32 v222, a126
v_accvgpr_read_b32 v223, a127
v_mfma_f32_16x16x32_bf16 v[156:159], a[188:191], v[92:95], v[156:159]
v_cvt_pk_bf16_f32 v126, v220, v221
v_cvt_pk_bf16_f32 v127, v222, v223
v_permlane16_swap_b32 v120, v124
v_permlane16_swap_b32 v121, v125
v_mfma_f32_16x16x32_bf16 v[128:131], a[192:195], v[96:99], v[128:131]
ds_read_b128 a[224:227], v1 offset:16640
v_permlane16_swap_b32 v122, v126
v_permlane16_swap_b32 v123, v127
v_mfma_f32_16x16x32_bf16 v[128:131], a[196:199], v[104:107], v[128:131]
v_mfma_f32_16x16x32_bf16 v[128:131], a[200:203], v[112:115], v[128:131]
ds_read_b128 a[228:231], v2 offset:16640
v_mfma_f32_16x16x32_bf16 v[128:131], a[204:207], v[120:123], v[128:131]
ds_read_b128 a[232:235], v3 offset:16640
buffer_load_dwordx4 v20, s[4:7], s25 offen offset:3072 lds
v_mfma_f32_16x16x32_bf16 v[132:135], a[192:195], v[100:103], v[132:135]
s_add_u32 s25, s25, 32768
v_lshlrev_b32 v63, 26, v0
v_mfma_f32_16x16x32_bf16 v[132:135], a[196:199], v[108:111], v[132:135]
ds_read_b128 a[236:239], v4 offset:16640
v_mfma_f32_16x16x32_bf16 v[132:135], a[200:203], v[116:119], v[132:135]
v_mov_b32 v242, 0
v_mov_b32 v243, 1
v_mfma_f32_16x16x32_bf16 v[132:135], a[204:207], v[124:127], v[132:135]
ds_read_b128 a[240:243], v1 offset:24832
v_min_u32 v63, 1, v63
v_mfma_f32_16x16x32_bf16 v[136:139], a[208:211], v[96:99], v[136:139]
v_lshlrev_b32 v63, 30, v63
s_waitcnt lgkmcnt(2)
v_mfma_f32_16x16x32_bf16 v[136:139], a[212:215], v[104:107], v[136:139]
ds_read_b128 a[244:247], v2 offset:24832
v_mov_b32 v29, 0
v_mfma_f32_16x16x32_bf16 v[136:139], a[216:219], v[112:115], v[136:139]
v_mov_b32 v30, 0
v_and_b32 v241, 63, v0
v_mfma_f32_16x16x32_bf16 v[136:139], a[220:223], v[120:123], v[136:139]
ds_read_b128 a[248:251], v3 offset:24832
v_max3_f32 v33, v128, v129, v130
v_max_f32 v33, v33, v131
v_mfma_f32_16x16x32_bf16 v[140:143], a[208:211], v[100:103], v[140:143]
v_min_u32 v241, 8, v241
v_lshlrev_b32 v241, 17, v241
v_max3_f32 v34, v132, v133, v134
v_mfma_f32_16x16x32_bf16 v[140:143], a[212:215], v[108:111], v[140:143]
ds_read_b128 a[252:255], v4 offset:24832
v_max_f32 v34, v34, v135
v_mov_b32 v35, v33
v_mfma_f32_16x16x32_bf16 v[140:143], a[216:219], v[116:119], v[140:143]
v_mov_b32 v36, v34
s_nop 1
v_mfma_f32_16x16x32_bf16 v[140:143], a[220:223], v[124:127], v[140:143]
v_subrev_u32 v1, 98304, v1
v_permlane32_swap_b32 v33, v35
v_permlane32_swap_b32 v34, v36
v_mfma_f32_16x16x32_bf16 v[144:147], a[224:227], v[96:99], v[144:147]
v_subrev_u32 v2, 98304, v2
v_max_f32 v33, v33, v35
v_max_f32 v34, v34, v36
v_mfma_f32_16x16x32_bf16 v[144:147], a[228:231], v[104:107], v[144:147]
v_mov_b32 v35, v33
v_mov_b32 v36, v34
v_mfma_f32_16x16x32_bf16 v[144:147], a[232:235], v[112:115], v[144:147]
v_subrev_u32 v3, 98304, v3
s_nop 1
s_waitcnt lgkmcnt(0)
v_mfma_f32_16x16x32_bf16 v[144:147], a[236:239], v[120:123], v[144:147]
v_subrev_u32 v4, 98304, v4
v_permlane16_swap_b32 v33, v35
v_permlane16_swap_b32 v34, v36
v_mfma_f32_16x16x32_bf16 v[148:151], a[224:227], v[100:103], v[148:151]
s_waitcnt vmcnt(16)
s_barrier
ds_read_b128 a[128:131], v1 offset:0
v_mfma_f32_16x16x32_bf16 v[148:151], a[228:231], v[108:111], v[148:151]
ds_read_b128 a[132:135], v2 offset:0
v_max_f32 v33, v33, v35
v_max_f32 v34, v34, v36
v_mfma_f32_16x16x32_bf16 v[148:151], a[232:235], v[116:119], v[148:151]
v_sub_f32 v48, 0, v33
v_sub_f32 v49, 0, v33
v_sub_f32 v50, 0, v33
v_mfma_f32_16x16x32_bf16 v[148:151], a[236:239], v[124:127], v[148:151]
ds_read_b128 a[136:139], v3 offset:0
v_sub_f32 v51, 0, v33
v_sub_f32 v52, 0, v34
v_mfma_f32_16x16x32_bf16 v[152:155], a[240:243], v[96:99], v[152:155]
s_add_u32 m0, s24, 98304
v_sub_f32 v53, 0, v34
v_sub_f32 v54, 0, v34
v_mfma_f32_16x16x32_bf16 v[152:155], a[244:247], v[104:107], v[152:155]
ds_read_b128 a[140:143], v4 offset:0
buffer_load_dwordx4 v21, s[8:11], s26 offen lds
v_sub_f32 v55, 0, v34
v_mfma_f32_16x16x32_bf16 v[152:155], a[248:251], v[112:115], v[152:155]
ds_read_b128 a[144:147], v1 offset:256
v_mfma_f32_16x16x32_bf16 v[152:155], a[252:255], v[120:123], v[152:155]
ds_read_b128 a[148:151], v2 offset:256
v_add_f32 v128, v48, v128
v_add_f32 v129, v48, v129
v_mfma_f32_16x16x32_bf16 v[156:159], a[240:243], v[100:103], v[156:159]
ds_read_b128 a[152:155], v3 offset:256
v_exp_f32 v40, v128
v_mfma_f32_16x16x32_bf16 v[156:159], a[244:247], v[108:111], v[156:159]
ds_read_b128 a[156:159], v4 offset:256
v_exp_f32 v41, v129
v_mfma_f32_16x16x32_bf16 v[156:159], a[248:251], v[116:119], v[156:159]
v_add_f32 v130, v48, v130
v_add_f32 v131, v48, v131
v_mfma_f32_16x16x32_bf16 v[156:159], a[252:255], v[124:127], v[156:159]
buffer_load_dwordx4 v22, s[8:11], s26 offen offset:1024 lds
v_exp_f32 v42, v130
v_add_f32 v31, v40, v41
s_waitcnt lgkmcnt(3)
v_mfma_f32_16x16x32_bf16 v[160:163], a[128:131], v[64:67], v[48:51]
v_exp_f32 v43, v131
v_mfma_f32_16x16x32_bf16 v[160:163], a[132:135], v[72:75], v[160:163]
v_cvt_pk_bf16_f32 v192, v40, v41
v_add_f32 v132, v52, v132
v_add_f32 v133, v52, v133
v_mfma_f32_16x16x32_bf16 v[160:163], a[136:139], v[80:83], v[160:163]
ds_read_b128 a[160:163], v1 offset:8192
buffer_store_dword v242, v241, s[20:23], s63 offen sc1
v_exp_f32 v44, v132
v_mfma_f32_16x16x32_bf16 v[160:163], a[140:143], v[88:91], v[160:163]
v_add_f32 v31, v42, v31
v_exp_f32 v45, v133
v_mfma_f32_16x16x32_bf16 v[160:163], a[144:147], v[96:99], v[160:163]
ds_read_b128 a[164:167], v2 offset:8192
v_cvt_pk_bf16_f32 v193, v42, v43
s_waitcnt lgkmcnt(2)
v_mfma_f32_16x16x32_bf16 v[160:163], a[148:151], v[104:107], v[160:163]
buffer_load_dwordx4 v23, s[8:11], s26 offen offset:2048 lds
v_add_f32 v31, v43, v31
v_add_f32 v134, v52, v134
v_mfma_f32_16x16x32_bf16 v[160:163], a[152:155], v[112:115], v[160:163]
ds_read_b128 a[168:171], v3 offset:8192
v_add_f32 v135, v52, v135
v_mfma_f32_16x16x32_bf16 v[160:163], a[156:159], v[120:123], v[160:163]
v_exp_f32 v46, v134
v_add_f32 v32, v44, v45
v_mfma_f32_16x16x32_bf16 v[164:167], a[128:131], v[68:71], v[52:55]
ds_read_b128 a[172:175], v4 offset:8192
v_exp_f32 v47, v135
v_cvt_pk_bf16_f32 v200, v44, v45
v_mfma_f32_16x16x32_bf16 v[164:167], a[132:135], v[76:79], v[164:167]
v_add_f32 v136, v48, v136
v_add_f32 v137, v48, v137
v_mfma_f32_16x16x32_bf16 v[164:167], a[136:139], v[84:87], v[164:167]
ds_read_b128 a[176:179], v1 offset:8448
v_exp_f32 v40, v136
v_add_f32 v32, v46, v32
v_mfma_f32_16x16x32_bf16 v[164:167], a[140:143], v[92:95], v[164:167]
ds_read_b128 a[180:183], v2 offset:8448
buffer_load_dwordx4 v24, s[8:11], s26 offen offset:3072 lds
v_mfma_f32_16x16x32_bf16 v[164:167], a[144:147], v[100:103], v[164:167]
ds_read_b128 a[184:187], v3 offset:8448
v_exp_f32 v41, v137
v_mfma_f32_16x16x32_bf16 v[164:167], a[148:151], v[108:111], v[164:167]
ds_read_b128 a[188:191], v4 offset:8448
v_cvt_pk_bf16_f32 v201, v46, v47
v_add_f32 v32, v47, v32
v_mfma_f32_16x16x32_bf16 v[164:167], a[152:155], v[116:119], v[164:167]
v_add_f32 v138, v48, v138
v_add_f32 v139, v48, v139
v_exp_f32 v42, v138
v_mfma_f32_16x16x32_bf16 v[164:167], a[156:159], v[124:127], v[164:167]
v_add_f32 v31, v40, v31
v_exp_f32 v43, v139
s_waitcnt lgkmcnt(3)
v_mfma_f32_16x16x32_bf16 v[168:171], a[160:163], v[64:67], v[48:51]
s_add_u32 m0, s24, 102400
v_cvt_pk_bf16_f32 v194, v40, v41
v_mfma_f32_16x16x32_bf16 v[168:171], a[164:167], v[72:75], v[168:171]
ds_read_b128 a[192:195], v1 offset:16384
buffer_load_dwordx4 v25, s[8:11], s26 offen lds
v_add_f32 v31, v41, v31
v_mfma_f32_16x16x32_bf16 v[168:171], a[168:171], v[80:83], v[168:171]
v_add_f32 v140, v52, v140
v_add_f32 v141, v52, v141
v_mfma_f32_16x16x32_bf16 v[168:171], a[172:175], v[88:91], v[168:171]
ds_read_b128 a[196:199], v2 offset:16384
v_exp_f32 v44, v140
v_add_f32 v31, v42, v31
v_mfma_f32_16x16x32_bf16 v[168:171], a[176:179], v[96:99], v[168:171]
v_exp_f32 v45, v141
v_cvt_pk_bf16_f32 v195, v42, v43
s_waitcnt lgkmcnt(2)
v_mfma_f32_16x16x32_bf16 v[168:171], a[180:183], v[104:107], v[168:171]
ds_read_b128 a[200:203], v3 offset:16384
v_add_f32 v31, v43, v31
v_add_f32 v142, v52, v142
v_mfma_f32_16x16x32_bf16 v[168:171], a[184:187], v[112:115], v[168:171]
v_add_f32 v143, v52, v143
v_exp_f32 v46, v142
v_mfma_f32_16x16x32_bf16 v[168:171], a[188:191], v[120:123], v[168:171]
ds_read_b128 a[204:207], v4 offset:16384
buffer_load_dwordx4 v26, s[8:11], s26 offen offset:1024 lds
v_mfma_f32_16x16x32_bf16 v[172:175], a[160:163], v[68:71], v[52:55]
ds_read_b128 a[208:211], v1 offset:16640
v_add_f32 v32, v44, v32
v_exp_f32 v47, v143
v_mfma_f32_16x16x32_bf16 v[172:175], a[164:167], v[76:79], v[172:175]
v_cvt_pk_bf16_f32 v202, v44, v45
v_add_f32 v32, v45, v32
v_mfma_f32_16x16x32_bf16 v[172:175], a[168:171], v[84:87], v[172:175]
ds_read_b128 a[212:215], v2 offset:16640
v_add_f32 v144, v48, v144
v_add_f32 v145, v48, v145
v_mfma_f32_16x16x32_bf16 v[172:175], a[172:175], v[92:95], v[172:175]
v_exp_f32 v40, v144
v_add_f32 v32, v46, v32
v_mfma_f32_16x16x32_bf16 v[172:175], a[176:179], v[100:103], v[172:175]
ds_read_b128 a[216:219], v3 offset:16640
v_exp_f32 v41, v145
v_mfma_f32_16x16x32_bf16 v[172:175], a[180:183], v[108:111], v[172:175]
ds_read_b128 a[220:223], v4 offset:16640
buffer_load_dwordx4 v27, s[8:11], s26 offen offset:2048 lds
v_cvt_pk_bf16_f32 v203, v46, v47
v_mfma_f32_16x16x32_bf16 v[172:175], a[184:187], v[116:119], v[172:175]
v_add_f32 v32, v47, v32
v_add_f32 v146, v48, v146
v_add_f32 v147, v48, v147
v_mfma_f32_16x16x32_bf16 v[172:175], a[188:191], v[124:127], v[172:175]
v_exp_f32 v42, v146
v_add_f32 v31, v40, v31
s_waitcnt lgkmcnt(2)
v_mfma_f32_16x16x32_bf16 v[176:179], a[192:195], v[64:67], v[48:51]
ds_read_b128 a[224:227], v1 offset:24576
v_exp_f32 v43, v147
v_mfma_f32_16x16x32_bf16 v[176:179], a[196:199], v[72:75], v[176:179]
v_cvt_pk_bf16_f32 v196, v40, v41
v_add_f32 v31, v41, v31
v_mfma_f32_16x16x32_bf16 v[176:179], a[200:203], v[80:83], v[176:179]
ds_read_b128 a[228:231], v2 offset:24576
v_add_f32 v148, v52, v148
v_add_f32 v149, v52, v149
v_mfma_f32_16x16x32_bf16 v[176:179], a[204:207], v[88:91], v[176:179]
ds_read_b128 a[232:235], v3 offset:24576
buffer_load_dwordx4 v28, s[8:11], s26 offen offset:3072 lds
v_exp_f32 v44, v148
v_mfma_f32_16x16x32_bf16 v[176:179], a[208:211], v[96:99], v[176:179]
s_add_u32 s26, s26, 32768
v_add_f32 v31, v42, v31
v_mfma_f32_16x16x32_bf16 v[176:179], a[212:215], v[104:107], v[176:179]
ds_read_b128 a[236:239], v4 offset:24576
v_exp_f32 v45, v149
s_waitcnt lgkmcnt(3)
v_mfma_f32_16x16x32_bf16 v[176:179], a[216:219], v[112:115], v[176:179]
v_cvt_pk_bf16_f32 v197, v42, v43
v_add_f32 v31, v43, v31
v_add_f32 v150, v52, v150
v_mfma_f32_16x16x32_bf16 v[176:179], a[220:223], v[120:123], v[176:179]
ds_read_b128 a[240:243], v1 offset:24832
v_add_f32 v151, v52, v151
v_mfma_f32_16x16x32_bf16 v[180:183], a[192:195], v[68:71], v[52:55]
v_exp_f32 v46, v150
v_add_f32 v32, v44, v32
v_mfma_f32_16x16x32_bf16 v[180:183], a[196:199], v[76:79], v[180:183]
ds_read_b128 a[244:247], v2 offset:24832
v_exp_f32 v47, v151
v_cvt_pk_bf16_f32 v204, v44, v45
v_mfma_f32_16x16x32_bf16 v[180:183], a[200:203], v[84:87], v[180:183]
v_add_f32 v32, v45, v32
v_add_f32 v152, v48, v152
v_add_f32 v153, v48, v153
v_mfma_f32_16x16x32_bf16 v[180:183], a[204:207], v[92:95], v[180:183]
ds_read_b128 a[248:251], v3 offset:24832
v_exp_f32 v40, v152
v_mfma_f32_16x16x32_bf16 v[180:183], a[208:211], v[100:103], v[180:183]
v_add_f32 v32, v46, v32
v_exp_f32 v41, v153
v_mfma_f32_16x16x32_bf16 v[180:183], a[212:215], v[108:111], v[180:183]
ds_read_b128 a[252:255], v4 offset:24832
v_cvt_pk_bf16_f32 v205, v46, v47
v_mfma_f32_16x16x32_bf16 v[180:183], a[216:219], v[116:119], v[180:183]
v_add_f32 v32, v47, v32
v_add_f32 v154, v48, v154
v_add_f32 v155, v48, v155
v_mfma_f32_16x16x32_bf16 v[180:183], a[220:223], v[124:127], v[180:183]
v_exp_f32 v42, v154
v_add_f32 v31, v40, v31
v_mfma_f32_16x16x32_bf16 v[184:187], a[224:227], v[64:67], v[48:51]
v_exp_f32 v43, v155
v_cvt_pk_bf16_f32 v198, v40, v41
s_waitcnt lgkmcnt(1)
v_mfma_f32_16x16x32_bf16 v[184:187], a[228:231], v[72:75], v[184:187]
v_add_f32 v31, v41, v31
v_add_f32 v156, v52, v156
v_add_f32 v157, v52, v157
v_mfma_f32_16x16x32_bf16 v[184:187], a[232:235], v[80:83], v[184:187]
v_exp_f32 v44, v156
v_add_f32 v31, v42, v31
v_mfma_f32_16x16x32_bf16 v[184:187], a[236:239], v[88:91], v[184:187]
v_exp_f32 v45, v157
v_cvt_pk_bf16_f32 v199, v42, v43
v_mfma_f32_16x16x32_bf16 v[184:187], a[240:243], v[96:99], v[184:187]
s_waitcnt vmcnt(17) lgkmcnt(0)
s_barrier
ds_read_b64_tr_b16 a[128:129], v5 offset:0
ds_read_b64_tr_b16 a[130:131], v5 offset:8192
v_mfma_f32_16x16x32_bf16 v[184:187], a[244:247], v[104:107], v[184:187]
ds_read_b64_tr_b16 a[132:133], v5 offset:16384
v_add_f32 v31, v43, v31
v_add_f32 v158, v52, v158
v_mfma_f32_16x16x32_bf16 v[184:187], a[248:251], v[112:115], v[184:187]
ds_read_b64_tr_b16 a[134:135], v5 offset:24576
v_add_f32 v159, v52, v159
v_mfma_f32_16x16x32_bf16 v[184:187], a[252:255], v[120:123], v[184:187]
ds_read_b64_tr_b16 a[136:137], v6 offset:0
v_exp_f32 v46, v158
v_add_f32 v32, v44, v32
v_mfma_f32_16x16x32_bf16 v[188:191], a[224:227], v[68:71], v[52:55]
ds_read_b64_tr_b16 a[138:139], v6 offset:8192
s_add_u32 m0, s24, 0
v_mfma_f32_16x16x32_bf16 v[188:191], a[228:231], v[76:79], v[188:191]
ds_read_b64_tr_b16 a[140:141], v6 offset:16384
buffer_load_dwordx4 v13, s[4:7], s25 offen lds
v_exp_f32 v47, v159
v_mfma_f32_16x16x32_bf16 v[188:191], a[232:235], v[84:87], v[188:191]
ds_read_b64_tr_b16 a[142:143], v6 offset:24576
v_cvt_pk_bf16_f32 v206, v44, v45
v_mfma_f32_16x16x32_bf16 v[188:191], a[236:239], v[92:95], v[188:191]
ds_read_b64_tr_b16 a[144:145], v7 offset:0
v_add_f32 v32, v45, v32
v_add_f32 v32, v46, v32
v_mfma_f32_16x16x32_bf16 v[188:191], a[240:243], v[100:103], v[188:191]
ds_read_b64_tr_b16 a[146:147], v7 offset:8192
v_cvt_pk_bf16_f32 v207, v46, v47
v_add_f32 v32, v47, v32
v_mfma_f32_16x16x32_bf16 v[188:191], a[244:247], v[108:111], v[188:191]
ds_read_b64_tr_b16 a[148:149], v7 offset:16384
v_max_f32 v33, v31, v32
v_cmp_nge_f32 vcc, s28, v33
v_mfma_f32_16x16x32_bf16 v[188:191], a[248:251], v[116:119], v[188:191]
ds_read_b64_tr_b16 a[150:151], v7 offset:24576
v_mfma_f32_16x16x32_bf16 v[188:191], a[252:255], v[124:127], v[188:191]
ds_read_b64_tr_b16 a[152:153], v8 offset:0
ds_read_b64_tr_b16 a[154:155], v8 offset:8192
buffer_load_dwordx4 v14, s[4:7], s25 offen offset:1024 lds
s_cbranch_vccnz K_STUB1
K_BACK1:
s_waitcnt lgkmcnt(6)
v_mfma_f32_16x16x32_bf16 a[0:3], a[128:131], v[192:195], 0
ds_read_b64_tr_b16 a[156:157], v8 offset:16384
v_add_f32 v29, v29, v31
v_add_f32 v30, v30, v32
v_mfma_f32_16x16x32_bf16 a[0:3], a[132:135], v[196:199], a[0:3]
ds_read_b64_tr_b16 a[158:159], v8 offset:24576
v_exp_f32 v40, v160
v_mfma_f32_16x16x32_bf16 a[4:7], a[128:131], v[200:203], 0
ds_read_b64_tr_b16 a[160:161], v9 offset:0
v_exp_f32 v41, v161
v_mfma_f32_16x16x32_bf16 a[4:7], a[132:135], v[204:207], a[4:7]
ds_read_b64_tr_b16 a[162:163], v9 offset:8192
v_mfma_f32_16x16x32_bf16 a[8:11], a[136:139], v[192:195], 0
ds_read_b64_tr_b16 a[164:165], v9 offset:16384
v_exp_f32 v42, v162
v_mfma_f32_16x16x32_bf16 a[8:11], a[140:143], v[196:199], a[8:11]
ds_read_b64_tr_b16 a[166:167], v9 offset:24576
buffer_load_dwordx4 v15, s[4:7], s25 offen offset:2048 lds
v_add_f32 v31, v40, v41
v_mfma_f32_16x16x32_bf16 a[12:15], a[136:139], v[200:203], 0
ds_read_b64_tr_b16 a[168:169], v10 offset:0
v_exp_f32 v43, v163
v_mfma_f32_16x16x32_bf16 a[12:15], a[140:143], v[204:207], a[12:15]
ds_read_b64_tr_b16 a[170:171], v10 offset:8192
v_cvt_pk_bf16_f32 v208, v40, v41
s_waitcnt lgkmcnt(5)
v_mfma_f32_16x16x32_bf16 a[16:19], a[144:147], v[192:195], 0
ds_read_b64_tr_b16 a[172:173], v10 offset:16384
v_exp_f32 v44, v164
v_mfma_f32_16x16x32_bf16 a[16:19], a[148:151], v[196:199], a[16:19]
ds_read_b64_tr_b16 a[174:175], v10 offset:24576
v_add_f32 v31, v42, v31
v_mfma_f32_16x16x32_bf16 a[20:23], a[144:147], v[200:203], 0
ds_read_b64_tr_b16 a[176:177], v11 offset:0
v_exp_f32 v45, v165
v_mfma_f32_16x16x32_bf16 a[20:23], a[148:151], v[204:207], a[20:23]
ds_read_b64_tr_b16 a[178:179], v11 offset:8192
ds_read_b64_tr_b16 a[180:181], v11 offset:16384
buffer_load_dwordx4 v16, s[4:7], s25 offen offset:3072 lds
v_mfma_f32_16x16x32_bf16 a[24:27], a[152:155], v[192:195], 0
ds_read_b64_tr_b16 a[182:183], v11 offset:24576
v_and_b32 v248, 63, v0
v_mfma_f32_16x16x32_bf16 a[24:27], a[156:159], v[196:199], a[24:27]
ds_read_b64_tr_b16 a[184:185], v12 offset:0
s_and_b32 s59, s58, 7
v_cvt_pk_bf16_f32 v209, v42, v43
v_mfma_f32_16x16x32_bf16 a[28:31], a[152:155], v[200:203], 0
ds_read_b64_tr_b16 a[186:187], v12 offset:8192
s_lshl2_add_u32 s60, s59, s56
v_mfma_f32_16x16x32_bf16 a[28:31], a[156:159], v[204:207], a[28:31]
ds_read_b64_tr_b16 a[188:189], v12 offset:16384
s_mul_i32 s60, s60, 3584
v_add_f32 v31, v43, v31
s_waitcnt lgkmcnt(6)
v_mfma_f32_16x16x32_bf16 a[32:35], a[160:163], v[192:195], 0
ds_read_b64_tr_b16 a[190:191], v12 offset:24576
s_add_u32 m0, s24, 4096
s_sub_u32 s60, s60, 1261568
v_mfma_f32_16x16x32_bf16 a[32:35], a[164:167], v[196:199], a[32:35]
ds_read_b64_tr_b16 a[192:193], v5 offset:256
buffer_load_dwordx4 v17, s[4:7], s25 offen lds
v_lshl_add_u32 v244, v248, 7, s60
v_mfma_f32_16x16x32_bf16 a[36:39], a[160:163], v[200:203], 0
ds_read_b64_tr_b16 a[194:195], v5 offset:8448
v_sub_u32 v249, 27, v248
v_mfma_f32_16x16x32_bf16 a[36:39], a[164:167], v[204:207], a[36:39]
ds_read_b64_tr_b16 a[196:197], v5 offset:16640
v_and_b32 v249, 1073741824, v249
v_mfma_f32_16x16x32_bf16 a[40:43], a[168:171], v[192:195], 0
ds_read_b64_tr_b16 a[198:199], v5 offset:24832
v_add_u32 v244, v244, v249
v_exp_f32 v46, v166
v_mfma_f32_16x16x32_bf16 a[40:43], a[172:175], v[196:199], a[40:43]
ds_read_b64_tr_b16 a[200:201], v6 offset:256
s_and_b32 s60, s56, 1
v_mfma_f32_16x16x32_bf16 a[44:47], a[168:171], v[200:203], 0
ds_read_b64_tr_b16 a[202:203], v6 offset:8448
s_lshl1_add_u32 s60, s59, s60
v_add_f32 v32, v44, v45
v_mfma_f32_16x16x32_bf16 a[44:47], a[172:175], v[204:207], a[44:47]
ds_read_b64_tr_b16 a[204:205], v6 offset:16640
ds_read_b64_tr_b16 a[206:207], v6 offset:24832
buffer_load_dwordx4 v18, s[4:7], s25 offen offset:1024 lds
s_mul_i32 s60, s60, 50176
s_waitcnt lgkmcnt(6)
v_mfma_f32_16x16x32_bf16 a[48:51], a[176:179], v[192:195], 0
ds_read_b64_tr_b16 a[208:209], v7 offset:256
s_sub_u32 s60, s60, 8830976
v_mfma_f32_16x16x32_bf16 a[48:51], a[180:183], v[196:199], a[48:51]
ds_read_b64_tr_b16 a[210:211], v7 offset:8448
v_lshrrev_b32 v249, 2, v248
v_mfma_f32_16x16x32_bf16 a[52:55], a[176:179], v[200:203], 0
ds_read_b64_tr_b16 a[212:213], v7 offset:16640
v_mul_u32_u24 v249, 3584, v249
v_exp_f32 v47, v167
v_mfma_f32_16x16x32_bf16 a[52:55], a[180:183], v[204:207], a[52:55]
ds_read_b64_tr_b16 a[214:215], v7 offset:24832
v_and_b32 v250, 3, v248
v_mfma_f32_16x16x32_bf16 a[56:59], a[184:187], v[192:195], 0
ds_read_b64_tr_b16 a[216:217], v8 offset:256
v_mul_u32_u24 v250, 72, v250
v_mfma_f32_16x16x32_bf16 a[56:59], a[188:191], v[196:199], a[56:59]
ds_read_b64_tr_b16 a[218:219], v8 offset:8448
buffer_load_dwordx4 v19, s[4:7], s25 offen offset:2048 lds
v_add3_u32 v245, v249, v250, s60
v_mfma_f32_16x16x32_bf16 a[60:63], a[184:187], v[200:203], 0
ds_read_b64_tr_b16 a[220:221], v8 offset:16640
v_sub_u32 v249, 55, v248
v_cvt_pk_bf16_f32 v216, v44, v45
v_mfma_f32_16x16x32_bf16 a[60:63], a[188:191], v[204:207], a[60:63]
ds_read_b64_tr_b16 a[222:223], v8 offset:24832
v_and_b32 v249, 1073741824, v249
v_mfma_f32_16x16x32_bf16 a[64:67], a[192:195], v[192:195], 0
ds_read_b64_tr_b16 a[224:225], v9 offset:256
v_add_u32 v245, v245, v249
v_exp_f32 v40, v168
s_waitcnt lgkmcnt(5)
v_mfma_f32_16x16x32_bf16 a[64:67], a[196:199], v[196:199], a[64:67]
ds_read_b64_tr_b16 a[226:227], v9 offset:8448
s_lshl2_add_u32 s60, s2, s56
v_mfma_f32_16x16x32_bf16 a[68:71], a[192:195], v[200:203], 0
ds_read_b64_tr_b16 a[228:229], v9 offset:16640
s_mul_i32 s60, s60, 896
v_mfma_f32_16x16x32_bf16 a[68:71], a[196:199], v[204:207], a[68:71]
ds_read_b64_tr_b16 a[230:231], v9 offset:24832
ds_read_b64_tr_b16 a[232:233], v10 offset:256
buffer_load_dwordx4 v20, s[4:7], s25 offen offset:3072 lds
s_sub_u32 s60, s60, 10092544
v_mfma_f32_16x16x32_bf16 a[72:75], a[200:203], v[192:195], 0
ds_read_b64_tr_b16 a[234:235], v10 offset:8448
s_add_u32 s25, s25, 32768
v_lshl_add_u32 v246, v248, 7, s60
v_mfma_f32_16x16x32_bf16 a[72:75], a[204:207], v[196:199], a[72:75]
ds_read_b64_tr_b16 a[236:237], v10 offset:16640
v_sub_u32 v249, 6, v248
v_add_f32 v32, v46, v32
v_mfma_f32_16x16x32_bf16 a[76:79], a[200:203], v[200:203], 0
ds_read_b64_tr_b16 a[238:239], v10 offset:24832
v_and_b32 v249, 1073741824, v249
v_mfma_f32_16x16x32_bf16 a[76:79], a[204:207], v[204:207], a[76:79]
ds_read_b64_tr_b16 a[240:241], v11 offset:256
v_add_u32 v246, v246, v249
v_mfma_f32_16x16x32_bf16 a[80:83], a[208:211], v[192:195], 0
ds_read_b64_tr_b16 a[242:243], v11 offset:8448
s_mul_i32 s59, s57, 224
v_exp_f32 v41, v169
v_mfma_f32_16x16x32_bf16 a[80:83], a[212:215], v[196:199], a[80:83]
ds_read_b64_tr_b16 a[244:245], v11 offset:16640
s_cmp_lt_u32 s56, 2
s_cselect_b32 s48, s76, s78
s_cselect_b32 s49, s77, s79
v_mfma_f32_16x16x32_bf16 a[84:87], a[208:211], v[200:203], 0
ds_read_b64_tr_b16 a[246:247], v11 offset:24832
s_add_u32 s48, s48, s59
s_addc_u32 s49, s49, 0
v_mfma_f32_16x16x32_bf16 a[84:87], a[212:215], v[204:207], a[84:87]
ds_read_b64_tr_b16 a[248:249], v12 offset:256
s_sub_u32 s50, 1605632, s59
v_cvt_pk_bf16_f32 v217, v46, v47
s_waitcnt lgkmcnt(5)
v_mfma_f32_16x16x32_bf16 a[88:91], a[216:219], v[192:195], 0
ds_read_b64_tr_b16 a[250:251], v12 offset:8448
s_mov_b32 s52, s80
v_add_f32 v32, v47, v32
v_mfma_f32_16x16x32_bf16 a[88:91], a[220:223], v[196:199], a[88:91]
ds_read_b64_tr_b16 a[252:253], v12 offset:16640
s_mov_b32 s53, s81
v_mfma_f32_16x16x32_bf16 a[92:95], a[216:219], v[200:203], 0
ds_read_b64_tr_b16 a[254:255], v12 offset:24832
s_mov_b32 s54, 1605632
v_mfma_f32_16x16x32_bf16 a[92:95], a[220:223], v[204:207], a[92:95]
v_exp_f32 v42, v170
v_add_f32 v31, v40, v31
v_mfma_f32_16x16x32_bf16 a[96:99], a[224:227], v[192:195], 0
v_exp_f32 v43, v171
v_cvt_pk_bf16_f32 v210, v40, v41
v_mfma_f32_16x16x32_bf16 a[96:99], a[228:231], v[196:199], a[96:99]
v_add_f32 v31, v41, v31
v_exp_f32 v44, v172
v_mfma_f32_16x16x32_bf16 a[100:103], a[224:227], v[200:203], 0
v_add_f32 v31, v42, v31
v_mfma_f32_16x16x32_bf16 a[100:103], a[228:231], v[204:207], a[100:103]
v_exp_f32 v45, v173
v_cvt_pk_bf16_f32 v211, v42, v43
v_mfma_f32_16x16x32_bf16 a[104:107], a[232:235], v[192:195], 0
s_waitcnt vmcnt(17) lgkmcnt(0)
s_barrier
ds_read_b128 a[128:131], v1 offset:32768
v_mfma_f32_16x16x32_bf16 a[104:107], a[236:239], v[196:199], a[104:107]
ds_read_b128 a[132:135], v2 offset:32768
s_mov_b32 s61, 4096
v_add_f32 v31, v43, v31
v_mfma_f32_16x16x32_bf16 a[108:111], a[232:235], v[200:203], 0
v_and_b32 v240, 63, v0
v_exp_f32 v46, v174
v_mfma_f32_16x16x32_bf16 a[108:111], a[236:239], v[204:207], a[108:111]
ds_read_b128 a[136:139], v3 offset:32768
v_lshlrev_b32 v233, 4, v240
v_mfma_f32_16x16x32_bf16 a[112:115], a[240:243], v[192:195], 0
s_add_u32 m0, s24, 65536
v_add_f32 v32, v44, v32
v_mfma_f32_16x16x32_bf16 a[112:115], a[244:247], v[196:199], a[112:115]
ds_read_b128 a[140:143], v4 offset:32768
buffer_load_dwordx4 v21, s[8:11], s26 offen lds
v_exp_f32 v47, v175
v_mfma_f32_16x16x32_bf16 a[116:119], a[240:243], v[200:203], 0
ds_read_b128 a[144:147], v1 offset:33024
v_add_u32 v234, 2048, v233
v_mfma_f32_16x16x32_bf16 a[116:119], a[244:247], v[204:207], a[116:119]
ds_read_b128 a[148:151], v2 offset:33024
v_cvt_pk_bf16_f32 v218, v44, v45
v_mfma_f32_16x16x32_bf16 a[120:123], a[248:251], v[192:195], 0
ds_read_b128 a[152:155], v3 offset:33024
v_lshrrev_b32 v241, 3, v240
v_add_f32 v32, v45, v32
v_mfma_f32_16x16x32_bf16 a[120:123], a[252:255], v[196:199], a[120:123]
ds_read_b128 a[156:159], v4 offset:33024
v_exp_f32 v40, v176
v_mfma_f32_16x16x32_bf16 a[124:127], a[248:251], v[200:203], 0
v_lshrrev_b32 v250, 6, v0
v_lshl_add_u32 v241, v250, 6, v241
v_mfma_f32_16x16x32_bf16 a[124:127], a[252:255], v[204:207], a[124:127]
buffer_load_dwordx4 v22, s[8:11], s26 offen offset:1024 lds
v_add_f32 v32, v46, v32
s_waitcnt lgkmcnt(3)
v_mfma_f32_16x16x32_bf16 v[128:131], a[128:131], v[64:67], v[48:51]
v_mul_u32_u24 v241, 896, v241
v_lshrrev_b32 v250, 3, v240
v_exp_f32 v41, v177
v_mfma_f32_16x16x32_bf16 v[128:131], a[132:135], v[72:75], v[128:131]
v_and_b32 v250, 6, v250
v_cvt_pk_bf16_f32 v219, v46, v47
v_mfma_f32_16x16x32_bf16 v[128:131], a[136:139], v[80:83], v[128:131]
ds_read_b128 a[160:163], v1 offset:40960
v_and_b32 v251, 7, v240
v_mfma_f32_16x16x32_bf16 v[128:131], a[140:143], v[88:91], v[128:131]
v_xor_b32 v250, v250, v251
v_lshl_add_u32 v232, v250, 4, v241
v_add_f32 v32, v47, v32
v_mfma_f32_16x16x32_bf16 v[128:131], a[144:147], v[96:99], v[128:131]
ds_read_b128 a[164:167], v2 offset:40960
v_exp_f32 v42, v178
s_waitcnt lgkmcnt(2)
v_mfma_f32_16x16x32_bf16 v[128:131], a[148:151], v[104:107], v[128:131]
buffer_load_dwordx4 v23, s[8:11], s26 offen offset:2048 lds
v_lshrrev_b32 v241, 2, v240
v_mfma_f32_16x16x32_bf16 v[128:131], a[152:155], v[112:115], v[128:131]
ds_read_b128 a[168:171], v3 offset:40960
v_add_f32 v31, v40, v31
v_mfma_f32_16x16x32_bf16 v[128:131], a[156:159], v[120:123], v[128:131]
v_lshlrev_b32 v241, 7, v241
v_bfe_u32 v250, v240, 3, 2
v_exp_f32 v43, v179
v_mfma_f32_16x16x32_bf16 v[132:135], a[128:131], v[68:71], v[52:55]
ds_read_b128 a[172:175], v4 offset:40960
v_cvt_pk_bf16_f32 v212, v40, v41
v_mfma_f32_16x16x32_bf16 v[132:135], a[132:135], v[76:79], v[132:135]
v_lshl_add_u32 v241, v250, 5, v241
v_and_b32 v250, 3, v240
v_mfma_f32_16x16x32_bf16 v[132:135], a[136:139], v[84:87], v[132:135]
ds_read_b128 a[176:179], v1 offset:41216
v_add_f32 v31, v41, v31
v_mfma_f32_16x16x32_bf16 v[132:135], a[140:143], v[92:95], v[132:135]
ds_read_b128 a[180:183], v2 offset:41216
buffer_load_dwordx4 v24, s[8:11], s26 offen offset:3072 lds
v_exp_f32 v44, v180
v_mfma_f32_16x16x32_bf16 v[132:135], a[144:147], v[100:103], v[132:135]
ds_read_b128 a[184:187], v3 offset:41216
v_lshl_add_u32 v224, v250, 3, v241
v_mfma_f32_16x16x32_bf16 v[132:135], a[148:151], v[108:111], v[132:135]
ds_read_b128 a[188:191], v4 offset:41216
v_add_f32 v31, v42, v31
v_mfma_f32_16x16x32_bf16 v[132:135], a[152:155], v[116:119], v[132:135]
v_xor_b32 v225, 32, v224
v_xor_b32 v226, 64, v224
v_mfma_f32_16x16x32_bf16 v[132:135], a[156:159], v[124:127], v[132:135]
v_xor_b32 v227, 96, v224
v_exp_f32 v45, v181
v_cvt_pk_bf16_f32 v213, v42, v43
s_waitcnt lgkmcnt(3)
v_mfma_f32_16x16x32_bf16 v[136:139], a[160:163], v[64:67], v[48:51]
s_add_u32 m0, s24, 69632
v_add_u32 v228, 0x10000, v224
v_mfma_f32_16x16x32_bf16 v[136:139], a[164:167], v[72:75], v[136:139]
ds_read_b128 a[192:195], v1 offset:49152
buffer_load_dwordx4 v25, s[8:11], s26 offen lds
v_add_f32 v31, v43, v31
v_mfma_f32_16x16x32_bf16 v[136:139], a[168:171], v[80:83], v[136:139]
v_add_u32 v229, 0x10000, v225
v_add_u32 v230, 0x10000, v226
v_mfma_f32_16x16x32_bf16 v[136:139], a[172:175], v[88:91], v[136:139]
ds_read_b128 a[196:199], v2 offset:49152
v_exp_f32 v46, v182
v_mfma_f32_16x16x32_bf16 v[136:139], a[176:179], v[96:99], v[136:139]
v_add_u32 v231, 0x10000, v227
v_add_u32 v241, 0, v240
s_waitcnt lgkmcnt(2)
v_mfma_f32_16x16x32_bf16 v[136:139], a[180:183], v[104:107], v[136:139]
ds_read_b128 a[200:203], v3 offset:49152
v_add_f32 v32, v44, v32
v_mfma_f32_16x16x32_bf16 v[136:139], a[184:187], v[112:115], v[136:139]
v_mul_u32_u24 v241, 4682, v241
v_lshrrev_b32 v241, 16, v241
v_exp_f32 v47, v183
v_mfma_f32_16x16x32_bf16 v[136:139], a[188:191], v[120:123], v[136:139]
ds_read_b128 a[204:207], v4 offset:49152
buffer_load_dwordx4 v26, s[8:11], s26 offen offset:1024 lds
v_mfma_f32_16x16x32_bf16 v[140:143], a[160:163], v[68:71], v[52:55]
ds_read_b128 a[208:211], v1 offset:49408
v_cvt_pk_bf16_f32 v220, v44, v45
v_add_f32 v32, v45, v32
v_mfma_f32_16x16x32_bf16 v[140:143], a[164:167], v[76:79], v[140:143]
v_mul_u32_u24 v241, 3360, v241
v_add3_u32 v56, v241, v233, 0
v_mfma_f32_16x16x32_bf16 v[140:143], a[168:171], v[84:87], v[140:143]
ds_read_b128 a[212:215], v2 offset:49408
v_exp_f32 v40, v184
v_mfma_f32_16x16x32_bf16 v[140:143], a[172:175], v[92:95], v[140:143]
v_add_u32 v241, 64, v240
v_mul_u32_u24 v241, 4682, v241
v_mfma_f32_16x16x32_bf16 v[140:143], a[176:179], v[100:103], v[140:143]
ds_read_b128 a[216:219], v3 offset:49408
v_add_f32 v32, v46, v32
v_mfma_f32_16x16x32_bf16 v[140:143], a[180:183], v[108:111], v[140:143]
ds_read_b128 a[220:223], v4 offset:49408
buffer_load_dwordx4 v27, s[8:11], s26 offen offset:2048 lds
v_exp_f32 v41, v185
v_mfma_f32_16x16x32_bf16 v[140:143], a[184:187], v[116:119], v[140:143]
v_lshrrev_b32 v241, 16, v241
v_mul_u32_u24 v241, 3360, v241
v_mfma_f32_16x16x32_bf16 v[140:143], a[188:191], v[124:127], v[140:143]
v_add3_u32 v57, v241, v233, 0
v_add_u32 v241, 128, v240
s_waitcnt lgkmcnt(2)
v_mfma_f32_16x16x32_bf16 v[144:147], a[192:195], v[64:67], v[48:51]
ds_read_b128 a[224:227], v1 offset:57344
v_cvt_pk_bf16_f32 v221, v46, v47
v_add_f32 v32, v47, v32
v_mfma_f32_16x16x32_bf16 v[144:147], a[196:199], v[72:75], v[144:147]
v_mul_u32_u24 v241, 4682, v241
v_lshrrev_b32 v241, 16, v241
v_mfma_f32_16x16x32_bf16 v[144:147], a[200:203], v[80:83], v[144:147]
ds_read_b128 a[228:231], v2 offset:57344
v_exp_f32 v42, v186
v_mfma_f32_16x16x32_bf16 v[144:147], a[204:207], v[88:91], v[144:147]
ds_read_b128 a[232:235], v3 offset:57344
buffer_load_dwordx4 v28, s[8:11], s26 offen offset:3072 lds
v_add_f32 v31, v40, v31
v_mfma_f32_16x16x32_bf16 v[144:147], a[208:211], v[96:99], v[144:147]
s_add_u32 s26, s26, 32768
v_mul_u32_u24 v241, 3360, v241
v_mfma_f32_16x16x32_bf16 v[144:147], a[212:215], v[104:107], v[144:147]
ds_read_b128 a[236:239], v4 offset:57344
v_exp_f32 v43, v187
s_waitcnt lgkmcnt(3)
v_mfma_f32_16x16x32_bf16 v[144:147], a[216:219], v[112:115], v[144:147]
v_add3_u32 v58, v241, v233, 0
v_add_u32 v241, 192, v240
v_mfma_f32_16x16x32_bf16 v[144:147], a[220:223], v[120:123], v[144:147]
ds_read_b128 a[240:243], v1 offset:57600
v_cvt_pk_bf16_f32 v214, v40, v41
v_add_f32 v31, v41, v31
v_mfma_f32_16x16x32_bf16 v[148:151], a[192:195], v[68:71], v[52:55]
v_mul_u32_u24 v241, 4682, v241
v_lshrrev_b32 v241, 16, v241
v_mfma_f32_16x16x32_bf16 v[148:151], a[196:199], v[76:79], v[148:151]
ds_read_b128 a[244:247], v2 offset:57600
v_exp_f32 v44, v188
v_mfma_f32_16x16x32_bf16 v[148:151], a[200:203], v[84:87], v[148:151]
v_mul_u32_u24 v241, 3360, v241
v_add3_u32 v59, v241, v233, 0
v_add_f32 v31, v42, v31
v_mfma_f32_16x16x32_bf16 v[148:151], a[204:207], v[92:95], v[148:151]
ds_read_b128 a[248:251], v3 offset:57600
v_exp_f32 v45, v189
v_mfma_f32_16x16x32_bf16 v[148:151], a[208:211], v[100:103], v[148:151]
v_add_u32 v241, 256, v240
v_mul_u32_u24 v241, 4682, v241
v_mfma_f32_16x16x32_bf16 v[148:151], a[212:215], v[108:111], v[148:151]
ds_read_b128 a[252:255], v4 offset:57600
v_lshrrev_b32 v241, 16, v241
v_mfma_f32_16x16x32_bf16 v[148:151], a[216:219], v[116:119], v[148:151]
v_mul_u32_u24 v241, 3360, v241
v_cvt_pk_bf16_f32 v215, v42, v43
v_add_f32 v31, v43, v31
v_mfma_f32_16x16x32_bf16 v[148:151], a[220:223], v[124:127], v[148:151]
v_add3_u32 v60, v241, v233, s61
v_add_u32 v241, 320, v240
v_mfma_f32_16x16x32_bf16 v[152:155], a[224:227], v[64:67], v[48:51]
v_mul_u32_u24 v241, 4682, v241
v_exp_f32 v46, v190
s_waitcnt lgkmcnt(1)
v_mfma_f32_16x16x32_bf16 v[152:155], a[228:231], v[72:75], v[152:155]
v_lshrrev_b32 v241, 16, v241
v_mul_u32_u24 v241, 3360, v241
v_mfma_f32_16x16x32_bf16 v[152:155], a[232:235], v[80:83], v[152:155]
v_add3_u32 v61, v241, v233, s61
v_add_f32 v32, v44, v32
v_mfma_f32_16x16x32_bf16 v[152:155], a[236:239], v[88:91], v[152:155]
v_add_u32 v241, 384, v240
v_mul_u32_u24 v241, 4682, v241
v_exp_f32 v47, v191
v_mfma_f32_16x16x32_bf16 v[152:155], a[240:243], v[96:99], v[152:155]
s_waitcnt vmcnt(16) lgkmcnt(0)
s_barrier
ds_read_b64_tr_b16 a[128:129], v5 offset:32768
ds_read_b64_tr_b16 a[130:131], v5 offset:40960
v_mfma_f32_16x16x32_bf16 v[152:155], a[244:247], v[104:107], v[152:155]
ds_read_b64_tr_b16 a[132:133], v5 offset:49152
v_cvt_pk_bf16_f32 v222, v44, v45
v_mfma_f32_16x16x32_bf16 v[152:155], a[248:251], v[112:115], v[152:155]
ds_read_b64_tr_b16 a[134:135], v5 offset:57344
s_and_b32 s62, s2, 15
s_lshl2_add_u32 s62, s62, s24
v_lshrrev_b32 v241, 16, v241
v_mfma_f32_16x16x32_bf16 v[152:155], a[252:255], v[120:123], v[152:155]
ds_read_b64_tr_b16 a[136:137], v6 offset:32768
buffer_atomic_add v243, v63, s[40:43], s62 offen offset:128 sc1
v_add_f32 v32, v45, v32
v_mfma_f32_16x16x32_bf16 v[156:159], a[224:227], v[68:71], v[52:55]
ds_read_b64_tr_b16 a[138:139], v6 offset:40960
s_add_u32 m0, s24, 32768
v_mfma_f32_16x16x32_bf16 v[156:159], a[228:231], v[76:79], v[156:159]
ds_read_b64_tr_b16 a[140:141], v6 offset:49152
buffer_load_dwordx4 v13, s[4:7], s25 offen lds
v_add_f32 v32, v46, v32
v_mfma_f32_16x16x32_bf16 v[156:159], a[232:235], v[84:87], v[156:159]
ds_read_b64_tr_b16 a[142:143], v6 offset:57344
v_mul_u32_u24 v241, 3360, v241
v_mfma_f32_16x16x32_bf16 v[156:159], a[236:239], v[92:95], v[156:159]
ds_read_b64_tr_b16 a[144:145], v7 offset:32768
v_cvt_pk_bf16_f32 v223, v46, v47
v_add_f32 v32, v47, v32
v_mfma_f32_16x16x32_bf16 v[156:159], a[240:243], v[100:103], v[156:159]
ds_read_b64_tr_b16 a[146:147], v7 offset:40960
v_add3_u32 v62, v241, v233, s61
v_mfma_f32_16x16x32_bf16 v[156:159], a[244:247], v[108:111], v[156:159]
ds_read_b64_tr_b16 a[148:149], v7 offset:49152
v_max_f32 v33, v31, v32
v_cmp_nge_f32 vcc, s28, v33
v_mfma_f32_16x16x32_bf16 v[156:159], a[248:251], v[116:119], v[156:159]
ds_read_b64_tr_b16 a[150:151], v7 offset:57344
v_mfma_f32_16x16x32_bf16 v[156:159], a[252:255], v[124:127], v[156:159]
ds_read_b64_tr_b16 a[152:153], v8 offset:32768
ds_read_b64_tr_b16 a[154:155], v8 offset:40960
buffer_load_dwordx4 v14, s[4:7], s25 offen offset:1024 lds
s_cbranch_vccnz K_STUB2
K_BACK2:
s_waitcnt lgkmcnt(6)
v_mfma_f32_16x16x32_bf16 a[0:3], a[128:131], v[208:211], a[0:3]
ds_read_b64_tr_b16 a[156:157], v8 offset:49152
v_add_f32 v29, v29, v31
v_add_f32 v30, v30, v32
v_mfma_f32_16x16x32_bf16 a[0:3], a[132:135], v[212:215], a[0:3]
ds_read_b64_tr_b16 a[158:159], v8 offset:57344
v_mfma_f32_16x16x32_bf16 a[4:7], a[128:131], v[216:219], a[4:7]
ds_read_b64_tr_b16 a[160:161], v9 offset:32768
v_exp_f32 v40, v128
v_mfma_f32_16x16x32_bf16 a[4:7], a[132:135], v[220:223], a[4:7]
ds_read_b64_tr_b16 a[162:163], v9 offset:40960
v_mfma_f32_16x16x32_bf16 a[8:11], a[136:139], v[208:211], a[8:11]
ds_read_b64_tr_b16 a[164:165], v9 offset:49152
v_mfma_f32_16x16x32_bf16 a[8:11], a[140:143], v[212:215], a[8:11]
ds_read_b64_tr_b16 a[166:167], v9 offset:57344
buffer_load_dwordx4 v15, s[4:7], s25 offen offset:2048 lds
v_mfma_f32_16x16x32_bf16 a[12:15], a[136:139], v[216:219], a[12:15]
ds_read_b64_tr_b16 a[168:169], v10 offset:32768
v_exp_f32 v41, v129
v_mfma_f32_16x16x32_bf16 a[12:15], a[140:143], v[220:223], a[12:15]
ds_read_b64_tr_b16 a[170:171], v10 offset:40960
s_waitcnt lgkmcnt(5)
v_mfma_f32_16x16x32_bf16 a[16:19], a[144:147], v[208:211], a[16:19]
ds_read_b64_tr_b16 a[172:173], v10 offset:49152
v_exp_f32 v42, v130
v_mfma_f32_16x16x32_bf16 a[16:19], a[148:151], v[212:215], a[16:19]
ds_read_b64_tr_b16 a[174:175], v10 offset:57344
v_mfma_f32_16x16x32_bf16 a[20:23], a[144:147], v[216:219], a[20:23]
ds_read_b64_tr_b16 a[176:177], v11 offset:32768
v_add_f32 v31, v40, v41
v_mfma_f32_16x16x32_bf16 a[20:23], a[148:151], v[220:223], a[20:23]
ds_read_b64_tr_b16 a[178:179], v11 offset:40960
ds_read_b64_tr_b16 a[180:181], v11 offset:49152
buffer_load_dwordx4 v16, s[4:7], s25 offen offset:3072 lds
v_mfma_f32_16x16x32_bf16 a[24:27], a[152:155], v[208:211], a[24:27]
ds_read_b64_tr_b16 a[182:183], v11 offset:57344
v_mfma_f32_16x16x32_bf16 a[24:27], a[156:159], v[212:215], a[24:27]
ds_read_b64_tr_b16 a[184:185], v12 offset:32768
v_exp_f32 v43, v131
v_mfma_f32_16x16x32_bf16 a[28:31], a[152:155], v[216:219], a[28:31]
ds_read_b64_tr_b16 a[186:187], v12 offset:40960
v_mfma_f32_16x16x32_bf16 a[28:31], a[156:159], v[220:223], a[28:31]
ds_read_b64_tr_b16 a[188:189], v12 offset:49152
v_cvt_pk_bf16_f32 v192, v40, v41
s_waitcnt lgkmcnt(6)
v_mfma_f32_16x16x32_bf16 a[32:35], a[160:163], v[208:211], a[32:35]
ds_read_b64_tr_b16 a[190:191], v12 offset:57344
s_add_u32 m0, s24, 36864
v_mfma_f32_16x16x32_bf16 a[32:35], a[164:167], v[212:215], a[32:35]
ds_read_b64_tr_b16 a[192:193], v5 offset:33024
buffer_load_dwordx4 v17, s[4:7], s25 offen lds
v_mfma_f32_16x16x32_bf16 a[36:39], a[160:163], v[216:219], a[36:39]
ds_read_b64_tr_b16 a[194:195], v5 offset:41216
v_mfma_f32_16x16x32_bf16 a[36:39], a[164:167], v[220:223], a[36:39]
ds_read_b64_tr_b16 a[196:197], v5 offset:49408
v_exp_f32 v44, v132
v_mfma_f32_16x16x32_bf16 a[40:43], a[168:171], v[208:211], a[40:43]
ds_read_b64_tr_b16 a[198:199], v5 offset:57600
v_mfma_f32_16x16x32_bf16 a[40:43], a[172:175], v[212:215], a[40:43]
ds_read_b64_tr_b16 a[200:201], v6 offset:33024
v_add_f32 v31, v42, v31
v_mfma_f32_16x16x32_bf16 a[44:47], a[168:171], v[216:219], a[44:47]
ds_read_b64_tr_b16 a[202:203], v6 offset:41216
v_mfma_f32_16x16x32_bf16 a[44:47], a[172:175], v[220:223], a[44:47]
ds_read_b64_tr_b16 a[204:205], v6 offset:49408
ds_read_b64_tr_b16 a[206:207], v6 offset:57600
buffer_load_dwordx4 v18, s[4:7], s25 offen offset:1024 lds
s_waitcnt lgkmcnt(6)
v_mfma_f32_16x16x32_bf16 a[48:51], a[176:179], v[208:211], a[48:51]
ds_read_b64_tr_b16 a[208:209], v7 offset:33024
v_exp_f32 v45, v133
v_mfma_f32_16x16x32_bf16 a[48:51], a[180:183], v[212:215], a[48:51]
ds_read_b64_tr_b16 a[210:211], v7 offset:41216
v_mfma_f32_16x16x32_bf16 a[52:55], a[176:179], v[216:219], a[52:55]
ds_read_b64_tr_b16 a[212:213], v7 offset:49408
v_cvt_pk_bf16_f32 v193, v42, v43
v_mfma_f32_16x16x32_bf16 a[52:55], a[180:183], v[220:223], a[52:55]
ds_read_b64_tr_b16 a[214:215], v7 offset:57600
v_mfma_f32_16x16x32_bf16 a[56:59], a[184:187], v[208:211], a[56:59]
ds_read_b64_tr_b16 a[216:217], v8 offset:33024
v_add_f32 v31, v43, v31
v_mfma_f32_16x16x32_bf16 a[56:59], a[188:191], v[212:215], a[56:59]
ds_read_b64_tr_b16 a[218:219], v8 offset:41216
buffer_load_dwordx4 v19, s[4:7], s25 offen offset:2048 lds
v_mfma_f32_16x16x32_bf16 a[60:63], a[184:187], v[216:219], a[60:63]
ds_read_b64_tr_b16 a[220:221], v8 offset:49408
v_mfma_f32_16x16x32_bf16 a[60:63], a[188:191], v[220:223], a[60:63]
ds_read_b64_tr_b16 a[222:223], v8 offset:57600
v_exp_f32 v46, v134
v_mfma_f32_16x16x32_bf16 a[64:67], a[192:195], v[208:211], a[64:67]
ds_read_b64_tr_b16 a[224:225], v9 offset:33024
s_waitcnt lgkmcnt(5)
v_mfma_f32_16x16x32_bf16 a[64:67], a[196:199], v[212:215], a[64:67]
ds_read_b64_tr_b16 a[226:227], v9 offset:41216
v_add_f32 v32, v44, v45
v_mfma_f32_16x16x32_bf16 a[68:71], a[192:195], v[216:219], a[68:71]
ds_read_b64_tr_b16 a[228:229], v9 offset:49408
v_mfma_f32_16x16x32_bf16 a[68:71], a[196:199], v[220:223], a[68:71]
ds_read_b64_tr_b16 a[230:231], v9 offset:57600
ds_read_b64_tr_b16 a[232:233], v10 offset:33024
buffer_load_dwordx4 v20, s[4:7], s25 offen offset:3072 lds
v_mfma_f32_16x16x32_bf16 a[72:75], a[200:203], v[208:211], a[72:75]
ds_read_b64_tr_b16 a[234:235], v10 offset:41216
s_add_u32 s25, s25, 32768
v_mfma_f32_16x16x32_bf16 a[72:75], a[204:207], v[212:215], a[72:75]
ds_read_b64_tr_b16 a[236:237], v10 offset:49408
v_exp_f32 v47, v135
v_mfma_f32_16x16x32_bf16 a[76:79], a[200:203], v[216:219], a[76:79]
ds_read_b64_tr_b16 a[238:239], v10 offset:57600
v_mfma_f32_16x16x32_bf16 a[76:79], a[204:207], v[220:223], a[76:79]
ds_read_b64_tr_b16 a[240:241], v11 offset:33024
v_cvt_pk_bf16_f32 v200, v44, v45
v_mfma_f32_16x16x32_bf16 a[80:83], a[208:211], v[208:211], a[80:83]
ds_read_b64_tr_b16 a[242:243], v11 offset:41216
v_mfma_f32_16x16x32_bf16 a[80:83], a[212:215], v[212:215], a[80:83]
ds_read_b64_tr_b16 a[244:245], v11 offset:49408
v_exp_f32 v40, v136
v_mfma_f32_16x16x32_bf16 a[84:87], a[208:211], v[216:219], a[84:87]
ds_read_b64_tr_b16 a[246:247], v11 offset:57600
v_mfma_f32_16x16x32_bf16 a[84:87], a[212:215], v[220:223], a[84:87]
ds_read_b64_tr_b16 a[248:249], v12 offset:33024
v_add_f32 v32, v46, v32
s_waitcnt lgkmcnt(5)
v_mfma_f32_16x16x32_bf16 a[88:91], a[216:219], v[208:211], a[88:91]
ds_read_b64_tr_b16 a[250:251], v12 offset:41216
v_mfma_f32_16x16x32_bf16 a[88:91], a[220:223], v[212:215], a[88:91]
ds_read_b64_tr_b16 a[252:253], v12 offset:49408
v_exp_f32 v41, v137
v_mfma_f32_16x16x32_bf16 a[92:95], a[216:219], v[216:219], a[92:95]
ds_read_b64_tr_b16 a[254:255], v12 offset:57600
v_mfma_f32_16x16x32_bf16 a[92:95], a[220:223], v[220:223], a[92:95]
v_cvt_pk_bf16_f32 v201, v46, v47
v_add_f32 v32, v47, v32
v_mfma_f32_16x16x32_bf16 a[96:99], a[224:227], v[208:211], a[96:99]
v_exp_f32 v42, v138
v_mfma_f32_16x16x32_bf16 a[96:99], a[228:231], v[212:215], a[96:99]
v_add_f32 v31, v40, v31
v_mfma_f32_16x16x32_bf16 a[100:103], a[224:227], v[216:219], a[100:103]
v_exp_f32 v43, v139
v_mfma_f32_16x16x32_bf16 a[100:103], a[228:231], v[220:223], a[100:103]
v_cvt_pk_bf16_f32 v194, v40, v41
v_add_f32 v31, v41, v31
s_mov_b32 s27, 12
K_LOOP:
v_mfma_f32_16x16x32_bf16 a[104:107], a[232:235], v[208:211], a[104:107]
s_waitcnt vmcnt(16) lgkmcnt(0)
s_barrier
ds_read_b128 a[128:131], v1 offset:0
v_mfma_f32_16x16x32_bf16 a[104:107], a[236:239], v[212:215], a[104:107]
ds_read_b128 a[132:135], v2 offset:0
v_mfma_f32_16x16x32_bf16 a[108:111], a[232:235], v[216:219], a[108:111]
buffer_load_dword v247, v244, s[16:19], 0 offen
v_exp_f32 v44, v140
v_add_f32 v31, v42, v31
v_mfma_f32_16x16x32_bf16 a[108:111], a[236:239], v[220:223], a[108:111]
ds_read_b128 a[136:139], v3 offset:0
v_add_u32 v244, 114688, v244
v_mfma_f32_16x16x32_bf16 a[112:115], a[240:243], v[208:211], a[112:115]
s_add_u32 m0, s24, 98304
v_exp_f32 v45, v141
v_mfma_f32_16x16x32_bf16 a[112:115], a[244:247], v[212:215], a[112:115]
ds_read_b128 a[140:143], v4 offset:0
buffer_load_dwordx4 v21, s[8:11], s26 offen lds
v_mfma_f32_16x16x32_bf16 a[116:119], a[240:243], v[216:219], a[116:119]
ds_read_b128 a[144:147], v1 offset:256
v_mfma_f32_16x16x32_bf16 a[116:119], a[244:247], v[220:223], a[116:119]
ds_read_b128 a[148:151], v2 offset:256
v_cvt_pk_bf16_f32 v195, v42, v43
v_mfma_f32_16x16x32_bf16 a[120:123], a[248:251], v[208:211], a[120:123]
ds_read_b128 a[152:155], v3 offset:256
v_mfma_f32_16x16x32_bf16 a[120:123], a[252:255], v[212:215], a[120:123]
ds_read_b128 a[156:159], v4 offset:256
v_add_f32 v31, v43, v31
v_mfma_f32_16x16x32_bf16 a[124:127], a[248:251], v[216:219], a[124:127]
v_exp_f32 v46, v142
v_mfma_f32_16x16x32_bf16 a[124:127], a[252:255], v[220:223], a[124:127]
buffer_load_dwordx4 v22, s[8:11], s26 offen offset:1024 lds
v_add_f32 v32, v44, v32
s_waitcnt lgkmcnt(3)
v_mfma_f32_16x16x32_bf16 v[160:163], a[128:131], v[64:67], v[48:51]
v_exp_f32 v47, v143
v_mfma_f32_16x16x32_bf16 v[160:163], a[132:135], v[72:75], v[160:163]
v_cvt_pk_bf16_f32 v202, v44, v45
v_mfma_f32_16x16x32_bf16 v[160:163], a[136:139], v[80:83], v[160:163]
ds_read_b128 a[160:163], v1 offset:8192
v_add_f32 v32, v45, v32
v_mfma_f32_16x16x32_bf16 v[160:163], a[140:143], v[88:91], v[160:163]
v_exp_f32 v40, v144
v_mfma_f32_16x16x32_bf16 v[160:163], a[144:147], v[96:99], v[160:163]
ds_read_b128 a[164:167], v2 offset:8192
s_waitcnt lgkmcnt(2)
v_mfma_f32_16x16x32_bf16 v[160:163], a[148:151], v[104:107], v[160:163]
buffer_load_dwordx4 v23, s[8:11], s26 offen offset:2048 lds
v_add_f32 v32, v46, v32
v_mfma_f32_16x16x32_bf16 v[160:163], a[152:155], v[112:115], v[160:163]
ds_read_b128 a[168:171], v3 offset:8192
v_mfma_f32_16x16x32_bf16 v[160:163], a[156:159], v[120:123], v[160:163]
v_exp_f32 v41, v145
v_cvt_pk_bf16_f32 v203, v46, v47
v_mfma_f32_16x16x32_bf16 v[164:167], a[128:131], v[68:71], v[52:55]
ds_read_b128 a[172:175], v4 offset:8192
v_mfma_f32_16x16x32_bf16 v[164:167], a[132:135], v[76:79], v[164:167]
v_add_f32 v32, v47, v32
v_exp_f32 v42, v146
v_mfma_f32_16x16x32_bf16 v[164:167], a[136:139], v[84:87], v[164:167]
ds_read_b128 a[176:179], v1 offset:8448
v_mfma_f32_16x16x32_bf16 v[164:167], a[140:143], v[92:95], v[164:167]
ds_read_b128 a[180:183], v2 offset:8448
buffer_load_dwordx4 v24, s[8:11], s26 offen offset:3072 lds
v_mfma_f32_16x16x32_bf16 v[164:167], a[144:147], v[100:103], v[164:167]
ds_read_b128 a[184:187], v3 offset:8448
v_add_f32 v31, v40, v31
v_mfma_f32_16x16x32_bf16 v[164:167], a[148:151], v[108:111], v[164:167]
ds_read_b128 a[188:191], v4 offset:8448
v_mfma_f32_16x16x32_bf16 v[164:167], a[152:155], v[116:119], v[164:167]
v_exp_f32 v43, v147
v_mfma_f32_16x16x32_bf16 v[164:167], a[156:159], v[124:127], v[164:167]
v_cvt_pk_bf16_f32 v196, v40, v41
v_add_f32 v31, v41, v31
s_waitcnt lgkmcnt(3)
v_mfma_f32_16x16x32_bf16 v[168:171], a[160:163], v[64:67], v[48:51]
s_add_u32 m0, s24, 102400
v_mfma_f32_16x16x32_bf16 v[168:171], a[164:167], v[72:75], v[168:171]
ds_read_b128 a[192:195], v1 offset:16384
buffer_load_dwordx4 v25, s[8:11], s26 offen lds
v_mfma_f32_16x16x32_bf16 v[168:171], a[168:171], v[80:83], v[168:171]
buffer_load_dword v247, v245, s[48:51], 0 offen
v_exp_f32 v44, v148
v_mfma_f32_16x16x32_bf16 v[168:171], a[172:175], v[88:91], v[168:171]
ds_read_b128 a[196:199], v2 offset:16384
v_add_u32 v245, 802816, v245
v_add_f32 v31, v42, v31
v_mfma_f32_16x16x32_bf16 v[168:171], a[176:179], v[96:99], v[168:171]
v_exp_f32 v45, v149
s_waitcnt lgkmcnt(2)
v_mfma_f32_16x16x32_bf16 v[168:171], a[180:183], v[104:107], v[168:171]
ds_read_b128 a[200:203], v3 offset:16384
v_cvt_pk_bf16_f32 v197, v42, v43
v_mfma_f32_16x16x32_bf16 v[168:171], a[184:187], v[112:115], v[168:171]
v_add_f32 v31, v43, v31
v_mfma_f32_16x16x32_bf16 v[168:171], a[188:191], v[120:123], v[168:171]
ds_read_b128 a[204:207], v4 offset:16384
buffer_load_dwordx4 v26, s[8:11], s26 offen offset:1024 lds
v_mfma_f32_16x16x32_bf16 v[172:175], a[160:163], v[68:71], v[52:55]
ds_read_b128 a[208:211], v1 offset:16640
v_exp_f32 v46, v150
v_mfma_f32_16x16x32_bf16 v[172:175], a[164:167], v[76:79], v[172:175]
v_add_f32 v32, v44, v32
v_mfma_f32_16x16x32_bf16 v[172:175], a[168:171], v[84:87], v[172:175]
ds_read_b128 a[212:215], v2 offset:16640
v_mfma_f32_16x16x32_bf16 v[172:175], a[172:175], v[92:95], v[172:175]
v_exp_f32 v47, v151
v_mfma_f32_16x16x32_bf16 v[172:175], a[176:179], v[100:103], v[172:175]
ds_read_b128 a[216:219], v3 offset:16640
v_cvt_pk_bf16_f32 v204, v44, v45
v_mfma_f32_16x16x32_bf16 v[172:175], a[180:183], v[108:111], v[172:175]
ds_read_b128 a[220:223], v4 offset:16640
buffer_load_dwordx4 v27, s[8:11], s26 offen offset:2048 lds
v_mfma_f32_16x16x32_bf16 v[172:175], a[184:187], v[116:119], v[172:175]
v_add_f32 v32, v45, v32
v_mfma_f32_16x16x32_bf16 v[172:175], a[188:191], v[124:127], v[172:175]
v_exp_f32 v40, v152
v_add_f32 v32, v46, v32
s_waitcnt lgkmcnt(2)
v_mfma_f32_16x16x32_bf16 v[176:179], a[192:195], v[64:67], v[48:51]
ds_read_b128 a[224:227], v1 offset:24576
v_mfma_f32_16x16x32_bf16 v[176:179], a[196:199], v[72:75], v[176:179]
v_exp_f32 v41, v153
v_mfma_f32_16x16x32_bf16 v[176:179], a[200:203], v[80:83], v[176:179]
ds_read_b128 a[228:231], v2 offset:24576
v_cvt_pk_bf16_f32 v205, v46, v47
v_mfma_f32_16x16x32_bf16 v[176:179], a[204:207], v[88:91], v[176:179]
ds_read_b128 a[232:235], v3 offset:24576
buffer_load_dwordx4 v28, s[8:11], s26 offen offset:3072 lds
v_mfma_f32_16x16x32_bf16 v[176:179], a[208:211], v[96:99], v[176:179]
s_add_u32 s26, s26, 32768
v_add_f32 v32, v47, v32
v_mfma_f32_16x16x32_bf16 v[176:179], a[212:215], v[104:107], v[176:179]
ds_read_b128 a[236:239], v4 offset:24576
s_waitcnt lgkmcnt(3)
v_mfma_f32_16x16x32_bf16 v[176:179], a[216:219], v[112:115], v[176:179]
v_exp_f32 v42, v154
v_mfma_f32_16x16x32_bf16 v[176:179], a[220:223], v[120:123], v[176:179]
ds_read_b128 a[240:243], v1 offset:24832
v_add_f32 v31, v40, v31
v_mfma_f32_16x16x32_bf16 v[180:183], a[192:195], v[68:71], v[52:55]
v_exp_f32 v43, v155
v_mfma_f32_16x16x32_bf16 v[180:183], a[196:199], v[76:79], v[180:183]
ds_read_b128 a[244:247], v2 offset:24832
v_mfma_f32_16x16x32_bf16 v[180:183], a[200:203], v[84:87], v[180:183]
v_cvt_pk_bf16_f32 v198, v40, v41
v_add_f32 v31, v41, v31
v_mfma_f32_16x16x32_bf16 v[180:183], a[204:207], v[92:95], v[180:183]
ds_read_b128 a[248:251], v3 offset:24832
v_mfma_f32_16x16x32_bf16 v[180:183], a[208:211], v[100:103], v[180:183]
v_exp_f32 v44, v156
v_add_f32 v31, v42, v31
v_mfma_f32_16x16x32_bf16 v[180:183], a[212:215], v[108:111], v[180:183]
ds_read_b128 a[252:255], v4 offset:24832
v_mfma_f32_16x16x32_bf16 v[180:183], a[216:219], v[116:119], v[180:183]
v_exp_f32 v45, v157
v_mfma_f32_16x16x32_bf16 v[180:183], a[220:223], v[124:127], v[180:183]
v_cvt_pk_bf16_f32 v199, v42, v43
v_add_f32 v31, v43, v31
v_mfma_f32_16x16x32_bf16 v[184:187], a[224:227], v[64:67], v[48:51]
v_exp_f32 v46, v158
s_waitcnt lgkmcnt(1)
v_mfma_f32_16x16x32_bf16 v[184:187], a[228:231], v[72:75], v[184:187]
v_add_f32 v32, v44, v32
v_mfma_f32_16x16x32_bf16 v[184:187], a[232:235], v[80:83], v[184:187]
v_exp_f32 v47, v159
v_mfma_f32_16x16x32_bf16 v[184:187], a[236:239], v[88:91], v[184:187]
v_cvt_pk_bf16_f32 v206, v44, v45
v_add_f32 v32, v45, v32
v_mfma_f32_16x16x32_bf16 v[184:187], a[240:243], v[96:99], v[184:187]
s_waitcnt vmcnt(18) lgkmcnt(0)
s_barrier
ds_read_b64_tr_b16 a[128:129], v5 offset:0
ds_read_b64_tr_b16 a[130:131], v5 offset:8192
v_mfma_f32_16x16x32_bf16 v[184:187], a[244:247], v[104:107], v[184:187]
ds_read_b64_tr_b16 a[132:133], v5 offset:16384
v_add_f32 v32, v46, v32
v_mfma_f32_16x16x32_bf16 v[184:187], a[248:251], v[112:115], v[184:187]
ds_read_b64_tr_b16 a[134:135], v5 offset:24576
buffer_load_dword v247, v246, s[52:55], 0 offen
v_mfma_f32_16x16x32_bf16 v[184:187], a[252:255], v[120:123], v[184:187]
ds_read_b64_tr_b16 a[136:137], v6 offset:0
v_add_u32 v246, 917504, v246
v_cvt_pk_bf16_f32 v207, v46, v47
v_mfma_f32_16x16x32_bf16 v[188:191], a[224:227], v[68:71], v[52:55]
ds_read_b64_tr_b16 a[138:139], v6 offset:8192
s_add_u32 m0, s24, 0
v_mfma_f32_16x16x32_bf16 v[188:191], a[228:231], v[76:79], v[188:191]
ds_read_b64_tr_b16 a[140:141], v6 offset:16384
buffer_load_dwordx4 v13, s[4:7], s25 offen lds
v_mfma_f32_16x16x32_bf16 v[188:191], a[232:235], v[84:87], v[188:191]
ds_read_b64_tr_b16 a[142:143], v6 offset:24576
v_add_f32 v32, v47, v32
v_mfma_f32_16x16x32_bf16 v[188:191], a[236:239], v[92:95], v[188:191]
ds_read_b64_tr_b16 a[144:145], v7 offset:0
v_max_f32 v33, v31, v32
v_mfma_f32_16x16x32_bf16 v[188:191], a[240:243], v[100:103], v[188:191]
ds_read_b64_tr_b16 a[146:147], v7 offset:8192
v_mfma_f32_16x16x32_bf16 v[188:191], a[244:247], v[108:111], v[188:191]
ds_read_b64_tr_b16 a[148:149], v7 offset:16384
v_cmp_nge_f32 vcc, s28, v33
v_mfma_f32_16x16x32_bf16 v[188:191], a[248:251], v[116:119], v[188:191]
ds_read_b64_tr_b16 a[150:151], v7 offset:24576
v_mfma_f32_16x16x32_bf16 v[188:191], a[252:255], v[124:127], v[188:191]
ds_read_b64_tr_b16 a[152:153], v8 offset:0
ds_read_b64_tr_b16 a[154:155], v8 offset:8192
buffer_load_dwordx4 v14, s[4:7], s25 offen offset:1024 lds
s_cbranch_vccnz K_STUB3
K_BACK3:
s_waitcnt lgkmcnt(6)
v_mfma_f32_16x16x32_bf16 a[0:3], a[128:131], v[192:195], a[0:3]
ds_read_b64_tr_b16 a[156:157], v8 offset:16384
v_add_f32 v29, v29, v31
v_add_f32 v30, v30, v32
v_mfma_f32_16x16x32_bf16 a[0:3], a[132:135], v[196:199], a[0:3]
ds_read_b64_tr_b16 a[158:159], v8 offset:24576
v_mfma_f32_16x16x32_bf16 a[4:7], a[128:131], v[200:203], a[4:7]
ds_read_b64_tr_b16 a[160:161], v9 offset:0
v_exp_f32 v40, v160
v_mfma_f32_16x16x32_bf16 a[4:7], a[132:135], v[204:207], a[4:7]
ds_read_b64_tr_b16 a[162:163], v9 offset:8192
v_mfma_f32_16x16x32_bf16 a[8:11], a[136:139], v[192:195], a[8:11]
ds_read_b64_tr_b16 a[164:165], v9 offset:16384
v_mfma_f32_16x16x32_bf16 a[8:11], a[140:143], v[196:199], a[8:11]
ds_read_b64_tr_b16 a[166:167], v9 offset:24576
buffer_load_dwordx4 v15, s[4:7], s25 offen offset:2048 lds
v_mfma_f32_16x16x32_bf16 a[12:15], a[136:139], v[200:203], a[12:15]
ds_read_b64_tr_b16 a[168:169], v10 offset:0
v_exp_f32 v41, v161
v_mfma_f32_16x16x32_bf16 a[12:15], a[140:143], v[204:207], a[12:15]
ds_read_b64_tr_b16 a[170:171], v10 offset:8192
s_waitcnt lgkmcnt(5)
v_mfma_f32_16x16x32_bf16 a[16:19], a[144:147], v[192:195], a[16:19]
ds_read_b64_tr_b16 a[172:173], v10 offset:16384
v_exp_f32 v42, v162
v_mfma_f32_16x16x32_bf16 a[16:19], a[148:151], v[196:199], a[16:19]
ds_read_b64_tr_b16 a[174:175], v10 offset:24576
v_mfma_f32_16x16x32_bf16 a[20:23], a[144:147], v[200:203], a[20:23]
ds_read_b64_tr_b16 a[176:177], v11 offset:0
v_add_f32 v31, v40, v41
v_mfma_f32_16x16x32_bf16 a[20:23], a[148:151], v[204:207], a[20:23]
ds_read_b64_tr_b16 a[178:179], v11 offset:8192
ds_read_b64_tr_b16 a[180:181], v11 offset:16384
buffer_load_dwordx4 v16, s[4:7], s25 offen offset:3072 lds
v_mfma_f32_16x16x32_bf16 a[24:27], a[152:155], v[192:195], a[24:27]
ds_read_b64_tr_b16 a[182:183], v11 offset:24576
v_mfma_f32_16x16x32_bf16 a[24:27], a[156:159], v[196:199], a[24:27]
ds_read_b64_tr_b16 a[184:185], v12 offset:0
v_exp_f32 v43, v163
v_mfma_f32_16x16x32_bf16 a[28:31], a[152:155], v[200:203], a[28:31]
ds_read_b64_tr_b16 a[186:187], v12 offset:8192
v_mfma_f32_16x16x32_bf16 a[28:31], a[156:159], v[204:207], a[28:31]
ds_read_b64_tr_b16 a[188:189], v12 offset:16384
v_cvt_pk_bf16_f32 v208, v40, v41
s_waitcnt lgkmcnt(6)
v_mfma_f32_16x16x32_bf16 a[32:35], a[160:163], v[192:195], a[32:35]
ds_read_b64_tr_b16 a[190:191], v12 offset:24576
s_add_u32 m0, s24, 4096
v_mfma_f32_16x16x32_bf16 a[32:35], a[164:167], v[196:199], a[32:35]
ds_read_b64_tr_b16 a[192:193], v5 offset:256
buffer_load_dwordx4 v17, s[4:7], s25 offen lds
v_mfma_f32_16x16x32_bf16 a[36:39], a[160:163], v[200:203], a[36:39]
ds_read_b64_tr_b16 a[194:195], v5 offset:8448
v_mfma_f32_16x16x32_bf16 a[36:39], a[164:167], v[204:207], a[36:39]
ds_read_b64_tr_b16 a[196:197], v5 offset:16640
v_exp_f32 v44, v164
v_mfma_f32_16x16x32_bf16 a[40:43], a[168:171], v[192:195], a[40:43]
ds_read_b64_tr_b16 a[198:199], v5 offset:24832
v_mfma_f32_16x16x32_bf16 a[40:43], a[172:175], v[196:199], a[40:43]
ds_read_b64_tr_b16 a[200:201], v6 offset:256
v_add_f32 v31, v42, v31
v_mfma_f32_16x16x32_bf16 a[44:47], a[168:171], v[200:203], a[44:47]
ds_read_b64_tr_b16 a[202:203], v6 offset:8448
v_mfma_f32_16x16x32_bf16 a[44:47], a[172:175], v[204:207], a[44:47]
ds_read_b64_tr_b16 a[204:205], v6 offset:16640
ds_read_b64_tr_b16 a[206:207], v6 offset:24832
buffer_load_dwordx4 v18, s[4:7], s25 offen offset:1024 lds
s_waitcnt lgkmcnt(6)
v_mfma_f32_16x16x32_bf16 a[48:51], a[176:179], v[192:195], a[48:51]
ds_read_b64_tr_b16 a[208:209], v7 offset:256
v_exp_f32 v45, v165
v_mfma_f32_16x16x32_bf16 a[48:51], a[180:183], v[196:199], a[48:51]
ds_read_b64_tr_b16 a[210:211], v7 offset:8448
v_mfma_f32_16x16x32_bf16 a[52:55], a[176:179], v[200:203], a[52:55]
ds_read_b64_tr_b16 a[212:213], v7 offset:16640
v_cvt_pk_bf16_f32 v209, v42, v43
v_mfma_f32_16x16x32_bf16 a[52:55], a[180:183], v[204:207], a[52:55]
ds_read_b64_tr_b16 a[214:215], v7 offset:24832
v_mfma_f32_16x16x32_bf16 a[56:59], a[184:187], v[192:195], a[56:59]
ds_read_b64_tr_b16 a[216:217], v8 offset:256
v_add_f32 v31, v43, v31
v_mfma_f32_16x16x32_bf16 a[56:59], a[188:191], v[196:199], a[56:59]
ds_read_b64_tr_b16 a[218:219], v8 offset:8448
buffer_load_dwordx4 v19, s[4:7], s25 offen offset:2048 lds
v_mfma_f32_16x16x32_bf16 a[60:63], a[184:187], v[200:203], a[60:63]
ds_read_b64_tr_b16 a[220:221], v8 offset:16640
v_mfma_f32_16x16x32_bf16 a[60:63], a[188:191], v[204:207], a[60:63]
ds_read_b64_tr_b16 a[222:223], v8 offset:24832
v_exp_f32 v46, v166
v_mfma_f32_16x16x32_bf16 a[64:67], a[192:195], v[192:195], a[64:67]
ds_read_b64_tr_b16 a[224:225], v9 offset:256
s_waitcnt lgkmcnt(5)
v_mfma_f32_16x16x32_bf16 a[64:67], a[196:199], v[196:199], a[64:67]
ds_read_b64_tr_b16 a[226:227], v9 offset:8448
v_add_f32 v32, v44, v45
v_mfma_f32_16x16x32_bf16 a[68:71], a[192:195], v[200:203], a[68:71]
ds_read_b64_tr_b16 a[228:229], v9 offset:16640
v_mfma_f32_16x16x32_bf16 a[68:71], a[196:199], v[204:207], a[68:71]
ds_read_b64_tr_b16 a[230:231], v9 offset:24832
ds_read_b64_tr_b16 a[232:233], v10 offset:256
buffer_load_dwordx4 v20, s[4:7], s25 offen offset:3072 lds
v_mfma_f32_16x16x32_bf16 a[72:75], a[200:203], v[192:195], a[72:75]
ds_read_b64_tr_b16 a[234:235], v10 offset:8448
s_add_u32 s25, s25, 32768
v_mfma_f32_16x16x32_bf16 a[72:75], a[204:207], v[196:199], a[72:75]
ds_read_b64_tr_b16 a[236:237], v10 offset:16640
v_exp_f32 v47, v167
v_mfma_f32_16x16x32_bf16 a[76:79], a[200:203], v[200:203], a[76:79]
ds_read_b64_tr_b16 a[238:239], v10 offset:24832
v_mfma_f32_16x16x32_bf16 a[76:79], a[204:207], v[204:207], a[76:79]
ds_read_b64_tr_b16 a[240:241], v11 offset:256
v_cvt_pk_bf16_f32 v216, v44, v45
v_mfma_f32_16x16x32_bf16 a[80:83], a[208:211], v[192:195], a[80:83]
ds_read_b64_tr_b16 a[242:243], v11 offset:8448
v_mfma_f32_16x16x32_bf16 a[80:83], a[212:215], v[196:199], a[80:83]
ds_read_b64_tr_b16 a[244:245], v11 offset:16640
v_exp_f32 v40, v168
v_mfma_f32_16x16x32_bf16 a[84:87], a[208:211], v[200:203], a[84:87]
ds_read_b64_tr_b16 a[246:247], v11 offset:24832
v_mfma_f32_16x16x32_bf16 a[84:87], a[212:215], v[204:207], a[84:87]
ds_read_b64_tr_b16 a[248:249], v12 offset:256
v_add_f32 v32, v46, v32
s_waitcnt lgkmcnt(5)
v_mfma_f32_16x16x32_bf16 a[88:91], a[216:219], v[192:195], a[88:91]
ds_read_b64_tr_b16 a[250:251], v12 offset:8448
v_mfma_f32_16x16x32_bf16 a[88:91], a[220:223], v[196:199], a[88:91]
ds_read_b64_tr_b16 a[252:253], v12 offset:16640
v_exp_f32 v41, v169
v_mfma_f32_16x16x32_bf16 a[92:95], a[216:219], v[200:203], a[92:95]
ds_read_b64_tr_b16 a[254:255], v12 offset:24832
v_mfma_f32_16x16x32_bf16 a[92:95], a[220:223], v[204:207], a[92:95]
v_cvt_pk_bf16_f32 v217, v46, v47
v_add_f32 v32, v47, v32
v_mfma_f32_16x16x32_bf16 a[96:99], a[224:227], v[192:195], a[96:99]
v_exp_f32 v42, v170
v_mfma_f32_16x16x32_bf16 a[96:99], a[228:231], v[196:199], a[96:99]
v_add_f32 v31, v40, v31
v_mfma_f32_16x16x32_bf16 a[100:103], a[224:227], v[200:203], a[100:103]
v_exp_f32 v43, v171
v_mfma_f32_16x16x32_bf16 a[100:103], a[228:231], v[204:207], a[100:103]
v_cvt_pk_bf16_f32 v210, v40, v41
v_add_f32 v31, v41, v31
v_mfma_f32_16x16x32_bf16 a[104:107], a[232:235], v[192:195], a[104:107]
s_waitcnt vmcnt(19) lgkmcnt(0)
s_barrier
ds_read_b128 a[128:131], v1 offset:32768
v_mfma_f32_16x16x32_bf16 a[104:107], a[236:239], v[196:199], a[104:107]
ds_read_b128 a[132:135], v2 offset:32768
v_mfma_f32_16x16x32_bf16 a[108:111], a[232:235], v[200:203], a[108:111]
v_exp_f32 v44, v172
v_add_f32 v31, v42, v31
v_mfma_f32_16x16x32_bf16 a[108:111], a[236:239], v[204:207], a[108:111]
ds_read_b128 a[136:139], v3 offset:32768
v_mfma_f32_16x16x32_bf16 a[112:115], a[240:243], v[192:195], a[112:115]
s_add_u32 m0, s24, 65536
v_exp_f32 v45, v173
v_mfma_f32_16x16x32_bf16 a[112:115], a[244:247], v[196:199], a[112:115]
ds_read_b128 a[140:143], v4 offset:32768
buffer_load_dwordx4 v21, s[8:11], s26 offen lds
v_mfma_f32_16x16x32_bf16 a[116:119], a[240:243], v[200:203], a[116:119]
ds_read_b128 a[144:147], v1 offset:33024
v_mfma_f32_16x16x32_bf16 a[116:119], a[244:247], v[204:207], a[116:119]
ds_read_b128 a[148:151], v2 offset:33024
v_cvt_pk_bf16_f32 v211, v42, v43
v_mfma_f32_16x16x32_bf16 a[120:123], a[248:251], v[192:195], a[120:123]
ds_read_b128 a[152:155], v3 offset:33024
v_mfma_f32_16x16x32_bf16 a[120:123], a[252:255], v[196:199], a[120:123]
ds_read_b128 a[156:159], v4 offset:33024
v_add_f32 v31, v43, v31
v_mfma_f32_16x16x32_bf16 a[124:127], a[248:251], v[200:203], a[124:127]
v_exp_f32 v46, v174
v_mfma_f32_16x16x32_bf16 a[124:127], a[252:255], v[204:207], a[124:127]
buffer_load_dwordx4 v22, s[8:11], s26 offen offset:1024 lds
v_add_f32 v32, v44, v32
s_waitcnt lgkmcnt(3)
v_mfma_f32_16x16x32_bf16 v[128:131], a[128:131], v[64:67], v[48:51]
v_exp_f32 v47, v175
v_mfma_f32_16x16x32_bf16 v[128:131], a[132:135], v[72:75], v[128:131]
v_cvt_pk_bf16_f32 v218, v44, v45
v_mfma_f32_16x16x32_bf16 v[128:131], a[136:139], v[80:83], v[128:131]
ds_read_b128 a[160:163], v1 offset:40960
v_add_f32 v32, v45, v32
v_mfma_f32_16x16x32_bf16 v[128:131], a[140:143], v[88:91], v[128:131]
v_exp_f32 v40, v176
v_mfma_f32_16x16x32_bf16 v[128:131], a[144:147], v[96:99], v[128:131]
ds_read_b128 a[164:167], v2 offset:40960
s_waitcnt lgkmcnt(2)
v_mfma_f32_16x16x32_bf16 v[128:131], a[148:151], v[104:107], v[128:131]
buffer_load_dwordx4 v23, s[8:11], s26 offen offset:2048 lds
v_add_f32 v32, v46, v32
v_mfma_f32_16x16x32_bf16 v[128:131], a[152:155], v[112:115], v[128:131]
ds_read_b128 a[168:171], v3 offset:40960
v_mfma_f32_16x16x32_bf16 v[128:131], a[156:159], v[120:123], v[128:131]
v_exp_f32 v41, v177
v_cvt_pk_bf16_f32 v219, v46, v47
v_mfma_f32_16x16x32_bf16 v[132:135], a[128:131], v[68:71], v[52:55]
ds_read_b128 a[172:175], v4 offset:40960
v_mfma_f32_16x16x32_bf16 v[132:135], a[132:135], v[76:79], v[132:135]
v_add_f32 v32, v47, v32
v_exp_f32 v42, v178
v_mfma_f32_16x16x32_bf16 v[132:135], a[136:139], v[84:87], v[132:135]
ds_read_b128 a[176:179], v1 offset:41216
v_mfma_f32_16x16x32_bf16 v[132:135], a[140:143], v[92:95], v[132:135]
ds_read_b128 a[180:183], v2 offset:41216
buffer_load_dwordx4 v24, s[8:11], s26 offen offset:3072 lds
v_mfma_f32_16x16x32_bf16 v[132:135], a[144:147], v[100:103], v[132:135]
ds_read_b128 a[184:187], v3 offset:41216
v_add_f32 v31, v40, v31
v_mfma_f32_16x16x32_bf16 v[132:135], a[148:151], v[108:111], v[132:135]
ds_read_b128 a[188:191], v4 offset:41216
v_mfma_f32_16x16x32_bf16 v[132:135], a[152:155], v[116:119], v[132:135]
v_exp_f32 v43, v179
v_mfma_f32_16x16x32_bf16 v[132:135], a[156:159], v[124:127], v[132:135]
v_cvt_pk_bf16_f32 v212, v40, v41
v_add_f32 v31, v41, v31
s_waitcnt lgkmcnt(3)
v_mfma_f32_16x16x32_bf16 v[136:139], a[160:163], v[64:67], v[48:51]
s_add_u32 m0, s24, 69632
v_mfma_f32_16x16x32_bf16 v[136:139], a[164:167], v[72:75], v[136:139]
ds_read_b128 a[192:195], v1 offset:49152
buffer_load_dwordx4 v25, s[8:11], s26 offen lds
v_mfma_f32_16x16x32_bf16 v[136:139], a[168:171], v[80:83], v[136:139]
v_exp_f32 v44, v180
v_mfma_f32_16x16x32_bf16 v[136:139], a[172:175], v[88:91], v[136:139]
ds_read_b128 a[196:199], v2 offset:49152
v_add_f32 v31, v42, v31
v_mfma_f32_16x16x32_bf16 v[136:139], a[176:179], v[96:99], v[136:139]
v_exp_f32 v45, v181
s_waitcnt lgkmcnt(2)
v_mfma_f32_16x16x32_bf16 v[136:139], a[180:183], v[104:107], v[136:139]
ds_read_b128 a[200:203], v3 offset:49152
v_cvt_pk_bf16_f32 v213, v42, v43
v_mfma_f32_16x16x32_bf16 v[136:139], a[184:187], v[112:115], v[136:139]
v_add_f32 v31, v43, v31
v_mfma_f32_16x16x32_bf16 v[136:139], a[188:191], v[120:123], v[136:139]
ds_read_b128 a[204:207], v4 offset:49152
buffer_load_dwordx4 v26, s[8:11], s26 offen offset:1024 lds
v_mfma_f32_16x16x32_bf16 v[140:143], a[160:163], v[68:71], v[52:55]
ds_read_b128 a[208:211], v1 offset:49408
v_exp_f32 v46, v182
v_mfma_f32_16x16x32_bf16 v[140:143], a[164:167], v[76:79], v[140:143]
v_add_f32 v32, v44, v32
v_mfma_f32_16x16x32_bf16 v[140:143], a[168:171], v[84:87], v[140:143]
ds_read_b128 a[212:215], v2 offset:49408
v_mfma_f32_16x16x32_bf16 v[140:143], a[172:175], v[92:95], v[140:143]
v_exp_f32 v47, v183
v_mfma_f32_16x16x32_bf16 v[140:143], a[176:179], v[100:103], v[140:143]
ds_read_b128 a[216:219], v3 offset:49408
v_cvt_pk_bf16_f32 v220, v44, v45
v_mfma_f32_16x16x32_bf16 v[140:143], a[180:183], v[108:111], v[140:143]
ds_read_b128 a[220:223], v4 offset:49408
buffer_load_dwordx4 v27, s[8:11], s26 offen offset:2048 lds
v_mfma_f32_16x16x32_bf16 v[140:143], a[184:187], v[116:119], v[140:143]
v_add_f32 v32, v45, v32
v_mfma_f32_16x16x32_bf16 v[140:143], a[188:191], v[124:127], v[140:143]
v_exp_f32 v40, v184
v_add_f32 v32, v46, v32
s_waitcnt lgkmcnt(2)
v_mfma_f32_16x16x32_bf16 v[144:147], a[192:195], v[64:67], v[48:51]
ds_read_b128 a[224:227], v1 offset:57344
v_mfma_f32_16x16x32_bf16 v[144:147], a[196:199], v[72:75], v[144:147]
v_exp_f32 v41, v185
v_mfma_f32_16x16x32_bf16 v[144:147], a[200:203], v[80:83], v[144:147]
ds_read_b128 a[228:231], v2 offset:57344
v_cvt_pk_bf16_f32 v221, v46, v47
v_mfma_f32_16x16x32_bf16 v[144:147], a[204:207], v[88:91], v[144:147]
ds_read_b128 a[232:235], v3 offset:57344
buffer_load_dwordx4 v28, s[8:11], s26 offen offset:3072 lds
v_mfma_f32_16x16x32_bf16 v[144:147], a[208:211], v[96:99], v[144:147]
s_add_u32 s26, s26, 32768
v_add_f32 v32, v47, v32
v_mfma_f32_16x16x32_bf16 v[144:147], a[212:215], v[104:107], v[144:147]
ds_read_b128 a[236:239], v4 offset:57344
s_waitcnt lgkmcnt(3)
v_mfma_f32_16x16x32_bf16 v[144:147], a[216:219], v[112:115], v[144:147]
v_exp_f32 v42, v186
v_mfma_f32_16x16x32_bf16 v[144:147], a[220:223], v[120:123], v[144:147]
ds_read_b128 a[240:243], v1 offset:57600
v_add_f32 v31, v40, v31
v_mfma_f32_16x16x32_bf16 v[148:151], a[192:195], v[68:71], v[52:55]
v_exp_f32 v43, v187
v_mfma_f32_16x16x32_bf16 v[148:151], a[196:199], v[76:79], v[148:151]
ds_read_b128 a[244:247], v2 offset:57600
v_mfma_f32_16x16x32_bf16 v[148:151], a[200:203], v[84:87], v[148:151]
v_cvt_pk_bf16_f32 v214, v40, v41
v_add_f32 v31, v41, v31
v_mfma_f32_16x16x32_bf16 v[148:151], a[204:207], v[92:95], v[148:151]
ds_read_b128 a[248:251], v3 offset:57600
v_mfma_f32_16x16x32_bf16 v[148:151], a[208:211], v[100:103], v[148:151]
v_exp_f32 v44, v188
v_add_f32 v31, v42, v31
v_mfma_f32_16x16x32_bf16 v[148:151], a[212:215], v[108:111], v[148:151]
ds_read_b128 a[252:255], v4 offset:57600
v_mfma_f32_16x16x32_bf16 v[148:151], a[216:219], v[116:119], v[148:151]
v_exp_f32 v45, v189
v_mfma_f32_16x16x32_bf16 v[148:151], a[220:223], v[124:127], v[148:151]
v_cvt_pk_bf16_f32 v215, v42, v43
v_add_f32 v31, v43, v31
v_mfma_f32_16x16x32_bf16 v[152:155], a[224:227], v[64:67], v[48:51]
v_exp_f32 v46, v190
s_waitcnt lgkmcnt(1)
v_mfma_f32_16x16x32_bf16 v[152:155], a[228:231], v[72:75], v[152:155]
v_add_f32 v32, v44, v32
v_mfma_f32_16x16x32_bf16 v[152:155], a[232:235], v[80:83], v[152:155]
v_exp_f32 v47, v191
v_mfma_f32_16x16x32_bf16 v[152:155], a[236:239], v[88:91], v[152:155]
v_cvt_pk_bf16_f32 v222, v44, v45
v_add_f32 v32, v45, v32
v_mfma_f32_16x16x32_bf16 v[152:155], a[240:243], v[96:99], v[152:155]
s_waitcnt vmcnt(17) lgkmcnt(0)
s_barrier
ds_read_b64_tr_b16 a[128:129], v5 offset:32768
ds_read_b64_tr_b16 a[130:131], v5 offset:40960
v_mfma_f32_16x16x32_bf16 v[152:155], a[244:247], v[104:107], v[152:155]
ds_read_b64_tr_b16 a[132:133], v5 offset:49152
v_add_f32 v32, v46, v32
v_mfma_f32_16x16x32_bf16 v[152:155], a[248:251], v[112:115], v[152:155]
ds_read_b64_tr_b16 a[134:135], v5 offset:57344
v_mfma_f32_16x16x32_bf16 v[152:155], a[252:255], v[120:123], v[152:155]
ds_read_b64_tr_b16 a[136:137], v6 offset:32768
v_cvt_pk_bf16_f32 v223, v46, v47
v_mfma_f32_16x16x32_bf16 v[156:159], a[224:227], v[68:71], v[52:55]
ds_read_b64_tr_b16 a[138:139], v6 offset:40960
s_add_u32 m0, s24, 32768
v_mfma_f32_16x16x32_bf16 v[156:159], a[228:231], v[76:79], v[156:159]
ds_read_b64_tr_b16 a[140:141], v6 offset:49152
buffer_load_dwordx4 v13, s[4:7], s25 offen lds
v_mfma_f32_16x16x32_bf16 v[156:159], a[232:235], v[84:87], v[156:159]
ds_read_b64_tr_b16 a[142:143], v6 offset:57344
v_add_f32 v32, v47, v32
v_mfma_f32_16x16x32_bf16 v[156:159], a[236:239], v[92:95], v[156:159]
ds_read_b64_tr_b16 a[144:145], v7 offset:32768
v_max_f32 v33, v31, v32
v_mfma_f32_16x16x32_bf16 v[156:159], a[240:243], v[100:103], v[156:159]
ds_read_b64_tr_b16 a[146:147], v7 offset:40960
v_mfma_f32_16x16x32_bf16 v[156:159], a[244:247], v[108:111], v[156:159]
ds_read_b64_tr_b16 a[148:149], v7 offset:49152
v_cmp_nge_f32 vcc, s28, v33
v_mfma_f32_16x16x32_bf16 v[156:159], a[248:251], v[116:119], v[156:159]
ds_read_b64_tr_b16 a[150:151], v7 offset:57344
v_mfma_f32_16x16x32_bf16 v[156:159], a[252:255], v[124:127], v[156:159]
ds_read_b64_tr_b16 a[152:153], v8 offset:32768
ds_read_b64_tr_b16 a[154:155], v8 offset:40960
buffer_load_dwordx4 v14, s[4:7], s25 offen offset:1024 lds
s_cbranch_vccnz K_STUB4
K_BACK4:
s_waitcnt lgkmcnt(6)
v_mfma_f32_16x16x32_bf16 a[0:3], a[128:131], v[208:211], a[0:3]
ds_read_b64_tr_b16 a[156:157], v8 offset:49152
v_add_f32 v29, v29, v31
v_add_f32 v30, v30, v32
v_mfma_f32_16x16x32_bf16 a[0:3], a[132:135], v[212:215], a[0:3]
ds_read_b64_tr_b16 a[158:159], v8 offset:57344
v_mfma_f32_16x16x32_bf16 a[4:7], a[128:131], v[216:219], a[4:7]
ds_read_b64_tr_b16 a[160:161], v9 offset:32768
v_exp_f32 v40, v128
v_mfma_f32_16x16x32_bf16 a[4:7], a[132:135], v[220:223], a[4:7]
ds_read_b64_tr_b16 a[162:163], v9 offset:40960
v_mfma_f32_16x16x32_bf16 a[8:11], a[136:139], v[208:211], a[8:11]
ds_read_b64_tr_b16 a[164:165], v9 offset:49152
v_mfma_f32_16x16x32_bf16 a[8:11], a[140:143], v[212:215], a[8:11]
ds_read_b64_tr_b16 a[166:167], v9 offset:57344
buffer_load_dwordx4 v15, s[4:7], s25 offen offset:2048 lds
v_mfma_f32_16x16x32_bf16 a[12:15], a[136:139], v[216:219], a[12:15]
ds_read_b64_tr_b16 a[168:169], v10 offset:32768
v_exp_f32 v41, v129
v_mfma_f32_16x16x32_bf16 a[12:15], a[140:143], v[220:223], a[12:15]
ds_read_b64_tr_b16 a[170:171], v10 offset:40960
s_waitcnt lgkmcnt(5)
v_mfma_f32_16x16x32_bf16 a[16:19], a[144:147], v[208:211], a[16:19]
ds_read_b64_tr_b16 a[172:173], v10 offset:49152
v_exp_f32 v42, v130
v_mfma_f32_16x16x32_bf16 a[16:19], a[148:151], v[212:215], a[16:19]
ds_read_b64_tr_b16 a[174:175], v10 offset:57344
v_mfma_f32_16x16x32_bf16 a[20:23], a[144:147], v[216:219], a[20:23]
ds_read_b64_tr_b16 a[176:177], v11 offset:32768
v_add_f32 v31, v40, v41
v_mfma_f32_16x16x32_bf16 a[20:23], a[148:151], v[220:223], a[20:23]
ds_read_b64_tr_b16 a[178:179], v11 offset:40960
ds_read_b64_tr_b16 a[180:181], v11 offset:49152
buffer_load_dwordx4 v16, s[4:7], s25 offen offset:3072 lds
v_mfma_f32_16x16x32_bf16 a[24:27], a[152:155], v[208:211], a[24:27]
ds_read_b64_tr_b16 a[182:183], v11 offset:57344
v_mfma_f32_16x16x32_bf16 a[24:27], a[156:159], v[212:215], a[24:27]
ds_read_b64_tr_b16 a[184:185], v12 offset:32768
v_exp_f32 v43, v131
v_mfma_f32_16x16x32_bf16 a[28:31], a[152:155], v[216:219], a[28:31]
ds_read_b64_tr_b16 a[186:187], v12 offset:40960
v_mfma_f32_16x16x32_bf16 a[28:31], a[156:159], v[220:223], a[28:31]
ds_read_b64_tr_b16 a[188:189], v12 offset:49152
v_cvt_pk_bf16_f32 v192, v40, v41
s_waitcnt lgkmcnt(6)
v_mfma_f32_16x16x32_bf16 a[32:35], a[160:163], v[208:211], a[32:35]
ds_read_b64_tr_b16 a[190:191], v12 offset:57344
s_add_u32 m0, s24, 36864
v_mfma_f32_16x16x32_bf16 a[32:35], a[164:167], v[212:215], a[32:35]
ds_read_b64_tr_b16 a[192:193], v5 offset:33024
buffer_load_dwordx4 v17, s[4:7], s25 offen lds
v_mfma_f32_16x16x32_bf16 a[36:39], a[160:163], v[216:219], a[36:39]
ds_read_b64_tr_b16 a[194:195], v5 offset:41216
v_mfma_f32_16x16x32_bf16 a[36:39], a[164:167], v[220:223], a[36:39]
ds_read_b64_tr_b16 a[196:197], v5 offset:49408
v_exp_f32 v44, v132
v_mfma_f32_16x16x32_bf16 a[40:43], a[168:171], v[208:211], a[40:43]
ds_read_b64_tr_b16 a[198:199], v5 offset:57600
v_mfma_f32_16x16x32_bf16 a[40:43], a[172:175], v[212:215], a[40:43]
ds_read_b64_tr_b16 a[200:201], v6 offset:33024
v_add_f32 v31, v42, v31
v_mfma_f32_16x16x32_bf16 a[44:47], a[168:171], v[216:219], a[44:47]
ds_read_b64_tr_b16 a[202:203], v6 offset:41216
v_mfma_f32_16x16x32_bf16 a[44:47], a[172:175], v[220:223], a[44:47]
ds_read_b64_tr_b16 a[204:205], v6 offset:49408
ds_read_b64_tr_b16 a[206:207], v6 offset:57600
buffer_load_dwordx4 v18, s[4:7], s25 offen offset:1024 lds
s_waitcnt lgkmcnt(6)
v_mfma_f32_16x16x32_bf16 a[48:51], a[176:179], v[208:211], a[48:51]
ds_read_b64_tr_b16 a[208:209], v7 offset:33024
v_exp_f32 v45, v133
v_mfma_f32_16x16x32_bf16 a[48:51], a[180:183], v[212:215], a[48:51]
ds_read_b64_tr_b16 a[210:211], v7 offset:41216
v_mfma_f32_16x16x32_bf16 a[52:55], a[176:179], v[216:219], a[52:55]
ds_read_b64_tr_b16 a[212:213], v7 offset:49408
v_cvt_pk_bf16_f32 v193, v42, v43
v_mfma_f32_16x16x32_bf16 a[52:55], a[180:183], v[220:223], a[52:55]
ds_read_b64_tr_b16 a[214:215], v7 offset:57600
v_mfma_f32_16x16x32_bf16 a[56:59], a[184:187], v[208:211], a[56:59]
ds_read_b64_tr_b16 a[216:217], v8 offset:33024
v_add_f32 v31, v43, v31
v_mfma_f32_16x16x32_bf16 a[56:59], a[188:191], v[212:215], a[56:59]
ds_read_b64_tr_b16 a[218:219], v8 offset:41216
buffer_load_dwordx4 v19, s[4:7], s25 offen offset:2048 lds
v_mfma_f32_16x16x32_bf16 a[60:63], a[184:187], v[216:219], a[60:63]
ds_read_b64_tr_b16 a[220:221], v8 offset:49408
v_mfma_f32_16x16x32_bf16 a[60:63], a[188:191], v[220:223], a[60:63]
ds_read_b64_tr_b16 a[222:223], v8 offset:57600
v_exp_f32 v46, v134
v_mfma_f32_16x16x32_bf16 a[64:67], a[192:195], v[208:211], a[64:67]
ds_read_b64_tr_b16 a[224:225], v9 offset:33024
s_waitcnt lgkmcnt(5)
v_mfma_f32_16x16x32_bf16 a[64:67], a[196:199], v[212:215], a[64:67]
ds_read_b64_tr_b16 a[226:227], v9 offset:41216
v_add_f32 v32, v44, v45
v_mfma_f32_16x16x32_bf16 a[68:71], a[192:195], v[216:219], a[68:71]
ds_read_b64_tr_b16 a[228:229], v9 offset:49408
v_mfma_f32_16x16x32_bf16 a[68:71], a[196:199], v[220:223], a[68:71]
ds_read_b64_tr_b16 a[230:231], v9 offset:57600
ds_read_b64_tr_b16 a[232:233], v10 offset:33024
buffer_load_dwordx4 v20, s[4:7], s25 offen offset:3072 lds
v_mfma_f32_16x16x32_bf16 a[72:75], a[200:203], v[208:211], a[72:75]
ds_read_b64_tr_b16 a[234:235], v10 offset:41216
s_add_u32 s25, s25, 32768
v_mfma_f32_16x16x32_bf16 a[72:75], a[204:207], v[212:215], a[72:75]
ds_read_b64_tr_b16 a[236:237], v10 offset:49408
v_exp_f32 v47, v135
v_mfma_f32_16x16x32_bf16 a[76:79], a[200:203], v[216:219], a[76:79]
ds_read_b64_tr_b16 a[238:239], v10 offset:57600
v_mfma_f32_16x16x32_bf16 a[76:79], a[204:207], v[220:223], a[76:79]
ds_read_b64_tr_b16 a[240:241], v11 offset:33024
v_cvt_pk_bf16_f32 v200, v44, v45
v_mfma_f32_16x16x32_bf16 a[80:83], a[208:211], v[208:211], a[80:83]
ds_read_b64_tr_b16 a[242:243], v11 offset:41216
v_mfma_f32_16x16x32_bf16 a[80:83], a[212:215], v[212:215], a[80:83]
ds_read_b64_tr_b16 a[244:245], v11 offset:49408
v_exp_f32 v40, v136
v_mfma_f32_16x16x32_bf16 a[84:87], a[208:211], v[216:219], a[84:87]
ds_read_b64_tr_b16 a[246:247], v11 offset:57600
v_mfma_f32_16x16x32_bf16 a[84:87], a[212:215], v[220:223], a[84:87]
ds_read_b64_tr_b16 a[248:249], v12 offset:33024
v_add_f32 v32, v46, v32
s_waitcnt lgkmcnt(5)
v_mfma_f32_16x16x32_bf16 a[88:91], a[216:219], v[208:211], a[88:91]
ds_read_b64_tr_b16 a[250:251], v12 offset:41216
v_mfma_f32_16x16x32_bf16 a[88:91], a[220:223], v[212:215], a[88:91]
ds_read_b64_tr_b16 a[252:253], v12 offset:49408
v_exp_f32 v41, v137
v_mfma_f32_16x16x32_bf16 a[92:95], a[216:219], v[216:219], a[92:95]
ds_read_b64_tr_b16 a[254:255], v12 offset:57600
v_mfma_f32_16x16x32_bf16 a[92:95], a[220:223], v[220:223], a[92:95]
v_cvt_pk_bf16_f32 v201, v46, v47
v_add_f32 v32, v47, v32
v_mfma_f32_16x16x32_bf16 a[96:99], a[224:227], v[208:211], a[96:99]
v_exp_f32 v42, v138
v_mfma_f32_16x16x32_bf16 a[96:99], a[228:231], v[212:215], a[96:99]
v_add_f32 v31, v40, v31
v_mfma_f32_16x16x32_bf16 a[100:103], a[224:227], v[216:219], a[100:103]
v_exp_f32 v43, v139
v_mfma_f32_16x16x32_bf16 a[100:103], a[228:231], v[220:223], a[100:103]
v_cvt_pk_bf16_f32 v194, v40, v41
v_add_f32 v31, v41, v31
s_sub_u32 s27, s27, 1
s_cbranch_scc0 K_LOOP
K_LEND:
v_mfma_f32_16x16x32_bf16 a[104:107], a[232:235], v[208:211], a[104:107]
s_waitcnt vmcnt(16) lgkmcnt(0)
s_barrier
ds_read_b128 a[128:131], v1 offset:0
v_mfma_f32_16x16x32_bf16 a[104:107], a[236:239], v[212:215], a[104:107]
ds_read_b128 a[132:135], v2 offset:0
v_mfma_f32_16x16x32_bf16 a[108:111], a[232:235], v[216:219], a[108:111]
v_exp_f32 v44, v140
v_add_f32 v31, v42, v31
v_mfma_f32_16x16x32_bf16 a[108:111], a[236:239], v[220:223], a[108:111]
ds_read_b128 a[136:139], v3 offset:0
v_mfma_f32_16x16x32_bf16 a[112:115], a[240:243], v[208:211], a[112:115]
s_add_u32 m0, s24, 98304
v_exp_f32 v45, v141
v_mfma_f32_16x16x32_bf16 a[112:115], a[244:247], v[212:215], a[112:115]
ds_read_b128 a[140:143], v4 offset:0
buffer_load_dwordx4 v21, s[8:11], s26 offen lds
v_mfma_f32_16x16x32_bf16 a[116:119], a[240:243], v[216:219], a[116:119]
ds_read_b128 a[144:147], v1 offset:256
v_mfma_f32_16x16x32_bf16 a[116:119], a[244:247], v[220:223], a[116:119]
ds_read_b128 a[148:151], v2 offset:256
v_cvt_pk_bf16_f32 v195, v42, v43
v_mfma_f32_16x16x32_bf16 a[120:123], a[248:251], v[208:211], a[120:123]
ds_read_b128 a[152:155], v3 offset:256
v_mfma_f32_16x16x32_bf16 a[120:123], a[252:255], v[212:215], a[120:123]
ds_read_b128 a[156:159], v4 offset:256
v_add_f32 v31, v43, v31
v_mfma_f32_16x16x32_bf16 a[124:127], a[248:251], v[216:219], a[124:127]
v_exp_f32 v46, v142
v_mfma_f32_16x16x32_bf16 a[124:127], a[252:255], v[220:223], a[124:127]
buffer_load_dwordx4 v22, s[8:11], s26 offen offset:1024 lds
v_add_f32 v32, v44, v32
s_waitcnt lgkmcnt(3)
v_mfma_f32_16x16x32_bf16 v[160:163], a[128:131], v[64:67], v[48:51]
v_exp_f32 v47, v143
v_mfma_f32_16x16x32_bf16 v[160:163], a[132:135], v[72:75], v[160:163]
v_cvt_pk_bf16_f32 v202, v44, v45
v_mfma_f32_16x16x32_bf16 v[160:163], a[136:139], v[80:83], v[160:163]
ds_read_b128 a[160:163], v1 offset:8192
v_add_f32 v32, v45, v32
v_mfma_f32_16x16x32_bf16 v[160:163], a[140:143], v[88:91], v[160:163]
v_exp_f32 v40, v144
v_mfma_f32_16x16x32_bf16 v[160:163], a[144:147], v[96:99], v[160:163]
ds_read_b128 a[164:167], v2 offset:8192
s_waitcnt lgkmcnt(2)
v_mfma_f32_16x16x32_bf16 v[160:163], a[148:151], v[104:107], v[160:163]
buffer_load_dwordx4 v23, s[8:11], s26 offen offset:2048 lds
v_add_f32 v32, v46, v32
v_mfma_f32_16x16x32_bf16 v[160:163], a[152:155], v[112:115], v[160:163]
ds_read_b128 a[168:171], v3 offset:8192
v_mfma_f32_16x16x32_bf16 v[160:163], a[156:159], v[120:123], v[160:163]
v_exp_f32 v41, v145
v_cvt_pk_bf16_f32 v203, v46, v47
v_mfma_f32_16x16x32_bf16 v[164:167], a[128:131], v[68:71], v[52:55]
ds_read_b128 a[172:175], v4 offset:8192
v_mfma_f32_16x16x32_bf16 v[164:167], a[132:135], v[76:79], v[164:167]
v_add_f32 v32, v47, v32
v_exp_f32 v42, v146
v_mfma_f32_16x16x32_bf16 v[164:167], a[136:139], v[84:87], v[164:167]
ds_read_b128 a[176:179], v1 offset:8448
v_mfma_f32_16x16x32_bf16 v[164:167], a[140:143], v[92:95], v[164:167]
ds_read_b128 a[180:183], v2 offset:8448
buffer_load_dwordx4 v24, s[8:11], s26 offen offset:3072 lds
v_mfma_f32_16x16x32_bf16 v[164:167], a[144:147], v[100:103], v[164:167]
ds_read_b128 a[184:187], v3 offset:8448
v_add_f32 v31, v40, v31
v_mfma_f32_16x16x32_bf16 v[164:167], a[148:151], v[108:111], v[164:167]
ds_read_b128 a[188:191], v4 offset:8448
v_mfma_f32_16x16x32_bf16 v[164:167], a[152:155], v[116:119], v[164:167]
v_exp_f32 v43, v147
v_mfma_f32_16x16x32_bf16 v[164:167], a[156:159], v[124:127], v[164:167]
v_cvt_pk_bf16_f32 v196, v40, v41
v_add_f32 v31, v41, v31
s_waitcnt lgkmcnt(3)
v_mfma_f32_16x16x32_bf16 v[168:171], a[160:163], v[64:67], v[48:51]
s_add_u32 m0, s24, 102400
v_mfma_f32_16x16x32_bf16 v[168:171], a[164:167], v[72:75], v[168:171]
ds_read_b128 a[192:195], v1 offset:16384
buffer_load_dwordx4 v25, s[8:11], s26 offen lds
v_mfma_f32_16x16x32_bf16 v[168:171], a[168:171], v[80:83], v[168:171]
v_exp_f32 v44, v148
v_mfma_f32_16x16x32_bf16 v[168:171], a[172:175], v[88:91], v[168:171]
ds_read_b128 a[196:199], v2 offset:16384
v_add_f32 v31, v42, v31
v_mfma_f32_16x16x32_bf16 v[168:171], a[176:179], v[96:99], v[168:171]
v_exp_f32 v45, v149
s_waitcnt lgkmcnt(2)
v_mfma_f32_16x16x32_bf16 v[168:171], a[180:183], v[104:107], v[168:171]
ds_read_b128 a[200:203], v3 offset:16384
v_cvt_pk_bf16_f32 v197, v42, v43
v_mfma_f32_16x16x32_bf16 v[168:171], a[184:187], v[112:115], v[168:171]
v_add_f32 v31, v43, v31
v_mfma_f32_16x16x32_bf16 v[168:171], a[188:191], v[120:123], v[168:171]
ds_read_b128 a[204:207], v4 offset:16384
buffer_load_dwordx4 v26, s[8:11], s26 offen offset:1024 lds
v_mfma_f32_16x16x32_bf16 v[172:175], a[160:163], v[68:71], v[52:55]
ds_read_b128 a[208:211], v1 offset:16640
v_exp_f32 v46, v150
v_mfma_f32_16x16x32_bf16 v[172:175], a[164:167], v[76:79], v[172:175]
v_add_f32 v32, v44, v32
v_mfma_f32_16x16x32_bf16 v[172:175], a[168:171], v[84:87], v[172:175]
ds_read_b128 a[212:215], v2 offset:16640
v_mfma_f32_16x16x32_bf16 v[172:175], a[172:175], v[92:95], v[172:175]
v_exp_f32 v47, v151
v_mfma_f32_16x16x32_bf16 v[172:175], a[176:179], v[100:103], v[172:175]
ds_read_b128 a[216:219], v3 offset:16640
v_cvt_pk_bf16_f32 v204, v44, v45
v_mfma_f32_16x16x32_bf16 v[172:175], a[180:183], v[108:111], v[172:175]
ds_read_b128 a[220:223], v4 offset:16640
buffer_load_dwordx4 v27, s[8:11], s26 offen offset:2048 lds
v_mfma_f32_16x16x32_bf16 v[172:175], a[184:187], v[116:119], v[172:175]
v_add_f32 v32, v45, v32
v_mfma_f32_16x16x32_bf16 v[172:175], a[188:191], v[124:127], v[172:175]
v_exp_f32 v40, v152
v_add_f32 v32, v46, v32
s_waitcnt lgkmcnt(2)
v_mfma_f32_16x16x32_bf16 v[176:179], a[192:195], v[64:67], v[48:51]
ds_read_b128 a[224:227], v1 offset:24576
v_mfma_f32_16x16x32_bf16 v[176:179], a[196:199], v[72:75], v[176:179]
v_exp_f32 v41, v153
v_mfma_f32_16x16x32_bf16 v[176:179], a[200:203], v[80:83], v[176:179]
ds_read_b128 a[228:231], v2 offset:24576
v_cvt_pk_bf16_f32 v205, v46, v47
v_mfma_f32_16x16x32_bf16 v[176:179], a[204:207], v[88:91], v[176:179]
ds_read_b128 a[232:235], v3 offset:24576
buffer_load_dwordx4 v28, s[8:11], s26 offen offset:3072 lds
v_mfma_f32_16x16x32_bf16 v[176:179], a[208:211], v[96:99], v[176:179]
s_add_u32 s26, s26, 32768
v_add_f32 v32, v47, v32
v_mfma_f32_16x16x32_bf16 v[176:179], a[212:215], v[104:107], v[176:179]
ds_read_b128 a[236:239], v4 offset:24576
s_waitcnt lgkmcnt(3)
v_mfma_f32_16x16x32_bf16 v[176:179], a[216:219], v[112:115], v[176:179]
v_exp_f32 v42, v154
v_mfma_f32_16x16x32_bf16 v[176:179], a[220:223], v[120:123], v[176:179]
ds_read_b128 a[240:243], v1 offset:24832
v_add_f32 v31, v40, v31
v_mfma_f32_16x16x32_bf16 v[180:183], a[192:195], v[68:71], v[52:55]
v_exp_f32 v43, v155
v_mfma_f32_16x16x32_bf16 v[180:183], a[196:199], v[76:79], v[180:183]
ds_read_b128 a[244:247], v2 offset:24832
v_mfma_f32_16x16x32_bf16 v[180:183], a[200:203], v[84:87], v[180:183]
v_cvt_pk_bf16_f32 v198, v40, v41
v_add_f32 v31, v41, v31
v_mfma_f32_16x16x32_bf16 v[180:183], a[204:207], v[92:95], v[180:183]
ds_read_b128 a[248:251], v3 offset:24832
v_mfma_f32_16x16x32_bf16 v[180:183], a[208:211], v[100:103], v[180:183]
v_exp_f32 v44, v156
v_add_f32 v31, v42, v31
v_mfma_f32_16x16x32_bf16 v[180:183], a[212:215], v[108:111], v[180:183]
ds_read_b128 a[252:255], v4 offset:24832
v_mfma_f32_16x16x32_bf16 v[180:183], a[216:219], v[116:119], v[180:183]
v_exp_f32 v45, v157
v_mfma_f32_16x16x32_bf16 v[180:183], a[220:223], v[124:127], v[180:183]
v_cvt_pk_bf16_f32 v199, v42, v43
v_add_f32 v31, v43, v31
v_mfma_f32_16x16x32_bf16 v[184:187], a[224:227], v[64:67], v[48:51]
v_exp_f32 v46, v158
s_waitcnt lgkmcnt(1)
v_mfma_f32_16x16x32_bf16 v[184:187], a[228:231], v[72:75], v[184:187]
v_add_f32 v32, v44, v32
v_mfma_f32_16x16x32_bf16 v[184:187], a[232:235], v[80:83], v[184:187]
v_exp_f32 v47, v159
v_mfma_f32_16x16x32_bf16 v[184:187], a[236:239], v[88:91], v[184:187]
v_cvt_pk_bf16_f32 v206, v44, v45
v_add_f32 v32, v45, v32
v_mfma_f32_16x16x32_bf16 v[184:187], a[240:243], v[96:99], v[184:187]
s_waitcnt vmcnt(16) lgkmcnt(0)
s_barrier
ds_read_b64_tr_b16 a[128:129], v5 offset:0
ds_read_b64_tr_b16 a[130:131], v5 offset:8192
v_mfma_f32_16x16x32_bf16 v[184:187], a[244:247], v[104:107], v[184:187]
ds_read_b64_tr_b16 a[132:133], v5 offset:16384
v_add_f32 v32, v46, v32
v_mfma_f32_16x16x32_bf16 v[184:187], a[248:251], v[112:115], v[184:187]
ds_read_b64_tr_b16 a[134:135], v5 offset:24576
v_mfma_f32_16x16x32_bf16 v[184:187], a[252:255], v[120:123], v[184:187]
ds_read_b64_tr_b16 a[136:137], v6 offset:0
v_cvt_pk_bf16_f32 v207, v46, v47
v_mfma_f32_16x16x32_bf16 v[188:191], a[224:227], v[68:71], v[52:55]
ds_read_b64_tr_b16 a[138:139], v6 offset:8192
s_add_u32 m0, s24, 0
v_mfma_f32_16x16x32_bf16 v[188:191], a[228:231], v[76:79], v[188:191]
ds_read_b64_tr_b16 a[140:141], v6 offset:16384
buffer_load_dwordx4 v13, s[4:7], s25 offen lds
v_mfma_f32_16x16x32_bf16 v[188:191], a[232:235], v[84:87], v[188:191]
ds_read_b64_tr_b16 a[142:143], v6 offset:24576
v_add_f32 v32, v47, v32
v_mfma_f32_16x16x32_bf16 v[188:191], a[236:239], v[92:95], v[188:191]
ds_read_b64_tr_b16 a[144:145], v7 offset:0
v_max_f32 v33, v31, v32
v_mfma_f32_16x16x32_bf16 v[188:191], a[240:243], v[100:103], v[188:191]
ds_read_b64_tr_b16 a[146:147], v7 offset:8192
v_mfma_f32_16x16x32_bf16 v[188:191], a[244:247], v[108:111], v[188:191]
ds_read_b64_tr_b16 a[148:149], v7 offset:16384
v_cmp_nge_f32 vcc, s28, v33
v_mfma_f32_16x16x32_bf16 v[188:191], a[248:251], v[116:119], v[188:191]
ds_read_b64_tr_b16 a[150:151], v7 offset:24576
v_mfma_f32_16x16x32_bf16 v[188:191], a[252:255], v[124:127], v[188:191]
ds_read_b64_tr_b16 a[152:153], v8 offset:0
ds_read_b64_tr_b16 a[154:155], v8 offset:8192
buffer_load_dwordx4 v14, s[4:7], s25 offen offset:1024 lds
s_cbranch_vccnz K_STUB5
K_BACK5:
s_waitcnt lgkmcnt(6)
v_mfma_f32_16x16x32_bf16 a[0:3], a[128:131], v[192:195], a[0:3]
ds_read_b64_tr_b16 a[156:157], v8 offset:16384
v_add_f32 v29, v29, v31
v_add_f32 v30, v30, v32
v_mfma_f32_16x16x32_bf16 a[0:3], a[132:135], v[196:199], a[0:3]
ds_read_b64_tr_b16 a[158:159], v8 offset:24576
v_mfma_f32_16x16x32_bf16 a[4:7], a[128:131], v[200:203], a[4:7]
ds_read_b64_tr_b16 a[160:161], v9 offset:0
v_exp_f32 v40, v160
v_mfma_f32_16x16x32_bf16 a[4:7], a[132:135], v[204:207], a[4:7]
ds_read_b64_tr_b16 a[162:163], v9 offset:8192
v_mfma_f32_16x16x32_bf16 a[8:11], a[136:139], v[192:195], a[8:11]
ds_read_b64_tr_b16 a[164:165], v9 offset:16384
v_and_b32 v240, 15, v0
v_mfma_f32_16x16x32_bf16 a[8:11], a[140:143], v[196:199], a[8:11]
ds_read_b64_tr_b16 a[166:167], v9 offset:24576
buffer_load_dwordx4 v15, s[4:7], s25 offen offset:2048 lds
v_cmp_gt_u32 vcc, 64, v0
v_mfma_f32_16x16x32_bf16 a[12:15], a[136:139], v[200:203], a[12:15]
ds_read_b64_tr_b16 a[168:169], v10 offset:0
v_lshlrev_b32 v240, 2, v240
v_mfma_f32_16x16x32_bf16 a[12:15], a[140:143], v[204:207], a[12:15]
ds_read_b64_tr_b16 a[170:171], v10 offset:8192
v_mov_b32 v242, 1073741824
s_waitcnt lgkmcnt(5)
v_mfma_f32_16x16x32_bf16 a[16:19], a[144:147], v[192:195], a[16:19]
ds_read_b64_tr_b16 a[172:173], v10 offset:16384
v_cndmask_b32 v240, v242, v240, vcc
v_mfma_f32_16x16x32_bf16 a[16:19], a[148:151], v[196:199], a[16:19]
ds_read_b64_tr_b16 a[174:175], v10 offset:24576
v_cndmask_b32 v241, 0, 16, vcc
v_mfma_f32_16x16x32_bf16 a[20:23], a[144:147], v[200:203], a[20:23]
ds_read_b64_tr_b16 a[176:177], v11 offset:0
v_exp_f32 v41, v161
v_mfma_f32_16x16x32_bf16 a[20:23], a[148:151], v[204:207], a[20:23]
ds_read_b64_tr_b16 a[178:179], v11 offset:8192
ds_read_b64_tr_b16 a[180:181], v11 offset:16384
buffer_load_dwordx4 v16, s[4:7], s25 offen offset:3072 lds
buffer_load_dword v242, v240, s[40:43], 0 offen offset:128 sc1
v_mfma_f32_16x16x32_bf16 a[24:27], a[152:155], v[192:195], a[24:27]
ds_read_b64_tr_b16 a[182:183], v11 offset:24576
v_mfma_f32_16x16x32_bf16 a[24:27], a[156:159], v[196:199], a[24:27]
ds_read_b64_tr_b16 a[184:185], v12 offset:0
v_exp_f32 v42, v162
v_mfma_f32_16x16x32_bf16 a[28:31], a[152:155], v[200:203], a[28:31]
ds_read_b64_tr_b16 a[186:187], v12 offset:8192
v_mfma_f32_16x16x32_bf16 a[28:31], a[156:159], v[204:207], a[28:31]
ds_read_b64_tr_b16 a[188:189], v12 offset:16384
v_add_f32 v31, v40, v41
s_waitcnt lgkmcnt(6)
v_mfma_f32_16x16x32_bf16 a[32:35], a[160:163], v[192:195], a[32:35]
ds_read_b64_tr_b16 a[190:191], v12 offset:24576
s_add_u32 m0, s24, 4096
v_mfma_f32_16x16x32_bf16 a[32:35], a[164:167], v[196:199], a[32:35]
ds_read_b64_tr_b16 a[192:193], v5 offset:256
buffer_load_dwordx4 v17, s[4:7], s25 offen lds
v_mfma_f32_16x16x32_bf16 a[36:39], a[160:163], v[200:203], a[36:39]
ds_read_b64_tr_b16 a[194:195], v5 offset:8448
v_mfma_f32_16x16x32_bf16 a[36:39], a[164:167], v[204:207], a[36:39]
ds_read_b64_tr_b16 a[196:197], v5 offset:16640
v_exp_f32 v43, v163
v_mfma_f32_16x16x32_bf16 a[40:43], a[168:171], v[192:195], a[40:43]
ds_read_b64_tr_b16 a[198:199], v5 offset:24832
v_cvt_pk_bf16_f32 v208, v40, v41
v_mfma_f32_16x16x32_bf16 a[40:43], a[172:175], v[196:199], a[40:43]
ds_read_b64_tr_b16 a[200:201], v6 offset:256
v_mfma_f32_16x16x32_bf16 a[44:47], a[168:171], v[200:203], a[44:47]
ds_read_b64_tr_b16 a[202:203], v6 offset:8448
v_exp_f32 v44, v164
v_mfma_f32_16x16x32_bf16 a[44:47], a[172:175], v[204:207], a[44:47]
ds_read_b64_tr_b16 a[204:205], v6 offset:16640
ds_read_b64_tr_b16 a[206:207], v6 offset:24832
buffer_load_dwordx4 v18, s[4:7], s25 offen offset:1024 lds
s_waitcnt lgkmcnt(6)
v_mfma_f32_16x16x32_bf16 a[48:51], a[176:179], v[192:195], a[48:51]
ds_read_b64_tr_b16 a[208:209], v7 offset:256
v_mfma_f32_16x16x32_bf16 a[48:51], a[180:183], v[196:199], a[48:51]
ds_read_b64_tr_b16 a[210:211], v7 offset:8448
v_add_f32 v31, v42, v31
v_mfma_f32_16x16x32_bf16 a[52:55], a[176:179], v[200:203], a[52:55]
ds_read_b64_tr_b16 a[212:213], v7 offset:16640
v_exp_f32 v45, v165
v_mfma_f32_16x16x32_bf16 a[52:55], a[180:183], v[204:207], a[52:55]
ds_read_b64_tr_b16 a[214:215], v7 offset:24832
v_mfma_f32_16x16x32_bf16 a[56:59], a[184:187], v[192:195], a[56:59]
ds_read_b64_tr_b16 a[216:217], v8 offset:256
v_cvt_pk_bf16_f32 v209, v42, v43
v_mfma_f32_16x16x32_bf16 a[56:59], a[188:191], v[196:199], a[56:59]
ds_read_b64_tr_b16 a[218:219], v8 offset:8448
buffer_load_dwordx4 v19, s[4:7], s25 offen offset:2048 lds
v_mfma_f32_16x16x32_bf16 a[60:63], a[184:187], v[200:203], a[60:63]
ds_read_b64_tr_b16 a[220:221], v8 offset:16640
v_add_f32 v31, v43, v31
v_mfma_f32_16x16x32_bf16 a[60:63], a[188:191], v[204:207], a[60:63]
ds_read_b64_tr_b16 a[222:223], v8 offset:24832
v_mfma_f32_16x16x32_bf16 a[64:67], a[192:195], v[192:195], a[64:67]
ds_read_b64_tr_b16 a[224:225], v9 offset:256
v_exp_f32 v46, v166
s_waitcnt lgkmcnt(5)
v_mfma_f32_16x16x32_bf16 a[64:67], a[196:199], v[196:199], a[64:67]
ds_read_b64_tr_b16 a[226:227], v9 offset:8448
v_add_f32 v32, v44, v45
v_mfma_f32_16x16x32_bf16 a[68:71], a[192:195], v[200:203], a[68:71]
ds_read_b64_tr_b16 a[228:229], v9 offset:16640
v_mfma_f32_16x16x32_bf16 a[68:71], a[196:199], v[204:207], a[68:71]
ds_read_b64_tr_b16 a[230:231], v9 offset:24832
ds_read_b64_tr_b16 a[232:233], v10 offset:256
buffer_load_dwordx4 v20, s[4:7], s25 offen offset:3072 lds
v_mfma_f32_16x16x32_bf16 a[72:75], a[200:203], v[192:195], a[72:75]
ds_read_b64_tr_b16 a[234:235], v10 offset:8448
s_add_u32 s25, s25, 32768
v_mfma_f32_16x16x32_bf16 a[72:75], a[204:207], v[196:199], a[72:75]
ds_read_b64_tr_b16 a[236:237], v10 offset:16640
v_exp_f32 v47, v167
v_mfma_f32_16x16x32_bf16 a[76:79], a[200:203], v[200:203], a[76:79]
ds_read_b64_tr_b16 a[238:239], v10 offset:24832
v_mfma_f32_16x16x32_bf16 a[76:79], a[204:207], v[204:207], a[76:79]
ds_read_b64_tr_b16 a[240:241], v11 offset:256
v_cvt_pk_bf16_f32 v216, v44, v45
v_mfma_f32_16x16x32_bf16 a[80:83], a[208:211], v[192:195], a[80:83]
ds_read_b64_tr_b16 a[242:243], v11 offset:8448
v_mfma_f32_16x16x32_bf16 a[80:83], a[212:215], v[196:199], a[80:83]
ds_read_b64_tr_b16 a[244:245], v11 offset:16640
v_exp_f32 v40, v168
v_mfma_f32_16x16x32_bf16 a[84:87], a[208:211], v[200:203], a[84:87]
ds_read_b64_tr_b16 a[246:247], v11 offset:24832
v_add_f32 v32, v46, v32
v_mfma_f32_16x16x32_bf16 a[84:87], a[212:215], v[204:207], a[84:87]
ds_read_b64_tr_b16 a[248:249], v12 offset:256
s_mov_b32 s29, 0
s_waitcnt lgkmcnt(5)
v_mfma_f32_16x16x32_bf16 a[88:91], a[216:219], v[192:195], a[88:91]
ds_read_b64_tr_b16 a[250:251], v12 offset:8448
s_add_u32 m0, s34, 131072
v_mfma_f32_16x16x32_bf16 a[88:91], a[220:223], v[196:199], a[88:91]
ds_read_b64_tr_b16 a[252:253], v12 offset:16640
buffer_load_dwordx4 v56, s[44:47], s29 offen lds
v_mfma_f32_16x16x32_bf16 a[92:95], a[216:219], v[200:203], a[92:95]
ds_read_b64_tr_b16 a[254:255], v12 offset:24832
v_mfma_f32_16x16x32_bf16 a[92:95], a[220:223], v[204:207], a[92:95]
buffer_load_dwordx4 v57, s[44:47], s29 offen offset:1024 lds
v_exp_f32 v41, v169
v_mfma_f32_16x16x32_bf16 a[96:99], a[224:227], v[192:195], a[96:99]
v_cvt_pk_bf16_f32 v217, v46, v47
v_mfma_f32_16x16x32_bf16 a[96:99], a[228:231], v[196:199], a[96:99]
buffer_load_dwordx4 v58, s[44:47], s29 offen offset:2048 lds
v_add_f32 v32, v47, v32
v_mfma_f32_16x16x32_bf16 a[100:103], a[224:227], v[200:203], a[100:103]
v_exp_f32 v42, v170
v_mfma_f32_16x16x32_bf16 a[100:103], a[228:231], v[204:207], a[100:103]
buffer_load_dwordx4 v59, s[44:47], s29 offen offset:3072 lds
v_add_f32 v31, v40, v31
v_mfma_f32_16x16x32_bf16 a[104:107], a[232:235], v[192:195], a[104:107]
s_waitcnt vmcnt(21) lgkmcnt(0)
s_barrier
ds_read_b128 a[128:131], v1 offset:32768
v_mfma_f32_16x16x32_bf16 a[104:107], a[236:239], v[196:199], a[104:107]
ds_read_b128 a[132:135], v2 offset:32768
v_mfma_f32_16x16x32_bf16 a[108:111], a[232:235], v[200:203], a[108:111]
v_exp_f32 v43, v171
v_cvt_pk_bf16_f32 v210, v40, v41
v_mfma_f32_16x16x32_bf16 a[108:111], a[236:239], v[204:207], a[108:111]
ds_read_b128 a[136:139], v3 offset:32768
v_add_f32 v31, v41, v31
v_mfma_f32_16x16x32_bf16 a[112:115], a[240:243], v[192:195], a[112:115]
s_add_u32 m0, s24, 65536
v_mfma_f32_16x16x32_bf16 a[112:115], a[244:247], v[196:199], a[112:115]
ds_read_b128 a[140:143], v4 offset:32768
buffer_load_dwordx4 v21, s[8:11], s26 offen lds
v_mfma_f32_16x16x32_bf16 a[116:119], a[240:243], v[200:203], a[116:119]
ds_read_b128 a[144:147], v1 offset:33024
v_exp_f32 v44, v172
v_mfma_f32_16x16x32_bf16 a[116:119], a[244:247], v[204:207], a[116:119]
ds_read_b128 a[148:151], v2 offset:33024
v_mfma_f32_16x16x32_bf16 a[120:123], a[248:251], v[192:195], a[120:123]
ds_read_b128 a[152:155], v3 offset:33024
v_add_f32 v31, v42, v31
v_mfma_f32_16x16x32_bf16 a[120:123], a[252:255], v[196:199], a[120:123]
ds_read_b128 a[156:159], v4 offset:33024
v_exp_f32 v45, v173
v_mfma_f32_16x16x32_bf16 a[124:127], a[248:251], v[200:203], a[124:127]
v_cvt_pk_bf16_f32 v211, v42, v43
v_mfma_f32_16x16x32_bf16 a[124:127], a[252:255], v[204:207], a[124:127]
buffer_load_dwordx4 v22, s[8:11], s26 offen offset:1024 lds
v_add_f32 v31, v43, v31
s_waitcnt lgkmcnt(3)
v_mfma_f32_16x16x32_bf16 v[128:131], a[128:131], v[64:67], v[48:51]
v_exp_f32 v46, v174
v_mfma_f32_16x16x32_bf16 v[128:131], a[132:135], v[72:75], v[128:131]
v_add_f32 v32, v44, v32
v_mfma_f32_16x16x32_bf16 v[128:131], a[136:139], v[80:83], v[128:131]
ds_read_b128 a[160:163], v1 offset:40960
v_exp_f32 v47, v175
v_mfma_f32_16x16x32_bf16 v[128:131], a[140:143], v[88:91], v[128:131]
v_cvt_pk_bf16_f32 v218, v44, v45
v_mfma_f32_16x16x32_bf16 v[128:131], a[144:147], v[96:99], v[128:131]
ds_read_b128 a[164:167], v2 offset:40960
v_add_f32 v32, v45, v32
s_waitcnt lgkmcnt(2)
v_mfma_f32_16x16x32_bf16 v[128:131], a[148:151], v[104:107], v[128:131]
buffer_load_dwordx4 v23, s[8:11], s26 offen offset:2048 lds
v_exp_f32 v40, v176
v_mfma_f32_16x16x32_bf16 v[128:131], a[152:155], v[112:115], v[128:131]
ds_read_b128 a[168:171], v3 offset:40960
v_mfma_f32_16x16x32_bf16 v[128:131], a[156:159], v[120:123], v[128:131]
v_add_f32 v32, v46, v32
v_mfma_f32_16x16x32_bf16 v[132:135], a[128:131], v[68:71], v[52:55]
ds_read_b128 a[172:175], v4 offset:40960
v_exp_f32 v41, v177
v_mfma_f32_16x16x32_bf16 v[132:135], a[132:135], v[76:79], v[132:135]
v_cvt_pk_bf16_f32 v219, v46, v47
v_add_f32 v32, v47, v32
v_mfma_f32_16x16x32_bf16 v[132:135], a[136:139], v[84:87], v[132:135]
ds_read_b128 a[176:179], v1 offset:41216
v_mfma_f32_16x16x32_bf16 v[132:135], a[140:143], v[92:95], v[132:135]
ds_read_b128 a[180:183], v2 offset:41216
buffer_load_dwordx4 v24, s[8:11], s26 offen offset:3072 lds
v_mfma_f32_16x16x32_bf16 v[132:135], a[144:147], v[100:103], v[132:135]
ds_read_b128 a[184:187], v3 offset:41216
v_exp_f32 v42, v178
v_mfma_f32_16x16x32_bf16 v[132:135], a[148:151], v[108:111], v[132:135]
ds_read_b128 a[188:191], v4 offset:41216
v_mfma_f32_16x16x32_bf16 v[132:135], a[152:155], v[116:119], v[132:135]
v_add_f32 v31, v40, v31
v_exp_f32 v43, v179
v_mfma_f32_16x16x32_bf16 v[132:135], a[156:159], v[124:127], v[132:135]
v_cvt_pk_bf16_f32 v212, v40, v41
s_waitcnt lgkmcnt(3)
v_mfma_f32_16x16x32_bf16 v[136:139], a[160:163], v[64:67], v[48:51]
s_add_u32 m0, s24, 69632
v_add_f32 v31, v41, v31
v_mfma_f32_16x16x32_bf16 v[136:139], a[164:167], v[72:75], v[136:139]
ds_read_b128 a[192:195], v1 offset:49152
buffer_load_dwordx4 v25, s[8:11], s26 offen lds
v_mfma_f32_16x16x32_bf16 v[136:139], a[168:171], v[80:83], v[136:139]
v_exp_f32 v44, v180
v_mfma_f32_16x16x32_bf16 v[136:139], a[172:175], v[88:91], v[136:139]
ds_read_b128 a[196:199], v2 offset:49152
v_add_f32 v31, v42, v31
v_mfma_f32_16x16x32_bf16 v[136:139], a[176:179], v[96:99], v[136:139]
v_exp_f32 v45, v181
s_waitcnt lgkmcnt(2)
v_mfma_f32_16x16x32_bf16 v[136:139], a[180:183], v[104:107], v[136:139]
ds_read_b128 a[200:203], v3 offset:49152
v_cvt_pk_bf16_f32 v213, v42, v43
v_mfma_f32_16x16x32_bf16 v[136:139], a[184:187], v[112:115], v[136:139]
v_add_f32 v31, v43, v31
v_mfma_f32_16x16x32_bf16 v[136:139], a[188:191], v[120:123], v[136:139]
ds_read_b128 a[204:207], v4 offset:49152
buffer_load_dwordx4 v26, s[8:11], s26 offen offset:1024 lds
v_mfma_f32_16x16x32_bf16 v[140:143], a[160:163], v[68:71], v[52:55]
ds_read_b128 a[208:211], v1 offset:49408
v_exp_f32 v46, v182
v_mfma_f32_16x16x32_bf16 v[140:143], a[164:167], v[76:79], v[140:143]
v_add_f32 v32, v44, v32
v_mfma_f32_16x16x32_bf16 v[140:143], a[168:171], v[84:87], v[140:143]
ds_read_b128 a[212:215], v2 offset:49408
v_exp_f32 v47, v183
v_mfma_f32_16x16x32_bf16 v[140:143], a[172:175], v[92:95], v[140:143]
v_cvt_pk_bf16_f32 v220, v44, v45
v_mfma_f32_16x16x32_bf16 v[140:143], a[176:179], v[100:103], v[140:143]
ds_read_b128 a[216:219], v3 offset:49408
v_add_f32 v32, v45, v32
v_mfma_f32_16x16x32_bf16 v[140:143], a[180:183], v[108:111], v[140:143]
ds_read_b128 a[220:223], v4 offset:49408
buffer_load_dwordx4 v27, s[8:11], s26 offen offset:2048 lds
v_mfma_f32_16x16x32_bf16 v[140:143], a[184:187], v[116:119], v[140:143]
v_exp_f32 v40, v184
v_mfma_f32_16x16x32_bf16 v[140:143], a[188:191], v[124:127], v[140:143]
v_add_f32 v32, v46, v32
s_waitcnt lgkmcnt(2)
v_mfma_f32_16x16x32_bf16 v[144:147], a[192:195], v[64:67], v[48:51]
ds_read_b128 a[224:227], v1 offset:57344
v_exp_f32 v41, v185
v_mfma_f32_16x16x32_bf16 v[144:147], a[196:199], v[72:75], v[144:147]
v_cvt_pk_bf16_f32 v221, v46, v47
v_mfma_f32_16x16x32_bf16 v[144:147], a[200:203], v[80:83], v[144:147]
ds_read_b128 a[228:231], v2 offset:57344
v_add_f32 v32, v47, v32
v_mfma_f32_16x16x32_bf16 v[144:147], a[204:207], v[88:91], v[144:147]
ds_read_b128 a[232:235], v3 offset:57344
buffer_load_dwordx4 v28, s[8:11], s26 offen offset:3072 lds
v_mfma_f32_16x16x32_bf16 v[144:147], a[208:211], v[96:99], v[144:147]
s_add_u32 s26, s26, 32768
v_exp_f32 v42, v186
v_mfma_f32_16x16x32_bf16 v[144:147], a[212:215], v[104:107], v[144:147]
ds_read_b128 a[236:239], v4 offset:57344
s_waitcnt lgkmcnt(3)
v_mfma_f32_16x16x32_bf16 v[144:147], a[216:219], v[112:115], v[144:147]
v_add_f32 v31, v40, v31
v_exp_f32 v43, v187
v_mfma_f32_16x16x32_bf16 v[144:147], a[220:223], v[120:123], v[144:147]
ds_read_b128 a[240:243], v1 offset:57600
v_mfma_f32_16x16x32_bf16 v[148:151], a[192:195], v[68:71], v[52:55]
v_cvt_pk_bf16_f32 v214, v40, v41
v_add_f32 v31, v41, v31
v_mfma_f32_16x16x32_bf16 v[148:151], a[196:199], v[76:79], v[148:151]
ds_read_b128 a[244:247], v2 offset:57600
v_mfma_f32_16x16x32_bf16 v[148:151], a[200:203], v[84:87], v[148:151]
v_exp_f32 v44, v188
v_add_f32 v31, v42, v31
v_mfma_f32_16x16x32_bf16 v[148:151], a[204:207], v[92:95], v[148:151]
ds_read_b128 a[248:251], v3 offset:57600
v_mfma_f32_16x16x32_bf16 v[148:151], a[208:211], v[100:103], v[148:151]
s_add_u32 m0, s34, 135168
v_exp_f32 v45, v189
v_mfma_f32_16x16x32_bf16 v[148:151], a[212:215], v[108:111], v[148:151]
ds_read_b128 a[252:255], v4 offset:57600
buffer_load_dwordx4 v60, s[44:47], s29 offen lds
v_mfma_f32_16x16x32_bf16 v[148:151], a[216:219], v[116:119], v[148:151]
v_cvt_pk_bf16_f32 v215, v42, v43
v_mfma_f32_16x16x32_bf16 v[148:151], a[220:223], v[124:127], v[148:151]
buffer_load_dwordx4 v61, s[44:47], s29 offen offset:1024 lds
v_add_f32 v31, v43, v31
v_mfma_f32_16x16x32_bf16 v[152:155], a[224:227], v[64:67], v[48:51]
v_exp_f32 v46, v190
s_waitcnt lgkmcnt(1)
v_mfma_f32_16x16x32_bf16 v[152:155], a[228:231], v[72:75], v[152:155]
buffer_load_dwordx4 v62, s[44:47], s29 offen offset:2048 lds
v_add_f32 v32, v44, v32
v_mfma_f32_16x16x32_bf16 v[152:155], a[232:235], v[80:83], v[152:155]
v_exp_f32 v47, v191
v_mfma_f32_16x16x32_bf16 v[152:155], a[236:239], v[88:91], v[152:155]
v_cvt_pk_bf16_f32 v222, v44, v45
v_add_f32 v32, v45, v32
v_mfma_f32_16x16x32_bf16 v[152:155], a[240:243], v[96:99], v[152:155]
s_waitcnt vmcnt(24) lgkmcnt(0)
s_barrier
ds_read_b64_tr_b16 a[128:129], v5 offset:32768
ds_read_b64_tr_b16 a[130:131], v5 offset:40960
v_mfma_f32_16x16x32_bf16 v[152:155], a[244:247], v[104:107], v[152:155]
ds_read_b64_tr_b16 a[132:133], v5 offset:49152
v_add_f32 v32, v46, v32
v_mfma_f32_16x16x32_bf16 v[152:155], a[248:251], v[112:115], v[152:155]
ds_read_b64_tr_b16 a[134:135], v5 offset:57344
v_mfma_f32_16x16x32_bf16 v[152:155], a[252:255], v[120:123], v[152:155]
ds_read_b64_tr_b16 a[136:137], v6 offset:32768
s_add_u32 m0, s24, 32768
v_mfma_f32_16x16x32_bf16 v[156:159], a[224:227], v[68:71], v[52:55]
ds_read_b64_tr_b16 a[138:139], v6 offset:40960
s_mov_b32 s29, 0
v_mfma_f32_16x16x32_bf16 v[156:159], a[228:231], v[76:79], v[156:159]
ds_read_b64_tr_b16 a[140:141], v6 offset:49152
buffer_load_dwordx4 v232, s[16:19], s29 offen lds
v_mfma_f32_16x16x32_bf16 v[156:159], a[232:235], v[84:87], v[156:159]
ds_read_b64_tr_b16 a[142:143], v6 offset:57344
v_cvt_pk_bf16_f32 v223, v46, v47
v_mfma_f32_16x16x32_bf16 v[156:159], a[236:239], v[92:95], v[156:159]
ds_read_b64_tr_b16 a[144:145], v7 offset:32768
v_add_f32 v32, v47, v32
v_mfma_f32_16x16x32_bf16 v[156:159], a[240:243], v[100:103], v[156:159]
ds_read_b64_tr_b16 a[146:147], v7 offset:40960
v_max_f32 v33, v31, v32
v_mfma_f32_16x16x32_bf16 v[156:159], a[244:247], v[108:111], v[156:159]
ds_read_b64_tr_b16 a[148:149], v7 offset:49152
v_cmp_nge_f32 vcc, s28, v33
v_mfma_f32_16x16x32_bf16 v[156:159], a[248:251], v[116:119], v[156:159]
ds_read_b64_tr_b16 a[150:151], v7 offset:57344
s_mov_b32 s29, 6144
v_mfma_f32_16x16x32_bf16 v[156:159], a[252:255], v[124:127], v[156:159]
ds_read_b64_tr_b16 a[152:153], v8 offset:32768
ds_read_b64_tr_b16 a[154:155], v8 offset:40960
buffer_load_dwordx4 v232, s[16:19], s29 offen offset:1024 lds
s_cbranch_vccnz K_STUB6
K_BACK6:
s_waitcnt lgkmcnt(6)
v_mfma_f32_16x16x32_bf16 a[0:3], a[128:131], v[208:211], a[0:3]
ds_read_b64_tr_b16 a[156:157], v8 offset:49152
v_add_f32 v29, v29, v31
v_add_f32 v30, v30, v32
v_mfma_f32_16x16x32_bf16 a[0:3], a[132:135], v[212:215], a[0:3]
ds_read_b64_tr_b16 a[158:159], v8 offset:57344
v_mfma_f32_16x16x32_bf16 a[4:7], a[128:131], v[216:219], a[4:7]
ds_read_b64_tr_b16 a[160:161], v9 offset:32768
v_exp_f32 v40, v128
v_mfma_f32_16x16x32_bf16 a[4:7], a[132:135], v[220:223], a[4:7]
ds_read_b64_tr_b16 a[162:163], v9 offset:40960
v_mfma_f32_16x16x32_bf16 a[8:11], a[136:139], v[208:211], a[8:11]
ds_read_b64_tr_b16 a[164:165], v9 offset:49152
s_mov_b32 s29, 12288
v_mfma_f32_16x16x32_bf16 a[8:11], a[140:143], v[212:215], a[8:11]
ds_read_b64_tr_b16 a[166:167], v9 offset:57344
buffer_load_dwordx4 v232, s[16:19], s29 offen offset:2048 lds
v_mfma_f32_16x16x32_bf16 a[12:15], a[136:139], v[216:219], a[12:15]
ds_read_b64_tr_b16 a[168:169], v10 offset:32768
v_exp_f32 v41, v129
v_mfma_f32_16x16x32_bf16 a[12:15], a[140:143], v[220:223], a[12:15]
ds_read_b64_tr_b16 a[170:171], v10 offset:40960
s_waitcnt lgkmcnt(5)
v_mfma_f32_16x16x32_bf16 a[16:19], a[144:147], v[208:211], a[16:19]
ds_read_b64_tr_b16 a[172:173], v10 offset:49152
v_mfma_f32_16x16x32_bf16 a[16:19], a[148:151], v[212:215], a[16:19]
ds_read_b64_tr_b16 a[174:175], v10 offset:57344
v_exp_f32 v42, v130
v_mfma_f32_16x16x32_bf16 a[20:23], a[144:147], v[216:219], a[20:23]
ds_read_b64_tr_b16 a[176:177], v11 offset:32768
s_mov_b32 s29, 18432
v_mfma_f32_16x16x32_bf16 a[20:23], a[148:151], v[220:223], a[20:23]
ds_read_b64_tr_b16 a[178:179], v11 offset:40960
ds_read_b64_tr_b16 a[180:181], v11 offset:49152
buffer_load_dwordx4 v232, s[16:19], s29 offen offset:3072 lds
v_mfma_f32_16x16x32_bf16 a[24:27], a[152:155], v[208:211], a[24:27]
ds_read_b64_tr_b16 a[182:183], v11 offset:57344
v_mfma_f32_16x16x32_bf16 a[24:27], a[156:159], v[212:215], a[24:27]
ds_read_b64_tr_b16 a[184:185], v12 offset:32768
v_add_f32 v31, v40, v41
v_mfma_f32_16x16x32_bf16 a[28:31], a[152:155], v[216:219], a[28:31]
ds_read_b64_tr_b16 a[186:187], v12 offset:40960
v_mfma_f32_16x16x32_bf16 a[28:31], a[156:159], v[220:223], a[28:31]
ds_read_b64_tr_b16 a[188:189], v12 offset:49152
s_add_u32 m0, s24, 36864
s_waitcnt lgkmcnt(6)
v_mfma_f32_16x16x32_bf16 a[32:35], a[160:163], v[208:211], a[32:35]
ds_read_b64_tr_b16 a[190:191], v12 offset:57344
s_mov_b32 s29, 28672
v_mfma_f32_16x16x32_bf16 a[32:35], a[164:167], v[212:215], a[32:35]
ds_read_b64_tr_b16 a[192:193], v5 offset:33024
buffer_load_dwordx4 v232, s[16:19], s29 offen lds
v_mfma_f32_16x16x32_bf16 a[36:39], a[160:163], v[216:219], a[36:39]
ds_read_b64_tr_b16 a[194:195], v5 offset:41216
v_exp_f32 v43, v131
v_mfma_f32_16x16x32_bf16 a[36:39], a[164:167], v[220:223], a[36:39]
ds_read_b64_tr_b16 a[196:197], v5 offset:49408
v_cvt_pk_bf16_f32 v192, v40, v41
v_mfma_f32_16x16x32_bf16 a[40:43], a[168:171], v[208:211], a[40:43]
ds_read_b64_tr_b16 a[198:199], v5 offset:57600
v_mfma_f32_16x16x32_bf16 a[40:43], a[172:175], v[212:215], a[40:43]
ds_read_b64_tr_b16 a[200:201], v6 offset:33024
v_exp_f32 v44, v132
v_mfma_f32_16x16x32_bf16 a[44:47], a[168:171], v[216:219], a[44:47]
ds_read_b64_tr_b16 a[202:203], v6 offset:41216
s_mov_b32 s29, 34816
v_mfma_f32_16x16x32_bf16 a[44:47], a[172:175], v[220:223], a[44:47]
ds_read_b64_tr_b16 a[204:205], v6 offset:49408
ds_read_b64_tr_b16 a[206:207], v6 offset:57600
buffer_load_dwordx4 v232, s[16:19], s29 offen offset:1024 lds
s_waitcnt lgkmcnt(6)
v_mfma_f32_16x16x32_bf16 a[48:51], a[176:179], v[208:211], a[48:51]
ds_read_b64_tr_b16 a[208:209], v7 offset:33024
v_mfma_f32_16x16x32_bf16 a[48:51], a[180:183], v[212:215], a[48:51]
ds_read_b64_tr_b16 a[210:211], v7 offset:41216
v_add_f32 v31, v42, v31
v_mfma_f32_16x16x32_bf16 a[52:55], a[176:179], v[216:219], a[52:55]
ds_read_b64_tr_b16 a[212:213], v7 offset:49408
v_mfma_f32_16x16x32_bf16 a[52:55], a[180:183], v[220:223], a[52:55]
ds_read_b64_tr_b16 a[214:215], v7 offset:57600
v_exp_f32 v45, v133
v_mfma_f32_16x16x32_bf16 a[56:59], a[184:187], v[208:211], a[56:59]
ds_read_b64_tr_b16 a[216:217], v8 offset:33024
s_mov_b32 s29, 40960
v_mfma_f32_16x16x32_bf16 a[56:59], a[188:191], v[212:215], a[56:59]
ds_read_b64_tr_b16 a[218:219], v8 offset:41216
buffer_load_dwordx4 v232, s[16:19], s29 offen offset:2048 lds
v_mfma_f32_16x16x32_bf16 a[60:63], a[184:187], v[216:219], a[60:63]
ds_read_b64_tr_b16 a[220:221], v8 offset:49408
v_mfma_f32_16x16x32_bf16 a[60:63], a[188:191], v[220:223], a[60:63]
ds_read_b64_tr_b16 a[222:223], v8 offset:57600
v_cvt_pk_bf16_f32 v193, v42, v43
v_mfma_f32_16x16x32_bf16 a[64:67], a[192:195], v[208:211], a[64:67]
ds_read_b64_tr_b16 a[224:225], v9 offset:33024
v_add_f32 v31, v43, v31
s_waitcnt lgkmcnt(5)
v_mfma_f32_16x16x32_bf16 a[64:67], a[196:199], v[212:215], a[64:67]
ds_read_b64_tr_b16 a[226:227], v9 offset:41216
v_mfma_f32_16x16x32_bf16 a[68:71], a[192:195], v[216:219], a[68:71]
ds_read_b64_tr_b16 a[228:229], v9 offset:49408
s_mov_b32 s29, 47104
v_mfma_f32_16x16x32_bf16 a[68:71], a[196:199], v[220:223], a[68:71]
ds_read_b64_tr_b16 a[230:231], v9 offset:57600
ds_read_b64_tr_b16 a[232:233], v10 offset:33024
buffer_load_dwordx4 v232, s[16:19], s29 offen offset:3072 lds
v_mfma_f32_16x16x32_bf16 a[72:75], a[200:203], v[208:211], a[72:75]
ds_read_b64_tr_b16 a[234:235], v10 offset:41216
v_exp_f32 v46, v134
v_mfma_f32_16x16x32_bf16 a[72:75], a[204:207], v[212:215], a[72:75]
ds_read_b64_tr_b16 a[236:237], v10 offset:49408
v_mfma_f32_16x16x32_bf16 a[76:79], a[200:203], v[216:219], a[76:79]
ds_read_b64_tr_b16 a[238:239], v10 offset:57600
v_add_f32 v32, v44, v45
v_mfma_f32_16x16x32_bf16 a[76:79], a[204:207], v[220:223], a[76:79]
ds_read_b64_tr_b16 a[240:241], v11 offset:33024
v_mfma_f32_16x16x32_bf16 a[80:83], a[208:211], v[208:211], a[80:83]
ds_read_b64_tr_b16 a[242:243], v11 offset:41216
s_lshr_b32 s59, s2, 4
v_exp_f32 v47, v135
v_lshlrev_b32 v238, 3, v233
v_min_u32 v238, 3456, v238
v_mfma_f32_16x16x32_bf16 a[80:83], a[212:215], v[212:215], a[80:83]
ds_read_b64_tr_b16 a[244:245], v11 offset:49408
s_bfe_u32 s60, s2, 0x10003
v_mfma_f32_16x16x32_bf16 a[84:87], a[208:211], v[216:219], a[84:87]
ds_read_b64_tr_b16 a[246:247], v11 offset:57600
s_mul_i32 s59, s59, 28
v_cvt_pk_bf16_f32 v200, v44, v45
v_mfma_f32_16x16x32_bf16 a[84:87], a[212:215], v[220:223], a[84:87]
ds_read_b64_tr_b16 a[248:249], v12 offset:33024
s_lshl2_add_u32 s60, s60, s56
s_waitcnt lgkmcnt(5)
v_mfma_f32_16x16x32_bf16 a[88:91], a[216:219], v[208:211], a[88:91]
ds_read_b64_tr_b16 a[250:251], v12 offset:41216
s_add_u32 s59, s59, s60
v_exp_f32 v40, v136
v_mfma_f32_16x16x32_bf16 a[88:91], a[220:223], v[212:215], a[88:91]
ds_read_b64_tr_b16 a[252:253], v12 offset:49408
s_mul_i32 s59, s59, 3584
v_mfma_f32_16x16x32_bf16 a[92:95], a[216:219], v[216:219], a[92:95]
ds_read_b64_tr_b16 a[254:255], v12 offset:57600
buffer_load_dword v239, v238, s[52:55], s59 offen
v_add_f32 v32, v46, v32
v_mfma_f32_16x16x32_bf16 a[92:95], a[220:223], v[220:223], a[92:95]
v_exp_f32 v41, v137
v_mfma_f32_16x16x32_bf16 a[96:99], a[224:227], v[208:211], a[96:99]
v_cvt_pk_bf16_f32 v201, v46, v47
v_add_f32 v32, v47, v32
v_mfma_f32_16x16x32_bf16 a[96:99], a[228:231], v[212:215], a[96:99]
v_exp_f32 v42, v138
v_mfma_f32_16x16x32_bf16 a[100:103], a[224:227], v[216:219], a[100:103]
v_add_f32 v31, v40, v31
v_mfma_f32_16x16x32_bf16 a[100:103], a[228:231], v[220:223], a[100:103]
v_exp_f32 v43, v139
v_mfma_f32_16x16x32_bf16 a[104:107], a[232:235], v[208:211], a[104:107]
s_waitcnt vmcnt(24) lgkmcnt(0)
s_barrier
ds_read_b128 a[128:131], v1 offset:0
v_mfma_f32_16x16x32_bf16 a[104:107], a[236:239], v[212:215], a[104:107]
ds_read_b128 a[132:135], v2 offset:0
v_cvt_pk_bf16_f32 v194, v40, v41
v_mfma_f32_16x16x32_bf16 a[108:111], a[232:235], v[216:219], a[108:111]
v_add_f32 v31, v41, v31
v_mfma_f32_16x16x32_bf16 a[108:111], a[236:239], v[220:223], a[108:111]
ds_read_b128 a[136:139], v3 offset:0
v_exp_f32 v44, v140
v_mfma_f32_16x16x32_bf16 a[112:115], a[240:243], v[208:211], a[112:115]
s_add_u32 m0, s24, 98304
v_mfma_f32_16x16x32_bf16 a[112:115], a[244:247], v[212:215], a[112:115]
ds_read_b128 a[140:143], v4 offset:0
buffer_load_dwordx4 v21, s[8:11], s26 offen lds
v_mfma_f32_16x16x32_bf16 a[116:119], a[240:243], v[216:219], a[116:119]
ds_read_b128 a[144:147], v1 offset:256
v_add_f32 v31, v42, v31
v_mfma_f32_16x16x32_bf16 a[116:119], a[244:247], v[220:223], a[116:119]
ds_read_b128 a[148:151], v2 offset:256
v_mfma_f32_16x16x32_bf16 a[120:123], a[248:251], v[208:211], a[120:123]
ds_read_b128 a[152:155], v3 offset:256
v_exp_f32 v45, v141
v_mfma_f32_16x16x32_bf16 a[120:123], a[252:255], v[212:215], a[120:123]
ds_read_b128 a[156:159], v4 offset:256
v_mfma_f32_16x16x32_bf16 a[124:127], a[248:251], v[216:219], a[124:127]
v_cvt_pk_bf16_f32 v195, v42, v43
v_add_f32 v31, v43, v31
v_mfma_f32_16x16x32_bf16 a[124:127], a[252:255], v[220:223], a[124:127]
buffer_load_dwordx4 v22, s[8:11], s26 offen offset:1024 lds
v_exp_f32 v46, v142
s_waitcnt lgkmcnt(3)
v_mfma_f32_16x16x32_bf16 v[160:163], a[128:131], v[64:67], v[48:51]
v_add_f32 v32, v44, v32
v_mfma_f32_16x16x32_bf16 v[160:163], a[132:135], v[72:75], v[160:163]
v_exp_f32 v47, v143
v_mfma_f32_16x16x32_bf16 v[160:163], a[136:139], v[80:83], v[160:163]
ds_read_b128 a[160:163], v1 offset:8192
v_mfma_f32_16x16x32_bf16 v[160:163], a[140:143], v[88:91], v[160:163]
v_cvt_pk_bf16_f32 v202, v44, v45
v_add_f32 v32, v45, v32
v_mfma_f32_16x16x32_bf16 v[160:163], a[144:147], v[96:99], v[160:163]
ds_read_b128 a[164:167], v2 offset:8192
s_waitcnt lgkmcnt(2)
v_mfma_f32_16x16x32_bf16 v[160:163], a[148:151], v[104:107], v[160:163]
buffer_load_dwordx4 v23, s[8:11], s26 offen offset:2048 lds
v_exp_f32 v40, v144
v_mfma_f32_16x16x32_bf16 v[160:163], a[152:155], v[112:115], v[160:163]
ds_read_b128 a[168:171], v3 offset:8192
v_add_f32 v32, v46, v32
v_mfma_f32_16x16x32_bf16 v[160:163], a[156:159], v[120:123], v[160:163]
v_exp_f32 v41, v145
v_mfma_f32_16x16x32_bf16 v[164:167], a[128:131], v[68:71], v[52:55]
ds_read_b128 a[172:175], v4 offset:8192
v_mfma_f32_16x16x32_bf16 v[164:167], a[132:135], v[76:79], v[164:167]
v_cvt_pk_bf16_f32 v203, v46, v47
v_add_f32 v32, v47, v32
v_mfma_f32_16x16x32_bf16 v[164:167], a[136:139], v[84:87], v[164:167]
ds_read_b128 a[176:179], v1 offset:8448
v_mfma_f32_16x16x32_bf16 v[164:167], a[140:143], v[92:95], v[164:167]
ds_read_b128 a[180:183], v2 offset:8448
buffer_load_dwordx4 v24, s[8:11], s26 offen offset:3072 lds
v_mfma_f32_16x16x32_bf16 v[164:167], a[144:147], v[100:103], v[164:167]
ds_read_b128 a[184:187], v3 offset:8448
v_exp_f32 v42, v146
v_mfma_f32_16x16x32_bf16 v[164:167], a[148:151], v[108:111], v[164:167]
ds_read_b128 a[188:191], v4 offset:8448
v_mfma_f32_16x16x32_bf16 v[164:167], a[152:155], v[116:119], v[164:167]
v_add_f32 v31, v40, v31
v_exp_f32 v43, v147
v_mfma_f32_16x16x32_bf16 v[164:167], a[156:159], v[124:127], v[164:167]
v_cvt_pk_bf16_f32 v196, v40, v41
s_waitcnt lgkmcnt(3)
v_mfma_f32_16x16x32_bf16 v[168:171], a[160:163], v[64:67], v[48:51]
s_add_u32 m0, s24, 102400
v_add_f32 v31, v41, v31
v_mfma_f32_16x16x32_bf16 v[168:171], a[164:167], v[72:75], v[168:171]
ds_read_b128 a[192:195], v1 offset:16384
buffer_load_dwordx4 v25, s[8:11], s26 offen lds
v_mfma_f32_16x16x32_bf16 v[168:171], a[168:171], v[80:83], v[168:171]
v_exp_f32 v44, v148
v_mfma_f32_16x16x32_bf16 v[168:171], a[172:175], v[88:91], v[168:171]
ds_read_b128 a[196:199], v2 offset:16384
v_mfma_f32_16x16x32_bf16 v[168:171], a[176:179], v[96:99], v[168:171]
v_add_f32 v31, v42, v31
v_exp_f32 v45, v149
s_waitcnt lgkmcnt(2)
v_mfma_f32_16x16x32_bf16 v[168:171], a[180:183], v[104:107], v[168:171]
ds_read_b128 a[200:203], v3 offset:16384
v_mfma_f32_16x16x32_bf16 v[168:171], a[184:187], v[112:115], v[168:171]
v_cvt_pk_bf16_f32 v197, v42, v43
v_add_f32 v31, v43, v31
v_mfma_f32_16x16x32_bf16 v[168:171], a[188:191], v[120:123], v[168:171]
ds_read_b128 a[204:207], v4 offset:16384
buffer_load_dwordx4 v26, s[8:11], s26 offen offset:1024 lds
v_mfma_f32_16x16x32_bf16 v[172:175], a[160:163], v[68:71], v[52:55]
ds_read_b128 a[208:211], v1 offset:16640
v_mfma_f32_16x16x32_bf16 v[172:175], a[164:167], v[76:79], v[172:175]
v_exp_f32 v46, v150
v_mfma_f32_16x16x32_bf16 v[172:175], a[168:171], v[84:87], v[172:175]
ds_read_b128 a[212:215], v2 offset:16640
v_add_f32 v32, v44, v32
v_mfma_f32_16x16x32_bf16 v[172:175], a[172:175], v[92:95], v[172:175]
v_exp_f32 v47, v151
v_mfma_f32_16x16x32_bf16 v[172:175], a[176:179], v[100:103], v[172:175]
ds_read_b128 a[216:219], v3 offset:16640
v_cvt_pk_bf16_f32 v204, v44, v45
v_mfma_f32_16x16x32_bf16 v[172:175], a[180:183], v[108:111], v[172:175]
ds_read_b128 a[220:223], v4 offset:16640
buffer_load_dwordx4 v27, s[8:11], s26 offen offset:2048 lds
v_mfma_f32_16x16x32_bf16 v[172:175], a[184:187], v[116:119], v[172:175]
v_add_f32 v32, v45, v32
v_mfma_f32_16x16x32_bf16 v[172:175], a[188:191], v[124:127], v[172:175]
v_exp_f32 v40, v152
s_waitcnt lgkmcnt(2)
v_mfma_f32_16x16x32_bf16 v[176:179], a[192:195], v[64:67], v[48:51]
ds_read_b128 a[224:227], v1 offset:24576
v_add_f32 v32, v46, v32
v_mfma_f32_16x16x32_bf16 v[176:179], a[196:199], v[72:75], v[176:179]
v_exp_f32 v41, v153
v_mfma_f32_16x16x32_bf16 v[176:179], a[200:203], v[80:83], v[176:179]
ds_read_b128 a[228:231], v2 offset:24576
v_cvt_pk_bf16_f32 v205, v46, v47
v_mfma_f32_16x16x32_bf16 v[176:179], a[204:207], v[88:91], v[176:179]
ds_read_b128 a[232:235], v3 offset:24576
buffer_load_dwordx4 v28, s[8:11], s26 offen offset:3072 lds
v_mfma_f32_16x16x32_bf16 v[176:179], a[208:211], v[96:99], v[176:179]
s_add_u32 s26, s26, 32768
v_mfma_f32_16x16x32_bf16 v[176:179], a[212:215], v[104:107], v[176:179]
ds_read_b128 a[236:239], v4 offset:24576
v_add_f32 v32, v47, v32
s_waitcnt lgkmcnt(3)
v_mfma_f32_16x16x32_bf16 v[176:179], a[216:219], v[112:115], v[176:179]
v_exp_f32 v42, v154
v_mfma_f32_16x16x32_bf16 v[176:179], a[220:223], v[120:123], v[176:179]
ds_read_b128 a[240:243], v1 offset:24832
v_add_f32 v31, v40, v31
v_mfma_f32_16x16x32_bf16 v[180:183], a[192:195], v[68:71], v[52:55]
v_exp_f32 v43, v155
v_mfma_f32_16x16x32_bf16 v[180:183], a[196:199], v[76:79], v[180:183]
ds_read_b128 a[244:247], v2 offset:24832
v_mfma_f32_16x16x32_bf16 v[180:183], a[200:203], v[84:87], v[180:183]
v_cvt_pk_bf16_f32 v198, v40, v41
v_add_f32 v31, v41, v31
v_mfma_f32_16x16x32_bf16 v[180:183], a[204:207], v[92:95], v[180:183]
ds_read_b128 a[248:251], v3 offset:24832
v_mfma_f32_16x16x32_bf16 v[180:183], a[208:211], v[100:103], v[180:183]
v_exp_f32 v44, v156
v_add_f32 v31, v42, v31
v_mfma_f32_16x16x32_bf16 v[180:183], a[212:215], v[108:111], v[180:183]
ds_read_b128 a[252:255], v4 offset:24832
v_mfma_f32_16x16x32_bf16 v[180:183], a[216:219], v[116:119], v[180:183]
v_exp_f32 v45, v157
v_mfma_f32_16x16x32_bf16 v[180:183], a[220:223], v[124:127], v[180:183]
v_cvt_pk_bf16_f32 v199, v42, v43
v_add_f32 v31, v43, v31
v_mfma_f32_16x16x32_bf16 v[184:187], a[224:227], v[64:67], v[48:51]
v_exp_f32 v46, v158
s_waitcnt lgkmcnt(1)
v_mfma_f32_16x16x32_bf16 v[184:187], a[228:231], v[72:75], v[184:187]
v_add_f32 v32, v44, v32
v_mfma_f32_16x16x32_bf16 v[184:187], a[232:235], v[80:83], v[184:187]
v_exp_f32 v47, v159
v_mfma_f32_16x16x32_bf16 v[184:187], a[236:239], v[88:91], v[184:187]
v_cvt_pk_bf16_f32 v206, v44, v45
v_add_f32 v32, v45, v32
v_mfma_f32_16x16x32_bf16 v[184:187], a[240:243], v[96:99], v[184:187]
s_waitcnt vmcnt(20) lgkmcnt(0)
s_barrier
ds_read_b64_tr_b16 a[128:129], v5 offset:0
ds_read_b64_tr_b16 a[130:131], v5 offset:8192
v_mfma_f32_16x16x32_bf16 v[184:187], a[244:247], v[104:107], v[184:187]
ds_read_b64_tr_b16 a[132:133], v5 offset:16384
v_add_f32 v32, v46, v32
v_mfma_f32_16x16x32_bf16 v[184:187], a[248:251], v[112:115], v[184:187]
ds_read_b64_tr_b16 a[134:135], v5 offset:24576
v_cvt_pk_bf16_f32 v207, v46, v47
v_mfma_f32_16x16x32_bf16 v[184:187], a[252:255], v[120:123], v[184:187]
ds_read_b64_tr_b16 a[136:137], v6 offset:0
s_add_u32 m0, s24, 0
v_mfma_f32_16x16x32_bf16 v[188:191], a[224:227], v[68:71], v[52:55]
ds_read_b64_tr_b16 a[138:139], v6 offset:8192
s_mov_b32 s29, 128
v_mfma_f32_16x16x32_bf16 v[188:191], a[228:231], v[76:79], v[188:191]
ds_read_b64_tr_b16 a[140:141], v6 offset:16384
buffer_load_dwordx4 v232, s[16:19], s29 offen lds
v_mfma_f32_16x16x32_bf16 v[188:191], a[232:235], v[84:87], v[188:191]
ds_read_b64_tr_b16 a[142:143], v6 offset:24576
v_add_f32 v32, v47, v32
v_mfma_f32_16x16x32_bf16 v[188:191], a[236:239], v[92:95], v[188:191]
ds_read_b64_tr_b16 a[144:145], v7 offset:0
v_mfma_f32_16x16x32_bf16 v[188:191], a[240:243], v[100:103], v[188:191]
ds_read_b64_tr_b16 a[146:147], v7 offset:8192
v_max_f32 v33, v31, v32
v_mfma_f32_16x16x32_bf16 v[188:191], a[244:247], v[108:111], v[188:191]
ds_read_b64_tr_b16 a[148:149], v7 offset:16384
v_cmp_nge_f32 vcc, s28, v33
v_mfma_f32_16x16x32_bf16 v[188:191], a[248:251], v[116:119], v[188:191]
ds_read_b64_tr_b16 a[150:151], v7 offset:24576
s_mov_b32 s29, 6272
v_mfma_f32_16x16x32_bf16 v[188:191], a[252:255], v[124:127], v[188:191]
ds_read_b64_tr_b16 a[152:153], v8 offset:0
ds_read_b64_tr_b16 a[154:155], v8 offset:8192
buffer_load_dwordx4 v232, s[16:19], s29 offen offset:1024 lds
s_cbranch_vccnz K_STUB7
K_BACK7:
s_waitcnt lgkmcnt(6)
v_mfma_f32_16x16x32_bf16 a[0:3], a[128:131], v[192:195], a[0:3]
ds_read_b64_tr_b16 a[156:157], v8 offset:16384
v_add_f32 v29, v29, v31
v_add_f32 v30, v30, v32
v_mfma_f32_16x16x32_bf16 a[0:3], a[132:135], v[196:199], a[0:3]
ds_read_b64_tr_b16 a[158:159], v8 offset:24576
v_exp_f32 v40, v160
v_mfma_f32_16x16x32_bf16 a[4:7], a[128:131], v[200:203], a[4:7]
ds_read_b64_tr_b16 a[160:161], v9 offset:0
v_exp_f32 v41, v161
v_mfma_f32_16x16x32_bf16 a[4:7], a[132:135], v[204:207], a[4:7]
ds_read_b64_tr_b16 a[162:163], v9 offset:8192
v_exp_f32 v42, v162
v_mfma_f32_16x16x32_bf16 a[8:11], a[136:139], v[192:195], a[8:11]
ds_read_b64_tr_b16 a[164:165], v9 offset:16384
s_mov_b32 s29, 12416
v_cmp_gt_u32 vcc, v241, v242
v_add_f32 v31, v40, v41
v_mfma_f32_16x16x32_bf16 a[8:11], a[140:143], v[196:199], a[8:11]
ds_read_b64_tr_b16 a[166:167], v9 offset:24576
buffer_load_dwordx4 v232, s[16:19], s29 offen offset:2048 lds
v_mfma_f32_16x16x32_bf16 a[12:15], a[136:139], v[200:203], a[12:15]
ds_read_b64_tr_b16 a[168:169], v10 offset:0
s_cbranch_vccnz CHK_SLOW
CHK_BACK:
v_exp_f32 v43, v163
v_mfma_f32_16x16x32_bf16 a[12:15], a[140:143], v[204:207], a[12:15]
ds_read_b64_tr_b16 a[170:171], v10 offset:8192
v_cvt_pk_bf16_f32 v208, v40, v41
s_waitcnt lgkmcnt(5)
v_mfma_f32_16x16x32_bf16 a[16:19], a[144:147], v[192:195], a[16:19]
ds_read_b64_tr_b16 a[172:173], v10 offset:16384
v_exp_f32 v44, v164
v_add_f32 v31, v42, v31
v_mfma_f32_16x16x32_bf16 a[16:19], a[148:151], v[196:199], a[16:19]
ds_read_b64_tr_b16 a[174:175], v10 offset:24576
v_exp_f32 v45, v165
v_mfma_f32_16x16x32_bf16 a[20:23], a[144:147], v[200:203], a[20:23]
ds_read_b64_tr_b16 a[176:177], v11 offset:0
s_mov_b32 s29, 18560
v_cvt_pk_bf16_f32 v209, v42, v43
v_mfma_f32_16x16x32_bf16 a[20:23], a[148:151], v[204:207], a[20:23]
ds_read_b64_tr_b16 a[178:179], v11 offset:8192
ds_read_b64_tr_b16 a[180:181], v11 offset:16384
buffer_load_dwordx4 v232, s[16:19], s29 offen offset:3072 lds
v_mfma_f32_16x16x32_bf16 a[24:27], a[152:155], v[192:195], a[24:27]
ds_read_b64_tr_b16 a[182:183], v11 offset:24576
v_add_f32 v31, v43, v31
v_exp_f32 v46, v166
v_mfma_f32_16x16x32_bf16 a[24:27], a[156:159], v[196:199], a[24:27]
ds_read_b64_tr_b16 a[184:185], v12 offset:0
v_add_f32 v32, v44, v45
v_mfma_f32_16x16x32_bf16 a[28:31], a[152:155], v[200:203], a[28:31]
ds_read_b64_tr_b16 a[186:187], v12 offset:8192
v_exp_f32 v47, v167
v_cvt_pk_bf16_f32 v216, v44, v45
v_mfma_f32_16x16x32_bf16 a[28:31], a[156:159], v[204:207], a[28:31]
ds_read_b64_tr_b16 a[188:189], v12 offset:16384
s_add_u32 m0, s24, 4096
v_exp_f32 v40, v168
s_waitcnt lgkmcnt(6)
v_mfma_f32_16x16x32_bf16 a[32:35], a[160:163], v[192:195], a[32:35]
ds_read_b64_tr_b16 a[190:191], v12 offset:24576
s_mov_b32 s29, 28800
v_mfma_f32_16x16x32_bf16 a[32:35], a[164:167], v[196:199], a[32:35]
ds_read_b64_tr_b16 a[192:193], v5 offset:256
buffer_load_dwordx4 v232, s[16:19], s29 offen lds
v_add_f32 v32, v46, v32
v_mfma_f32_16x16x32_bf16 a[36:39], a[160:163], v[200:203], a[36:39]
ds_read_b64_tr_b16 a[194:195], v5 offset:8448
v_exp_f32 v41, v169
v_mfma_f32_16x16x32_bf16 a[36:39], a[164:167], v[204:207], a[36:39]
ds_read_b64_tr_b16 a[196:197], v5 offset:16640
v_cvt_pk_bf16_f32 v217, v46, v47
v_add_f32 v32, v47, v32
v_mfma_f32_16x16x32_bf16 a[40:43], a[168:171], v[192:195], a[40:43]
ds_read_b64_tr_b16 a[198:199], v5 offset:24832
v_exp_f32 v42, v170
v_add_f32 v31, v40, v31
v_mfma_f32_16x16x32_bf16 a[40:43], a[172:175], v[196:199], a[40:43]
ds_read_b64_tr_b16 a[200:201], v6 offset:256
v_exp_f32 v43, v171
v_mfma_f32_16x16x32_bf16 a[44:47], a[168:171], v[200:203], a[44:47]
ds_read_b64_tr_b16 a[202:203], v6 offset:8448
s_mov_b32 s29, 34944
v_cvt_pk_bf16_f32 v210, v40, v41
v_mfma_f32_16x16x32_bf16 a[44:47], a[172:175], v[204:207], a[44:47]
ds_read_b64_tr_b16 a[204:205], v6 offset:16640
ds_read_b64_tr_b16 a[206:207], v6 offset:24832
buffer_load_dwordx4 v232, s[16:19], s29 offen offset:1024 lds
s_waitcnt lgkmcnt(6)
v_mfma_f32_16x16x32_bf16 a[48:51], a[176:179], v[192:195], a[48:51]
ds_read_b64_tr_b16 a[208:209], v7 offset:256
v_add_f32 v31, v41, v31
v_exp_f32 v44, v172
v_mfma_f32_16x16x32_bf16 a[48:51], a[180:183], v[196:199], a[48:51]
ds_read_b64_tr_b16 a[210:211], v7 offset:8448
v_add_f32 v31, v42, v31
v_mfma_f32_16x16x32_bf16 a[52:55], a[176:179], v[200:203], a[52:55]
ds_read_b64_tr_b16 a[212:213], v7 offset:16640
v_exp_f32 v45, v173
v_mfma_f32_16x16x32_bf16 a[52:55], a[180:183], v[204:207], a[52:55]
ds_read_b64_tr_b16 a[214:215], v7 offset:24832
v_cvt_pk_bf16_f32 v211, v42, v43
v_add_f32 v31, v43, v31
v_mfma_f32_16x16x32_bf16 a[56:59], a[184:187], v[192:195], a[56:59]
ds_read_b64_tr_b16 a[216:217], v8 offset:256
s_mov_b32 s29, 41088
v_exp_f32 v46, v174
v_mfma_f32_16x16x32_bf16 a[56:59], a[188:191], v[196:199], a[56:59]
ds_read_b64_tr_b16 a[218:219], v8 offset:8448
buffer_load_dwordx4 v232, s[16:19], s29 offen offset:2048 lds
v_add_f32 v32, v44, v32
v_mfma_f32_16x16x32_bf16 a[60:63], a[184:187], v[200:203], a[60:63]
ds_read_b64_tr_b16 a[220:221], v8 offset:16640
v_exp_f32 v47, v175
v_mfma_f32_16x16x32_bf16 a[60:63], a[188:191], v[204:207], a[60:63]
ds_read_b64_tr_b16 a[222:223], v8 offset:24832
v_cvt_pk_bf16_f32 v218, v44, v45
v_add_f32 v32, v45, v32
v_mfma_f32_16x16x32_bf16 a[64:67], a[192:195], v[192:195], a[64:67]
ds_read_b64_tr_b16 a[224:225], v9 offset:256
v_exp_f32 v40, v176
s_waitcnt lgkmcnt(5)
v_mfma_f32_16x16x32_bf16 a[64:67], a[196:199], v[196:199], a[64:67]
ds_read_b64_tr_b16 a[226:227], v9 offset:8448
v_add_f32 v32, v46, v32
v_exp_f32 v41, v177
v_mfma_f32_16x16x32_bf16 a[68:71], a[192:195], v[200:203], a[68:71]
ds_read_b64_tr_b16 a[228:229], v9 offset:16640
s_mov_b32 s29, 47232
v_cvt_pk_bf16_f32 v219, v46, v47
v_mfma_f32_16x16x32_bf16 a[68:71], a[196:199], v[204:207], a[68:71]
ds_read_b64_tr_b16 a[230:231], v9 offset:24832
ds_read_b64_tr_b16 a[232:233], v10 offset:256
buffer_load_dwordx4 v232, s[16:19], s29 offen offset:3072 lds
v_mfma_f32_16x16x32_bf16 a[72:75], a[200:203], v[192:195], a[72:75]
ds_read_b64_tr_b16 a[234:235], v10 offset:8448
v_add_f32 v32, v47, v32
v_mfma_f32_16x16x32_bf16 a[72:75], a[204:207], v[196:199], a[72:75]
ds_read_b64_tr_b16 a[236:237], v10 offset:16640
v_exp_f32 v42, v178
v_add_f32 v31, v40, v31
v_mfma_f32_16x16x32_bf16 a[76:79], a[200:203], v[200:203], a[76:79]
ds_read_b64_tr_b16 a[238:239], v10 offset:24832
v_exp_f32 v43, v179
v_mfma_f32_16x16x32_bf16 a[76:79], a[204:207], v[204:207], a[76:79]
ds_read_b64_tr_b16 a[240:241], v11 offset:256
v_cvt_pk_bf16_f32 v212, v40, v41
v_add_f32 v31, v41, v31
v_mfma_f32_16x16x32_bf16 a[80:83], a[208:211], v[192:195], a[80:83]
ds_read_b64_tr_b16 a[242:243], v11 offset:8448
v_exp_f32 v44, v180
v_mfma_f32_16x16x32_bf16 a[80:83], a[212:215], v[196:199], a[80:83]
ds_read_b64_tr_b16 a[244:245], v11 offset:16640
v_add_f32 v31, v42, v31
v_exp_f32 v45, v181
v_mfma_f32_16x16x32_bf16 a[84:87], a[208:211], v[200:203], a[84:87]
ds_read_b64_tr_b16 a[246:247], v11 offset:24832
v_cvt_pk_bf16_f32 v213, v42, v43
v_add_f32 v31, v43, v31
v_mfma_f32_16x16x32_bf16 a[84:87], a[212:215], v[204:207], a[84:87]
ds_read_b64_tr_b16 a[248:249], v12 offset:256
v_exp_f32 v46, v182
s_waitcnt lgkmcnt(5)
v_mfma_f32_16x16x32_bf16 a[88:91], a[216:219], v[192:195], a[88:91]
ds_read_b64_tr_b16 a[250:251], v12 offset:8448
v_add_f32 v32, v44, v32
v_mfma_f32_16x16x32_bf16 a[88:91], a[220:223], v[196:199], a[88:91]
ds_read_b64_tr_b16 a[252:253], v12 offset:16640
v_exp_f32 v47, v183
v_cvt_pk_bf16_f32 v220, v44, v45
v_mfma_f32_16x16x32_bf16 a[92:95], a[216:219], v[200:203], a[92:95]
ds_read_b64_tr_b16 a[254:255], v12 offset:24832
v_add_f32 v32, v45, v32
v_exp_f32 v40, v184
v_mfma_f32_16x16x32_bf16 a[92:95], a[220:223], v[204:207], a[92:95]
v_add_f32 v32, v46, v32
v_exp_f32 v41, v185
v_mfma_f32_16x16x32_bf16 a[96:99], a[224:227], v[192:195], a[96:99]
v_cvt_pk_bf16_f32 v221, v46, v47
v_add_f32 v32, v47, v32
v_mfma_f32_16x16x32_bf16 a[96:99], a[228:231], v[196:199], a[96:99]
v_exp_f32 v42, v186
v_add_f32 v31, v40, v31
v_mfma_f32_16x16x32_bf16 a[100:103], a[224:227], v[200:203], a[100:103]
v_exp_f32 v43, v187
v_cvt_pk_bf16_f32 v214, v40, v41
v_add_f32 v31, v41, v31
v_mfma_f32_16x16x32_bf16 a[100:103], a[228:231], v[204:207], a[100:103]
v_exp_f32 v44, v188
v_add_f32 v31, v42, v31
v_mfma_f32_16x16x32_bf16 a[104:107], a[232:235], v[192:195], a[104:107]
s_waitcnt vmcnt(8) lgkmcnt(0)
s_barrier
ds_read_b64_tr_b16 a[128:129], v5 offset:32768
ds_read_b64_tr_b16 a[130:131], v5 offset:40960
v_mfma_f32_16x16x32_bf16 a[104:107], a[236:239], v[196:199], a[104:107]
ds_read_b64_tr_b16 a[132:133], v5 offset:49152
v_exp_f32 v45, v189
v_mfma_f32_16x16x32_bf16 a[108:111], a[232:235], v[200:203], a[108:111]
ds_read_b64_tr_b16 a[134:135], v5 offset:57344
v_cvt_pk_bf16_f32 v215, v42, v43
v_add_f32 v31, v43, v31
v_mfma_f32_16x16x32_bf16 a[108:111], a[236:239], v[204:207], a[108:111]
ds_read_b64_tr_b16 a[136:137], v6 offset:32768
s_add_u32 m0, s24, 65536
v_exp_f32 v46, v190
v_mfma_f32_16x16x32_bf16 a[112:115], a[240:243], v[192:195], a[112:115]
ds_read_b64_tr_b16 a[138:139], v6 offset:40960
s_mov_b32 s29, 256
v_mfma_f32_16x16x32_bf16 a[112:115], a[244:247], v[196:199], a[112:115]
ds_read_b64_tr_b16 a[140:141], v6 offset:49152
buffer_load_dwordx4 v232, s[16:19], s29 offen lds
v_add_f32 v32, v44, v32
v_mfma_f32_16x16x32_bf16 a[116:119], a[240:243], v[200:203], a[116:119]
ds_read_b64_tr_b16 a[142:143], v6 offset:57344
v_exp_f32 v47, v191
v_cvt_pk_bf16_f32 v222, v44, v45
v_mfma_f32_16x16x32_bf16 a[116:119], a[244:247], v[204:207], a[116:119]
ds_read_b64_tr_b16 a[144:145], v7 offset:32768
v_add_f32 v32, v45, v32
v_add_f32 v32, v46, v32
v_mfma_f32_16x16x32_bf16 a[120:123], a[248:251], v[192:195], a[120:123]
ds_read_b64_tr_b16 a[146:147], v7 offset:40960
v_cvt_pk_bf16_f32 v223, v46, v47
v_add_f32 v32, v47, v32
v_mfma_f32_16x16x32_bf16 a[120:123], a[252:255], v[196:199], a[120:123]
ds_read_b64_tr_b16 a[148:149], v7 offset:49152
v_max_f32 v33, v31, v32
v_cmp_nge_f32 vcc, s28, v33
v_mfma_f32_16x16x32_bf16 a[124:127], a[248:251], v[200:203], a[124:127]
ds_read_b64_tr_b16 a[150:151], v7 offset:57344
s_mov_b32 s29, 6400
v_mfma_f32_16x16x32_bf16 a[124:127], a[252:255], v[204:207], a[124:127]
ds_read_b64_tr_b16 a[152:153], v8 offset:32768
ds_read_b64_tr_b16 a[154:155], v8 offset:40960
buffer_load_dwordx4 v232, s[16:19], s29 offen offset:1024 lds
s_cbranch_vccnz K_STUB8
K_BACK8:
s_waitcnt lgkmcnt(6)
v_mfma_f32_16x16x32_bf16 a[0:3], a[128:131], v[208:211], a[0:3]
ds_read_b64_tr_b16 a[156:157], v8 offset:49152
v_add_f32 v29, v29, v31
v_add_f32 v30, v30, v32
v_mfma_f32_16x16x32_bf16 a[0:3], a[132:135], v[212:215], a[0:3]
ds_read_b64_tr_b16 a[158:159], v8 offset:57344
v_mov_b32 v33, v29
s_nop 1
v_mfma_f32_16x16x32_bf16 a[4:7], a[128:131], v[216:219], a[4:7]
ds_read_b64_tr_b16 a[160:161], v9 offset:32768
v_permlane32_swap_b32 v29, v33
v_add_f32 v29, v29, v33
v_mfma_f32_16x16x32_bf16 a[4:7], a[132:135], v[220:223], a[4:7]
ds_read_b64_tr_b16 a[162:163], v9 offset:40960
v_mov_b32 v33, v29
s_nop 1
v_mfma_f32_16x16x32_bf16 a[8:11], a[136:139], v[208:211], a[8:11]
ds_read_b64_tr_b16 a[164:165], v9 offset:49152
s_mov_b32 s29, 12544
v_permlane16_swap_b32 v29, v33
v_add_f32 v29, v29, v33
v_mfma_f32_16x16x32_bf16 a[8:11], a[140:143], v[212:215], a[8:11]
ds_read_b64_tr_b16 a[166:167], v9 offset:57344
buffer_load_dwordx4 v232, s[16:19], s29 offen offset:2048 lds
v_rcp_f32 v236, v29
v_mfma_f32_16x16x32_bf16 a[12:15], a[136:139], v[216:219], a[12:15]
ds_read_b64_tr_b16 a[168:169], v10 offset:32768
v_mov_b32 v33, v30
s_nop 1
v_mfma_f32_16x16x32_bf16 a[12:15], a[140:143], v[220:223], a[12:15]
ds_read_b64_tr_b16 a[170:171], v10 offset:40960
v_permlane32_swap_b32 v30, v33
v_add_f32 v30, v30, v33
s_waitcnt lgkmcnt(5)
v_mfma_f32_16x16x32_bf16 a[16:19], a[144:147], v[208:211], a[16:19]
ds_read_b64_tr_b16 a[172:173], v10 offset:49152
v_mov_b32 v33, v30
s_nop 1
v_mfma_f32_16x16x32_bf16 a[16:19], a[148:151], v[212:215], a[16:19]
ds_read_b64_tr_b16 a[174:175], v10 offset:57344
v_permlane16_swap_b32 v30, v33
v_add_f32 v30, v30, v33
v_mfma_f32_16x16x32_bf16 a[20:23], a[144:147], v[216:219], a[20:23]
ds_read_b64_tr_b16 a[176:177], v11 offset:32768
s_mov_b32 s29, 18688
v_rcp_f32 v237, v30
v_mfma_f32_16x16x32_bf16 a[20:23], a[148:151], v[220:223], a[20:23]
ds_read_b64_tr_b16 a[178:179], v11 offset:40960
ds_read_b64_tr_b16 a[180:181], v11 offset:49152
buffer_load_dwordx4 v232, s[16:19], s29 offen offset:3072 lds
v_mfma_f32_16x16x32_bf16 a[24:27], a[152:155], v[208:211], a[24:27]
ds_read_b64_tr_b16 a[182:183], v11 offset:57344
v_accvgpr_read_b32 v240, a0
v_accvgpr_read_b32 v241, a1
v_accvgpr_read_b32 v242, a2
v_mfma_f32_16x16x32_bf16 a[24:27], a[156:159], v[212:215], a[24:27]
ds_read_b64_tr_b16 a[184:185], v12 offset:32768
v_accvgpr_read_b32 v243, a3
v_accvgpr_read_b32 v244, a8
v_mfma_f32_16x16x32_bf16 a[28:31], a[152:155], v[216:219], a[28:31]
ds_read_b64_tr_b16 a[186:187], v12 offset:40960
v_accvgpr_read_b32 v245, a9
v_accvgpr_read_b32 v246, a10
v_accvgpr_read_b32 v247, a11
v_mfma_f32_16x16x32_bf16 a[28:31], a[156:159], v[220:223], a[28:31]
ds_read_b64_tr_b16 a[188:189], v12 offset:49152
s_add_u32 m0, s24, 69632
v_cvt_pk_bf16_f32 v64, v240, v241
s_waitcnt lgkmcnt(6)
v_mfma_f32_16x16x32_bf16 a[32:35], a[160:163], v[208:211], a[32:35]
ds_read_b64_tr_b16 a[190:191], v12 offset:57344
s_mov_b32 s29, 28928
v_cvt_pk_bf16_f32 v65, v242, v243
v_cvt_pk_bf16_f32 v66, v244, v245
v_mfma_f32_16x16x32_bf16 a[32:35], a[164:167], v[212:215], a[32:35]
ds_read_b64_tr_b16 a[192:193], v5 offset:33024
buffer_load_dwordx4 v232, s[16:19], s29 offen lds
v_cvt_pk_bf16_f32 v67, v246, v247
v_mfma_f32_16x16x32_bf16 a[36:39], a[160:163], v[216:219], a[36:39]
ds_read_b64_tr_b16 a[194:195], v5 offset:41216
v_accvgpr_read_b32 v248, a4
v_accvgpr_read_b32 v249, a5
v_accvgpr_read_b32 v250, a6
v_mfma_f32_16x16x32_bf16 a[36:39], a[164:167], v[220:223], a[36:39]
ds_read_b64_tr_b16 a[196:197], v5 offset:49408
v_accvgpr_read_b32 v251, a7
v_accvgpr_read_b32 v252, a12
v_mfma_f32_16x16x32_bf16 a[40:43], a[168:171], v[208:211], a[40:43]
ds_read_b64_tr_b16 a[198:199], v5 offset:57600
v_accvgpr_read_b32 v253, a13
v_accvgpr_read_b32 v254, a14
v_accvgpr_read_b32 v255, a15
v_mfma_f32_16x16x32_bf16 a[40:43], a[172:175], v[212:215], a[40:43]
ds_read_b64_tr_b16 a[200:201], v6 offset:33024
v_cvt_pk_bf16_f32 v68, v248, v249
v_cvt_pk_bf16_f32 v69, v250, v251
v_mfma_f32_16x16x32_bf16 a[44:47], a[168:171], v[216:219], a[44:47]
ds_read_b64_tr_b16 a[202:203], v6 offset:41216
s_mov_b32 s29, 35072
v_cvt_pk_bf16_f32 v70, v252, v253
v_cvt_pk_bf16_f32 v71, v254, v255
v_mfma_f32_16x16x32_bf16 a[44:47], a[172:175], v[220:223], a[44:47]
ds_read_b64_tr_b16 a[204:205], v6 offset:49408
ds_read_b64_tr_b16 a[206:207], v6 offset:57600
buffer_load_dwordx4 v232, s[16:19], s29 offen offset:1024 lds
s_waitcnt lgkmcnt(6)
v_mfma_f32_16x16x32_bf16 a[48:51], a[176:179], v[208:211], a[48:51]
ds_read_b64_tr_b16 a[208:209], v7 offset:33024
v_accvgpr_read_b32 v240, a16
v_accvgpr_read_b32 v241, a17
v_mfma_f32_16x16x32_bf16 a[48:51], a[180:183], v[212:215], a[48:51]
ds_read_b64_tr_b16 a[210:211], v7 offset:41216
v_accvgpr_read_b32 v242, a18
v_accvgpr_read_b32 v243, a19
v_accvgpr_read_b32 v244, a24
v_mfma_f32_16x16x32_bf16 a[52:55], a[176:179], v[216:219], a[52:55]
ds_read_b64_tr_b16 a[212:213], v7 offset:49408
v_accvgpr_read_b32 v245, a25
v_accvgpr_read_b32 v246, a26
v_mfma_f32_16x16x32_bf16 a[52:55], a[180:183], v[220:223], a[52:55]
ds_read_b64_tr_b16 a[214:215], v7 offset:57600
v_accvgpr_read_b32 v247, a27
v_cvt_pk_bf16_f32 v72, v240, v241
v_mfma_f32_16x16x32_bf16 a[56:59], a[184:187], v[208:211], a[56:59]
ds_read_b64_tr_b16 a[216:217], v8 offset:33024
s_mov_b32 s29, 41216
v_cvt_pk_bf16_f32 v73, v242, v243
v_cvt_pk_bf16_f32 v74, v244, v245
v_mfma_f32_16x16x32_bf16 a[56:59], a[188:191], v[212:215], a[56:59]
ds_read_b64_tr_b16 a[218:219], v8 offset:41216
buffer_load_dwordx4 v232, s[16:19], s29 offen offset:2048 lds
v_cvt_pk_bf16_f32 v75, v246, v247
v_mfma_f32_16x16x32_bf16 a[60:63], a[184:187], v[216:219], a[60:63]
ds_read_b64_tr_b16 a[220:221], v8 offset:49408
v_accvgpr_read_b32 v248, a20
v_accvgpr_read_b32 v249, a21
v_accvgpr_read_b32 v250, a22
v_mfma_f32_16x16x32_bf16 a[60:63], a[188:191], v[220:223], a[60:63]
ds_read_b64_tr_b16 a[222:223], v8 offset:57600
v_accvgpr_read_b32 v251, a23
v_accvgpr_read_b32 v252, a28
v_mfma_f32_16x16x32_bf16 a[64:67], a[192:195], v[208:211], a[64:67]
ds_read_b64_tr_b16 a[224:225], v9 offset:33024
v_accvgpr_read_b32 v253, a29
v_accvgpr_read_b32 v254, a30
v_accvgpr_read_b32 v255, a31
s_waitcnt lgkmcnt(5)
v_mfma_f32_16x16x32_bf16 a[64:67], a[196:199], v[212:215], a[64:67]
ds_read_b64_tr_b16 a[226:227], v9 offset:41216
v_cvt_pk_bf16_f32 v76, v248, v249
v_cvt_pk_bf16_f32 v77, v250, v251
v_mfma_f32_16x16x32_bf16 a[68:71], a[192:195], v[216:219], a[68:71]
ds_read_b64_tr_b16 a[228:229], v9 offset:49408
s_mov_b32 s29, 47360
v_cvt_pk_bf16_f32 v78, v252, v253
v_cvt_pk_bf16_f32 v79, v254, v255
v_mfma_f32_16x16x32_bf16 a[68:71], a[196:199], v[220:223], a[68:71]
ds_read_b64_tr_b16 a[230:231], v9 offset:57600
ds_read_b64_tr_b16 a[232:233], v10 offset:33024
buffer_load_dwordx4 v232, s[16:19], s29 offen offset:3072 lds
v_mfma_f32_16x16x32_bf16 a[72:75], a[200:203], v[208:211], a[72:75]
ds_read_b64_tr_b16 a[234:235], v10 offset:41216
v_accvgpr_read_b32 v240, a32
v_accvgpr_read_b32 v241, a33
v_mfma_f32_16x16x32_bf16 a[72:75], a[204:207], v[212:215], a[72:75]
ds_read_b64_tr_b16 a[236:237], v10 offset:49408
v_accvgpr_read_b32 v242, a34
v_accvgpr_read_b32 v243, a35
v_mfma_f32_16x16x32_bf16 a[76:79], a[200:203], v[216:219], a[76:79]
ds_read_b64_tr_b16 a[238:239], v10 offset:57600
v_accvgpr_read_b32 v244, a40
v_accvgpr_read_b32 v245, a41
v_mfma_f32_16x16x32_bf16 a[76:79], a[204:207], v[220:223], a[76:79]
ds_read_b64_tr_b16 a[240:241], v11 offset:33024
v_accvgpr_read_b32 v246, a42
v_accvgpr_read_b32 v247, a43
v_mfma_f32_16x16x32_bf16 a[80:83], a[208:211], v[208:211], a[80:83]
ds_read_b64_tr_b16 a[242:243], v11 offset:41216
v_cvt_pk_bf16_f32 v80, v240, v241
v_cvt_pk_bf16_f32 v81, v242, v243
v_mfma_f32_16x16x32_bf16 a[80:83], a[212:215], v[212:215], a[80:83]
ds_read_b64_tr_b16 a[244:245], v11 offset:49408
v_cvt_pk_bf16_f32 v82, v244, v245
v_cvt_pk_bf16_f32 v83, v246, v247
v_mfma_f32_16x16x32_bf16 a[84:87], a[208:211], v[216:219], a[84:87]
ds_read_b64_tr_b16 a[246:247], v11 offset:57600
v_accvgpr_read_b32 v248, a36
v_accvgpr_read_b32 v249, a37
v_mfma_f32_16x16x32_bf16 a[84:87], a[212:215], v[220:223], a[84:87]
ds_read_b64_tr_b16 a[248:249], v12 offset:33024
v_accvgpr_read_b32 v250, a38
v_accvgpr_read_b32 v251, a39
s_waitcnt lgkmcnt(5)
v_mfma_f32_16x16x32_bf16 a[88:91], a[216:219], v[208:211], a[88:91]
ds_read_b64_tr_b16 a[250:251], v12 offset:41216
v_accvgpr_read_b32 v252, a44
v_accvgpr_read_b32 v253, a45
v_mfma_f32_16x16x32_bf16 a[88:91], a[220:223], v[212:215], a[88:91]
ds_read_b64_tr_b16 a[252:253], v12 offset:49408
v_accvgpr_read_b32 v254, a46
v_mfma_f32_16x16x32_bf16 a[92:95], a[216:219], v[216:219], a[92:95]
ds_read_b64_tr_b16 a[254:255], v12 offset:57600
v_accvgpr_read_b32 v255, a47
v_cvt_pk_bf16_f32 v84, v248, v249
v_mfma_f32_16x16x32_bf16 a[92:95], a[220:223], v[220:223], a[92:95]
v_cvt_pk_bf16_f32 v85, v250, v251
v_cvt_pk_bf16_f32 v86, v252, v253
v_cvt_pk_bf16_f32 v87, v254, v255
v_mfma_f32_16x16x32_bf16 a[96:99], a[224:227], v[208:211], a[96:99]
v_accvgpr_read_b32 v240, a48
v_accvgpr_read_b32 v241, a49
v_accvgpr_read_b32 v242, a50
v_mfma_f32_16x16x32_bf16 a[96:99], a[228:231], v[212:215], a[96:99]
v_accvgpr_read_b32 v243, a51
v_accvgpr_read_b32 v244, a56
v_mfma_f32_16x16x32_bf16 a[100:103], a[224:227], v[216:219], a[100:103]
v_accvgpr_read_b32 v245, a57
v_accvgpr_read_b32 v246, a58
v_accvgpr_read_b32 v247, a59
v_mfma_f32_16x16x32_bf16 a[100:103], a[228:231], v[220:223], a[100:103]
v_cvt_pk_bf16_f32 v88, v240, v241
v_cvt_pk_bf16_f32 v89, v242, v243
v_mfma_f32_16x16x32_bf16 a[104:107], a[232:235], v[208:211], a[104:107]
s_waitcnt lgkmcnt(0)
s_barrier
ds_read_b64_tr_b16 a[128:129], v224 offset:32768
ds_read_b64_tr_b16 a[130:131], v224 offset:34816
v_mfma_f32_16x16x32_bf16 a[104:107], a[236:239], v[212:215], a[104:107]
ds_read_b64_tr_b16 a[132:133], v225 offset:32768
v_cvt_pk_bf16_f32 v90, v244, v245
v_cvt_pk_bf16_f32 v91, v246, v247
v_mfma_f32_16x16x32_bf16 a[108:111], a[232:235], v[216:219], a[108:111]
ds_read_b64_tr_b16 a[134:135], v225 offset:34816
v_accvgpr_read_b32 v248, a52
v_accvgpr_read_b32 v249, a53
v_accvgpr_read_b32 v250, a54
v_mfma_f32_16x16x32_bf16 a[108:111], a[236:239], v[220:223], a[108:111]
ds_read_b64_tr_b16 a[136:137], v226 offset:32768
s_add_u32 m0, s24, 98304
v_accvgpr_read_b32 v251, a55
v_mfma_f32_16x16x32_bf16 a[112:115], a[240:243], v[208:211], a[112:115]
ds_read_b64_tr_b16 a[138:139], v226 offset:34816
s_mov_b32 s29, 384
v_accvgpr_read_b32 v252, a60
v_accvgpr_read_b32 v253, a61
v_mfma_f32_16x16x32_bf16 a[112:115], a[244:247], v[212:215], a[112:115]
ds_read_b64_tr_b16 a[140:141], v227 offset:32768
buffer_load_dwordx4 v232, s[16:19], s29 offen lds
v_accvgpr_read_b32 v254, a62
v_mfma_f32_16x16x32_bf16 a[116:119], a[240:243], v[216:219], a[116:119]
ds_read_b64_tr_b16 a[142:143], v227 offset:34816
v_accvgpr_read_b32 v255, a63
v_cvt_pk_bf16_f32 v92, v248, v249
v_cvt_pk_bf16_f32 v93, v250, v251
v_mfma_f32_16x16x32_bf16 a[116:119], a[244:247], v[220:223], a[116:119]
ds_read_b64_tr_b16 a[144:145], v224 offset:36864
v_cvt_pk_bf16_f32 v94, v252, v253
v_cvt_pk_bf16_f32 v95, v254, v255
v_mfma_f32_16x16x32_bf16 a[120:123], a[248:251], v[208:211], a[120:123]
ds_read_b64_tr_b16 a[146:147], v224 offset:38912
v_accvgpr_read_b32 v240, a64
v_accvgpr_read_b32 v241, a65
v_accvgpr_read_b32 v242, a66
v_mfma_f32_16x16x32_bf16 a[120:123], a[252:255], v[212:215], a[120:123]
ds_read_b64_tr_b16 a[148:149], v225 offset:36864
v_accvgpr_read_b32 v243, a67
v_accvgpr_read_b32 v244, a72
v_mfma_f32_16x16x32_bf16 a[124:127], a[248:251], v[216:219], a[124:127]
ds_read_b64_tr_b16 a[150:151], v225 offset:38912
s_mov_b32 s29, 6528
v_accvgpr_read_b32 v245, a73
v_accvgpr_read_b32 v246, a74
v_mfma_f32_16x16x32_bf16 a[124:127], a[252:255], v[220:223], a[124:127]
ds_read_b64_tr_b16 a[152:153], v226 offset:36864
ds_read_b64_tr_b16 a[154:155], v226 offset:38912
buffer_load_dwordx4 v232, s[16:19], s29 offen offset:1024 lds
s_waitcnt lgkmcnt(6)
v_mfma_f32_16x16x32_bf16 v[128:131], a[128:131], v[64:67], 0
ds_read_b64_tr_b16 a[156:157], v227 offset:36864
v_accvgpr_read_b32 v247, a75
v_cvt_pk_bf16_f32 v96, v240, v241
v_cvt_pk_bf16_f32 v97, v242, v243
v_mfma_f32_16x16x32_bf16 v[132:135], a[128:131], v[68:71], 0
ds_read_b64_tr_b16 a[158:159], v227 offset:38912
v_cvt_pk_bf16_f32 v98, v244, v245
v_cvt_pk_bf16_f32 v99, v246, v247
v_mfma_f32_16x16x32_bf16 v[136:139], a[132:135], v[64:67], 0
ds_read_b64_tr_b16 a[160:161], v224 offset:40960
v_accvgpr_read_b32 v248, a68
v_accvgpr_read_b32 v249, a69
v_mfma_f32_16x16x32_bf16 v[140:143], a[132:135], v[68:71], 0
ds_read_b64_tr_b16 a[162:163], v224 offset:43008
v_accvgpr_read_b32 v250, a70
v_accvgpr_read_b32 v251, a71
v_accvgpr_read_b32 v252, a76
v_mfma_f32_16x16x32_bf16 v[144:147], a[136:139], v[64:67], 0
ds_read_b64_tr_b16 a[164:165], v225 offset:40960
s_mov_b32 s29, 12672
v_accvgpr_read_b32 v253, a77
v_mfma_f32_16x16x32_bf16 v[148:151], a[136:139], v[68:71], 0
ds_read_b64_tr_b16 a[166:167], v225 offset:43008
buffer_load_dwordx4 v232, s[16:19], s29 offen offset:2048 lds
v_accvgpr_read_b32 v254, a78
v_mfma_f32_16x16x32_bf16 v[152:155], a[140:143], v[64:67], 0
ds_read_b64_tr_b16 a[168:169], v226 offset:40960
v_accvgpr_read_b32 v255, a79
v_cvt_pk_bf16_f32 v100, v248, v249
v_cvt_pk_bf16_f32 v101, v250, v251
v_mfma_f32_16x16x32_bf16 v[156:159], a[140:143], v[68:71], 0
ds_read_b64_tr_b16 a[170:171], v226 offset:43008
v_cvt_pk_bf16_f32 v102, v252, v253
v_cvt_pk_bf16_f32 v103, v254, v255
s_waitcnt lgkmcnt(5)
v_mfma_f32_16x16x32_bf16 v[128:131], a[144:147], v[72:75], v[128:131]
ds_read_b64_tr_b16 a[172:173], v227 offset:40960
v_accvgpr_read_b32 v240, a80
v_accvgpr_read_b32 v241, a81
v_accvgpr_read_b32 v242, a82
v_mfma_f32_16x16x32_bf16 v[132:135], a[144:147], v[76:79], v[132:135]
ds_read_b64_tr_b16 a[174:175], v227 offset:43008
v_accvgpr_read_b32 v243, a83
v_accvgpr_read_b32 v244, a88
v_mfma_f32_16x16x32_bf16 v[136:139], a[148:151], v[72:75], v[136:139]
ds_read_b64_tr_b16 a[176:177], v224 offset:45056
s_mov_b32 s29, 18816
v_accvgpr_read_b32 v245, a89
v_accvgpr_read_b32 v246, a90
v_mfma_f32_16x16x32_bf16 v[140:143], a[148:151], v[76:79], v[140:143]
ds_read_b64_tr_b16 a[178:179], v224 offset:47104
ds_read_b64_tr_b16 a[180:181], v225 offset:45056
buffer_load_dwordx4 v232, s[16:19], s29 offen offset:3072 lds
v_mfma_f32_16x16x32_bf16 v[144:147], a[152:155], v[72:75], v[144:147]
ds_read_b64_tr_b16 a[182:183], v225 offset:47104
v_accvgpr_read_b32 v247, a91
v_cvt_pk_bf16_f32 v104, v240, v241
v_cvt_pk_bf16_f32 v105, v242, v243
v_mfma_f32_16x16x32_bf16 v[148:151], a[152:155], v[76:79], v[148:151]
ds_read_b64_tr_b16 a[184:185], v226 offset:45056
v_cvt_pk_bf16_f32 v106, v244, v245
v_cvt_pk_bf16_f32 v107, v246, v247
v_mfma_f32_16x16x32_bf16 v[152:155], a[156:159], v[72:75], v[152:155]
ds_read_b64_tr_b16 a[186:187], v226 offset:47104
v_accvgpr_read_b32 v248, a84
v_accvgpr_read_b32 v249, a85
v_accvgpr_read_b32 v250, a86
v_mfma_f32_16x16x32_bf16 v[156:159], a[156:159], v[76:79], v[156:159]
ds_read_b64_tr_b16 a[188:189], v227 offset:45056
s_add_u32 m0, s24, 102400
v_accvgpr_read_b32 v251, a87
s_waitcnt lgkmcnt(6)
v_mfma_f32_16x16x32_bf16 v[128:131], a[160:163], v[80:83], v[128:131]
ds_read_b64_tr_b16 a[190:191], v227 offset:47104
s_mov_b32 s29, 29056
v_accvgpr_read_b32 v252, a92
v_accvgpr_read_b32 v253, a93
v_mfma_f32_16x16x32_bf16 v[132:135], a[160:163], v[84:87], v[132:135]
ds_read_b64_tr_b16 a[192:193], v224 offset:49152
buffer_load_dwordx4 v232, s[16:19], s29 offen lds
v_accvgpr_read_b32 v254, a94
v_mfma_f32_16x16x32_bf16 v[136:139], a[164:167], v[80:83], v[136:139]
ds_read_b64_tr_b16 a[194:195], v224 offset:51200
v_accvgpr_read_b32 v255, a95
v_cvt_pk_bf16_f32 v108, v248, v249
v_cvt_pk_bf16_f32 v109, v250, v251
v_mfma_f32_16x16x32_bf16 v[140:143], a[164:167], v[84:87], v[140:143]
ds_read_b64_tr_b16 a[196:197], v225 offset:49152
v_cvt_pk_bf16_f32 v110, v252, v253
v_cvt_pk_bf16_f32 v111, v254, v255
v_mfma_f32_16x16x32_bf16 v[144:147], a[168:171], v[80:83], v[144:147]
ds_read_b64_tr_b16 a[198:199], v225 offset:51200
v_accvgpr_read_b32 v240, a96
v_accvgpr_read_b32 v241, a97
v_accvgpr_read_b32 v242, a98
v_mfma_f32_16x16x32_bf16 v[148:151], a[168:171], v[84:87], v[148:151]
ds_read_b64_tr_b16 a[200:201], v226 offset:49152
v_accvgpr_read_b32 v243, a99
v_accvgpr_read_b32 v244, a104
v_mfma_f32_16x16x32_bf16 v[152:155], a[172:175], v[80:83], v[152:155]
ds_read_b64_tr_b16 a[202:203], v226 offset:51200
s_mov_b32 s29, 35200
v_accvgpr_read_b32 v245, a105
v_accvgpr_read_b32 v246, a106
v_mfma_f32_16x16x32_bf16 v[156:159], a[172:175], v[84:87], v[156:159]
ds_read_b64_tr_b16 a[204:205], v227 offset:49152
ds_read_b64_tr_b16 a[206:207], v227 offset:51200
buffer_load_dwordx4 v232, s[16:19], s29 offen offset:1024 lds
s_waitcnt lgkmcnt(6)
v_mfma_f32_16x16x32_bf16 v[128:131], a[176:179], v[88:91], v[128:131]
ds_read_b64_tr_b16 a[208:209], v224 offset:53248
v_accvgpr_read_b32 v247, a107
v_cvt_pk_bf16_f32 v112, v240, v241
v_cvt_pk_bf16_f32 v113, v242, v243
v_mfma_f32_16x16x32_bf16 v[132:135], a[176:179], v[92:95], v[132:135]
ds_read_b64_tr_b16 a[210:211], v224 offset:55296
v_cvt_pk_bf16_f32 v114, v244, v245
v_cvt_pk_bf16_f32 v115, v246, v247
v_mfma_f32_16x16x32_bf16 v[136:139], a[180:183], v[88:91], v[136:139]
ds_read_b64_tr_b16 a[212:213], v225 offset:53248
v_accvgpr_read_b32 v248, a100
v_accvgpr_read_b32 v249, a101
v_mfma_f32_16x16x32_bf16 v[140:143], a[180:183], v[92:95], v[140:143]
ds_read_b64_tr_b16 a[214:215], v225 offset:55296
v_accvgpr_read_b32 v250, a102
v_accvgpr_read_b32 v251, a103
v_accvgpr_read_b32 v252, a108
v_mfma_f32_16x16x32_bf16 v[144:147], a[184:187], v[88:91], v[144:147]
ds_read_b64_tr_b16 a[216:217], v226 offset:53248
s_mov_b32 s29, 41344
v_accvgpr_read_b32 v253, a109
v_mfma_f32_16x16x32_bf16 v[148:151], a[184:187], v[92:95], v[148:151]
ds_read_b64_tr_b16 a[218:219], v226 offset:55296
buffer_load_dwordx4 v232, s[16:19], s29 offen offset:2048 lds
v_accvgpr_read_b32 v254, a110
v_mfma_f32_16x16x32_bf16 v[152:155], a[188:191], v[88:91], v[152:155]
ds_read_b64_tr_b16 a[220:221], v227 offset:53248
v_accvgpr_read_b32 v255, a111
v_cvt_pk_bf16_f32 v116, v248, v249
v_cvt_pk_bf16_f32 v117, v250, v251
v_mfma_f32_16x16x32_bf16 v[156:159], a[188:191], v[92:95], v[156:159]
ds_read_b64_tr_b16 a[222:223], v227 offset:55296
v_cvt_pk_bf16_f32 v118, v252, v253
v_cvt_pk_bf16_f32 v119, v254, v255
v_mfma_f32_16x16x32_bf16 v[128:131], a[192:195], v[96:99], v[128:131]
ds_read_b64_tr_b16 a[224:225], v224 offset:57344
v_accvgpr_read_b32 v240, a112
v_accvgpr_read_b32 v241, a113
v_accvgpr_read_b32 v242, a114
v_mfma_f32_16x16x32_bf16 v[132:135], a[192:195], v[100:103], v[132:135]
ds_read_b64_tr_b16 a[226:227], v224 offset:59392
v_accvgpr_read_b32 v243, a115
v_accvgpr_read_b32 v244, a120
s_waitcnt lgkmcnt(5)
v_mfma_f32_16x16x32_bf16 v[136:139], a[196:199], v[96:99], v[136:139]
ds_read_b64_tr_b16 a[228:229], v225 offset:57344
s_mov_b32 s29, 47488
v_accvgpr_read_b32 v245, a121
v_accvgpr_read_b32 v246, a122
v_mfma_f32_16x16x32_bf16 v[140:143], a[196:199], v[100:103], v[140:143]
ds_read_b64_tr_b16 a[230:231], v225 offset:59392
ds_read_b64_tr_b16 a[232:233], v226 offset:57344
buffer_load_dwordx4 v232, s[16:19], s29 offen offset:3072 lds
v_mfma_f32_16x16x32_bf16 v[144:147], a[200:203], v[96:99], v[144:147]
ds_read_b64_tr_b16 a[234:235], v226 offset:59392
v_accvgpr_read_b32 v247, a123
v_cvt_pk_bf16_f32 v120, v240, v241
v_cvt_pk_bf16_f32 v121, v242, v243
v_mfma_f32_16x16x32_bf16 v[148:151], a[200:203], v[100:103], v[148:151]
ds_read_b64_tr_b16 a[236:237], v227 offset:57344
v_cvt_pk_bf16_f32 v122, v244, v245
v_cvt_pk_bf16_f32 v123, v246, v247
v_mfma_f32_16x16x32_bf16 v[152:155], a[204:207], v[96:99], v[152:155]
ds_read_b64_tr_b16 a[238:239], v227 offset:59392
v_accvgpr_read_b32 v248, a116
v_accvgpr_read_b32 v249, a117
v_mfma_f32_16x16x32_bf16 v[156:159], a[204:207], v[100:103], v[156:159]
ds_read_b64_tr_b16 a[240:241], v224 offset:61440
v_accvgpr_read_b32 v250, a118
v_accvgpr_read_b32 v251, a119
v_mfma_f32_16x16x32_bf16 v[128:131], a[208:211], v[104:107], v[128:131]
ds_read_b64_tr_b16 a[242:243], v224 offset:63488
v_accvgpr_read_b32 v252, a124
v_accvgpr_read_b32 v253, a125
v_mfma_f32_16x16x32_bf16 v[132:135], a[208:211], v[108:111], v[132:135]
ds_read_b64_tr_b16 a[244:245], v225 offset:61440
v_accvgpr_read_b32 v254, a126
v_accvgpr_read_b32 v255, a127
v_mfma_f32_16x16x32_bf16 v[136:139], a[212:215], v[104:107], v[136:139]
ds_read_b64_tr_b16 a[246:247], v225 offset:63488
v_cvt_pk_bf16_f32 v124, v248, v249
v_cvt_pk_bf16_f32 v125, v250, v251
v_mfma_f32_16x16x32_bf16 v[140:143], a[212:215], v[108:111], v[140:143]
ds_read_b64_tr_b16 a[248:249], v226 offset:61440
v_cvt_pk_bf16_f32 v126, v252, v253
v_cvt_pk_bf16_f32 v127, v254, v255
s_waitcnt lgkmcnt(5)
v_mfma_f32_16x16x32_bf16 v[144:147], a[216:219], v[104:107], v[144:147]
ds_read_b64_tr_b16 a[250:251], v226 offset:63488
v_mfma_f32_16x16x32_bf16 v[148:151], a[216:219], v[108:111], v[148:151]
ds_read_b64_tr_b16 a[252:253], v227 offset:61440
v_mfma_f32_16x16x32_bf16 v[152:155], a[220:223], v[104:107], v[152:155]
ds_read_b64_tr_b16 a[254:255], v227 offset:63488
v_mfma_f32_16x16x32_bf16 v[156:159], a[220:223], v[108:111], v[156:159]
v_mfma_f32_16x16x32_bf16 v[128:131], a[224:227], v[112:115], v[128:131]
v_mfma_f32_16x16x32_bf16 v[132:135], a[224:227], v[116:119], v[132:135]
v_mfma_f32_16x16x32_bf16 v[136:139], a[228:231], v[112:115], v[136:139]
v_mfma_f32_16x16x32_bf16 v[140:143], a[228:231], v[116:119], v[140:143]
v_mfma_f32_16x16x32_bf16 v[144:147], a[232:235], v[112:115], v[144:147]
s_waitcnt vmcnt(16) lgkmcnt(0)
s_barrier
ds_read_b64_tr_b16 a[128:129], v224 offset:0
ds_read_b64_tr_b16 a[130:131], v224 offset:2048
v_mfma_f32_16x16x32_bf16 v[148:151], a[232:235], v[116:119], v[148:151]
ds_read_b64_tr_b16 a[132:133], v224 offset:4096
v_mfma_f32_16x16x32_bf16 v[152:155], a[236:239], v[112:115], v[152:155]
ds_read_b64_tr_b16 a[134:135], v224 offset:6144
v_mfma_f32_16x16x32_bf16 v[156:159], a[236:239], v[116:119], v[156:159]
ds_read_b64_tr_b16 a[136:137], v224 offset:8192
s_add_u32 m0, s24, 32768
v_mfma_f32_16x16x32_bf16 v[128:131], a[240:243], v[120:123], v[128:131]
ds_read_b64_tr_b16 a[138:139], v224 offset:10240
s_mov_b32 s29, 512
v_mfma_f32_16x16x32_bf16 v[132:135], a[240:243], v[124:127], v[132:135]
ds_read_b64_tr_b16 a[140:141], v224 offset:12288
ds_read_b64_tr_b16 a[142:143], v224 offset:14336
buffer_load_dwordx4 v232, s[16:19], s29 offen lds
v_mfma_f32_16x16x32_bf16 v[136:139], a[244:247], v[120:123], v[136:139]
ds_read_b64_tr_b16 a[144:145], v224 offset:16384
ds_read_b64_tr_b16 a[146:147], v224 offset:18432
v_mfma_f32_16x16x32_bf16 v[140:143], a[244:247], v[124:127], v[140:143]
ds_read_b64_tr_b16 a[148:149], v224 offset:20480
ds_read_b64_tr_b16 a[150:151], v224 offset:22528
v_mfma_f32_16x16x32_bf16 v[144:147], a[248:251], v[120:123], v[144:147]
ds_read_b64_tr_b16 a[152:153], v224 offset:24576
ds_read_b64_tr_b16 a[154:155], v224 offset:26624
v_mfma_f32_16x16x32_bf16 v[148:151], a[248:251], v[124:127], v[148:151]
ds_read_b64_tr_b16 a[156:157], v224 offset:28672
ds_read_b64_tr_b16 a[158:159], v224 offset:30720
v_mfma_f32_16x16x32_bf16 v[152:155], a[252:255], v[120:123], v[152:155]
s_mov_b32 s29, 6656
v_mfma_f32_16x16x32_bf16 v[156:159], a[252:255], v[124:127], v[156:159]
buffer_load_dwordx4 v232, s[16:19], s29 offen offset:1024 lds
s_waitcnt lgkmcnt(6)
v_mfma_f32_16x16x32_bf16 v[160:163], a[128:131], v[64:67], 0
v_mfma_f32_16x16x32_bf16 v[160:163], a[132:135], v[72:75], v[160:163]
v_mfma_f32_16x16x32_bf16 v[160:163], a[136:139], v[80:83], v[160:163]
ds_read_b64_tr_b16 a[160:161], v225 offset:0
v_mfma_f32_16x16x32_bf16 v[160:163], a[140:143], v[88:91], v[160:163]
ds_read_b64_tr_b16 a[162:163], v225 offset:2048
v_mfma_f32_16x16x32_bf16 v[160:163], a[144:147], v[96:99], v[160:163]
ds_read_b64_tr_b16 a[164:165], v225 offset:4096
s_mov_b32 s29, 12800
s_add_u32 s33, s32, 0
v_mul_f32 v128, v236, v128
s_waitcnt lgkmcnt(3)
v_mfma_f32_16x16x32_bf16 v[160:163], a[148:151], v[104:107], v[160:163]
ds_read_b64_tr_b16 a[166:167], v225 offset:6144
buffer_load_dwordx4 v232, s[16:19], s29 offen offset:2048 lds
v_mul_f32 v129, v236, v129
v_mfma_f32_16x16x32_bf16 v[160:163], a[152:155], v[112:115], v[160:163]
ds_read_b64_tr_b16 a[168:169], v225 offset:8192
v_mul_f32 v130, v236, v130
v_mul_f32 v131, v236, v131
v_mul_f32 v136, v236, v136
v_mfma_f32_16x16x32_bf16 v[160:163], a[156:159], v[120:123], v[160:163]
ds_read_b64_tr_b16 a[170:171], v225 offset:10240
v_mul_f32 v137, v236, v137
v_mul_f32 v138, v236, v138
v_mul_f32 v139, v236, v139
v_mfma_f32_16x16x32_bf16 v[164:167], a[128:131], v[68:71], 0
ds_read_b64_tr_b16 a[172:173], v225 offset:12288
v_cvt_pk_bf16_f32 v192, v128, v129
v_cvt_pk_bf16_f32 v193, v130, v131
v_mfma_f32_16x16x32_bf16 v[164:167], a[132:135], v[76:79], v[164:167]
ds_read_b64_tr_b16 a[174:175], v225 offset:14336
v_or_b32 v192, 1, v192
v_cvt_pk_bf16_f32 v194, v136, v137
v_cvt_pk_bf16_f32 v195, v138, v139
v_mfma_f32_16x16x32_bf16 v[164:167], a[136:139], v[84:87], v[164:167]
ds_read_b64_tr_b16 a[176:177], v225 offset:16384
ds_read_b64_tr_b16 a[178:179], v225 offset:18432
s_mov_b32 s29, 18944
v_mfma_f32_16x16x32_bf16 v[164:167], a[140:143], v[92:95], v[164:167]
ds_read_b64_tr_b16 a[180:181], v225 offset:20480
ds_read_b64_tr_b16 a[182:183], v225 offset:22528
buffer_load_dwordx4 v232, s[16:19], s29 offen offset:3072 lds
buffer_store_dwordx4 v[192:195], v233, s[20:23], s33 offen sc1
v_mfma_f32_16x16x32_bf16 v[164:167], a[144:147], v[100:103], v[164:167]
ds_read_b64_tr_b16 a[184:185], v225 offset:24576
ds_read_b64_tr_b16 a[186:187], v225 offset:26624
v_mul_f32 v132, v237, v132
v_mfma_f32_16x16x32_bf16 v[164:167], a[148:151], v[108:111], v[164:167]
ds_read_b64_tr_b16 a[188:189], v225 offset:28672
ds_read_b64_tr_b16 a[190:191], v225 offset:30720
v_mul_f32 v133, v237, v133
v_mfma_f32_16x16x32_bf16 v[164:167], a[152:155], v[116:119], v[164:167]
v_mul_f32 v134, v237, v134
v_mul_f32 v135, v237, v135
v_mul_f32 v140, v237, v140
v_mfma_f32_16x16x32_bf16 v[164:167], a[156:159], v[124:127], v[164:167]
s_add_u32 m0, s24, 36864
v_mul_f32 v141, v237, v141
v_mul_f32 v142, v237, v142
s_waitcnt lgkmcnt(6)
v_mfma_f32_16x16x32_bf16 v[168:171], a[160:163], v[64:67], 0
s_mov_b32 s29, 29184
v_mul_f32 v143, v237, v143
v_cvt_pk_bf16_f32 v196, v132, v133
v_mfma_f32_16x16x32_bf16 v[168:171], a[164:167], v[72:75], v[168:171]
ds_read_b64_tr_b16 a[192:193], v226 offset:0
buffer_load_dwordx4 v232, s[16:19], s29 offen lds
v_cvt_pk_bf16_f32 v197, v134, v135
v_mfma_f32_16x16x32_bf16 v[168:171], a[168:171], v[80:83], v[168:171]
ds_read_b64_tr_b16 a[194:195], v226 offset:2048
v_or_b32 v196, 1, v196
v_cvt_pk_bf16_f32 v198, v140, v141
v_mfma_f32_16x16x32_bf16 v[168:171], a[172:175], v[88:91], v[168:171]
ds_read_b64_tr_b16 a[196:197], v226 offset:4096
v_cvt_pk_bf16_f32 v199, v142, v143
buffer_store_dwordx4 v[196:199], v234, s[20:23], s33 offen sc1
v_mfma_f32_16x16x32_bf16 v[168:171], a[176:179], v[96:99], v[168:171]
ds_read_b64_tr_b16 a[198:199], v226 offset:6144
v_mul_f32 v144, v236, v144
v_mul_f32 v145, v236, v145
s_waitcnt lgkmcnt(4)
v_mfma_f32_16x16x32_bf16 v[168:171], a[180:183], v[104:107], v[168:171]
ds_read_b64_tr_b16 a[200:201], v226 offset:8192
v_mul_f32 v146, v236, v146
v_mul_f32 v147, v236, v147
v_mfma_f32_16x16x32_bf16 v[168:171], a[184:187], v[112:115], v[168:171]
ds_read_b64_tr_b16 a[202:203], v226 offset:10240
s_mov_b32 s29, 35328
v_mul_f32 v152, v236, v152
v_mfma_f32_16x16x32_bf16 v[168:171], a[188:191], v[120:123], v[168:171]
ds_read_b64_tr_b16 a[204:205], v226 offset:12288
ds_read_b64_tr_b16 a[206:207], v226 offset:14336
buffer_load_dwordx4 v232, s[16:19], s29 offen offset:1024 lds
v_mul_f32 v153, v236, v153
v_mfma_f32_16x16x32_bf16 v[172:175], a[160:163], v[68:71], 0
ds_read_b64_tr_b16 a[208:209], v226 offset:16384
v_mul_f32 v154, v236, v154
v_mul_f32 v155, v236, v155
v_mfma_f32_16x16x32_bf16 v[172:175], a[164:167], v[76:79], v[172:175]
ds_read_b64_tr_b16 a[210:211], v226 offset:18432
v_cvt_pk_bf16_f32 v200, v144, v145
v_cvt_pk_bf16_f32 v201, v146, v147
v_mfma_f32_16x16x32_bf16 v[172:175], a[168:171], v[84:87], v[172:175]
ds_read_b64_tr_b16 a[212:213], v226 offset:20480
v_or_b32 v200, 1, v200
v_cvt_pk_bf16_f32 v202, v152, v153
v_mfma_f32_16x16x32_bf16 v[172:175], a[172:175], v[92:95], v[172:175]
ds_read_b64_tr_b16 a[214:215], v226 offset:22528
v_cvt_pk_bf16_f32 v203, v154, v155
buffer_store_dwordx4 v[200:203], v233, s[20:23], s33 offen offset:1024 sc1
v_mfma_f32_16x16x32_bf16 v[172:175], a[176:179], v[100:103], v[172:175]
ds_read_b64_tr_b16 a[216:217], v226 offset:24576
ds_read_b64_tr_b16 a[218:219], v226 offset:26624
s_mov_b32 s29, 41472
v_mfma_f32_16x16x32_bf16 v[172:175], a[180:183], v[108:111], v[172:175]
ds_read_b64_tr_b16 a[220:221], v226 offset:28672
ds_read_b64_tr_b16 a[222:223], v226 offset:30720
buffer_load_dwordx4 v232, s[16:19], s29 offen offset:2048 lds
v_mul_f32 v148, v237, v148
v_mfma_f32_16x16x32_bf16 v[172:175], a[184:187], v[116:119], v[172:175]
v_mul_f32 v149, v237, v149
v_mul_f32 v150, v237, v150
v_mul_f32 v151, v237, v151
v_mfma_f32_16x16x32_bf16 v[172:175], a[188:191], v[124:127], v[172:175]
v_mul_f32 v156, v237, v156
v_mul_f32 v157, v237, v157
v_mul_f32 v158, v237, v158
v_mul_f32 v159, v237, v159
s_waitcnt lgkmcnt(5)
v_mfma_f32_16x16x32_bf16 v[176:179], a[192:195], v[64:67], 0
ds_read_b64_tr_b16 a[224:225], v227 offset:0
v_cvt_pk_bf16_f32 v204, v148, v149
v_cvt_pk_bf16_f32 v205, v150, v151
v_mfma_f32_16x16x32_bf16 v[176:179], a[196:199], v[72:75], v[176:179]
ds_read_b64_tr_b16 a[226:227], v227 offset:2048
v_or_b32 v204, 1, v204
v_cvt_pk_bf16_f32 v206, v156, v157
v_mfma_f32_16x16x32_bf16 v[176:179], a[200:203], v[80:83], v[176:179]
ds_read_b64_tr_b16 a[228:229], v227 offset:4096
s_mov_b32 s29, 47616
v_cvt_pk_bf16_f32 v207, v158, v159
buffer_store_dwordx4 v[204:207], v234, s[20:23], s33 offen offset:1024 sc1
v_mfma_f32_16x16x32_bf16 v[176:179], a[204:207], v[88:91], v[176:179]
ds_read_b64_tr_b16 a[230:231], v227 offset:6144
ds_read_b64_tr_b16 a[232:233], v227 offset:8192
buffer_load_dwordx4 v232, s[16:19], s29 offen offset:3072 lds
v_mfma_f32_16x16x32_bf16 v[176:179], a[208:211], v[96:99], v[176:179]
ds_read_b64_tr_b16 a[234:235], v227 offset:10240
s_waitcnt lgkmcnt(6)
v_mfma_f32_16x16x32_bf16 v[176:179], a[212:215], v[104:107], v[176:179]
ds_read_b64_tr_b16 a[236:237], v227 offset:12288
s_add_u32 s33, s32, 4194304
v_mul_f32 v160, v236, v160
v_mfma_f32_16x16x32_bf16 v[176:179], a[216:219], v[112:115], v[176:179]
ds_read_b64_tr_b16 a[238:239], v227 offset:14336
v_mul_f32 v161, v236, v161
v_mul_f32 v162, v236, v162
v_mfma_f32_16x16x32_bf16 v[176:179], a[220:223], v[120:123], v[176:179]
ds_read_b64_tr_b16 a[240:241], v227 offset:16384
v_mul_f32 v163, v236, v163
v_mfma_f32_16x16x32_bf16 v[180:183], a[192:195], v[68:71], 0
ds_read_b64_tr_b16 a[242:243], v227 offset:18432
v_mul_f32 v168, v236, v168
v_mul_f32 v169, v236, v169
v_mfma_f32_16x16x32_bf16 v[180:183], a[196:199], v[76:79], v[180:183]
ds_read_b64_tr_b16 a[244:245], v227 offset:20480
v_mul_f32 v170, v236, v170
v_mul_f32 v171, v236, v171
v_mfma_f32_16x16x32_bf16 v[180:183], a[200:203], v[84:87], v[180:183]
ds_read_b64_tr_b16 a[246:247], v227 offset:22528
v_cvt_pk_bf16_f32 v208, v160, v161
v_cvt_pk_bf16_f32 v209, v162, v163
v_mfma_f32_16x16x32_bf16 v[180:183], a[204:207], v[92:95], v[180:183]
ds_read_b64_tr_b16 a[248:249], v227 offset:24576
v_or_b32 v208, 1, v208
v_mfma_f32_16x16x32_bf16 v[180:183], a[208:211], v[100:103], v[180:183]
ds_read_b64_tr_b16 a[250:251], v227 offset:26624
v_cvt_pk_bf16_f32 v210, v168, v169
v_cvt_pk_bf16_f32 v211, v170, v171
v_mfma_f32_16x16x32_bf16 v[180:183], a[212:215], v[108:111], v[180:183]
ds_read_b64_tr_b16 a[252:253], v227 offset:28672
ds_read_b64_tr_b16 a[254:255], v227 offset:30720
buffer_store_dwordx4 v[208:211], v233, s[20:23], s33 offen sc1
v_mfma_f32_16x16x32_bf16 v[180:183], a[216:219], v[116:119], v[180:183]
v_mfma_f32_16x16x32_bf16 v[180:183], a[220:223], v[124:127], v[180:183]
s_waitcnt lgkmcnt(4)
v_mfma_f32_16x16x32_bf16 v[184:187], a[224:227], v[64:67], 0
v_mfma_f32_16x16x32_bf16 v[184:187], a[228:231], v[72:75], v[184:187]
v_mfma_f32_16x16x32_bf16 v[184:187], a[232:235], v[80:83], v[184:187]
v_mfma_f32_16x16x32_bf16 v[184:187], a[236:239], v[88:91], v[184:187]
v_mul_f32 v164, v237, v164
v_mul_f32 v165, v237, v165
v_mul_f32 v166, v237, v166
v_mfma_f32_16x16x32_bf16 v[184:187], a[240:243], v[96:99], v[184:187]
s_waitcnt vmcnt(21) lgkmcnt(0)
s_barrier
ds_read_b64_tr_b16 a[128:129], v228 offset:0
ds_read_b64_tr_b16 a[130:131], v228 offset:2048
v_mfma_f32_16x16x32_bf16 v[184:187], a[244:247], v[104:107], v[184:187]
ds_read_b64_tr_b16 a[132:133], v228 offset:4096
v_mul_f32 v167, v237, v167
v_mul_f32 v172, v237, v172
v_mul_f32 v173, v237, v173
v_mfma_f32_16x16x32_bf16 v[184:187], a[248:251], v[112:115], v[184:187]
ds_read_b64_tr_b16 a[134:135], v228 offset:6144
v_mul_f32 v174, v237, v174
v_mul_f32 v175, v237, v175
v_mfma_f32_16x16x32_bf16 v[184:187], a[252:255], v[120:123], v[184:187]
ds_read_b64_tr_b16 a[136:137], v228 offset:8192
s_add_u32 m0, s24, 0
v_cvt_pk_bf16_f32 v212, v164, v165
v_cvt_pk_bf16_f32 v213, v166, v167
v_mfma_f32_16x16x32_bf16 v[188:191], a[224:227], v[68:71], 0
ds_read_b64_tr_b16 a[138:139], v228 offset:10240
s_mov_b32 s29, 640
v_or_b32 v212, 1, v212
v_mfma_f32_16x16x32_bf16 v[188:191], a[228:231], v[76:79], v[188:191]
ds_read_b64_tr_b16 a[140:141], v228 offset:12288
ds_read_b64_tr_b16 a[142:143], v228 offset:14336
buffer_load_dwordx4 v232, s[16:19], s29 offen lds
v_mfma_f32_16x16x32_bf16 v[188:191], a[232:235], v[84:87], v[188:191]
ds_read_b64_tr_b16 a[144:145], v228 offset:16384
ds_read_b64_tr_b16 a[146:147], v228 offset:18432
v_cvt_pk_bf16_f32 v214, v172, v173
v_cvt_pk_bf16_f32 v215, v174, v175
v_mfma_f32_16x16x32_bf16 v[188:191], a[236:239], v[92:95], v[188:191]
ds_read_b64_tr_b16 a[148:149], v228 offset:20480
ds_read_b64_tr_b16 a[150:151], v228 offset:22528
buffer_store_dwordx4 v[212:215], v234, s[20:23], s33 offen sc1
v_mfma_f32_16x16x32_bf16 v[188:191], a[240:243], v[100:103], v[188:191]
ds_read_b64_tr_b16 a[152:153], v228 offset:24576
ds_read_b64_tr_b16 a[154:155], v228 offset:26624
v_mfma_f32_16x16x32_bf16 v[188:191], a[244:247], v[108:111], v[188:191]
ds_read_b64_tr_b16 a[156:157], v228 offset:28672
ds_read_b64_tr_b16 a[158:159], v228 offset:30720
v_mfma_f32_16x16x32_bf16 v[188:191], a[248:251], v[116:119], v[188:191]
s_mov_b32 s29, 6784
v_mul_f32 v176, v236, v176
v_mul_f32 v177, v236, v177
v_mfma_f32_16x16x32_bf16 v[188:191], a[252:255], v[124:127], v[188:191]
buffer_load_dwordx4 v232, s[16:19], s29 offen offset:1024 lds
v_mul_f32 v178, v236, v178
s_waitcnt lgkmcnt(6)
v_mfma_f32_16x16x32_bf16 v[128:131], a[128:131], v[64:67], 0
v_mul_f32 v179, v236, v179
v_mul_f32 v184, v236, v184
v_mfma_f32_16x16x32_bf16 v[128:131], a[132:135], v[72:75], v[128:131]
v_mul_f32 v185, v236, v185
v_mul_f32 v186, v236, v186
v_mfma_f32_16x16x32_bf16 v[128:131], a[136:139], v[80:83], v[128:131]
ds_read_b64_tr_b16 a[160:161], v229 offset:0
v_mul_f32 v187, v236, v187
v_cvt_pk_bf16_f32 v216, v176, v177
v_mfma_f32_16x16x32_bf16 v[128:131], a[140:143], v[88:91], v[128:131]
ds_read_b64_tr_b16 a[162:163], v229 offset:2048
v_cvt_pk_bf16_f32 v217, v178, v179
v_mfma_f32_16x16x32_bf16 v[128:131], a[144:147], v[96:99], v[128:131]
ds_read_b64_tr_b16 a[164:165], v229 offset:4096
s_mov_b32 s29, 12928
s_waitcnt lgkmcnt(3)
v_mfma_f32_16x16x32_bf16 v[128:131], a[148:151], v[104:107], v[128:131]
ds_read_b64_tr_b16 a[166:167], v229 offset:6144
buffer_load_dwordx4 v232, s[16:19], s29 offen offset:2048 lds
v_mfma_f32_16x16x32_bf16 v[128:131], a[152:155], v[112:115], v[128:131]
ds_read_b64_tr_b16 a[168:169], v229 offset:8192
v_or_b32 v216, 1, v216
v_cvt_pk_bf16_f32 v218, v184, v185
v_mfma_f32_16x16x32_bf16 v[128:131], a[156:159], v[120:123], v[128:131]
ds_read_b64_tr_b16 a[170:171], v229 offset:10240
v_cvt_pk_bf16_f32 v219, v186, v187
v_mfma_f32_16x16x32_bf16 v[132:135], a[128:131], v[68:71], 0
ds_read_b64_tr_b16 a[172:173], v229 offset:12288
buffer_store_dwordx4 v[216:219], v233, s[20:23], s33 offen offset:1024 sc1
v_mfma_f32_16x16x32_bf16 v[132:135], a[132:135], v[76:79], v[132:135]
ds_read_b64_tr_b16 a[174:175], v229 offset:14336
v_mul_f32 v180, v237, v180
v_mfma_f32_16x16x32_bf16 v[132:135], a[136:139], v[84:87], v[132:135]
ds_read_b64_tr_b16 a[176:177], v229 offset:16384
ds_read_b64_tr_b16 a[178:179], v229 offset:18432
s_mov_b32 s29, 19072
v_mfma_f32_16x16x32_bf16 v[132:135], a[140:143], v[92:95], v[132:135]
ds_read_b64_tr_b16 a[180:181], v229 offset:20480
ds_read_b64_tr_b16 a[182:183], v229 offset:22528
buffer_load_dwordx4 v232, s[16:19], s29 offen offset:3072 lds
v_mfma_f32_16x16x32_bf16 v[132:135], a[144:147], v[100:103], v[132:135]
ds_read_b64_tr_b16 a[184:185], v229 offset:24576
ds_read_b64_tr_b16 a[186:187], v229 offset:26624
v_mul_f32 v181, v237, v181
v_mfma_f32_16x16x32_bf16 v[132:135], a[148:151], v[108:111], v[132:135]
ds_read_b64_tr_b16 a[188:189], v229 offset:28672
ds_read_b64_tr_b16 a[190:191], v229 offset:30720
v_mfma_f32_16x16x32_bf16 v[132:135], a[152:155], v[116:119], v[132:135]
v_mul_f32 v182, v237, v182
v_mul_f32 v183, v237, v183
v_mul_f32 v188, v237, v188
v_mfma_f32_16x16x32_bf16 v[132:135], a[156:159], v[124:127], v[132:135]
s_add_u32 m0, s24, 4096
v_mul_f32 v189, v237, v189
s_waitcnt lgkmcnt(6)
v_mfma_f32_16x16x32_bf16 v[136:139], a[160:163], v[64:67], 0
s_mov_b32 s29, 29312
v_mul_f32 v190, v237, v190
v_mul_f32 v191, v237, v191
v_mfma_f32_16x16x32_bf16 v[136:139], a[164:167], v[72:75], v[136:139]
ds_read_b64_tr_b16 a[192:193], v230 offset:0
buffer_load_dwordx4 v232, s[16:19], s29 offen lds
v_mfma_f32_16x16x32_bf16 v[136:139], a[168:171], v[80:83], v[136:139]
ds_read_b64_tr_b16 a[194:195], v230 offset:2048
v_cvt_pk_bf16_f32 v220, v180, v181
v_mfma_f32_16x16x32_bf16 v[136:139], a[172:175], v[88:91], v[136:139]
ds_read_b64_tr_b16 a[196:197], v230 offset:4096
v_cvt_pk_bf16_f32 v221, v182, v183
v_or_b32 v220, 1, v220
v_mfma_f32_16x16x32_bf16 v[136:139], a[176:179], v[96:99], v[136:139]
ds_read_b64_tr_b16 a[198:199], v230 offset:6144
v_cvt_pk_bf16_f32 v222, v188, v189
s_waitcnt lgkmcnt(4)
v_mfma_f32_16x16x32_bf16 v[136:139], a[180:183], v[104:107], v[136:139]
ds_read_b64_tr_b16 a[200:201], v230 offset:8192
v_cvt_pk_bf16_f32 v223, v190, v191
buffer_store_dwordx4 v[220:223], v234, s[20:23], s33 offen offset:1024 sc1
v_mfma_f32_16x16x32_bf16 v[136:139], a[184:187], v[112:115], v[136:139]
ds_read_b64_tr_b16 a[202:203], v230 offset:10240
s_mov_b32 s29, 35456
s_lshl4_add_u32 s59, s58, s57
v_mfma_f32_16x16x32_bf16 v[136:139], a[188:191], v[120:123], v[136:139]
ds_read_b64_tr_b16 a[204:205], v230 offset:12288
ds_read_b64_tr_b16 a[206:207], v230 offset:14336
buffer_load_dwordx4 v232, s[16:19], s29 offen offset:1024 lds
v_mfma_f32_16x16x32_bf16 v[140:143], a[160:163], v[68:71], 0
ds_read_b64_tr_b16 a[208:209], v230 offset:16384
s_mul_i32 s28, s59, 7168
v_mfma_f32_16x16x32_bf16 v[140:143], a[164:167], v[76:79], v[140:143]
ds_read_b64_tr_b16 a[210:211], v230 offset:18432
s_and_b32 s59, s59, -4
v_mfma_f32_16x16x32_bf16 v[140:143], a[168:171], v[84:87], v[140:143]
ds_read_b64_tr_b16 a[212:213], v230 offset:20480
s_add_u32 s59, s59, s56
v_mfma_f32_16x16x32_bf16 v[140:143], a[172:175], v[92:95], v[140:143]
ds_read_b64_tr_b16 a[214:215], v230 offset:22528
s_add_u32 s33, s32, 8388608
v_mfma_f32_16x16x32_bf16 v[140:143], a[176:179], v[100:103], v[140:143]
ds_read_b64_tr_b16 a[216:217], v230 offset:24576
ds_read_b64_tr_b16 a[218:219], v230 offset:26624
s_mov_b32 s29, 41600
v_mfma_f32_16x16x32_bf16 v[140:143], a[180:183], v[108:111], v[140:143]
ds_read_b64_tr_b16 a[220:221], v230 offset:28672
ds_read_b64_tr_b16 a[222:223], v230 offset:30720
buffer_load_dwordx4 v232, s[16:19], s29 offen offset:2048 lds
v_mfma_f32_16x16x32_bf16 v[140:143], a[184:187], v[116:119], v[140:143]
v_mul_f32 v128, v236, v128
v_mul_f32 v129, v236, v129
v_mul_f32 v130, v236, v130
v_mfma_f32_16x16x32_bf16 v[140:143], a[188:191], v[124:127], v[140:143]
v_mul_f32 v131, v236, v131
v_mul_f32 v136, v236, v136
s_lshl_b32 s59, s59, 9
s_waitcnt lgkmcnt(5)
v_mfma_f32_16x16x32_bf16 v[144:147], a[192:195], v[64:67], 0
ds_read_b64_tr_b16 a[224:225], v231 offset:0
v_mul_f32 v137, v236, v137
v_mfma_f32_16x16x32_bf16 v[144:147], a[196:199], v[72:75], v[144:147]
ds_read_b64_tr_b16 a[226:227], v231 offset:2048
v_mul_f32 v138, v236, v138
v_mfma_f32_16x16x32_bf16 v[144:147], a[200:203], v[80:83], v[144:147]
ds_read_b64_tr_b16 a[228:229], v231 offset:4096
s_mov_b32 s29, 47744
v_mul_f32 v139, v236, v139
v_mfma_f32_16x16x32_bf16 v[144:147], a[204:207], v[88:91], v[144:147]
ds_read_b64_tr_b16 a[230:231], v231 offset:6144
ds_read_b64_tr_b16 a[232:233], v231 offset:8192
buffer_load_dwordx4 v232, s[16:19], s29 offen offset:3072 lds
v_mfma_f32_16x16x32_bf16 v[144:147], a[208:211], v[96:99], v[144:147]
ds_read_b64_tr_b16 a[234:235], v231 offset:10240
v_cvt_pk_bf16_f32 v192, v128, v129
s_waitcnt lgkmcnt(6)
v_mfma_f32_16x16x32_bf16 v[144:147], a[212:215], v[104:107], v[144:147]
ds_read_b64_tr_b16 a[236:237], v231 offset:12288
v_cvt_pk_bf16_f32 v193, v130, v131
v_mfma_f32_16x16x32_bf16 v[144:147], a[216:219], v[112:115], v[144:147]
ds_read_b64_tr_b16 a[238:239], v231 offset:14336
v_or_b32 v192, 1, v192
s_add_u32 s101, s59, 262144
v_mfma_f32_16x16x32_bf16 v[144:147], a[220:223], v[120:123], v[144:147]
ds_read_b64_tr_b16 a[240:241], v231 offset:16384
v_cvt_pk_bf16_f32 v194, v136, v137
v_cvt_pk_bf16_f32 v195, v138, v139
v_mfma_f32_16x16x32_bf16 v[148:151], a[192:195], v[68:71], 0
ds_read_b64_tr_b16 a[242:243], v231 offset:18432
buffer_store_dwordx4 v[192:195], v233, s[20:23], s33 offen sc1
v_mfma_f32_16x16x32_bf16 v[148:151], a[196:199], v[76:79], v[148:151]
ds_read_b64_tr_b16 a[244:245], v231 offset:20480
v_mul_f32 v132, v237, v132
v_mfma_f32_16x16x32_bf16 v[148:151], a[200:203], v[84:87], v[148:151]
ds_read_b64_tr_b16 a[246:247], v231 offset:22528
v_and_b32 v34, 7, v0
v_mfma_f32_16x16x32_bf16 v[148:151], a[204:207], v[92:95], v[148:151]
ds_read_b64_tr_b16 a[248:249], v231 offset:24576
v_mul_f32 v133, v237, v133
v_mfma_f32_16x16x32_bf16 v[148:151], a[208:211], v[100:103], v[148:151]
ds_read_b64_tr_b16 a[250:251], v231 offset:26624
v_mul_f32 v134, v237, v134
v_mfma_f32_16x16x32_bf16 v[148:151], a[212:215], v[108:111], v[148:151]
ds_read_b64_tr_b16 a[252:253], v231 offset:28672
ds_read_b64_tr_b16 a[254:255], v231 offset:30720
v_bfe_u32 v33, v0, 3, 1
v_mfma_f32_16x16x32_bf16 v[148:151], a[216:219], v[116:119], v[148:151]
v_mul_f32 v135, v237, v135
s_and_b32 s59, s56, 2
v_mfma_f32_16x16x32_bf16 v[148:151], a[220:223], v[124:127], v[148:151]
v_mul_f32 v140, v237, v140
v_mul_f32 v141, v237, v141
s_waitcnt lgkmcnt(4)
v_mfma_f32_16x16x32_bf16 v[152:155], a[224:227], v[64:67], 0
v_mul_f32 v142, v237, v142
v_mul_f32 v143, v237, v143
v_mfma_f32_16x16x32_bf16 v[152:155], a[228:231], v[72:75], v[152:155]
v_cvt_pk_bf16_f32 v196, v132, v133
s_add_u32 s59, s59, s56
v_mfma_f32_16x16x32_bf16 v[152:155], a[232:235], v[80:83], v[152:155]
v_cvt_pk_bf16_f32 v197, v134, v135
v_or_b32 v196, 1, v196
s_lshl_b32 s59, s59, 5
v_mfma_f32_16x16x32_bf16 v[152:155], a[236:239], v[88:91], v[152:155]
v_cvt_pk_bf16_f32 v198, v140, v141
v_cvt_pk_bf16_f32 v199, v142, v143
v_mfma_f32_16x16x32_bf16 v[152:155], a[240:243], v[96:99], v[152:155]
s_waitcnt vmcnt(25) lgkmcnt(0)
s_barrier
ds_read_b64_tr_b16 a[128:129], v228 offset:32768
ds_read_b64_tr_b16 a[130:131], v228 offset:34816
v_mfma_f32_16x16x32_bf16 v[152:155], a[244:247], v[104:107], v[152:155]
ds_read_b64_tr_b16 a[132:133], v228 offset:36864
v_lshl_add_u32 v22, v33, 4, s59
v_mfma_f32_16x16x32_bf16 v[152:155], a[248:251], v[112:115], v[152:155]
ds_read_b64_tr_b16 a[134:135], v228 offset:38912
buffer_store_dwordx4 v[196:199], v234, s[20:23], s33 offen sc1
v_mfma_f32_16x16x32_bf16 v[152:155], a[252:255], v[120:123], v[152:155]
ds_read_b64_tr_b16 a[136:137], v228 offset:40960
s_add_u32 m0, s24, 65536
v_mfma_f32_16x16x32_bf16 v[156:159], a[224:227], v[68:71], 0
ds_read_b64_tr_b16 a[138:139], v228 offset:43008
s_mov_b32 s29, 768
v_bfe_u32 v32, v0, 4, 1
v_mfma_f32_16x16x32_bf16 v[156:159], a[228:231], v[76:79], v[156:159]
ds_read_b64_tr_b16 a[140:141], v228 offset:45056
ds_read_b64_tr_b16 a[142:143], v228 offset:47104
buffer_load_dwordx4 v232, s[16:19], s29 offen lds
v_mfma_f32_16x16x32_bf16 v[156:159], a[232:235], v[84:87], v[156:159]
ds_read_b64_tr_b16 a[144:145], v228 offset:49152
ds_read_b64_tr_b16 a[146:147], v228 offset:51200
v_mfma_f32_16x16x32_bf16 v[156:159], a[236:239], v[92:95], v[156:159]
ds_read_b64_tr_b16 a[148:149], v228 offset:53248
ds_read_b64_tr_b16 a[150:151], v228 offset:55296
v_mfma_f32_16x16x32_bf16 v[156:159], a[240:243], v[100:103], v[156:159]
ds_read_b64_tr_b16 a[152:153], v228 offset:57344
ds_read_b64_tr_b16 a[154:155], v228 offset:59392
v_mfma_f32_16x16x32_bf16 v[156:159], a[244:247], v[108:111], v[156:159]
ds_read_b64_tr_b16 a[156:157], v228 offset:61440
ds_read_b64_tr_b16 a[158:159], v228 offset:63488
v_mul_f32 v144, v236, v144
v_mfma_f32_16x16x32_bf16 v[156:159], a[248:251], v[116:119], v[156:159]
s_mov_b32 s29, 6912
v_mul_f32 v145, v236, v145
v_mfma_f32_16x16x32_bf16 v[156:159], a[252:255], v[124:127], v[156:159]
buffer_load_dwordx4 v232, s[16:19], s29 offen offset:1024 lds
v_mul_f32 v146, v236, v146
v_bfe_u32 v35, v0, 5, 1
s_waitcnt lgkmcnt(6)
v_mfma_f32_16x16x32_bf16 v[160:163], a[128:131], v[64:67], 0
v_mul_f32 v147, v236, v147
v_mul_f32 v152, v236, v152
v_mfma_f32_16x16x32_bf16 v[160:163], a[132:135], v[72:75], v[160:163]
v_mul_f32 v153, v236, v153
v_mul_f32 v154, v236, v154
v_mul_f32 v155, v236, v155
v_mfma_f32_16x16x32_bf16 v[160:163], a[136:139], v[80:83], v[160:163]
ds_read_b64_tr_b16 a[160:161], v229 offset:32768
v_cvt_pk_bf16_f32 v200, v144, v145
v_mfma_f32_16x16x32_bf16 v[160:163], a[140:143], v[88:91], v[160:163]
ds_read_b64_tr_b16 a[162:163], v229 offset:34816
v_cvt_pk_bf16_f32 v201, v146, v147
v_mfma_f32_16x16x32_bf16 v[160:163], a[144:147], v[96:99], v[160:163]
ds_read_b64_tr_b16 a[164:165], v229 offset:36864
s_mov_b32 s29, 13056
s_waitcnt lgkmcnt(3)
v_mfma_f32_16x16x32_bf16 v[160:163], a[148:151], v[104:107], v[160:163]
ds_read_b64_tr_b16 a[166:167], v229 offset:38912
buffer_load_dwordx4 v232, s[16:19], s29 offen offset:2048 lds
v_lshl_add_u32 v22, v32, 6, v22
v_mfma_f32_16x16x32_bf16 v[160:163], a[152:155], v[112:115], v[160:163]
ds_read_b64_tr_b16 a[168:169], v229 offset:40960
v_or_b32 v200, 1, v200
v_cvt_pk_bf16_f32 v202, v152, v153
v_mfma_f32_16x16x32_bf16 v[160:163], a[156:159], v[120:123], v[160:163]
ds_read_b64_tr_b16 a[170:171], v229 offset:43008
v_cvt_pk_bf16_f32 v203, v154, v155
v_mfma_f32_16x16x32_bf16 v[164:167], a[128:131], v[68:71], 0
ds_read_b64_tr_b16 a[172:173], v229 offset:45056
buffer_store_dwordx4 v[200:203], v233, s[20:23], s33 offen offset:1024 sc1
v_mfma_f32_16x16x32_bf16 v[164:167], a[132:135], v[76:79], v[164:167]
ds_read_b64_tr_b16 a[174:175], v229 offset:47104
v_mul_f32 v148, v237, v148
v_mov_b32 v5, 2
v_mfma_f32_16x16x32_bf16 v[164:167], a[136:139], v[84:87], v[164:167]
ds_read_b64_tr_b16 a[176:177], v229 offset:49152
ds_read_b64_tr_b16 a[178:179], v229 offset:51200
s_mov_b32 s29, 19200
v_mfma_f32_16x16x32_bf16 v[164:167], a[140:143], v[92:95], v[164:167]
ds_read_b64_tr_b16 a[180:181], v229 offset:53248
ds_read_b64_tr_b16 a[182:183], v229 offset:55296
buffer_load_dwordx4 v232, s[16:19], s29 offen offset:3072 lds
s_waitcnt vmcnt(10)
buffer_store_dword v5, v63, s[20:23], s63 offen sc1
v_mfma_f32_16x16x32_bf16 v[164:167], a[144:147], v[100:103], v[164:167]
ds_read_b64_tr_b16 a[184:185], v229 offset:57344
ds_read_b64_tr_b16 a[186:187], v229 offset:59392
v_mul_f32 v149, v237, v149
v_mfma_f32_16x16x32_bf16 v[164:167], a[148:151], v[108:111], v[164:167]
ds_read_b64_tr_b16 a[188:189], v229 offset:61440
ds_read_b64_tr_b16 a[190:191], v229 offset:63488
v_mfma_f32_16x16x32_bf16 v[164:167], a[152:155], v[116:119], v[164:167]
v_mul_f32 v150, v237, v150
v_mul_f32 v151, v237, v151
v_mul_f32 v156, v237, v156
v_mfma_f32_16x16x32_bf16 v[164:167], a[156:159], v[124:127], v[164:167]
s_add_u32 m0, s24, 69632
v_mul_f32 v157, v237, v157
s_waitcnt lgkmcnt(6)
v_mfma_f32_16x16x32_bf16 v[168:171], a[160:163], v[64:67], 0
s_mov_b32 s29, 29440
v_mul_f32 v158, v237, v158
v_mul_f32 v159, v237, v159
v_mfma_f32_16x16x32_bf16 v[168:171], a[164:167], v[72:75], v[168:171]
ds_read_b64_tr_b16 a[192:193], v230 offset:32768
buffer_load_dwordx4 v232, s[16:19], s29 offen lds
v_lshl_add_u32 v22, v35, 8, v22
v_mfma_f32_16x16x32_bf16 v[168:171], a[168:171], v[80:83], v[168:171]
ds_read_b64_tr_b16 a[194:195], v230 offset:34816
v_cvt_pk_bf16_f32 v204, v148, v149
v_mfma_f32_16x16x32_bf16 v[168:171], a[172:175], v[88:91], v[168:171]
ds_read_b64_tr_b16 a[196:197], v230 offset:36864
v_cvt_pk_bf16_f32 v205, v150, v151
v_or_b32 v204, 1, v204
v_mfma_f32_16x16x32_bf16 v[168:171], a[176:179], v[96:99], v[168:171]
ds_read_b64_tr_b16 a[198:199], v230 offset:38912
v_cvt_pk_bf16_f32 v206, v156, v157
s_waitcnt lgkmcnt(4)
v_mfma_f32_16x16x32_bf16 v[168:171], a[180:183], v[104:107], v[168:171]
ds_read_b64_tr_b16 a[200:201], v230 offset:40960
v_cvt_pk_bf16_f32 v207, v158, v159
buffer_store_dwordx4 v[204:207], v234, s[20:23], s33 offen offset:1024 sc1
v_mfma_f32_16x16x32_bf16 v[168:171], a[184:187], v[112:115], v[168:171]
ds_read_b64_tr_b16 a[202:203], v230 offset:43008
s_mov_b32 s29, 35584
v_mfma_f32_16x16x32_bf16 v[168:171], a[188:191], v[120:123], v[168:171]
ds_read_b64_tr_b16 a[204:205], v230 offset:45056
ds_read_b64_tr_b16 a[206:207], v230 offset:47104
buffer_load_dwordx4 v232, s[16:19], s29 offen offset:1024 lds
v_mfma_f32_16x16x32_bf16 v[172:175], a[160:163], v[68:71], 0
ds_read_b64_tr_b16 a[208:209], v230 offset:49152
v_mul_u32_u24 v20, 1792, v34
v_mfma_f32_16x16x32_bf16 v[172:175], a[164:167], v[76:79], v[172:175]
ds_read_b64_tr_b16 a[210:211], v230 offset:51200
v_add_u32 v20, v20, v22
v_lshrrev_b32 v20, 1, v20
v_mfma_f32_16x16x32_bf16 v[172:175], a[168:171], v[84:87], v[172:175]
ds_read_b64_tr_b16 a[212:213], v230 offset:53248
v_lshl_add_u32 v53, v35, 30, v22
v_mfma_f32_16x16x32_bf16 v[172:175], a[172:175], v[92:95], v[172:175]
ds_read_b64_tr_b16 a[214:215], v230 offset:55296
s_add_u32 s33, s32, 12582912
v_mfma_f32_16x16x32_bf16 v[172:175], a[176:179], v[100:103], v[172:175]
ds_read_b64_tr_b16 a[216:217], v230 offset:57344
ds_read_b64_tr_b16 a[218:219], v230 offset:59392
s_mov_b32 s29, 41728
v_mfma_f32_16x16x32_bf16 v[172:175], a[180:183], v[108:111], v[172:175]
ds_read_b64_tr_b16 a[220:221], v230 offset:61440
ds_read_b64_tr_b16 a[222:223], v230 offset:63488
buffer_load_dwordx4 v232, s[16:19], s29 offen offset:2048 lds
v_mfma_f32_16x16x32_bf16 v[172:175], a[184:187], v[116:119], v[172:175]
v_mul_f32 v160, v236, v160
v_mul_f32 v161, v236, v161
v_mfma_f32_16x16x32_bf16 v[172:175], a[188:191], v[124:127], v[172:175]
v_mul_f32 v162, v236, v162
v_mul_f32 v163, v236, v163
v_mul_f32 v168, v236, v168
s_waitcnt lgkmcnt(5)
v_mfma_f32_16x16x32_bf16 v[176:179], a[192:195], v[64:67], 0
ds_read_b64_tr_b16 a[224:225], v231 offset:32768
v_mul_f32 v169, v236, v169
v_mfma_f32_16x16x32_bf16 v[176:179], a[196:199], v[72:75], v[176:179]
ds_read_b64_tr_b16 a[226:227], v231 offset:34816
v_mul_f32 v170, v236, v170
v_lshl_add_u32 v54, v35, 30, v20
v_mfma_f32_16x16x32_bf16 v[176:179], a[200:203], v[80:83], v[176:179]
ds_read_b64_tr_b16 a[228:229], v231 offset:36864
s_mov_b32 s29, 47872
v_mfma_f32_16x16x32_bf16 v[176:179], a[204:207], v[88:91], v[176:179]
ds_read_b64_tr_b16 a[230:231], v231 offset:38912
ds_read_b64_tr_b16 a[232:233], v231 offset:40960
buffer_load_dwordx4 v232, s[16:19], s29 offen offset:3072 lds
v_mfma_f32_16x16x32_bf16 v[176:179], a[208:211], v[96:99], v[176:179]
ds_read_b64_tr_b16 a[234:235], v231 offset:43008
v_mul_f32 v171, v236, v171
s_waitcnt lgkmcnt(6)
v_mfma_f32_16x16x32_bf16 v[176:179], a[212:215], v[104:107], v[176:179]
ds_read_b64_tr_b16 a[236:237], v231 offset:45056
v_cvt_pk_bf16_f32 v208, v160, v161
v_mfma_f32_16x16x32_bf16 v[176:179], a[216:219], v[112:115], v[176:179]
ds_read_b64_tr_b16 a[238:239], v231 offset:47104
v_cvt_pk_bf16_f32 v209, v162, v163
v_cvt_pk_bf16_f32 v210, v168, v169
v_mfma_f32_16x16x32_bf16 v[176:179], a[220:223], v[120:123], v[176:179]
ds_read_b64_tr_b16 a[240:241], v231 offset:49152
v_cvt_pk_bf16_f32 v211, v170, v171
v_mfma_f32_16x16x32_bf16 v[180:183], a[192:195], v[68:71], 0
ds_read_b64_tr_b16 a[242:243], v231 offset:51200
buffer_store_dwordx4 v[208:211], v233, s[20:23], s33 offen sc1
s_mov_b32 s60, 4096
v_mfma_f32_16x16x32_bf16 v[180:183], a[196:199], v[76:79], v[180:183]
ds_read_b64_tr_b16 a[244:245], v231 offset:53248
v_mul_f32 v164, v237, v164
v_mfma_f32_16x16x32_bf16 v[180:183], a[200:203], v[84:87], v[180:183]
ds_read_b64_tr_b16 a[246:247], v231 offset:55296
v_bfe_u32 v33, v0, 2, 2
v_mfma_f32_16x16x32_bf16 v[180:183], a[204:207], v[92:95], v[180:183]
ds_read_b64_tr_b16 a[248:249], v231 offset:57344
v_mul_f32 v165, v237, v165
v_mfma_f32_16x16x32_bf16 v[180:183], a[208:211], v[100:103], v[180:183]
ds_read_b64_tr_b16 a[250:251], v231 offset:59392
v_and_b32 v34, 3, v0
v_mfma_f32_16x16x32_bf16 v[180:183], a[212:215], v[108:111], v[180:183]
ds_read_b64_tr_b16 a[252:253], v231 offset:61440
ds_read_b64_tr_b16 a[254:255], v231 offset:63488
v_lshl_add_u32 v33, v35, 2, v33
v_mfma_f32_16x16x32_bf16 v[180:183], a[216:219], v[116:119], v[180:183]
v_mul_f32 v166, v237, v166
v_mul_f32 v167, v237, v167
v_mfma_f32_16x16x32_bf16 v[180:183], a[220:223], v[124:127], v[180:183]
v_mul_f32 v172, v237, v172
v_mul_f32 v173, v237, v173
s_waitcnt lgkmcnt(4)
v_mfma_f32_16x16x32_bf16 v[184:187], a[224:227], v[64:67], 0
v_mul_f32 v174, v237, v174
v_lshlrev_b32 v34, 3, v34
v_mfma_f32_16x16x32_bf16 v[184:187], a[228:231], v[72:75], v[184:187]
v_mul_f32 v175, v237, v175
v_cvt_pk_bf16_f32 v212, v164, v165
v_mfma_f32_16x16x32_bf16 v[184:187], a[232:235], v[80:83], v[184:187]
v_cvt_pk_bf16_f32 v213, v166, v167
v_mul_u32_u24 v9, 224, v33
v_mfma_f32_16x16x32_bf16 v[184:187], a[236:239], v[88:91], v[184:187]
v_cvt_pk_bf16_f32 v214, v172, v173
v_cvt_pk_bf16_f32 v215, v174, v175
v_mul_u32_u24 v35, 14464, v32
v_mfma_f32_16x16x32_bf16 v[184:187], a[240:243], v[96:99], v[184:187]
s_waitcnt lgkmcnt(0)
s_barrier
ds_read_b64_tr_b16 a[128:129], v224 offset:32768
ds_read_b64_tr_b16 a[130:131], v224 offset:34816
v_mfma_f32_16x16x32_bf16 v[184:187], a[244:247], v[104:107], v[184:187]
ds_read_b64_tr_b16 a[132:133], v224 offset:36864
v_add3_u32 v9, v9, v35, v34
v_mfma_f32_16x16x32_bf16 v[184:187], a[248:251], v[112:115], v[184:187]
ds_read_b64_tr_b16 a[134:135], v224 offset:38912
buffer_store_dwordx4 v[212:215], v234, s[20:23], s33 offen sc1
v_mfma_f32_16x16x32_bf16 v[184:187], a[252:255], v[120:123], v[184:187]
ds_read_b64_tr_b16 a[136:137], v224 offset:40960
s_mov_b32 s29, 229376
v_mfma_f32_16x16x32_bf16 v[188:191], a[224:227], v[68:71], 0
ds_read_b64_tr_b16 a[138:139], v224 offset:43008
s_add_u32 m0, s34, 98304
v_mfma_f32_16x16x32_bf16 v[188:191], a[228:231], v[76:79], v[188:191]
ds_read_b64_tr_b16 a[140:141], v224 offset:45056
ds_read_b64_tr_b16 a[142:143], v224 offset:47104
buffer_load_dwordx4 v56, s[44:47], s29 offen lds
v_mfma_f32_16x16x32_bf16 v[188:191], a[232:235], v[84:87], v[188:191]
ds_read_b64_tr_b16 a[144:145], v224 offset:49152
ds_read_b64_tr_b16 a[146:147], v224 offset:51200
v_add_u32 v11, 0x20000, v9
v_mfma_f32_16x16x32_bf16 v[188:191], a[236:239], v[92:95], v[188:191]
ds_read_b64_tr_b16 a[148:149], v224 offset:53248
ds_read_b64_tr_b16 a[150:151], v224 offset:55296
v_mfma_f32_16x16x32_bf16 v[188:191], a[240:243], v[100:103], v[188:191]
ds_read_b64_tr_b16 a[152:153], v224 offset:57344
ds_read_b64_tr_b16 a[154:155], v224 offset:59392
v_mul_f32 v176, v236, v176
v_mfma_f32_16x16x32_bf16 v[188:191], a[244:247], v[108:111], v[188:191]
ds_read_b64_tr_b16 a[156:157], v224 offset:61440
ds_read_b64_tr_b16 a[158:159], v224 offset:63488
v_mfma_f32_16x16x32_bf16 v[188:191], a[248:251], v[116:119], v[188:191]
v_mul_f32 v177, v236, v177
v_mul_f32 v178, v236, v178
v_mul_f32 v179, v236, v179
v_mfma_f32_16x16x32_bf16 v[188:191], a[252:255], v[124:127], v[188:191]
v_mul_f32 v184, v236, v184
v_mul_f32 v185, v236, v185
s_waitcnt lgkmcnt(6)
v_mfma_f32_16x16x32_bf16 v[128:131], a[128:131], v[64:67], 0
ds_read_b64_tr_b16 a[0:1], v11 offset:0
v_mul_f32 v186, v236, v186
v_mfma_f32_16x16x32_bf16 v[128:131], a[132:135], v[72:75], v[128:131]
buffer_load_dwordx4 v57, s[44:47], s29 offen offset:1024 lds
ds_read_b64_tr_b16 a[2:3], v11 offset:3584
v_mul_f32 v187, v236, v187
v_mfma_f32_16x16x32_bf16 v[128:131], a[136:139], v[80:83], v[128:131]
ds_read_b64_tr_b16 a[160:161], v225 offset:32768
buffer_load_dwordx2 v[40:41], v20, s[36:39], s28 offen
v_mfma_f32_16x16x32_bf16 v[128:131], a[140:143], v[88:91], v[128:131]
ds_read_b64_tr_b16 a[162:163], v225 offset:34816
ds_read_b64_tr_b16 a[4:5], v11 offset:32
v_mfma_f32_16x16x32_bf16 v[128:131], a[144:147], v[96:99], v[128:131]
ds_read_b64_tr_b16 a[164:165], v225 offset:36864
v_cvt_pk_bf16_f32 v216, v176, v177
v_cvt_pk_bf16_f32 v217, v178, v179
s_waitcnt lgkmcnt(6)
v_mfma_f32_16x16x32_bf16 v[128:131], a[148:151], v[104:107], v[128:131]
ds_read_b64_tr_b16 a[166:167], v225 offset:38912
ds_read_b64_tr_b16 a[6:7], v11 offset:3616
v_mfma_f32_16x16x32_bf16 v[128:131], a[152:155], v[112:115], v[128:131]
ds_read_b64_tr_b16 a[168:169], v225 offset:40960
v_cvt_pk_bf16_f32 v218, v184, v185
v_cvt_pk_bf16_f32 v219, v186, v187
v_mfma_f32_16x16x32_bf16 v[128:131], a[156:159], v[120:123], v[128:131]
ds_read_b64_tr_b16 a[170:171], v225 offset:43008
ds_read_b64_tr_b16 a[8:9], v11 offset:64
buffer_load_dwordx4 a[112:115], v22, s[20:23], s60 offen sc1
v_mfma_f32_16x16x32_bf16 v[132:135], a[128:131], v[68:71], 0
ds_read_b64_tr_b16 a[172:173], v225 offset:45056
buffer_store_dwordx4 v[216:219], v233, s[20:23], s33 offen offset:1024 sc1
v_mfma_f32_16x16x32_bf16 v[132:135], a[132:135], v[76:79], v[132:135]
ds_read_b64_tr_b16 a[174:175], v225 offset:47104
buffer_load_dwordx4 v58, s[44:47], s29 offen offset:2048 lds
v_mul_f32 v180, v237, v180
v_mfma_f32_16x16x32_bf16 v[132:135], a[136:139], v[84:87], v[132:135]
ds_read_b64_tr_b16 a[176:177], v225 offset:49152
ds_read_b64_tr_b16 a[178:179], v225 offset:51200
v_mfma_f32_16x16x32_bf16 v[132:135], a[140:143], v[92:95], v[132:135]
ds_read_b64_tr_b16 a[180:181], v225 offset:53248
ds_read_b64_tr_b16 a[182:183], v225 offset:55296
v_mul_f32 v181, v237, v181
v_mfma_f32_16x16x32_bf16 v[132:135], a[144:147], v[100:103], v[132:135]
ds_read_b64_tr_b16 a[184:185], v225 offset:57344
ds_read_b64_tr_b16 a[186:187], v225 offset:59392
buffer_load_dwordx2 v[42:43], v20, s[36:39], s28 offen offset:256
v_mfma_f32_16x16x32_bf16 v[132:135], a[148:151], v[108:111], v[132:135]
ds_read_b64_tr_b16 a[188:189], v225 offset:61440
ds_read_b64_tr_b16 a[190:191], v225 offset:63488
v_mul_f32 v182, v237, v182
v_mfma_f32_16x16x32_bf16 v[132:135], a[152:155], v[116:119], v[132:135]
ds_read_b64_tr_b16 a[10:11], v11 offset:3648
v_mul_f32 v183, v237, v183
v_mfma_f32_16x16x32_bf16 v[132:135], a[156:159], v[124:127], v[132:135]
v_mul_f32 v188, v237, v188
v_mul_f32 v189, v237, v189
v_mul_f32 v190, v237, v190
s_waitcnt lgkmcnt(7)
v_mfma_f32_16x16x32_bf16 v[136:139], a[160:163], v[64:67], 0
ds_read_b64_tr_b16 a[12:13], v11 offset:96
v_mul_f32 v191, v237, v191
v_mfma_f32_16x16x32_bf16 v[136:139], a[164:167], v[72:75], v[136:139]
ds_read_b64_tr_b16 a[192:193], v226 offset:32768
buffer_load_dwordx4 v59, s[44:47], s29 offen offset:3072 lds
buffer_load_dwordx4 a[116:119], v22, s[20:23], s60 offen offset:512 sc1
v_mfma_f32_16x16x32_bf16 v[136:139], a[168:171], v[80:83], v[136:139]
ds_read_b64_tr_b16 a[194:195], v226 offset:34816
v_cvt_pk_bf16_f32 v220, v180, v181
v_cvt_pk_bf16_f32 v221, v182, v183
v_mfma_f32_16x16x32_bf16 v[136:139], a[172:175], v[88:91], v[136:139]
ds_read_b64_tr_b16 a[196:197], v226 offset:36864
ds_read_b64_tr_b16 a[14:15], v11 offset:3680
v_cvt_pk_bf16_f32 v222, v188, v189
v_mfma_f32_16x16x32_bf16 v[136:139], a[176:179], v[96:99], v[136:139]
ds_read_b64_tr_b16 a[198:199], v226 offset:38912
v_cvt_pk_bf16_f32 v223, v190, v191
s_waitcnt lgkmcnt(6)
v_mfma_f32_16x16x32_bf16 v[136:139], a[180:183], v[104:107], v[136:139]
ds_read_b64_tr_b16 a[200:201], v226 offset:40960
ds_read_b64_tr_b16 a[16:17], v11 offset:128
buffer_store_dwordx4 v[220:223], v234, s[20:23], s33 offen offset:1024 sc1
v_mfma_f32_16x16x32_bf16 v[136:139], a[184:187], v[112:115], v[136:139]
ds_read_b64_tr_b16 a[202:203], v226 offset:43008
ds_read_b64_tr_b16 a[18:19], v11 offset:3712
buffer_load_dwordx2 v[44:45], v20, s[36:39], s28 offen offset:512
v_mfma_f32_16x16x32_bf16 v[136:139], a[188:191], v[120:123], v[136:139]
ds_read_b64_tr_b16 a[204:205], v226 offset:45056
ds_read_b64_tr_b16 a[206:207], v226 offset:47104
v_mfma_f32_16x16x32_bf16 v[140:143], a[160:163], v[68:71], 0
ds_read_b64_tr_b16 a[208:209], v226 offset:49152
s_add_u32 m0, s34, 102400
v_mfma_f32_16x16x32_bf16 v[140:143], a[164:167], v[76:79], v[140:143]
ds_read_b64_tr_b16 a[210:211], v226 offset:51200
buffer_load_dwordx4 v60, s[44:47], s29 offen lds
v_mfma_f32_16x16x32_bf16 v[140:143], a[168:171], v[84:87], v[140:143]
ds_read_b64_tr_b16 a[212:213], v226 offset:53248
v_mfma_f32_16x16x32_bf16 v[140:143], a[172:175], v[92:95], v[140:143]
ds_read_b64_tr_b16 a[214:215], v226 offset:55296
ds_read_b64_tr_b16 a[20:21], v11 offset:160
buffer_load_dwordx4 a[120:123], v22, s[20:23], s60 offen offset:1024 sc1
v_mfma_f32_16x16x32_bf16 v[140:143], a[176:179], v[100:103], v[140:143]
ds_read_b64_tr_b16 a[216:217], v226 offset:57344
ds_read_b64_tr_b16 a[218:219], v226 offset:59392
s_add_u32 s33, s32, 16777216
v_mfma_f32_16x16x32_bf16 v[140:143], a[180:183], v[108:111], v[140:143]
ds_read_b64_tr_b16 a[220:221], v226 offset:61440
ds_read_b64_tr_b16 a[222:223], v226 offset:63488
v_mfma_f32_16x16x32_bf16 v[140:143], a[184:187], v[116:119], v[140:143]
v_mul_f32 v128, v236, v128
v_mul_f32 v129, v236, v129
v_mul_f32 v130, v236, v130
v_mfma_f32_16x16x32_bf16 v[140:143], a[188:191], v[124:127], v[140:143]
ds_read_b64_tr_b16 a[22:23], v11 offset:3744
v_mul_f32 v131, v236, v131
v_mul_f32 v136, v236, v136
s_waitcnt lgkmcnt(7)
v_mfma_f32_16x16x32_bf16 v[144:147], a[192:195], v[64:67], 0
ds_read_b64_tr_b16 a[224:225], v227 offset:32768
buffer_load_dwordx2 v[46:47], v54, s[36:39], s28 offen offset:768
v_mfma_f32_16x16x32_bf16 v[144:147], a[196:199], v[72:75], v[144:147]
ds_read_b64_tr_b16 a[226:227], v227 offset:34816
buffer_load_dwordx4 v61, s[44:47], s29 offen offset:1024 lds
v_mul_f32 v137, v236, v137
v_mfma_f32_16x16x32_bf16 v[144:147], a[200:203], v[80:83], v[144:147]
ds_read_b64_tr_b16 a[228:229], v227 offset:36864
ds_read_b64_tr_b16 a[24:25], v11 offset:192
v_mul_f32 v138, v236, v138
v_mfma_f32_16x16x32_bf16 v[144:147], a[204:207], v[88:91], v[144:147]
ds_read_b64_tr_b16 a[230:231], v227 offset:38912
ds_read_b64_tr_b16 a[232:233], v227 offset:40960
v_mfma_f32_16x16x32_bf16 v[144:147], a[208:211], v[96:99], v[144:147]
ds_read_b64_tr_b16 a[234:235], v227 offset:43008
v_mul_f32 v139, v236, v139
v_cvt_pk_bf16_f32 v192, v128, v129
s_waitcnt lgkmcnt(7)
v_mfma_f32_16x16x32_bf16 v[144:147], a[212:215], v[104:107], v[144:147]
ds_read_b64_tr_b16 a[236:237], v227 offset:45056
ds_read_b64_tr_b16 a[26:27], v11 offset:3776
buffer_load_dwordx4 a[124:127], v53, s[20:23], s60 offen offset:1536 sc1
v_mfma_f32_16x16x32_bf16 v[144:147], a[216:219], v[112:115], v[144:147]
ds_read_b64_tr_b16 a[238:239], v227 offset:47104
v_cvt_pk_bf16_f32 v193, v130, v131
v_cvt_pk_bf16_f32 v194, v136, v137
v_mfma_f32_16x16x32_bf16 v[144:147], a[220:223], v[120:123], v[144:147]
ds_read_b64_tr_b16 a[240:241], v227 offset:49152
ds_read_b64_tr_b16 a[28:29], v11 offset:1792
v_mfma_f32_16x16x32_bf16 v[148:151], a[192:195], v[68:71], 0
ds_read_b64_tr_b16 a[242:243], v227 offset:51200
v_cvt_pk_bf16_f32 v195, v138, v139
buffer_store_dwordx4 v[192:195], v233, s[20:23], s33 offen sc1
v_mfma_f32_16x16x32_bf16 v[148:151], a[196:199], v[76:79], v[148:151]
ds_read_b64_tr_b16 a[244:245], v227 offset:53248
buffer_load_dwordx4 v62, s[44:47], s29 offen offset:2048 lds
v_mfma_f32_16x16x32_bf16 v[148:151], a[200:203], v[84:87], v[148:151]
ds_read_b64_tr_b16 a[246:247], v227 offset:55296
ds_read_b64_tr_b16 a[30:31], v11 offset:5376
v_mfma_f32_16x16x32_bf16 v[148:151], a[204:207], v[92:95], v[148:151]
ds_read_b64_tr_b16 a[248:249], v227 offset:57344
v_mul_f32 v132, v237, v132
v_mfma_f32_16x16x32_bf16 v[148:151], a[208:211], v[100:103], v[148:151]
ds_read_b64_tr_b16 a[250:251], v227 offset:59392
v_mul_f32 v133, v237, v133
v_mfma_f32_16x16x32_bf16 v[148:151], a[212:215], v[108:111], v[148:151]
ds_read_b64_tr_b16 a[252:253], v227 offset:61440
ds_read_b64_tr_b16 a[254:255], v227 offset:63488
v_mfma_f32_16x16x32_bf16 v[148:151], a[216:219], v[116:119], v[148:151]
v_mul_f32 v134, v237, v134
v_mfma_f32_16x16x32_bf16 v[148:151], a[220:223], v[124:127], v[148:151]
v_mul_f32 v135, v237, v135
v_mul_f32 v140, v237, v140
s_waitcnt lgkmcnt(4)
v_mfma_f32_16x16x32_bf16 v[152:155], a[224:227], v[64:67], 0
v_mul_f32 v141, v237, v141
v_mul_f32 v142, v237, v142
v_mfma_f32_16x16x32_bf16 v[152:155], a[228:231], v[72:75], v[152:155]
v_mul_f32 v143, v237, v143
v_cvt_pk_bf16_f32 v196, v132, v133
v_mfma_f32_16x16x32_bf16 v[152:155], a[232:235], v[80:83], v[152:155]
v_cvt_pk_bf16_f32 v197, v134, v135
v_mfma_f32_16x16x32_bf16 v[152:155], a[236:239], v[88:91], v[152:155]
v_cvt_pk_bf16_f32 v198, v140, v141
v_cvt_pk_bf16_f32 v199, v142, v143
v_mfma_f32_16x16x32_bf16 v[152:155], a[240:243], v[96:99], v[152:155]
s_waitcnt vmcnt(33) lgkmcnt(0)
s_barrier
ds_read_b64_tr_b16 a[128:129], v224 offset:0
ds_read_b64_tr_b16 a[130:131], v224 offset:2048
v_mfma_f32_16x16x32_bf16 v[152:155], a[244:247], v[104:107], v[152:155]
ds_read_b64_tr_b16 a[132:133], v224 offset:4096
buffer_store_dwordx4 v[196:199], v234, s[20:23], s33 offen sc1
v_mfma_f32_16x16x32_bf16 v[152:155], a[248:251], v[112:115], v[152:155]
ds_read_b64_tr_b16 a[134:135], v224 offset:6144
ds_read_b64_tr_b16 a[32:33], v11 offset:1824
v_mfma_f32_16x16x32_bf16 v[152:155], a[252:255], v[120:123], v[152:155]
ds_read_b64_tr_b16 a[136:137], v224 offset:8192
s_mov_b32 s29, 458752
v_mfma_f32_16x16x32_bf16 v[156:159], a[224:227], v[68:71], 0
ds_read_b64_tr_b16 a[138:139], v224 offset:10240
s_add_u32 m0, s34, 32768
v_mfma_f32_16x16x32_bf16 v[156:159], a[228:231], v[76:79], v[156:159]
ds_read_b64_tr_b16 a[140:141], v224 offset:12288
ds_read_b64_tr_b16 a[142:143], v224 offset:14336
buffer_load_dwordx4 v56, s[44:47], s29 offen lds
v_mfma_f32_16x16x32_bf16 v[156:159], a[232:235], v[84:87], v[156:159]
ds_read_b64_tr_b16 a[144:145], v224 offset:16384
ds_read_b64_tr_b16 a[146:147], v224 offset:18432
v_mfma_f32_16x16x32_bf16 v[156:159], a[236:239], v[92:95], v[156:159]
ds_read_b64_tr_b16 a[148:149], v224 offset:20480
ds_read_b64_tr_b16 a[150:151], v224 offset:22528
v_mfma_f32_16x16x32_bf16 v[156:159], a[240:243], v[100:103], v[156:159]
ds_read_b64_tr_b16 a[152:153], v224 offset:24576
ds_read_b64_tr_b16 a[154:155], v224 offset:26624
v_mul_f32 v144, v236, v144
v_mfma_f32_16x16x32_bf16 v[156:159], a[244:247], v[108:111], v[156:159]
ds_read_b64_tr_b16 a[156:157], v224 offset:28672
ds_read_b64_tr_b16 a[158:159], v224 offset:30720
v_mfma_f32_16x16x32_bf16 v[156:159], a[248:251], v[116:119], v[156:159]
ds_read_b64_tr_b16 a[34:35], v11 offset:5408
v_mul_f32 v145, v236, v145
v_mfma_f32_16x16x32_bf16 v[156:159], a[252:255], v[124:127], v[156:159]
v_mul_f32 v146, v236, v146
v_mul_f32 v147, v236, v147
v_mul_f32 v152, v236, v152
s_waitcnt lgkmcnt(7)
v_mfma_f32_16x16x32_bf16 v[160:163], a[128:131], v[64:67], 0
ds_read_b64_tr_b16 a[36:37], v11 offset:1856
v_mul_f32 v153, v236, v153
v_mfma_f32_16x16x32_bf16 v[160:163], a[132:135], v[72:75], v[160:163]
buffer_load_dwordx4 v57, s[44:47], s29 offen offset:1024 lds
v_mul_f32 v154, v236, v154
v_mul_f32 v155, v236, v155
v_mfma_f32_16x16x32_bf16 v[160:163], a[136:139], v[80:83], v[160:163]
ds_read_b64_tr_b16 a[160:161], v225 offset:0
ds_read_b64_tr_b16 a[38:39], v11 offset:5440
v_mfma_f32_16x16x32_bf16 v[160:163], a[140:143], v[88:91], v[160:163]
ds_read_b64_tr_b16 a[162:163], v225 offset:2048
v_cvt_pk_bf16_f32 v200, v144, v145
v_mfma_f32_16x16x32_bf16 v[160:163], a[144:147], v[96:99], v[160:163]
ds_read_b64_tr_b16 a[164:165], v225 offset:4096
ds_read_b64_tr_b16 a[40:41], v11 offset:1888
v_cvt_pk_bf16_f32 v201, v146, v147
s_waitcnt lgkmcnt(6)
v_mfma_f32_16x16x32_bf16 v[160:163], a[148:151], v[104:107], v[160:163]
ds_read_b64_tr_b16 a[166:167], v225 offset:6144
v_cvt_pk_bf16_f32 v202, v152, v153
v_mfma_f32_16x16x32_bf16 v[160:163], a[152:155], v[112:115], v[160:163]
ds_read_b64_tr_b16 a[168:169], v225 offset:8192
ds_read_b64_tr_b16 a[42:43], v11 offset:5472
v_mfma_f32_16x16x32_bf16 v[160:163], a[156:159], v[120:123], v[160:163]
ds_read_b64_tr_b16 a[170:171], v225 offset:10240
v_cvt_pk_bf16_f32 v203, v154, v155
buffer_store_dwordx4 v[200:203], v233, s[20:23], s33 offen offset:1024 sc1
v_mfma_f32_16x16x32_bf16 v[164:167], a[128:131], v[68:71], 0
ds_read_b64_tr_b16 a[172:173], v225 offset:12288
ds_read_b64_tr_b16 a[44:45], v11 offset:1920
v_mfma_f32_16x16x32_bf16 v[164:167], a[132:135], v[76:79], v[164:167]
ds_read_b64_tr_b16 a[174:175], v225 offset:14336
buffer_load_dwordx4 v58, s[44:47], s29 offen offset:2048 lds
v_mov_b32 v5, 4
v_mfma_f32_16x16x32_bf16 v[164:167], a[136:139], v[84:87], v[164:167]
ds_read_b64_tr_b16 a[176:177], v225 offset:16384
ds_read_b64_tr_b16 a[178:179], v225 offset:18432
v_mul_f32 v148, v237, v148
v_mfma_f32_16x16x32_bf16 v[164:167], a[140:143], v[92:95], v[164:167]
ds_read_b64_tr_b16 a[180:181], v225 offset:20480
ds_read_b64_tr_b16 a[182:183], v225 offset:22528
s_waitcnt vmcnt(13)
buffer_store_dword v5, v63, s[20:23], s63 offen sc1
v_mfma_f32_16x16x32_bf16 v[164:167], a[144:147], v[100:103], v[164:167]
ds_read_b64_tr_b16 a[184:185], v225 offset:24576
ds_read_b64_tr_b16 a[186:187], v225 offset:26624
v_mul_f32 v149, v237, v149
v_mfma_f32_16x16x32_bf16 v[164:167], a[148:151], v[108:111], v[164:167]
ds_read_b64_tr_b16 a[188:189], v225 offset:28672
ds_read_b64_tr_b16 a[190:191], v225 offset:30720
v_mfma_f32_16x16x32_bf16 v[164:167], a[152:155], v[116:119], v[164:167]
v_mul_f32 v150, v237, v150
v_mul_f32 v151, v237, v151
v_mul_f32 v156, v237, v156
v_mfma_f32_16x16x32_bf16 v[164:167], a[156:159], v[124:127], v[164:167]
ds_read_b64_tr_b16 a[46:47], v11 offset:5504
v_mul_f32 v157, v237, v157
s_waitcnt lgkmcnt(7)
v_mfma_f32_16x16x32_bf16 v[168:171], a[160:163], v[64:67], 0
v_mul_f32 v158, v237, v158
v_mul_f32 v159, v237, v159
v_mfma_f32_16x16x32_bf16 v[168:171], a[164:167], v[72:75], v[168:171]
ds_read_b64_tr_b16 a[192:193], v226 offset:0
buffer_load_dwordx4 v59, s[44:47], s29 offen offset:3072 lds
v_cvt_pk_bf16_f32 v204, v148, v149
v_mfma_f32_16x16x32_bf16 v[168:171], a[168:171], v[80:83], v[168:171]
ds_read_b64_tr_b16 a[194:195], v226 offset:2048
ds_read_b64_tr_b16 a[48:49], v11 offset:1952
v_mfma_f32_16x16x32_bf16 v[168:171], a[172:175], v[88:91], v[168:171]
ds_read_b64_tr_b16 a[196:197], v226 offset:4096
v_cvt_pk_bf16_f32 v205, v150, v151
v_cvt_pk_bf16_f32 v206, v156, v157
v_mfma_f32_16x16x32_bf16 v[168:171], a[176:179], v[96:99], v[168:171]
ds_read_b64_tr_b16 a[198:199], v226 offset:6144
ds_read_b64_tr_b16 a[50:51], v11 offset:5536
s_waitcnt lgkmcnt(6)
v_mfma_f32_16x16x32_bf16 v[168:171], a[180:183], v[104:107], v[168:171]
ds_read_b64_tr_b16 a[200:201], v226 offset:8192
ds_read_b64_tr_b16 a[52:53], v11 offset:1984
v_cvt_pk_bf16_f32 v207, v158, v159
v_mfma_f32_16x16x32_bf16 v[168:171], a[184:187], v[112:115], v[168:171]
ds_read_b64_tr_b16 a[202:203], v226 offset:10240
buffer_store_dwordx4 v[204:207], v234, s[20:23], s33 offen offset:1024 sc1
v_mfma_f32_16x16x32_bf16 v[168:171], a[188:191], v[120:123], v[168:171]
ds_read_b64_tr_b16 a[204:205], v226 offset:12288
ds_read_b64_tr_b16 a[206:207], v226 offset:14336
v_mfma_f32_16x16x32_bf16 v[172:175], a[160:163], v[68:71], 0
ds_read_b64_tr_b16 a[208:209], v226 offset:16384
s_add_u32 m0, s34, 36864
v_mfma_f32_16x16x32_bf16 v[172:175], a[164:167], v[76:79], v[172:175]
ds_read_b64_tr_b16 a[210:211], v226 offset:18432
buffer_load_dwordx4 v60, s[44:47], s29 offen lds
v_mfma_f32_16x16x32_bf16 v[172:175], a[168:171], v[84:87], v[172:175]
ds_read_b64_tr_b16 a[212:213], v226 offset:20480
ds_read_b64_tr_b16 a[54:55], v11 offset:5568
v_mfma_f32_16x16x32_bf16 v[172:175], a[172:175], v[92:95], v[172:175]
ds_read_b64_tr_b16 a[214:215], v226 offset:22528
s_add_u32 s33, s32, 20971520
v_mul_f32 v160, v236, v160
v_mfma_f32_16x16x32_bf16 v[172:175], a[176:179], v[100:103], v[172:175]
ds_read_b64_tr_b16 a[216:217], v226 offset:24576
ds_read_b64_tr_b16 a[218:219], v226 offset:26624
v_mfma_f32_16x16x32_bf16 v[172:175], a[180:183], v[108:111], v[172:175]
ds_read_b64_tr_b16 a[220:221], v226 offset:28672
ds_read_b64_tr_b16 a[222:223], v226 offset:30720
v_mul_f32 v161, v236, v161
v_mfma_f32_16x16x32_bf16 v[172:175], a[184:187], v[116:119], v[172:175]
ds_read_b64_tr_b16 a[56:57], v11 offset:7168
v_mul_f32 v162, v236, v162
v_mfma_f32_16x16x32_bf16 v[172:175], a[188:191], v[124:127], v[172:175]
v_mul_f32 v163, v236, v163
v_mul_f32 v168, v236, v168
v_mul_f32 v169, v236, v169
s_waitcnt lgkmcnt(6)
v_mfma_f32_16x16x32_bf16 v[176:179], a[192:195], v[64:67], 0
ds_read_b64_tr_b16 a[224:225], v227 offset:0
ds_read_b64_tr_b16 a[58:59], v11 offset:10752
v_mfma_f32_16x16x32_bf16 v[176:179], a[196:199], v[72:75], v[176:179]
ds_read_b64_tr_b16 a[226:227], v227 offset:2048
buffer_load_dwordx4 v61, s[44:47], s29 offen offset:1024 lds
v_mul_f32 v170, v236, v170
v_mfma_f32_16x16x32_bf16 v[176:179], a[200:203], v[80:83], v[176:179]
ds_read_b64_tr_b16 a[228:229], v227 offset:4096
v_mul_f32 v171, v236, v171
v_mfma_f32_16x16x32_bf16 v[176:179], a[204:207], v[88:91], v[176:179]
ds_read_b64_tr_b16 a[230:231], v227 offset:6144
ds_read_b64_tr_b16 a[232:233], v227 offset:8192
v_cvt_pk_bf16_f32 v208, v160, v161
v_mfma_f32_16x16x32_bf16 v[176:179], a[208:211], v[96:99], v[176:179]
ds_read_b64_tr_b16 a[234:235], v227 offset:10240
ds_read_b64_tr_b16 a[60:61], v11 offset:7200
s_waitcnt lgkmcnt(8)
v_mfma_f32_16x16x32_bf16 v[176:179], a[212:215], v[104:107], v[176:179]
ds_read_b64_tr_b16 a[236:237], v227 offset:12288
v_cvt_pk_bf16_f32 v209, v162, v163
v_cvt_pk_bf16_f32 v210, v168, v169
v_mfma_f32_16x16x32_bf16 v[176:179], a[216:219], v[112:115], v[176:179]
ds_read_b64_tr_b16 a[238:239], v227 offset:14336
ds_read_b64_tr_b16 a[62:63], v11 offset:10784
v_mfma_f32_16x16x32_bf16 v[176:179], a[220:223], v[120:123], v[176:179]
ds_read_b64_tr_b16 a[240:241], v227 offset:16384
v_cvt_pk_bf16_f32 v211, v170, v171
buffer_store_dwordx4 v[208:211], v233, s[20:23], s33 offen sc1
v_mfma_f32_16x16x32_bf16 v[180:183], a[192:195], v[68:71], 0
ds_read_b64_tr_b16 a[242:243], v227 offset:18432
ds_read_b64_tr_b16 a[64:65], v11 offset:7232
v_mfma_f32_16x16x32_bf16 v[180:183], a[196:199], v[76:79], v[180:183]
ds_read_b64_tr_b16 a[244:245], v227 offset:20480
buffer_load_dwordx4 v62, s[44:47], s29 offen offset:2048 lds
v_mfma_f32_16x16x32_bf16 v[180:183], a[200:203], v[84:87], v[180:183]
ds_read_b64_tr_b16 a[246:247], v227 offset:22528
v_mul_f32 v164, v237, v164
v_mfma_f32_16x16x32_bf16 v[180:183], a[204:207], v[92:95], v[180:183]
ds_read_b64_tr_b16 a[248:249], v227 offset:24576
v_mul_f32 v165, v237, v165
v_mfma_f32_16x16x32_bf16 v[180:183], a[208:211], v[100:103], v[180:183]
ds_read_b64_tr_b16 a[250:251], v227 offset:26624
v_mfma_f32_16x16x32_bf16 v[180:183], a[212:215], v[108:111], v[180:183]
ds_read_b64_tr_b16 a[252:253], v227 offset:28672
ds_read_b64_tr_b16 a[254:255], v227 offset:30720
v_mfma_f32_16x16x32_bf16 v[180:183], a[216:219], v[116:119], v[180:183]
v_mul_f32 v166, v237, v166
v_mul_f32 v167, v237, v167
v_mfma_f32_16x16x32_bf16 v[180:183], a[220:223], v[124:127], v[180:183]
v_mul_f32 v172, v237, v172
v_mul_f32 v173, v237, v173
s_waitcnt lgkmcnt(4)
v_mfma_f32_16x16x32_bf16 v[184:187], a[224:227], v[64:67], 0
v_mul_f32 v174, v237, v174
v_mul_f32 v175, v237, v175
v_mfma_f32_16x16x32_bf16 v[184:187], a[228:231], v[72:75], v[184:187]
v_cvt_pk_bf16_f32 v212, v164, v165
v_mfma_f32_16x16x32_bf16 v[184:187], a[232:235], v[80:83], v[184:187]
v_cvt_pk_bf16_f32 v213, v166, v167
v_cvt_pk_bf16_f32 v214, v172, v173
v_mfma_f32_16x16x32_bf16 v[184:187], a[236:239], v[88:91], v[184:187]
v_cvt_pk_bf16_f32 v215, v174, v175
buffer_store_dwordx4 v[212:215], v234, s[20:23], s33 offen sc1
v_mfma_f32_16x16x32_bf16 v[184:187], a[240:243], v[96:99], v[184:187]
s_waitcnt lgkmcnt(0)
s_barrier
ds_read_b64_tr_b16 a[128:129], v228 offset:0
ds_read_b64_tr_b16 a[130:131], v228 offset:2048
v_mfma_f32_16x16x32_bf16 v[184:187], a[244:247], v[104:107], v[184:187]
ds_read_b64_tr_b16 a[132:133], v228 offset:4096
ds_read_b64_tr_b16 a[66:67], v11 offset:10816
v_mfma_f32_16x16x32_bf16 v[184:187], a[248:251], v[112:115], v[184:187]
ds_read_b64_tr_b16 a[134:135], v228 offset:6144
ds_read_b64_tr_b16 a[136:137], v228 offset:8192
v_mfma_f32_16x16x32_bf16 v[184:187], a[252:255], v[120:123], v[184:187]
ds_read_b64_tr_b16 a[138:139], v228 offset:10240
s_mov_b32 s29, 688128
v_mfma_f32_16x16x32_bf16 v[188:191], a[224:227], v[68:71], 0
ds_read_b64_tr_b16 a[140:141], v228 offset:12288
ds_read_b64_tr_b16 a[142:143], v228 offset:14336
s_add_u32 m0, s34, 0
v_mfma_f32_16x16x32_bf16 v[188:191], a[228:231], v[76:79], v[188:191]
ds_read_b64_tr_b16 a[144:145], v228 offset:16384
buffer_load_dwordx4 v56, s[44:47], s29 offen lds
v_mfma_f32_16x16x32_bf16 v[188:191], a[232:235], v[84:87], v[188:191]
ds_read_b64_tr_b16 a[146:147], v228 offset:18432
ds_read_b64_tr_b16 a[68:69], v11 offset:7264
v_mfma_f32_16x16x32_bf16 v[188:191], a[236:239], v[92:95], v[188:191]
ds_read_b64_tr_b16 a[148:149], v228 offset:20480
ds_read_b64_tr_b16 a[150:151], v228 offset:22528
v_mul_f32 v176, v236, v176
v_mfma_f32_16x16x32_bf16 v[188:191], a[240:243], v[100:103], v[188:191]
ds_read_b64_tr_b16 a[152:153], v228 offset:24576
ds_read_b64_tr_b16 a[154:155], v228 offset:26624
v_mfma_f32_16x16x32_bf16 v[188:191], a[244:247], v[108:111], v[188:191]
ds_read_b64_tr_b16 a[156:157], v228 offset:28672
ds_read_b64_tr_b16 a[158:159], v228 offset:30720
v_mul_f32 v177, v236, v177
v_mfma_f32_16x16x32_bf16 v[188:191], a[248:251], v[116:119], v[188:191]
v_mul_f32 v178, v236, v178
v_mul_f32 v179, v236, v179
v_mul_f32 v184, v236, v184
v_mfma_f32_16x16x32_bf16 v[188:191], a[252:255], v[124:127], v[188:191]
ds_read_b64_tr_b16 a[160:161], v229 offset:0
ds_read_b64_tr_b16 a[162:163], v229 offset:2048
s_waitcnt lgkmcnt(8)
v_mfma_f32_16x16x32_bf16 v[128:131], a[128:131], v[64:67], 0
ds_read_b64_tr_b16 a[164:165], v229 offset:4096
ds_read_b64_tr_b16 a[70:71], v11 offset:10848
v_mul_f32 v185, v236, v185
v_mfma_f32_16x16x32_bf16 v[128:131], a[132:135], v[72:75], v[128:131]
ds_read_b64_tr_b16 a[166:167], v229 offset:6144
buffer_load_dwordx4 v57, s[44:47], s29 offen offset:1024 lds
v_mul_f32 v186, v236, v186
v_mfma_f32_16x16x32_bf16 v[128:131], a[136:139], v[80:83], v[128:131]
ds_read_b64_tr_b16 a[168:169], v229 offset:8192
ds_read_b64_tr_b16 a[170:171], v229 offset:10240
v_mfma_f32_16x16x32_bf16 v[128:131], a[140:143], v[88:91], v[128:131]
ds_read_b64_tr_b16 a[172:173], v229 offset:12288
v_mul_f32 v187, v236, v187
v_cvt_pk_bf16_f32 v216, v176, v177
v_mfma_f32_16x16x32_bf16 v[128:131], a[144:147], v[96:99], v[128:131]
ds_read_b64_tr_b16 a[174:175], v229 offset:14336
ds_read_b64_tr_b16 a[176:177], v229 offset:16384
s_waitcnt lgkmcnt(8)
v_mfma_f32_16x16x32_bf16 v[128:131], a[148:151], v[104:107], v[128:131]
ds_read_b64_tr_b16 a[178:179], v229 offset:18432
ds_read_b64_tr_b16 a[72:73], v11 offset:7296
v_cvt_pk_bf16_f32 v217, v178, v179
v_mfma_f32_16x16x32_bf16 v[128:131], a[152:155], v[112:115], v[128:131]
ds_read_b64_tr_b16 a[180:181], v229 offset:20480
ds_read_b64_tr_b16 a[182:183], v229 offset:22528
v_cvt_pk_bf16_f32 v218, v184, v185
v_mfma_f32_16x16x32_bf16 v[128:131], a[156:159], v[120:123], v[128:131]
ds_read_b64_tr_b16 a[184:185], v229 offset:24576
v_cvt_pk_bf16_f32 v219, v186, v187
v_mfma_f32_16x16x32_bf16 v[132:135], a[128:131], v[68:71], 0
ds_read_b64_tr_b16 a[186:187], v229 offset:26624
ds_read_b64_tr_b16 a[74:75], v11 offset:10880
buffer_store_dwordx4 v[216:219], v233, s[20:23], s33 offen offset:1024 sc1
v_mfma_f32_16x16x32_bf16 v[132:135], a[132:135], v[76:79], v[132:135]
ds_read_b64_tr_b16 a[188:189], v229 offset:28672
ds_read_b64_tr_b16 a[190:191], v229 offset:30720
buffer_load_dwordx4 v58, s[44:47], s29 offen offset:2048 lds
v_mfma_f32_16x16x32_bf16 v[132:135], a[136:139], v[84:87], v[132:135]
ds_read_b64_tr_b16 a[192:193], v230 offset:0
v_mul_f32 v180, v237, v180
v_mul_f32 v181, v237, v181
v_mfma_f32_16x16x32_bf16 v[132:135], a[140:143], v[92:95], v[132:135]
ds_read_b64_tr_b16 a[194:195], v230 offset:2048
ds_read_b64_tr_b16 a[196:197], v230 offset:4096
v_mfma_f32_16x16x32_bf16 v[132:135], a[144:147], v[100:103], v[132:135]
ds_read_b64_tr_b16 a[198:199], v230 offset:6144
ds_read_b64_tr_b16 a[76:77], v11 offset:7328
v_mul_f32 v182, v237, v182
v_mfma_f32_16x16x32_bf16 v[132:135], a[148:151], v[108:111], v[132:135]
ds_read_b64_tr_b16 a[200:201], v230 offset:8192
v_mul_f32 v183, v237, v183
v_mul_f32 v188, v237, v188
v_mfma_f32_16x16x32_bf16 v[132:135], a[152:155], v[116:119], v[132:135]
ds_read_b64_tr_b16 a[202:203], v230 offset:10240
ds_read_b64_tr_b16 a[204:205], v230 offset:12288
v_mfma_f32_16x16x32_bf16 v[132:135], a[156:159], v[124:127], v[132:135]
ds_read_b64_tr_b16 a[206:207], v230 offset:14336
ds_read_b64_tr_b16 a[78:79], v11 offset:10912
v_mul_f32 v189, v237, v189
v_mfma_f32_16x16x32_bf16 v[136:139], a[160:163], v[64:67], 0
ds_read_b64_tr_b16 a[208:209], v230 offset:16384
ds_read_b64_tr_b16 a[210:211], v230 offset:18432
v_mul_f32 v190, v237, v190
s_waitcnt lgkmcnt(9)
v_mfma_f32_16x16x32_bf16 v[136:139], a[164:167], v[72:75], v[136:139]
ds_read_b64_tr_b16 a[212:213], v230 offset:20480
buffer_load_dwordx4 v59, s[44:47], s29 offen offset:3072 lds
v_mul_f32 v191, v237, v191
v_mfma_f32_16x16x32_bf16 v[136:139], a[168:171], v[80:83], v[136:139]
ds_read_b64_tr_b16 a[214:215], v230 offset:22528
ds_read_b64_tr_b16 a[216:217], v230 offset:24576
v_mfma_f32_16x16x32_bf16 v[136:139], a[172:175], v[88:91], v[136:139]
ds_read_b64_tr_b16 a[218:219], v230 offset:26624
v_cvt_pk_bf16_f32 v220, v180, v181
v_cvt_pk_bf16_f32 v221, v182, v183
v_mfma_f32_16x16x32_bf16 v[136:139], a[176:179], v[96:99], v[136:139]
ds_read_b64_tr_b16 a[220:221], v230 offset:28672
ds_read_b64_tr_b16 a[80:81], v11 offset:7360
v_cvt_pk_bf16_f32 v222, v188, v189
v_mfma_f32_16x16x32_bf16 v[136:139], a[180:183], v[104:107], v[136:139]
ds_read_b64_tr_b16 a[222:223], v230 offset:30720
ds_read_b64_tr_b16 a[224:225], v231 offset:0
v_mfma_f32_16x16x32_bf16 v[136:139], a[184:187], v[112:115], v[136:139]
ds_read_b64_tr_b16 a[226:227], v231 offset:2048
v_cvt_pk_bf16_f32 v223, v190, v191
buffer_store_dwordx4 v[220:223], v234, s[20:23], s33 offen offset:1024 sc1
v_mfma_f32_16x16x32_bf16 v[136:139], a[188:191], v[120:123], v[136:139]
ds_read_b64_tr_b16 a[228:229], v231 offset:4096
ds_read_b64_tr_b16 a[230:231], v231 offset:6144
v_mfma_f32_16x16x32_bf16 v[140:143], a[160:163], v[68:71], 0
ds_read_b64_tr_b16 a[232:233], v231 offset:8192
s_add_u32 m0, s34, 4096
v_mfma_f32_16x16x32_bf16 v[140:143], a[164:167], v[76:79], v[140:143]
ds_read_b64_tr_b16 a[234:235], v231 offset:10240
ds_read_b64_tr_b16 a[236:237], v231 offset:12288
buffer_load_dwordx4 v60, s[44:47], s29 offen lds
v_mfma_f32_16x16x32_bf16 v[140:143], a[168:171], v[84:87], v[140:143]
ds_read_b64_tr_b16 a[238:239], v231 offset:14336
ds_read_b64_tr_b16 a[82:83], v11 offset:10944
v_mfma_f32_16x16x32_bf16 v[140:143], a[172:175], v[92:95], v[140:143]
ds_read_b64_tr_b16 a[240:241], v231 offset:16384
s_add_u32 s33, s32, 25165824
v_mfma_f32_16x16x32_bf16 v[140:143], a[176:179], v[100:103], v[140:143]
ds_read_b64_tr_b16 a[242:243], v231 offset:18432
ds_read_b64_tr_b16 a[244:245], v231 offset:20480
v_mfma_f32_16x16x32_bf16 v[140:143], a[180:183], v[108:111], v[140:143]
ds_read_b64_tr_b16 a[246:247], v231 offset:22528
v_mfma_f32_16x16x32_bf16 v[140:143], a[184:187], v[116:119], v[140:143]
ds_read_b64_tr_b16 a[248:249], v231 offset:24576
ds_read_b64_tr_b16 a[250:251], v231 offset:26624
v_mfma_f32_16x16x32_bf16 v[140:143], a[188:191], v[124:127], v[140:143]
ds_read_b64_tr_b16 a[252:253], v231 offset:28672
v_mul_f32 v128, v236, v128
v_mfma_f32_16x16x32_bf16 v[144:147], a[192:195], v[64:67], 0
ds_read_b64_tr_b16 a[254:255], v231 offset:30720
s_waitcnt lgkmcnt(7)
v_mfma_f32_16x16x32_bf16 v[144:147], a[196:199], v[72:75], v[144:147]
buffer_load_dwordx4 v61, s[44:47], s29 offen offset:1024 lds
v_mul_f32 v129, v236, v129
v_mfma_f32_16x16x32_bf16 v[144:147], a[200:203], v[80:83], v[144:147]
v_mul_f32 v130, v236, v130
v_mul_f32 v131, v236, v131
v_mfma_f32_16x16x32_bf16 v[144:147], a[204:207], v[88:91], v[144:147]
v_mul_f32 v136, v236, v136
v_mfma_f32_16x16x32_bf16 v[144:147], a[208:211], v[96:99], v[144:147]
v_mul_f32 v137, v236, v137
v_mul_f32 v138, v236, v138
v_mfma_f32_16x16x32_bf16 v[144:147], a[212:215], v[104:107], v[144:147]
v_mul_f32 v139, v236, v139
v_mfma_f32_16x16x32_bf16 v[144:147], a[216:219], v[112:115], v[144:147]
v_cvt_pk_bf16_f32 v192, v128, v129
v_cvt_pk_bf16_f32 v193, v130, v131
v_mfma_f32_16x16x32_bf16 v[144:147], a[220:223], v[120:123], v[144:147]
s_waitcnt lgkmcnt(0)
s_buffer_load_dword s64, s[20:23], s101 glc
s_buffer_load_dword s65, s[20:23], s101 offset:128 glc
v_cvt_pk_bf16_f32 v194, v136, v137
v_mfma_f32_16x16x32_bf16 v[148:151], a[192:195], v[68:71], 0
s_buffer_load_dword s66, s[20:23], s101 offset:256 glc
s_buffer_load_dword s67, s[20:23], s101 offset:384 glc
v_cvt_pk_bf16_f32 v195, v138, v139
buffer_store_dwordx4 v[192:195], v233, s[20:23], s33 offen sc1
v_mfma_f32_16x16x32_bf16 v[148:151], a[196:199], v[76:79], v[148:151]
buffer_load_dwordx4 v62, s[44:47], s29 offen offset:2048 lds
v_mfma_f32_16x16x32_bf16 v[148:151], a[200:203], v[84:87], v[148:151]
v_mul_f32 v132, v237, v132
v_mfma_f32_16x16x32_bf16 v[148:151], a[204:207], v[92:95], v[148:151]
v_mul_f32 v133, v237, v133
v_mfma_f32_16x16x32_bf16 v[148:151], a[208:211], v[100:103], v[148:151]
v_mul_f32 v134, v237, v134
v_mfma_f32_16x16x32_bf16 v[148:151], a[212:215], v[108:111], v[148:151]
v_mul_f32 v135, v237, v135
v_mfma_f32_16x16x32_bf16 v[148:151], a[216:219], v[116:119], v[148:151]
v_mul_f32 v140, v237, v140
v_mfma_f32_16x16x32_bf16 v[148:151], a[220:223], v[124:127], v[148:151]
v_mul_f32 v141, v237, v141
v_mfma_f32_16x16x32_bf16 v[152:155], a[224:227], v[64:67], 0
v_mul_f32 v142, v237, v142
v_mfma_f32_16x16x32_bf16 v[152:155], a[228:231], v[72:75], v[152:155]
v_mul_f32 v143, v237, v143
v_mfma_f32_16x16x32_bf16 v[152:155], a[232:235], v[80:83], v[152:155]
v_cvt_pk_bf16_f32 v196, v132, v133
v_mfma_f32_16x16x32_bf16 v[152:155], a[236:239], v[88:91], v[152:155]
v_cvt_pk_bf16_f32 v197, v134, v135
v_mfma_f32_16x16x32_bf16 v[152:155], a[240:243], v[96:99], v[152:155]
v_cvt_pk_bf16_f32 v198, v140, v141
v_mfma_f32_16x16x32_bf16 v[152:155], a[244:247], v[104:107], v[152:155]
v_cvt_pk_bf16_f32 v199, v142, v143
v_mfma_f32_16x16x32_bf16 v[152:155], a[248:251], v[112:115], v[152:155]
buffer_store_dwordx4 v[196:199], v234, s[20:23], s33 offen sc1
v_mfma_f32_16x16x32_bf16 v[152:155], a[252:255], v[120:123], v[152:155]
v_mfma_f32_16x16x32_bf16 v[156:159], a[224:227], v[68:71], 0
v_mfma_f32_16x16x32_bf16 v[156:159], a[228:231], v[76:79], v[156:159]
v_mfma_f32_16x16x32_bf16 v[156:159], a[232:235], v[84:87], v[156:159]
v_mfma_f32_16x16x32_bf16 v[156:159], a[236:239], v[92:95], v[156:159]
v_mfma_f32_16x16x32_bf16 v[156:159], a[240:243], v[100:103], v[156:159]
v_mfma_f32_16x16x32_bf16 v[156:159], a[244:247], v[108:111], v[156:159]
v_mfma_f32_16x16x32_bf16 v[156:159], a[248:251], v[116:119], v[156:159]
v_mfma_f32_16x16x32_bf16 v[156:159], a[252:255], v[124:127], v[156:159]
s_nop 7
v_mul_f32 v144, v236, v144
v_mul_f32 v145, v236, v145
v_mul_f32 v146, v236, v146
v_mul_f32 v147, v236, v147
v_mul_f32 v152, v236, v152
v_mul_f32 v153, v236, v153
v_mul_f32 v154, v236, v154
v_mul_f32 v155, v236, v155
v_cvt_pk_bf16_f32 v200, v144, v145
v_cvt_pk_bf16_f32 v201, v146, v147
v_cvt_pk_bf16_f32 v202, v152, v153
v_cvt_pk_bf16_f32 v203, v154, v155
buffer_store_dwordx4 v[200:203], v233, s[20:23], s33 offen offset:1024 sc1
s_nop 7
v_mul_f32 v148, v237, v148
v_mul_f32 v149, v237, v149
v_mul_f32 v150, v237, v150
v_mul_f32 v151, v237, v151
v_mul_f32 v156, v237, v156
v_mul_f32 v157, v237, v157
v_mul_f32 v158, v237, v158
v_mul_f32 v159, v237, v159
v_cvt_pk_bf16_f32 v204, v148, v149
v_cvt_pk_bf16_f32 v205, v150, v151
v_cvt_pk_bf16_f32 v206, v156, v157
v_cvt_pk_bf16_f32 v207, v158, v159
buffer_store_dwordx4 v[204:207], v234, s[20:23], s33 offen offset:1024 sc1
ds_read_b64_tr_b16 a[84:85], v11 offset:8960
s_lshl_b32 s59, s56, 2
ds_read_b64_tr_b16 a[86:87], v11 offset:12544
s_xor_b32 s72, s59, s57
ds_read_b64_tr_b16 a[88:89], v11 offset:8992
s_min_u32 s72, s72, 4
ds_read_b64_tr_b16 a[90:91], v11 offset:12576
s_add_u32 s59, s59, 127744
ds_read_b64_tr_b16 a[92:93], v11 offset:9024
v_mov_b32 v28, s59
ds_read_b64_tr_b16 a[94:95], v11 offset:12608
v_mov_b32 v6, 127744
ds_read_b64_tr_b16 a[96:97], v11 offset:9056
v_and_b32 v36, 7, v0
ds_read_b64_tr_b16 a[98:99], v11 offset:12640
v_bfe_u32 v37, v0, 3, 1
ds_read_b64_tr_b16 a[100:101], v11 offset:9088
v_lshlrev_b32 v36, 4, v36
ds_read_b64_tr_b16 a[102:103], v11 offset:12672
v_lshl_add_u32 v18, v37, 8, v36
ds_read_b64_tr_b16 a[104:105], v11 offset:9120
v_bfe_u32 v48, v0, 4, 2
ds_read_b64_tr_b16 a[106:107], v11 offset:12704
v_lshl_add_u32 v48, v48, 18, v18
ds_read_b64_tr_b16 a[108:109], v11 offset:9152
v_add_u32 v49, 1048576, v48
ds_read_b64_tr_b16 a[110:111], v11 offset:12736
v_add_u32 v50, 2097152, v48
v_add_u32 v51, 3145728, v48
s_lshl4_add_u32 s59, s58, s57
s_lshr_b32 s60, s59, 1
s_and_b32 s94, s59, 1
s_lshl4_add_u32 s94, s60, s94
s_lshl2_add_u32 s94, s56, s94
s_lshl_b32 s94, s94, 7
s_add_u32 s94, s94, 16777216
s_add_u32 s100, s101, 131072
s_mov_b32 m0, s72
s_waitcnt lgkmcnt(0)
s_mov_b32 s74, s64
s_mov_b32 s75, s65
s_mov_b32 s76, s66
s_mov_b32 s77, s67
s_movreld_b32 s64, 4
s_min_u32 s64, s64, s65
s_min_u32 s66, s66, s67
s_min_u32 s64, s64, s66
v_mov_b32 v248, s64
ds_write_b32 v28, v248
s_mov_b32 s73, 0
s_waitcnt lgkmcnt(0)
s_barrier
ds_read_b128 v[248:251], v6
s_waitcnt lgkmcnt(0)
v_min3_u32 v248, v248, v249, v250
v_min_u32 v248, v248, v251
s_nop 0
v_readfirstlane_b32 s30, v248
s_nop 0
s_cmp_ge_u32 s30, 2
s_cselect_b32 s95, s94, 1073741824
s_cselect_b32 s73, 1, s73
buffer_load_dwordx4 a[128:131], v48, s[20:23], s95 offen sc1
buffer_load_dwordx4 a[132:135], v49, s[20:23], s95 offen sc1
buffer_load_dwordx4 a[136:139], v50, s[20:23], s95 offen sc1
buffer_load_dwordx4 a[140:143], v51, s[20:23], s95 offen sc1
s_add_u32 s95, s95, 4194304
buffer_load_dwordx4 a[144:147], v48, s[20:23], s95 offen sc1
buffer_load_dwordx4 a[148:151], v49, s[20:23], s95 offen sc1
buffer_load_dwordx4 a[152:155], v50, s[20:23], s95 offen sc1
buffer_load_dwordx4 a[156:159], v51, s[20:23], s95 offen sc1
v_mov_b32 v5, 7
s_add_u32 s35, s63, 131072
s_waitcnt vmcnt(8)
buffer_store_dword v5, v63, s[20:23], s35 offen sc1
s_buffer_load_dword s64, s[20:23], s100 glc
s_buffer_load_dword s65, s[20:23], s100 offset:128 glc
s_buffer_load_dword s66, s[20:23], s100 offset:256 glc
s_buffer_load_dword s67, s[20:23], s100 offset:384 glc
s_buffer_load_dword s74, s[20:23], s101 glc
s_buffer_load_dword s75, s[20:23], s101 offset:128 glc
s_buffer_load_dword s76, s[20:23], s101 offset:256 glc
s_buffer_load_dword s77, s[20:23], s101 offset:384 glc
s_cmp_gt_u32 s73, 0
s_cbranch_scc1 T2A0
s_cmp_ge_u32 s30, 2
s_cbranch_scc0 T2A
s_add_u32 s95, s94, 0
buffer_load_dwordx4 a[128:131], v48, s[20:23], s95 offen sc1
buffer_load_dwordx4 a[132:135], v49, s[20:23], s95 offen sc1
buffer_load_dwordx4 a[136:139], v50, s[20:23], s95 offen sc1
buffer_load_dwordx4 a[140:143], v51, s[20:23], s95 offen sc1
s_add_u32 s95, s95, 4194304
buffer_load_dwordx4 a[144:147], v48, s[20:23], s95 offen sc1
buffer_load_dwordx4 a[148:151], v49, s[20:23], s95 offen sc1
buffer_load_dwordx4 a[152:155], v50, s[20:23], s95 offen sc1
buffer_load_dwordx4 a[156:159], v51, s[20:23], s95 offen sc1
s_mov_b32 s73, 1
T2A0:
s_cmp_gt_u32 s73, 1
s_cbranch_scc1 T2A1
s_cmp_ge_u32 s30, 4
s_cbranch_scc0 T2A
s_add_u32 s95, s94, 8388608
buffer_load_dwordx4 a[160:163], v48, s[20:23], s95 offen sc1
buffer_load_dwordx4 a[164:167], v49, s[20:23], s95 offen sc1
buffer_load_dwordx4 a[168:171], v50, s[20:23], s95 offen sc1
buffer_load_dwordx4 a[172:175], v51, s[20:23], s95 offen sc1
s_add_u32 s95, s95, 4194304
buffer_load_dwordx4 a[176:179], v48, s[20:23], s95 offen sc1
buffer_load_dwordx4 a[180:183], v49, s[20:23], s95 offen sc1
buffer_load_dwordx4 a[184:187], v50, s[20:23], s95 offen sc1
buffer_load_dwordx4 a[188:191], v51, s[20:23], s95 offen sc1
s_mov_b32 s73, 2
T2A1:
T2A:
v_bfe_u32 v37, v0, 5, 1
v_lshl_add_u32 v24, v22, 5, v36
v_lshl_add_u32 v55, v37, 30, v24
v_lshl_add_u32 v18, v32, 19, v18
v_lshl_add_u32 v18, v37, 18, v18
v_and_b32 v35, v32, v37
v_lshl_add_u32 v7, v35, 30, v18
v_sub_u32 v37, 1, v37
v_cvt_f32_u32 v26, v37
v_lshrrev_b32 v30, 1, v36
v_add_u32 v30, 127488, v30
v_lshl_add_u32 v29, s56, 6, v30
v_add_u32 v10, 0x10000, v9
v_lshl_add_u32 v34, v32, 5, v34
v_lshl_add_u32 v34, v33, 7, v34
v_lshrrev_b32 v35, 3, v0
v_xor_b32 v35, v35, v0
v_bfe_u32 v35, v35, 3, 1
v_lshl_add_u32 v34, v35, 6, v34
v_add_u32 v12, s24, v34
v_and_b32 v32, 63, v0
v_lshrrev_b32 v33, 3, v32
v_mul_u32_u24 v33, 896, v33
v_bfe_u32 v34, v32, 4, 1
v_lshlrev_b32 v34, 2, v34
v_and_b32 v35, 7, v32
v_xor_b32 v34, v34, v35
v_lshl_add_u32 v8, v34, 4, v33
v_add_u32 v19, 6144, v8
v_add_u32 v23, 98304, v8
v_add_u32 v25, 104448, v8
s_and_b32 s92, s2, 7
s_bfe_u32 s93, s2, 0x10003
s_lshl1_add_u32 s92, s92, s93
s_lshr_b32 s93, s2, 4
s_lshr_b32 s59, s93, 1
s_lshl_b32 s59, s59, 7
s_mul_i32 s60, s56, 401408
s_add_u32 s59, s59, s60
v_lshlrev_b32 v31, 4, v32
s_add_u32 s12, s80, s59
s_addc_u32 s13, s81, 0
s_sub_u32 s14, 1605632, s59
s_mov_b32 s15, 0x20000
v_accvgpr_read_b32 v64, a112
v_accvgpr_read_b32 v65, a113
v_accvgpr_read_b32 v66, a114
v_accvgpr_read_b32 v67, a115
v_accvgpr_read_b32 v68, a116
v_accvgpr_read_b32 v69, a117
v_accvgpr_read_b32 v70, a118
v_accvgpr_read_b32 v71, a119
v_accvgpr_read_b32 v72, a120
v_accvgpr_read_b32 v73, a121
v_accvgpr_read_b32 v74, a122
v_accvgpr_read_b32 v75, a123
v_accvgpr_read_b32 v76, a124
v_accvgpr_read_b32 v77, a125
v_accvgpr_read_b32 v78, a126
v_accvgpr_read_b32 v79, a127
s_mov_b32 s61, 5888
buffer_load_dwordx4 v[96:99], v22, s[20:23], s61 offen sc1
buffer_load_dwordx4 v[80:83], v22, s[20:23], s61 offen offset:1792 sc1
buffer_load_dwordx4 v[100:103], v22, s[20:23], s61 offen offset:512 sc1
buffer_load_dwordx4 v[84:87], v22, s[20:23], s61 offen offset:2304 sc1
buffer_load_dwordx4 v[104:107], v22, s[20:23], s61 offen offset:1024 sc1
buffer_load_dwordx4 v[88:91], v22, s[20:23], s61 offen offset:2816 sc1
buffer_load_dwordx4 v[108:111], v53, s[20:23], s61 offen offset:1536 sc1
buffer_load_dwordx4 v[92:95], v53, s[20:23], s61 offen offset:3328 sc1
s_lshl4_add_u32 s59, s58, s57
s_lshr_b32 s60, s59, 2
s_and_b32 s59, s59, 3
s_lshl_b32 s59, s59, 7
s_mul_i32 s33, s60, 28672
s_lshl_b32 s27, s33, 1
s_add_u32 s27, s27, s59
s_add_u32 s27, s27, 4194304
s_add_u32 s33, s33, s59
s_lshl_b32 s59, s56, 10
s_add_u32 s33, s33, s59
s_add_u32 s33, s33, 2097152
s_lshl4_add_u32 s25, s58, s56
s_lshl_b32 s25, s25, 9
s_add_u32 s25, s25, 524288
s_lshl_b32 s26, s92, 13
s_add_u32 s26, s26, 524288
v_and_b32 v33, 1, v32
v_lshlrev_b32 v33, 4, v33
s_movk_i32 s59, 0x3f80
v_lshlrev_b32 v33, v33, s59
v_bfe_u32 v34, v32, 1, 3
v_cmp_eq_u32 vcc, 0, v34
v_cmp_eq_u32 s[96:97], 1, v34
v_cmp_eq_u32 s[98:99], 2, v34
v_cndmask_b32 v240, 0, v33, vcc
v_cmp_eq_u32 vcc, 3, v34
v_cndmask_b32 v241, 0, v33, s[96:97]
v_cmp_eq_u32 s[96:97], 4, v34
v_cndmask_b32 v242, 0, v33, s[98:99]
v_cmp_eq_u32 s[98:99], 5, v34
v_cndmask_b32 v243, 0, v33, vcc
v_cmp_eq_u32 vcc, 6, v34
v_cndmask_b32 v244, 0, v33, s[96:97]
v_cmp_eq_u32 s[96:97], 7, v34
v_cndmask_b32 v245, 0, v33, s[98:99]
v_cndmask_b32 v246, 0, v33, vcc
s_nop 0
v_cndmask_b32 v247, 0, v33, s[96:97]
v_bfe_u32 v33, v32, 2, 2
v_and_b32 v34, 3, v32
v_lshlrev_b32 v52, 7, v34
v_lshl_add_u32 v52, v33, 11, v52
v_xor_b32 v13, 64, v12
v_add_u32 v14, 0x10000, v12
v_add_u32 v15, 0x10000, v13
v_add_u32 v16, 0x20000, v12
v_add_u32 v17, 0x20000, v13
v_lshrrev_b32 v33, 5, v32
v_lshlrev_b32 v1, 4, v33
v_and_b32 v34, 31, v32
v_mul_u32_u24 v34, 896, v34
v_add_u32 v2, v34, v1
s_mov_b32 s48, s86
s_mov_b32 s49, s87
s_mov_b32 s50, 1835008
s_mov_b32 s51, 0x20000
s_and_b32 s59, s93, 1
s_lshr_b32 s60, s56, 1
s_lshl1_add_u32 s60, s59, s60
s_lshl3_add_u32 s59, s59, s56
v_bfe_u32 v34, v32, 2, 2
v_lshl_add_u32 v35, v33, 3, v34
v_cmp_eq_u32 vcc, s60, v34
v_cmp_eq_u32 s[96:97], s59, v35
s_nop 0
s_or_b64 vcc, vcc, s[96:97]
s_cmp_lt_u32 s93, 14
s_cselect_b64 vcc, vcc, 0
v_cndmask_b32 v27, 0, 8, vcc
v_and_b32 v21, 8, v27
v_xor_b32 v21, 8, v21
v_lshlrev_b32 v21, 27, v21
v_lshl_add_u32 v21, v32, 7, v21
s_mov_b32 s10, s32
s_add_u32 s11, s32, 4194304
s_mov_b32 s62, 0
s_branch T2P
T2M:
s_sleep 2
s_and_b32 s59, s62, 0
s_cmp_lg_u32 s59, 0
s_cbranch_scc1 T2F
s_cmp_ge_u32 s73, 2
s_cbranch_scc1 T2F
s_buffer_load_dword s74, s[20:23], s101 glc
s_buffer_load_dword s75, s[20:23], s101 offset:128 glc
s_buffer_load_dword s76, s[20:23], s101 offset:256 glc
s_buffer_load_dword s77, s[20:23], s101 offset:384 glc
T2F:
s_buffer_load_dword s64, s[20:23], s100 glc
s_buffer_load_dword s65, s[20:23], s100 offset:128 glc
s_buffer_load_dword s66, s[20:23], s100 offset:256 glc
s_buffer_load_dword s67, s[20:23], s100 offset:384 glc
s_add_u32 s62, s62, 1
s_cmp_lg_u32 s62, 3
s_cbranch_scc1 T2P
s_mov_b32 s29, 0
s_add_u32 m0, s24, 65536
s_nop 0
buffer_load_dwordx4 v8, s[12:15], s29 offen lds
buffer_load_dwordx4 v19, s[12:15], s29 offen offset:1024 lds
buffer_load_dwordx4 v23, s[12:15], s29 offen offset:2048 lds
buffer_load_dwordx4 v25, s[12:15], s29 offen offset:3072 lds
s_mov_b32 s29, 200704
s_add_u32 m0, s24, 69632
s_nop 0
buffer_load_dwordx4 v8, s[12:15], s29 offen lds
buffer_load_dwordx4 v19, s[12:15], s29 offen offset:1024 lds
buffer_load_dwordx4 v23, s[12:15], s29 offen offset:2048 lds
buffer_load_dwordx4 v25, s[12:15], s29 offen offset:3072 lds
s_mov_b32 s29, 14336
s_add_u32 m0, s24, 131072
s_nop 0
buffer_load_dwordx4 v8, s[12:15], s29 offen lds
buffer_load_dwordx4 v19, s[12:15], s29 offen offset:1024 lds
buffer_load_dwordx4 v23, s[12:15], s29 offen offset:2048 lds
buffer_load_dwordx4 v25, s[12:15], s29 offen offset:3072 lds
s_mov_b32 s29, 215040
s_add_u32 m0, s24, 135168
s_nop 0
buffer_load_dwordx4 v8, s[12:15], s29 offen lds
buffer_load_dwordx4 v19, s[12:15], s29 offen offset:1024 lds
buffer_load_dwordx4 v23, s[12:15], s29 offen offset:2048 lds
buffer_load_dwordx4 v25, s[12:15], s29 offen offset:3072 lds
T2P:
s_mov_b32 m0, s72
s_waitcnt lgkmcnt(0)
s_max_u32 s64, s64, s74
s_max_u32 s65, s65, s75
s_max_u32 s66, s66, s76
s_max_u32 s67, s67, s77
s_movreld_b32 s64, 8
s_min_u32 s64, s64, s65
s_min_u32 s66, s66, s67
s_min_u32 s64, s64, s66
v_mov_b32 v248, s64
ds_write_b32 v28, v248
ds_read_b128 v[248:251], v6
s_waitcnt lgkmcnt(0)
v_min3_u32 v248, v248, v249, v250
v_min_u32 v248, v248, v251
s_nop 0
v_readfirstlane_b32 s30, v248
s_cmp_gt_u32 s62, 16384
s_cselect_b32 s30, 16, s30
s_cmp_gt_u32 s73, 0
s_cbranch_scc1 T2Q0
s_cmp_ge_u32 s30, 2
s_cbranch_scc0 T2M
s_add_u32 s95, s94, 0
buffer_load_dwordx4 a[128:131], v48, s[20:23], s95 offen sc1
buffer_load_dwordx4 a[132:135], v49, s[20:23], s95 offen sc1
buffer_load_dwordx4 a[136:139], v50, s[20:23], s95 offen sc1
buffer_load_dwordx4 a[140:143], v51, s[20:23], s95 offen sc1
s_add_u32 s95, s95, 4194304
buffer_load_dwordx4 a[144:147], v48, s[20:23], s95 offen sc1
buffer_load_dwordx4 a[148:151], v49, s[20:23], s95 offen sc1
buffer_load_dwordx4 a[152:155], v50, s[20:23], s95 offen sc1
buffer_load_dwordx4 a[156:159], v51, s[20:23], s95 offen sc1
s_mov_b32 s73, 1
T2Q0:
s_cmp_gt_u32 s73, 1
s_cbranch_scc1 T2Q1
s_cmp_ge_u32 s30, 4
s_cbranch_scc0 T2M
s_add_u32 s95, s94, 8388608
buffer_load_dwordx4 a[160:163], v48, s[20:23], s95 offen sc1
buffer_load_dwordx4 a[164:167], v49, s[20:23], s95 offen sc1
buffer_load_dwordx4 a[168:171], v50, s[20:23], s95 offen sc1
buffer_load_dwordx4 a[172:175], v51, s[20:23], s95 offen sc1
s_add_u32 s95, s95, 4194304
buffer_load_dwordx4 a[176:179], v48, s[20:23], s95 offen sc1
buffer_load_dwordx4 a[180:183], v49, s[20:23], s95 offen sc1
buffer_load_dwordx4 a[184:187], v50, s[20:23], s95 offen sc1
buffer_load_dwordx4 a[188:191], v51, s[20:23], s95 offen sc1
s_mov_b32 s73, 2
T2Q1:
s_cmp_ge_u32 s30, 7
s_cbranch_scc0 T2M
s_cmp_lt_u32 s62, 3
s_cbranch_scc1 T2LA
s_add_u32 s95, s94, 16777216
buffer_load_dwordx4 a[192:195], v48, s[20:23], s95 offen sc1
buffer_load_dwordx4 a[196:199], v49, s[20:23], s95 offen sc1
buffer_load_dwordx4 a[200:203], v50, s[20:23], s95 offen sc1
buffer_load_dwordx4 a[204:207], v51, s[20:23], s95 offen sc1
s_add_u32 s95, s95, 4194304
buffer_load_dwordx4 a[208:211], v48, s[20:23], s95 offen sc1
buffer_load_dwordx4 a[212:215], v49, s[20:23], s95 offen sc1
buffer_load_dwordx4 a[216:219], v50, s[20:23], s95 offen sc1
buffer_load_dwordx4 a[220:223], v51, s[20:23], s95 offen sc1
s_add_u32 s95, s95, 4194304
buffer_load_dwordx4 a[224:227], v48, s[20:23], s95 offen sc1
buffer_load_dwordx4 a[228:231], v49, s[20:23], s95 offen sc1
buffer_load_dwordx4 a[232:235], v50, s[20:23], s95 offen sc1
buffer_load_dwordx4 a[236:239], v51, s[20:23], s95 offen sc1
s_mov_b32 s61, 0xffff0000
s_mov_b32 s60, 0x3c124925
s_waitcnt vmcnt(12)
v_mfma_f32_16x16x32_bf16 v[112:115], v[240:243], a[128:131], 0
v_mfma_f32_16x16x32_bf16 v[112:115], v[240:243], a[132:135], v[112:115]
v_mfma_f32_16x16x32_bf16 v[112:115], v[240:243], a[136:139], v[112:115]
v_mfma_f32_16x16x32_bf16 v[112:115], v[240:243], a[140:143], v[112:115]
v_mfma_f32_16x16x32_bf16 v[112:115], v[244:247], a[144:147], v[112:115]
v_mfma_f32_16x16x32_bf16 v[112:115], v[244:247], a[148:151], v[112:115]
v_mfma_f32_16x16x32_bf16 v[112:115], v[244:247], a[152:155], v[112:115]
v_mfma_f32_16x16x32_bf16 v[112:115], v[244:247], a[156:159], v[112:115]
v_mfma_f32_16x16x32_bf16 v[116:119], v[240:243], a[160:163], 0
v_mfma_f32_16x16x32_bf16 v[116:119], v[240:243], a[164:167], v[116:119]
v_mfma_f32_16x16x32_bf16 v[116:119], v[240:243], a[168:171], v[116:119]
v_mfma_f32_16x16x32_bf16 v[116:119], v[240:243], a[172:175], v[116:119]
v_mfma_f32_16x16x32_bf16 v[116:119], v[244:247], a[176:179], v[116:119]
v_mfma_f32_16x16x32_bf16 v[116:119], v[244:247], a[180:183], v[116:119]
v_mfma_f32_16x16x32_bf16 v[116:119], v[244:247], a[184:187], v[116:119]
v_mfma_f32_16x16x32_bf16 v[116:119], v[244:247], a[188:191], v[116:119]
v_lshlrev_b32 v128, 16, v40
v_and_b32 v129, s61, v40
v_lshlrev_b32 v130, 16, v41
v_and_b32 v131, s61, v41
v_lshlrev_b32 v132, 16, v42
v_and_b32 v133, s61, v42
v_lshlrev_b32 v134, 16, v43
v_and_b32 v135, s61, v43
v_lshlrev_b32 v136, 16, v44
v_and_b32 v137, s61, v44
v_lshlrev_b32 v138, 16, v45
v_and_b32 v139, s61, v45
v_lshlrev_b32 v140, 16, v46
v_and_b32 v141, s61, v46
v_lshlrev_b32 v142, 16, v47
v_and_b32 v143, s61, v47
s_waitcnt vmcnt(8)
v_mfma_f32_16x16x32_bf16 v[120:123], v[240:243], a[192:195], 0
v_mfma_f32_16x16x32_bf16 v[120:123], v[240:243], a[196:199], v[120:123]
v_mfma_f32_16x16x32_bf16 v[120:123], v[240:243], a[200:203], v[120:123]
v_mfma_f32_16x16x32_bf16 v[120:123], v[240:243], a[204:207], v[120:123]
s_waitcnt vmcnt(4)
v_mfma_f32_16x16x32_bf16 v[120:123], v[244:247], a[208:211], v[120:123]
v_mfma_f32_16x16x32_bf16 v[120:123], v[244:247], a[212:215], v[120:123]
v_mfma_f32_16x16x32_bf16 v[120:123], v[244:247], a[216:219], v[120:123]
v_mfma_f32_16x16x32_bf16 v[120:123], v[244:247], a[220:223], v[120:123]
s_waitcnt vmcnt(0)
v_mfma_f32_16x16x32_bf16 v[124:127], v[240:243], a[224:227], 0
v_mfma_f32_16x16x32_bf16 v[124:127], v[240:243], a[228:231], v[124:127]
v_mfma_f32_16x16x32_bf16 v[124:127], v[240:243], a[232:235], v[124:127]
v_mfma_f32_16x16x32_bf16 v[124:127], v[240:243], a[236:239], v[124:127]
s_waitcnt vmcnt(0)
s_branch T2C
T2LA:
s_add_u32 s95, s94, 16777216
buffer_load_dwordx4 a[192:195], v48, s[20:23], s95 offen sc1
buffer_load_dwordx4 a[196:199], v49, s[20:23], s95 offen sc1
buffer_load_dwordx4 a[200:203], v50, s[20:23], s95 offen sc1
buffer_load_dwordx4 a[204:207], v51, s[20:23], s95 offen sc1
s_add_u32 s95, s95, 4194304
buffer_load_dwordx4 a[208:211], v48, s[20:23], s95 offen sc1
buffer_load_dwordx4 a[212:215], v49, s[20:23], s95 offen sc1
buffer_load_dwordx4 a[216:219], v50, s[20:23], s95 offen sc1
buffer_load_dwordx4 a[220:223], v51, s[20:23], s95 offen sc1
s_add_u32 s95, s95, 4194304
buffer_load_dwordx4 a[224:227], v48, s[20:23], s95 offen sc1
buffer_load_dwordx4 a[228:231], v49, s[20:23], s95 offen sc1
buffer_load_dwordx4 a[232:235], v50, s[20:23], s95 offen sc1
buffer_load_dwordx4 a[236:239], v51, s[20:23], s95 offen sc1
s_mov_b32 s29, 0
s_add_u32 m0, s24, 65536
s_nop 0
buffer_load_dwordx4 v8, s[12:15], s29 offen lds
buffer_load_dwordx4 v19, s[12:15], s29 offen offset:1024 lds
buffer_load_dwordx4 v23, s[12:15], s29 offen offset:2048 lds
buffer_load_dwordx4 v25, s[12:15], s29 offen offset:3072 lds
s_mov_b32 s29, 200704
s_add_u32 m0, s24, 69632
s_nop 0
buffer_load_dwordx4 v8, s[12:15], s29 offen lds
buffer_load_dwordx4 v19, s[12:15], s29 offen offset:1024 lds
buffer_load_dwordx4 v23, s[12:15], s29 offen offset:2048 lds
buffer_load_dwordx4 v25, s[12:15], s29 offen offset:3072 lds
s_mov_b32 s29, 14336
s_add_u32 m0, s24, 131072
s_nop 0
buffer_load_dwordx4 v8, s[12:15], s29 offen lds
buffer_load_dwordx4 v19, s[12:15], s29 offen offset:1024 lds
buffer_load_dwordx4 v23, s[12:15], s29 offen offset:2048 lds
buffer_load_dwordx4 v25, s[12:15], s29 offen offset:3072 lds
s_mov_b32 s29, 215040
s_add_u32 m0, s24, 135168
s_nop 0
buffer_load_dwordx4 v8, s[12:15], s29 offen lds
buffer_load_dwordx4 v19, s[12:15], s29 offen offset:1024 lds
buffer_load_dwordx4 v23, s[12:15], s29 offen offset:2048 lds
buffer_load_dwordx4 v25, s[12:15], s29 offen offset:3072 lds
s_mov_b32 s61, 0xffff0000
s_mov_b32 s60, 0x3c124925
s_waitcnt vmcnt(28)
v_mfma_f32_16x16x32_bf16 v[112:115], v[240:243], a[128:131], 0
v_mfma_f32_16x16x32_bf16 v[112:115], v[240:243], a[132:135], v[112:115]
v_mfma_f32_16x16x32_bf16 v[112:115], v[240:243], a[136:139], v[112:115]
v_mfma_f32_16x16x32_bf16 v[112:115], v[240:243], a[140:143], v[112:115]
v_mfma_f32_16x16x32_bf16 v[112:115], v[244:247], a[144:147], v[112:115]
v_mfma_f32_16x16x32_bf16 v[112:115], v[244:247], a[148:151], v[112:115]
v_mfma_f32_16x16x32_bf16 v[112:115], v[244:247], a[152:155], v[112:115]
v_mfma_f32_16x16x32_bf16 v[112:115], v[244:247], a[156:159], v[112:115]
v_mfma_f32_16x16x32_bf16 v[116:119], v[240:243], a[160:163], 0
v_mfma_f32_16x16x32_bf16 v[116:119], v[240:243], a[164:167], v[116:119]
v_mfma_f32_16x16x32_bf16 v[116:119], v[240:243], a[168:171], v[116:119]
v_mfma_f32_16x16x32_bf16 v[116:119], v[240:243], a[172:175], v[116:119]
v_mfma_f32_16x16x32_bf16 v[116:119], v[244:247], a[176:179], v[116:119]
v_mfma_f32_16x16x32_bf16 v[116:119], v[244:247], a[180:183], v[116:119]
v_mfma_f32_16x16x32_bf16 v[116:119], v[244:247], a[184:187], v[116:119]
v_mfma_f32_16x16x32_bf16 v[116:119], v[244:247], a[188:191], v[116:119]
v_lshlrev_b32 v128, 16, v40
v_and_b32 v129, s61, v40
v_lshlrev_b32 v130, 16, v41
v_and_b32 v131, s61, v41
v_lshlrev_b32 v132, 16, v42
v_and_b32 v133, s61, v42
v_lshlrev_b32 v134, 16, v43
v_and_b32 v135, s61, v43
v_lshlrev_b32 v136, 16, v44
v_and_b32 v137, s61, v44
v_lshlrev_b32 v138, 16, v45
v_and_b32 v139, s61, v45
v_lshlrev_b32 v140, 16, v46
v_and_b32 v141, s61, v46
v_lshlrev_b32 v142, 16, v47
v_and_b32 v143, s61, v47
s_waitcnt vmcnt(24)
v_mfma_f32_16x16x32_bf16 v[120:123], v[240:243], a[192:195], 0
v_mfma_f32_16x16x32_bf16 v[120:123], v[240:243], a[196:199], v[120:123]
v_mfma_f32_16x16x32_bf16 v[120:123], v[240:243], a[200:203], v[120:123]
v_mfma_f32_16x16x32_bf16 v[120:123], v[240:243], a[204:207], v[120:123]
s_waitcnt vmcnt(20)
v_mfma_f32_16x16x32_bf16 v[120:123], v[244:247], a[208:211], v[120:123]
v_mfma_f32_16x16x32_bf16 v[120:123], v[244:247], a[212:215], v[120:123]
v_mfma_f32_16x16x32_bf16 v[120:123], v[244:247], a[216:219], v[120:123]
v_mfma_f32_16x16x32_bf16 v[120:123], v[244:247], a[220:223], v[120:123]
s_waitcnt vmcnt(16)
v_mfma_f32_16x16x32_bf16 v[124:127], v[240:243], a[224:227], 0
v_mfma_f32_16x16x32_bf16 v[124:127], v[240:243], a[228:231], v[124:127]
v_mfma_f32_16x16x32_bf16 v[124:127], v[240:243], a[232:235], v[124:127]
v_mfma_f32_16x16x32_bf16 v[124:127], v[240:243], a[236:239], v[124:127]
T2C:
v_pk_fma_f32 v[112:113], v[112:113], v[64:65], v[128:129]
v_pk_fma_f32 v[114:115], v[114:115], v[66:67], v[130:131]
v_pk_fma_f32 v[116:117], v[116:117], v[68:69], v[132:133]
v_pk_fma_f32 v[118:119], v[118:119], v[70:71], v[134:135]
v_pk_fma_f32 v[120:121], v[120:121], v[72:73], v[136:137]
v_pk_fma_f32 v[122:123], v[122:123], v[74:75], v[138:139]
s_nop 1
v_pk_fma_f32 v[124:125], v[124:125], v[76:77], v[140:141]
v_pk_fma_f32 v[126:127], v[126:127], v[78:79], v[142:143]
buffer_store_dwordx4 v[112:115], v24, s[20:23], s27 offen sc1
s_add_u32 s27, s27, 16384
buffer_store_dwordx4 v[116:119], v24, s[20:23], s27 offen sc1
s_add_u32 s27, s27, 16384
buffer_store_dwordx4 v[120:123], v24, s[20:23], s27 offen sc1
s_add_u32 s27, s27, 16384
buffer_store_dwordx4 v[124:127], v55, s[20:23], s27 offen sc1
v_pk_add_f32 v[128:129], v[112:113], v[120:121]
v_pk_mul_f32 v[136:137], v[112:113], v[112:113]
v_pk_add_f32 v[130:131], v[114:115], v[122:123]
v_pk_mul_f32 v[138:139], v[114:115], v[114:115]
v_pk_add_f32 v[132:133], v[116:117], v[124:125]
v_pk_mul_f32 v[140:141], v[116:117], v[116:117]
v_pk_add_f32 v[134:135], v[118:119], v[126:127]
v_pk_mul_f32 v[142:143], v[118:119], v[118:119]
v_pk_fma_f32 v[136:137], v[120:121], v[120:121], v[136:137]
v_pk_fma_f32 v[138:139], v[122:123], v[122:123], v[138:139]
v_pk_fma_f32 v[140:141], v[124:125], v[124:125], v[140:141]
v_pk_fma_f32 v[142:143], v[126:127], v[126:127], v[142:143]
v_pk_add_f32 v[128:129], v[128:129], v[132:133]
v_pk_add_f32 v[130:131], v[130:131], v[134:135]
v_pk_add_f32 v[136:137], v[136:137], v[140:141]
v_pk_add_f32 v[138:139], v[138:139], v[142:143]
v_pk_add_f32 v[128:129], v[128:129], v[130:131]
v_pk_add_f32 v[136:137], v[136:137], v[138:139]
v_add_f32 v160, v128, v129
v_add_f32 v161, v136, v137
s_nop 0
v_add_f32_dpp v160, v160, v160 row_ror:8 row_mask:0xf bank_mask:0xf
v_add_f32_dpp v161, v161, v161 row_ror:8 row_mask:0xf bank_mask:0xf
v_mov_b32 v144, v160
v_mov_b32 v145, v161
s_nop 1
v_permlane32_swap_b32 v160, v144
v_permlane32_swap_b32 v161, v145
v_add_f32 v160, v160, v144
v_add_f32 v161, v161, v145
v_mov_b32 v144, v160
v_mov_b32 v145, v161
s_nop 1
v_permlane16_swap_b32 v160, v144
v_permlane16_swap_b32 v161, v145
v_add_f32 v160, v160, v144
v_add_f32 v161, v161, v145
ds_write_b64 v29, v[160:161]
s_mov_b32 s59, 0x3b124925
s_waitcnt lgkmcnt(0)
s_barrier
ds_read_b64 v[144:145], v30
ds_read_b64 v[146:147], v30 offset:64
ds_read_b64 v[148:149], v30 offset:128
ds_read_b64 v[150:151], v30 offset:192
s_waitcnt lgkmcnt(0)
v_pk_add_f32 v[144:145], v[144:145], v[146:147]
v_pk_add_f32 v[148:149], v[148:149], v[150:151]
v_pk_add_f32 v[144:145], v[144:145], v[148:149]
v_mul_f32 v160, s59, v144
v_mul_f32 v161, s59, v145
v_fma_f32 v161, -v160, v160, v161
v_max_f32 v161, 0, v161
v_add_f32 v161, 0x3727c5ac, v161
v_rsq_f32 v146, v161
v_pk_add_f32 v[128:129], v[112:113], v[160:161] op_sel_hi:[1,0] neg_lo:[0,1] neg_hi:[0,1]
v_pk_add_f32 v[130:131], v[114:115], v[160:161] op_sel_hi:[1,0] neg_lo:[0,1] neg_hi:[0,1]
v_pk_add_f32 v[132:133], v[116:117], v[160:161] op_sel_hi:[1,0] neg_lo:[0,1] neg_hi:[0,1]
v_pk_add_f32 v[134:135], v[118:119], v[160:161] op_sel_hi:[1,0] neg_lo:[0,1] neg_hi:[0,1]
v_pk_add_f32 v[136:137], v[120:121], v[160:161] op_sel_hi:[1,0] neg_lo:[0,1] neg_hi:[0,1]
v_pk_add_f32 v[138:139], v[122:123], v[160:161] op_sel_hi:[1,0] neg_lo:[0,1] neg_hi:[0,1]
v_pk_add_f32 v[140:141], v[124:125], v[160:161] op_sel_hi:[1,0] neg_lo:[0,1] neg_hi:[0,1]
v_pk_add_f32 v[142:143], v[126:127], v[160:161] op_sel_hi:[1,0] neg_lo:[0,1] neg_hi:[0,1]
v_pk_mul_f32 v[80:81], v[80:81], v[146:147] op_sel_hi:[1,0]
v_pk_mul_f32 v[82:83], v[82:83], v[146:147] op_sel_hi:[1,0]
v_pk_mul_f32 v[84:85], v[84:85], v[146:147] op_sel_hi:[1,0]
v_pk_mul_f32 v[86:87], v[86:87], v[146:147] op_sel_hi:[1,0]
v_pk_mul_f32 v[88:89], v[88:89], v[146:147] op_sel_hi:[1,0]
v_pk_mul_f32 v[90:91], v[90:91], v[146:147] op_sel_hi:[1,0]
v_pk_mul_f32 v[92:93], v[92:93], v[146:147] op_sel_hi:[1,0]
v_pk_mul_f32 v[94:95], v[94:95], v[146:147] op_sel_hi:[1,0]
v_pk_fma_f32 v[128:129], v[128:129], v[80:81], v[96:97]
v_pk_fma_f32 v[130:131], v[130:131], v[82:83], v[98:99]
v_pk_fma_f32 v[132:133], v[132:133], v[84:85], v[100:101]
v_pk_fma_f32 v[134:135], v[134:135], v[86:87], v[102:103]
v_pk_fma_f32 v[136:137], v[136:137], v[88:89], v[104:105]
v_pk_fma_f32 v[138:139], v[138:139], v[90:91], v[106:107]
v_pk_fma_f32 v[140:141], v[140:141], v[92:93], v[108:109]
v_pk_fma_f32 v[142:143], v[142:143], v[94:95], v[110:111]
v_cvt_pk_bf16_f32 v144, v128, v129
v_cvt_pk_bf16_f32 v145, v130, v131
v_cvt_pk_bf16_f32 v146, v132, v133
v_cvt_pk_bf16_f32 v147, v134, v135
v_cvt_pk_bf16_f32 v148, v136, v137
v_cvt_pk_bf16_f32 v149, v138, v139
v_cvt_pk_bf16_f32 v150, v140, v141
v_cvt_pk_bf16_f32 v151, v142, v143
v_permlane16_swap_b32 v144, v146
v_permlane16_swap_b32 v145, v147
v_permlane16_swap_b32 v148, v150
v_permlane16_swap_b32 v149, v151
v_and_b32 v144, -2, v144
v_and_b32 v148, -2, v148
s_add_u32 s33, s94, 8388608
buffer_store_dwordx4 v[144:147], v18, s[20:23], s33 offen sc1
s_add_u32 s33, s33, 1048576
buffer_store_dwordx4 v[148:151], v7, s[20:23], s33 offen sc1
s_lshl2_add_u32 s61, s58, s56
s_mul_i32 s61, s61, 4096
s_add_u32 s61, s61, 25165824
s_mov_b32 s59, 0xbdd2d3e8
v_mov_b32 v180, 0xc0135761
v_and_b32 v6, 0xf0, v31
v_bfe_u32 v33, v0, 4, 1
v_bfe_u32 v34, v0, 5, 1
v_lshl_add_u32 v6, v33, 11, v6
v_lshl_add_u32 v6, v34, 8, v6
s_add_u32 s4, s61, 262144
s_add_u32 s5, s61, 524288
s_add_u32 s6, s61, 786432
s_add_u32 s7, s61, 1048576
s_add_u32 s8, s61, 1310720
s_add_u32 s9, s61, 1572864
s_waitcnt vmcnt(14)
ds_read_b64_tr_b16 v[192:193], v14 offset:0
ds_read_b64_tr_b16 v[194:195], v14 offset:1024
ds_read_b64_tr_b16 v[196:197], v15 offset:0
ds_read_b64_tr_b16 v[198:199], v15 offset:1024
ds_read_b64_tr_b16 v[200:201], v14 offset:2048
ds_read_b64_tr_b16 v[202:203], v14 offset:3072
ds_read_b64_tr_b16 v[204:205], v15 offset:2048
ds_read_b64_tr_b16 v[206:207], v15 offset:3072
ds_read_b64_tr_b16 v[208:209], v14 offset:4096
ds_read_b64_tr_b16 v[210:211], v14 offset:5120
ds_read_b64_tr_b16 v[212:213], v15 offset:4096
ds_read_b64_tr_b16 v[214:215], v15 offset:5120
ds_read_b64_tr_b16 v[216:217], v14 offset:6144
ds_read_b64_tr_b16 v[218:219], v14 offset:7168
ds_read_b64_tr_b16 v[220:221], v15 offset:6144
ds_read_b64_tr_b16 v[222:223], v15 offset:7168
s_waitcnt vmcnt(6)
ds_read_b64_tr_b16 v[224:225], v16 offset:0
ds_read_b64_tr_b16 v[226:227], v16 offset:1024
ds_read_b64_tr_b16 v[228:229], v17 offset:0
ds_read_b64_tr_b16 v[230:231], v17 offset:1024
ds_read_b64_tr_b16 v[232:233], v16 offset:2048
ds_read_b64_tr_b16 v[234:235], v16 offset:3072
ds_read_b64_tr_b16 v[236:237], v17 offset:2048
ds_read_b64_tr_b16 v[238:239], v17 offset:3072
ds_read_b64_tr_b16 v[240:241], v16 offset:4096
ds_read_b64_tr_b16 v[242:243], v16 offset:5120
ds_read_b64_tr_b16 v[244:245], v17 offset:4096
ds_read_b64_tr_b16 v[246:247], v17 offset:5120
ds_read_b64_tr_b16 v[248:249], v16 offset:6144
ds_read_b64_tr_b16 v[250:251], v16 offset:7168
ds_read_b64_tr_b16 v[252:253], v17 offset:6144
ds_read_b64_tr_b16 v[254:255], v17 offset:7168
s_waitcnt lgkmcnt(0)
s_barrier
s_mov_b32 s62, 16384
s_mov_b32 s29, 917504
s_add_u32 m0, s34, 65536
s_nop 0
buffer_load_dwordx4 v56, s[44:47], s29 offen lds
buffer_load_dwordx4 v57, s[44:47], s29 offen offset:1024 lds
buffer_load_dwordx4 v58, s[44:47], s29 offen offset:2048 lds
buffer_load_dwordx4 v59, s[44:47], s29 offen offset:3072 lds
s_add_u32 m0, s34, 69632
s_nop 0
buffer_load_dwordx4 v60, s[44:47], s29 offen lds
buffer_load_dwordx4 v61, s[44:47], s29 offen offset:1024 lds
buffer_load_dwordx4 v62, s[44:47], s29 offen offset:2048 lds
buffer_load_dwordx4 a[128:131], v6, s[20:23], s61 offen sc1
buffer_load_dwordx4 a[132:135], v6, s[20:23], s61 offen offset:512 sc1
buffer_load_dwordx4 a[136:139], v6, s[20:23], s61 offen offset:1024 sc1
buffer_load_dwordx4 a[140:143], v6, s[20:23], s61 offen offset:1536 sc1
s_waitcnt vmcnt(0)
v_accvgpr_read_b32 v36, a128
v_accvgpr_read_b32 v37, a132
v_accvgpr_read_b32 v38, a136
v_or3_b32 v36, v36, v37, v38
v_accvgpr_read_b32 v37, a140
v_bitop3_b32 v36, v36, v37, 1 bitop3:0xa8
v_cmp_ne_u32 vcc, 0, v36
s_nop 0
s_cbranch_vccnz RT2_0
RT2_0_B:
buffer_load_dwordx4 a[144:147], v6, s[20:23], s4 offen sc1
buffer_load_dwordx4 a[148:151], v6, s[20:23], s4 offen offset:512 sc1
buffer_load_dwordx4 a[152:155], v6, s[20:23], s4 offen offset:1024 sc1
buffer_load_dwordx4 a[156:159], v6, s[20:23], s4 offen offset:1536 sc1
buffer_load_dwordx4 a[160:163], v6, s[20:23], s5 offen sc1
buffer_load_dwordx4 a[164:167], v6, s[20:23], s5 offen offset:512 sc1
buffer_load_dwordx4 a[168:171], v6, s[20:23], s5 offen offset:1024 sc1
buffer_load_dwordx4 a[172:175], v6, s[20:23], s5 offen offset:1536 sc1
buffer_load_dwordx4 a[176:179], v6, s[20:23], s6 offen sc1
buffer_load_dwordx4 a[180:183], v6, s[20:23], s6 offen offset:512 sc1
buffer_load_dwordx4 a[184:187], v6, s[20:23], s6 offen offset:1024 sc1
buffer_load_dwordx4 a[188:191], v6, s[20:23], s6 offen offset:1536 sc1
buffer_load_dwordx4 a[192:195], v6, s[20:23], s7 offen sc1
buffer_load_dwordx4 a[196:199], v6, s[20:23], s7 offen offset:512 sc1
buffer_load_dwordx4 a[200:203], v6, s[20:23], s7 offen offset:1024 sc1
buffer_load_dwordx4 a[204:207], v6, s[20:23], s7 offen offset:1536 sc1
buffer_load_dwordx4 a[208:211], v6, s[20:23], s8 offen sc1
buffer_load_dwordx4 a[212:215], v6, s[20:23], s8 offen offset:512 sc1
buffer_load_dwordx4 a[216:219], v6, s[20:23], s8 offen offset:1024 sc1
buffer_load_dwordx4 a[220:223], v6, s[20:23], s8 offen offset:1536 sc1
buffer_load_dwordx4 a[224:227], v6, s[20:23], s9 offen sc1
buffer_load_dwordx4 a[228:231], v6, s[20:23], s9 offen offset:512 sc1
buffer_load_dwordx4 a[232:235], v6, s[20:23], s9 offen offset:1024 sc1
buffer_load_dwordx4 a[236:239], v6, s[20:23], s9 offen offset:1536 sc1
v_mov_b32 v5, 8
s_add_u32 s35, s63, 262144
buffer_store_dword v5, v63, s[20:23], s35 offen sc1
v_mfma_f32_32x32x16_bf16 v[64:79], a[0:3], a[128:131], 0
ds_read_b64_tr_b16 a[112:113], v10 offset:32768
ds_read_b64_tr_b16 a[114:115], v10 offset:36352
v_mfma_f32_32x32x16_bf16 v[80:95], a[4:7], a[128:131], 0
ds_read_b64_tr_b16 a[116:117], v10 offset:32800
ds_read_b64_tr_b16 a[118:119], v10 offset:36384
s_add_u32 m0, s34, 131072
s_mov_b32 s29, 1146880
buffer_load_dwordx4 v56, s[44:47], s29 offen lds
v_mfma_f32_32x32x16_bf16 v[96:111], a[8:11], a[128:131], 0
ds_read_b64_tr_b16 a[120:121], v10 offset:32832
ds_read_b64_tr_b16 a[122:123], v10 offset:36416
v_mfma_f32_32x32x16_bf16 v[112:127], a[12:15], a[128:131], 0
ds_read_b64_tr_b16 a[124:125], v10 offset:32864
ds_read_b64_tr_b16 a[126:127], v10 offset:36448
buffer_load_dwordx4 v57, s[44:47], s29 offen offset:1024 lds
v_mfma_f32_32x32x16_bf16 v[128:143], a[16:19], a[128:131], 0
ds_read_b64_tr_b16 a[0:1], v10 offset:32896
ds_read_b64_tr_b16 a[2:3], v10 offset:36480
v_mfma_f32_32x32x16_bf16 v[144:159], a[20:23], a[128:131], 0
ds_read_b64_tr_b16 a[4:5], v10 offset:32928
ds_read_b64_tr_b16 a[6:7], v10 offset:36512
buffer_load_dwordx4 v58, s[44:47], s29 offen offset:2048 lds
v_mfma_f32_32x32x16_bf16 v[160:175], a[24:27], a[128:131], 0
ds_read_b64_tr_b16 a[8:9], v10 offset:32960
ds_read_b64_tr_b16 a[10:11], v10 offset:36544
v_mfma_f32_32x32x16_bf16 v[64:79], a[28:31], a[132:135], v[64:79]
ds_read_b64_tr_b16 a[12:13], v10 offset:34560
ds_read_b64_tr_b16 a[14:15], v10 offset:38144
buffer_load_dwordx4 v59, s[44:47], s29 offen offset:3072 lds
v_mfma_f32_32x32x16_bf16 v[80:95], a[32:35], a[132:135], v[80:95]
ds_read_b64_tr_b16 a[16:17], v10 offset:34592
ds_read_b64_tr_b16 a[18:19], v10 offset:38176
v_mfma_f32_32x32x16_bf16 v[96:111], a[36:39], a[132:135], v[96:111]
ds_read_b64_tr_b16 a[20:21], v10 offset:34624
ds_read_b64_tr_b16 a[22:23], v10 offset:38208
s_add_u32 m0, s34, 135168
s_nop 0
buffer_load_dwordx4 v60, s[44:47], s29 offen lds
v_mfma_f32_32x32x16_bf16 v[112:127], a[40:43], a[132:135], v[112:127]
ds_read_b64_tr_b16 a[24:25], v10 offset:34656
ds_read_b64_tr_b16 a[26:27], v10 offset:38240
v_mfma_f32_32x32x16_bf16 v[128:143], a[44:47], a[132:135], v[128:143]
ds_read_b64_tr_b16 a[28:29], v10 offset:34688
ds_read_b64_tr_b16 a[30:31], v10 offset:38272
buffer_load_dwordx4 v61, s[44:47], s29 offen offset:1024 lds
v_mfma_f32_32x32x16_bf16 v[144:159], a[48:51], a[132:135], v[144:159]
ds_read_b64_tr_b16 a[32:33], v10 offset:34720
ds_read_b64_tr_b16 a[34:35], v10 offset:38304
v_mfma_f32_32x32x16_bf16 v[160:175], a[52:55], a[132:135], v[160:175]
ds_read_b64_tr_b16 a[36:37], v10 offset:34752
ds_read_b64_tr_b16 a[38:39], v10 offset:38336
buffer_load_dwordx4 v62, s[44:47], s29 offen offset:2048 lds
v_mfma_f32_32x32x16_bf16 v[64:79], a[56:59], a[136:139], v[64:79]
ds_read_b64_tr_b16 a[40:41], v10 offset:39936
ds_read_b64_tr_b16 a[42:43], v10 offset:43520
v_mfma_f32_32x32x16_bf16 v[80:95], a[60:63], a[136:139], v[80:95]
ds_read_b64_tr_b16 a[44:45], v10 offset:39968
ds_read_b64_tr_b16 a[46:47], v10 offset:43552
v_mfma_f32_32x32x16_bf16 v[96:111], a[64:67], a[136:139], v[96:111]
ds_read_b64_tr_b16 a[48:49], v10 offset:40000
ds_read_b64_tr_b16 a[50:51], v10 offset:43584
v_mfma_f32_32x32x16_bf16 v[112:127], a[68:71], a[136:139], v[112:127]
ds_read_b64_tr_b16 a[52:53], v10 offset:40032
ds_read_b64_tr_b16 a[54:55], v10 offset:43616
v_mfma_f32_32x32x16_bf16 v[128:143], a[72:75], a[136:139], v[128:143]
ds_read_b64_tr_b16 a[56:57], v10 offset:40064
ds_read_b64_tr_b16 a[58:59], v10 offset:43648
v_mfma_f32_32x32x16_bf16 v[144:159], a[76:79], a[136:139], v[144:159]
ds_read_b64_tr_b16 a[60:61], v10 offset:40096
ds_read_b64_tr_b16 a[62:63], v10 offset:43680
v_mfma_f32_32x32x16_bf16 v[160:175], a[80:83], a[136:139], v[160:175]
ds_read_b64_tr_b16 a[64:65], v10 offset:40128
ds_read_b64_tr_b16 a[66:67], v10 offset:43712
v_mfma_f32_32x32x16_bf16 v[64:79], a[84:87], a[140:143], v[64:79]
ds_read_b64_tr_b16 a[68:69], v10 offset:41728
ds_read_b64_tr_b16 a[70:71], v10 offset:45312
v_mfma_f32_32x32x16_bf16 v[80:95], a[88:91], a[140:143], v[80:95]
ds_read_b64_tr_b16 a[72:73], v10 offset:41760
ds_read_b64_tr_b16 a[74:75], v10 offset:45344
s_waitcnt vmcnt(28)
v_accvgpr_read_b32 v36, a144
v_accvgpr_read_b32 v37, a148
v_accvgpr_read_b32 v38, a152
v_mfma_f32_32x32x16_bf16 v[96:111], a[92:95], a[140:143], v[96:111]
ds_read_b64_tr_b16 a[76:77], v10 offset:41792
ds_read_b64_tr_b16 a[78:79], v10 offset:45376
v_or3_b32 v36, v36, v37, v38
v_accvgpr_read_b32 v37, a156
v_bitop3_b32 v36, v36, v37, 1 bitop3:0xa8
v_mfma_f32_32x32x16_bf16 v[112:127], a[96:99], a[140:143], v[112:127]
ds_read_b64_tr_b16 a[80:81], v10 offset:41824
ds_read_b64_tr_b16 a[82:83], v10 offset:45408
v_cmp_ne_u32 vcc, 0, v36
v_mfma_f32_32x32x16_bf16 v[128:143], a[100:103], a[140:143], v[128:143]
ds_read_b64_tr_b16 a[84:85], v10 offset:41856
ds_read_b64_tr_b16 a[86:87], v10 offset:45440
s_cbranch_vccnz RT2_1
RT2_1_B:
v_mfma_f32_32x32x16_bf16 v[144:159], a[104:107], a[140:143], v[144:159]
ds_read_b64_tr_b16 a[88:89], v10 offset:41888
ds_read_b64_tr_b16 a[90:91], v10 offset:45472
v_mfma_f32_32x32x16_bf16 v[160:175], a[108:111], a[140:143], v[160:175]
ds_read_b64_tr_b16 a[92:93], v10 offset:41920
ds_read_b64_tr_b16 a[94:95], v10 offset:45504
s_waitcnt lgkmcnt(4)
v_mfma_f32_32x32x16_bf16 v[64:79], a[112:115], a[144:147], v[64:79]
ds_read_b64_tr_b16 a[96:97], v9 offset:32768
ds_read_b64_tr_b16 a[98:99], v9 offset:36352
v_mfma_f32_32x32x16_bf16 v[80:95], a[116:119], a[144:147], v[80:95]
ds_read_b64_tr_b16 a[100:101], v9 offset:32800
ds_read_b64_tr_b16 a[102:103], v9 offset:36384
v_mfma_f32_32x32x16_bf16 v[96:111], a[120:123], a[144:147], v[96:111]
s_waitcnt lgkmcnt(4)
s_barrier
ds_read_b64_tr_b16 a[104:105], v9 offset:32832
ds_read_b64_tr_b16 a[106:107], v9 offset:36416
v_mfma_f32_32x32x16_bf16 v[112:127], a[124:127], a[144:147], v[112:127]
s_mov_b32 s29, 1376256
ds_read_b64_tr_b16 a[108:109], v9 offset:32864
ds_read_b64_tr_b16 a[110:111], v9 offset:36448
v_mfma_f32_32x32x16_bf16 v[128:143], a[0:3], a[144:147], v[128:143]
s_add_u32 m0, s34, 98304
ds_read_b64_tr_b16 a[112:113], v9 offset:32896
ds_read_b64_tr_b16 a[114:115], v9 offset:36480
v_mfma_f32_32x32x16_bf16 v[144:159], a[4:7], a[144:147], v[144:159]
buffer_load_dwordx4 v56, s[44:47], s29 offen lds
ds_read_b64_tr_b16 a[116:117], v9 offset:32928
ds_read_b64_tr_b16 a[118:119], v9 offset:36512
v_mfma_f32_32x32x16_bf16 v[160:175], a[8:11], a[144:147], v[160:175]
ds_read_b64_tr_b16 a[120:121], v9 offset:32960
ds_read_b64_tr_b16 a[122:123], v9 offset:36544
v_mfma_f32_32x32x16_bf16 v[64:79], a[12:15], a[148:151], v[64:79]
buffer_load_dwordx4 v57, s[44:47], s29 offen offset:1024 lds
ds_read_b64_tr_b16 a[124:125], v9 offset:34560
ds_read_b64_tr_b16 a[126:127], v9 offset:38144
v_mfma_f32_32x32x16_bf16 v[80:95], a[16:19], a[148:151], v[80:95]
ds_read_b64_tr_b16 a[0:1], v9 offset:34592
ds_read_b64_tr_b16 a[2:3], v9 offset:38176
v_mfma_f32_32x32x16_bf16 v[96:111], a[20:23], a[148:151], v[96:111]
buffer_load_dwordx4 v58, s[44:47], s29 offen offset:2048 lds
ds_read_b64_tr_b16 a[4:5], v9 offset:34624
ds_read_b64_tr_b16 a[6:7], v9 offset:38208
v_mfma_f32_32x32x16_bf16 v[112:127], a[24:27], a[148:151], v[112:127]
ds_read_b64_tr_b16 a[8:9], v9 offset:34656
ds_read_b64_tr_b16 a[10:11], v9 offset:38240
v_mfma_f32_32x32x16_bf16 v[128:143], a[28:31], a[148:151], v[128:143]
buffer_load_dwordx4 v59, s[44:47], s29 offen offset:3072 lds
ds_read_b64_tr_b16 a[12:13], v9 offset:34688
ds_read_b64_tr_b16 a[14:15], v9 offset:38272
v_mfma_f32_32x32x16_bf16 v[144:159], a[32:35], a[148:151], v[144:159]
s_add_u32 m0, s34, 102400
ds_read_b64_tr_b16 a[16:17], v9 offset:34720
ds_read_b64_tr_b16 a[18:19], v9 offset:38304
v_mfma_f32_32x32x16_bf16 v[160:175], a[36:39], a[148:151], v[160:175]
buffer_load_dwordx4 v60, s[44:47], s29 offen lds
ds_read_b64_tr_b16 a[20:21], v9 offset:34752
ds_read_b64_tr_b16 a[22:23], v9 offset:38336
v_mfma_f32_32x32x16_bf16 v[64:79], a[40:43], a[152:155], v[64:79]
ds_read_b64_tr_b16 a[24:25], v9 offset:39936
ds_read_b64_tr_b16 a[26:27], v9 offset:43520
v_mfma_f32_32x32x16_bf16 v[80:95], a[44:47], a[152:155], v[80:95]
buffer_load_dwordx4 v61, s[44:47], s29 offen offset:1024 lds
ds_read_b64_tr_b16 a[28:29], v9 offset:39968
ds_read_b64_tr_b16 a[30:31], v9 offset:43552
v_mfma_f32_32x32x16_bf16 v[96:111], a[48:51], a[152:155], v[96:111]
ds_read_b64_tr_b16 a[32:33], v9 offset:40000
ds_read_b64_tr_b16 a[34:35], v9 offset:43584
v_mfma_f32_32x32x16_bf16 v[112:127], a[52:55], a[152:155], v[112:127]
buffer_load_dwordx4 v62, s[44:47], s29 offen offset:2048 lds
ds_read_b64_tr_b16 a[36:37], v9 offset:40032
ds_read_b64_tr_b16 a[38:39], v9 offset:43616
v_mfma_f32_32x32x16_bf16 v[128:143], a[56:59], a[152:155], v[128:143]
ds_read_b64_tr_b16 a[40:41], v9 offset:40064
ds_read_b64_tr_b16 a[42:43], v9 offset:43648
s_and_b32 s64, s93, 1
v_mfma_f32_32x32x16_bf16 v[144:159], a[60:63], a[152:155], v[144:159]
ds_read_b64_tr_b16 a[44:45], v9 offset:40096
ds_read_b64_tr_b16 a[46:47], v9 offset:43680
s_lshl_b32 s64, s64, 1
v_mfma_f32_32x32x16_bf16 v[160:175], a[64:67], a[152:155], v[160:175]
ds_read_b64_tr_b16 a[48:49], v9 offset:40128
ds_read_b64_tr_b16 a[50:51], v9 offset:43712
s_lshl2_add_u32 s64, s92, s64
s_lshr_b32 s65, s56, 1
v_mfma_f32_32x32x16_bf16 v[64:79], a[68:71], a[156:159], v[64:79]
ds_read_b64_tr_b16 a[52:53], v9 offset:41728
ds_read_b64_tr_b16 a[54:55], v9 offset:45312
s_add_u32 s64, s64, s65
v_mfma_f32_32x32x16_bf16 v[80:95], a[72:75], a[156:159], v[80:95]
ds_read_b64_tr_b16 a[56:57], v9 offset:41760
ds_read_b64_tr_b16 a[58:59], v9 offset:45344
s_mul_i32 s32, s56, 256
s_waitcnt vmcnt(31)
v_accvgpr_read_b32 v36, a160
v_accvgpr_read_b32 v37, a164
v_accvgpr_read_b32 v38, a168
v_mfma_f32_32x32x16_bf16 v[96:111], a[76:79], a[156:159], v[96:111]
ds_read_b64_tr_b16 a[60:61], v9 offset:41792
ds_read_b64_tr_b16 a[62:63], v9 offset:45376
s_add_u32 s32, s32, s64
v_or3_b32 v36, v36, v37, v38
v_accvgpr_read_b32 v37, a172
v_bitop3_b32 v36, v36, v37, 1 bitop3:0xa8
v_mfma_f32_32x32x16_bf16 v[112:127], a[80:83], a[156:159], v[112:127]
ds_read_b64_tr_b16 a[64:65], v9 offset:41824
ds_read_b64_tr_b16 a[66:67], v9 offset:45408
s_lshl_b32 s32, s32, 12
s_add_u32 s65, s93, 2
v_cmp_ne_u32 vcc, 0, v36
v_mfma_f32_32x32x16_bf16 v[128:143], a[84:87], a[156:159], v[128:143]
ds_read_b64_tr_b16 a[68:69], v9 offset:41856
ds_read_b64_tr_b16 a[70:71], v9 offset:45440
s_lshr_b32 s65, s65, 4
s_cbranch_vccnz RT2_2
RT2_2_B:
v_mfma_f32_32x32x16_bf16 v[144:159], a[88:91], a[156:159], v[144:159]
ds_read_b64_tr_b16 a[72:73], v9 offset:41888
ds_read_b64_tr_b16 a[74:75], v9 offset:45472
s_lshl_b32 s65, s65, 30
v_mfma_f32_32x32x16_bf16 v[160:175], a[92:95], a[156:159], v[160:175]
ds_read_b64_tr_b16 a[76:77], v9 offset:41920
ds_read_b64_tr_b16 a[78:79], v9 offset:45504
s_add_u32 s32, s32, s65
s_waitcnt lgkmcnt(4)
v_mfma_f32_32x32x16_bf16 v[64:79], a[96:99], a[160:163], v[64:79]
ds_read_b64_tr_b16 a[80:81], v9 offset:0
ds_read_b64_tr_b16 a[82:83], v9 offset:3584
s_add_u32 s32, s32, 16777216
s_xor_b32 s33, s32, 4096
v_mfma_f32_32x32x16_bf16 v[80:95], a[100:103], a[160:163], v[80:95]
ds_read_b64_tr_b16 a[84:85], v9 offset:32
ds_read_b64_tr_b16 a[86:87], v9 offset:3616
s_add_u32 s68, s32, 4194304
v_mfma_f32_32x32x16_bf16 v[96:111], a[104:107], a[160:163], v[96:111]
s_waitcnt lgkmcnt(4)
s_barrier
ds_read_b64_tr_b16 a[88:89], v9 offset:64
ds_read_b64_tr_b16 a[90:91], v9 offset:3648
v_mfma_f32_32x32x16_bf16 v[112:127], a[108:111], a[160:163], v[112:127]
s_mov_b32 s29, 28672
ds_read_b64_tr_b16 a[92:93], v9 offset:96
ds_read_b64_tr_b16 a[94:95], v9 offset:3680
v_mfma_f32_32x32x16_bf16 v[128:143], a[112:115], a[160:163], v[128:143]
s_add_u32 m0, s24, 32768
ds_read_b64_tr_b16 a[96:97], v9 offset:128
ds_read_b64_tr_b16 a[98:99], v9 offset:3712
v_mfma_f32_32x32x16_bf16 v[144:159], a[116:119], a[160:163], v[144:159]
buffer_load_dwordx4 v8, s[12:15], s29 offen lds
ds_read_b64_tr_b16 a[100:101], v9 offset:160
ds_read_b64_tr_b16 a[102:103], v9 offset:3744
s_add_u32 s69, s33, 4194304
v_mfma_f32_32x32x16_bf16 v[160:175], a[120:123], a[160:163], v[160:175]
ds_read_b64_tr_b16 a[104:105], v9 offset:192
ds_read_b64_tr_b16 a[106:107], v9 offset:3776
s_and_b32 s65, s93, 14
v_mfma_f32_32x32x16_bf16 v[64:79], a[124:127], a[164:167], v[64:79]
buffer_load_dwordx4 v19, s[12:15], s29 offen offset:1024 lds
ds_read_b64_tr_b16 a[108:109], v9 offset:1792
ds_read_b64_tr_b16 a[110:111], v9 offset:5376
v_mfma_f32_32x32x16_bf16 v[80:95], a[0:3], a[164:167], v[80:95]
ds_read_b64_tr_b16 a[112:113], v9 offset:1824
ds_read_b64_tr_b16 a[114:115], v9 offset:5408
s_and_b32 s66, s56, 1
v_mfma_f32_32x32x16_bf16 v[96:111], a[4:7], a[164:167], v[96:111]
buffer_load_dwordx4 v23, s[12:15], s29 offen offset:2048 lds
ds_read_b64_tr_b16 a[116:117], v9 offset:1856
ds_read_b64_tr_b16 a[118:119], v9 offset:5440
s_add_u32 s65, s65, s66
v_mfma_f32_32x32x16_bf16 v[112:127], a[8:11], a[164:167], v[112:127]
ds_read_b64_tr_b16 a[120:121], v9 offset:1888
ds_read_b64_tr_b16 a[122:123], v9 offset:5472
s_mul_i32 s27, s64, 57344
v_mfma_f32_32x32x16_bf16 v[128:143], a[12:15], a[164:167], v[128:143]
buffer_load_dwordx4 v25, s[12:15], s29 offen offset:3072 lds
s_mov_b32 s29, 229376
ds_read_b64_tr_b16 a[124:125], v9 offset:1920
ds_read_b64_tr_b16 a[126:127], v9 offset:5504
v_mfma_f32_32x32x16_bf16 v[144:159], a[16:19], a[164:167], v[144:159]
s_add_u32 m0, s24, 36864
ds_read_b64_tr_b16 a[0:1], v9 offset:1952
ds_read_b64_tr_b16 a[2:3], v9 offset:5536
v_mfma_f32_32x32x16_bf16 v[160:175], a[20:23], a[164:167], v[160:175]
buffer_load_dwordx4 v8, s[12:15], s29 offen lds
ds_read_b64_tr_b16 a[4:5], v9 offset:1984
ds_read_b64_tr_b16 a[6:7], v9 offset:5568
v_mfma_f32_32x32x16_bf16 v[64:79], a[24:27], a[168:171], v[64:79]
ds_read_b64_tr_b16 a[8:9], v9 offset:7168
ds_read_b64_tr_b16 a[10:11], v9 offset:10752
s_lshl_b32 s66, s65, 12
s_add_u32 s27, s27, s66
v_mfma_f32_32x32x16_bf16 v[80:95], a[28:31], a[168:171], v[80:95]
buffer_load_dwordx4 v19, s[12:15], s29 offen offset:1024 lds
ds_read_b64_tr_b16 a[12:13], v9 offset:7200
ds_read_b64_tr_b16 a[14:15], v9 offset:10784
v_mfma_f32_32x32x16_bf16 v[96:111], a[32:35], a[168:171], v[96:111]
ds_read_b64_tr_b16 a[16:17], v9 offset:7232
ds_read_b64_tr_b16 a[18:19], v9 offset:10816
s_add_u32 s27, s27, 4194304
v_mfma_f32_32x32x16_bf16 v[112:127], a[36:39], a[168:171], v[112:127]
buffer_load_dwordx4 v23, s[12:15], s29 offen offset:2048 lds
ds_read_b64_tr_b16 a[20:21], v9 offset:7264
ds_read_b64_tr_b16 a[22:23], v9 offset:10848
v_mfma_f32_32x32x16_bf16 v[128:143], a[40:43], a[168:171], v[128:143]
ds_read_b64_tr_b16 a[24:25], v9 offset:7296
ds_read_b64_tr_b16 a[26:27], v9 offset:10880
s_mul_i32 s28, s64, 28672
s_lshl_b32 s66, s65, 6
v_mfma_f32_32x32x16_bf16 v[144:159], a[44:47], a[168:171], v[144:159]
buffer_load_dwordx4 v25, s[12:15], s29 offen offset:3072 lds
ds_read_b64_tr_b16 a[28:29], v9 offset:7328
ds_read_b64_tr_b16 a[30:31], v9 offset:10912
v_mfma_f32_32x32x16_bf16 v[160:175], a[48:51], a[168:171], v[160:175]
ds_read_b64_tr_b16 a[32:33], v9 offset:7360
ds_read_b64_tr_b16 a[34:35], v9 offset:10944
s_add_u32 s28, s28, s66
v_mfma_f32_32x32x16_bf16 v[64:79], a[52:55], a[172:175], v[64:79]
ds_read_b64_tr_b16 a[36:37], v9 offset:8960
ds_read_b64_tr_b16 a[38:39], v9 offset:12544
s_lshl_b32 s67, s65, 7
v_mfma_f32_32x32x16_bf16 v[80:95], a[56:59], a[172:175], v[80:95]
ds_read_b64_tr_b16 a[40:41], v9 offset:8992
ds_read_b64_tr_b16 a[42:43], v9 offset:12576
s_add_u32 s67, s67, 9472
v_add_u32 v33, 262144, v31
s_waitcnt vmcnt(35)
v_accvgpr_read_b32 v36, a176
v_accvgpr_read_b32 v37, a180
v_accvgpr_read_b32 v38, a184
v_mfma_f32_32x32x16_bf16 v[96:111], a[60:63], a[172:175], v[96:111]
ds_read_b64_tr_b16 a[44:45], v9 offset:9024
ds_read_b64_tr_b16 a[46:47], v9 offset:12608
v_add_u32 v34, 524288, v31
v_or3_b32 v36, v36, v37, v38
v_accvgpr_read_b32 v37, a188
v_bitop3_b32 v36, v36, v37, 1 bitop3:0xa8
v_mfma_f32_32x32x16_bf16 v[112:127], a[64:67], a[172:175], v[112:127]
ds_read_b64_tr_b16 a[48:49], v9 offset:9056
ds_read_b64_tr_b16 a[50:51], v9 offset:12640
v_add_u32 v35, 786432, v31
v_cmp_ne_u32 vcc, 0, v36
v_mfma_f32_32x32x16_bf16 v[128:143], a[68:71], a[172:175], v[128:143]
ds_read_b64_tr_b16 a[52:53], v9 offset:9088
ds_read_b64_tr_b16 a[54:55], v9 offset:12672
v_add_u32 v3, s24, v31
s_cbranch_vccnz RT2_3
RT2_3_B:
v_mfma_f32_32x32x16_bf16 v[144:159], a[72:75], a[172:175], v[144:159]
ds_read_b64_tr_b16 a[56:57], v9 offset:9120
ds_read_b64_tr_b16 a[58:59], v9 offset:12704
v_add_u32 v3, 0x10000, v3
v_xor_b32 v4, 8192, v3
v_mfma_f32_32x32x16_bf16 v[160:175], a[76:79], a[172:175], v[160:175]
ds_read_b64_tr_b16 a[60:61], v9 offset:9152
ds_read_b64_tr_b16 a[62:63], v9 offset:12736
v_xor_b32 v18, 16384, v3
s_waitcnt lgkmcnt(4)
v_mfma_f32_32x32x16_bf16 v[64:79], a[80:83], a[176:179], v[64:79]
ds_read_b64_tr_b16 a[64:65], v10 offset:0
ds_read_b64_tr_b16 a[66:67], v10 offset:3584
v_xor_b32 v20, 24576, v3
v_mfma_f32_32x32x16_bf16 v[80:95], a[84:87], a[176:179], v[80:95]
ds_read_b64_tr_b16 a[68:69], v10 offset:1792
ds_read_b64_tr_b16 a[70:71], v10 offset:5376
v_mfma_f32_32x32x16_bf16 v[96:111], a[88:91], a[176:179], v[96:111]
s_waitcnt vmcnt(15) lgkmcnt(4)
s_barrier
ds_read_b64_tr_b16 a[72:73], v10 offset:7168
ds_read_b64_tr_b16 a[74:75], v10 offset:10752
v_mfma_f32_32x32x16_bf16 v[112:127], a[92:95], a[176:179], v[112:127]
s_mov_b32 s29, 43008
ds_read_b64_tr_b16 a[76:77], v10 offset:8960
ds_read_b64_tr_b16 a[78:79], v10 offset:12544
v_mfma_f32_32x32x16_bf16 v[128:143], a[96:99], a[176:179], v[128:143]
s_add_u32 m0, s24, 0
ds_read_b64_tr_b16 a[80:81], v11 offset:0
ds_read_b64_tr_b16 a[82:83], v11 offset:3584
v_mfma_f32_32x32x16_bf16 v[144:159], a[100:103], a[176:179], v[144:159]
buffer_load_dwordx4 v8, s[12:15], s29 offen lds
ds_read_b64_tr_b16 a[84:85], v11 offset:1792
ds_read_b64_tr_b16 a[86:87], v11 offset:5376
v_mfma_f32_32x32x16_bf16 v[160:175], a[104:107], a[176:179], v[160:175]
ds_read_b64_tr_b16 a[88:89], v11 offset:7168
ds_read_b64_tr_b16 a[90:91], v11 offset:10752
v_mfma_f32_32x32x16_bf16 v[64:79], a[108:111], a[180:183], v[64:79]
buffer_load_dwordx4 v19, s[12:15], s29 offen offset:1024 lds
ds_read_b64_tr_b16 a[92:93], v11 offset:8960
ds_read_b64_tr_b16 a[94:95], v11 offset:12544
v_mfma_f32_32x32x16_bf16 v[80:95], a[112:115], a[180:183], v[80:95]
s_waitcnt vmcnt(10)
s_barrier
ds_read_b64_tr_b16 a[96:97], v10 offset:32768
ds_read_b64_tr_b16 a[98:99], v10 offset:36352
v_mfma_f32_32x32x16_bf16 v[96:111], a[116:119], a[180:183], v[96:111]
buffer_load_dwordx4 v23, s[12:15], s29 offen offset:2048 lds
ds_read_b64_tr_b16 a[100:101], v10 offset:34560
ds_read_b64_tr_b16 a[102:103], v10 offset:38144
v_mfma_f32_32x32x16_bf16 v[112:127], a[120:123], a[180:183], v[112:127]
ds_read_b64_tr_b16 a[104:105], v10 offset:39936
ds_read_b64_tr_b16 a[106:107], v10 offset:43520
v_accvgpr_read_b32 v36, a192
v_accvgpr_read_b32 v37, a196
v_accvgpr_read_b32 v38, a200
v_mfma_f32_32x32x16_bf16 v[128:143], a[124:127], a[180:183], v[128:143]
buffer_load_dwordx4 v25, s[12:15], s29 offen offset:3072 lds
s_mov_b32 s29, 243712
ds_read_b64_tr_b16 a[108:109], v10 offset:41728
ds_read_b64_tr_b16 a[110:111], v10 offset:45312
v_or3_b32 v36, v36, v37, v38
v_accvgpr_read_b32 v37, a204
v_bitop3_b32 v36, v36, v37, 1 bitop3:0xa8
v_mfma_f32_32x32x16_bf16 v[144:159], a[0:3], a[180:183], v[144:159]
s_add_u32 m0, s24, 4096
ds_read_b64_tr_b16 a[112:113], v10 offset:32
ds_read_b64_tr_b16 a[114:115], v10 offset:3616
v_cmp_ne_u32 vcc, 0, v36
v_mfma_f32_32x32x16_bf16 v[160:175], a[4:7], a[180:183], v[160:175]
buffer_load_dwordx4 v8, s[12:15], s29 offen lds
ds_read_b64_tr_b16 a[116:117], v10 offset:1824
ds_read_b64_tr_b16 a[118:119], v10 offset:5408
s_cbranch_vccnz RT2_4
RT2_4_B:
v_mfma_f32_32x32x16_bf16 v[64:79], a[8:11], a[184:187], v[64:79]
ds_read_b64_tr_b16 a[120:121], v10 offset:7200
ds_read_b64_tr_b16 a[122:123], v10 offset:10784
v_mfma_f32_32x32x16_bf16 v[80:95], a[12:15], a[184:187], v[80:95]
buffer_load_dwordx4 v19, s[12:15], s29 offen offset:1024 lds
ds_read_b64_tr_b16 a[124:125], v10 offset:8992
ds_read_b64_tr_b16 a[126:127], v10 offset:12576
v_mfma_f32_32x32x16_bf16 v[96:111], a[16:19], a[184:187], v[96:111]
s_waitcnt vmcnt(6)
ds_read_b64_tr_b16 a[240:241], v12 offset:32768
ds_read_b64_tr_b16 a[242:243], v12 offset:33792
ds_read_b64_tr_b16 a[0:1], v11 offset:32
ds_read_b64_tr_b16 a[2:3], v11 offset:3616
v_accvgpr_read_b32 v36, a208
v_accvgpr_read_b32 v37, a212
v_accvgpr_read_b32 v38, a216
v_mfma_f32_32x32x16_bf16 v[112:127], a[20:23], a[184:187], v[112:127]
buffer_load_dwordx4 v23, s[12:15], s29 offen offset:2048 lds
ds_read_b64_tr_b16 a[244:245], v13 offset:32768
ds_read_b64_tr_b16 a[246:247], v13 offset:33792
ds_read_b64_tr_b16 a[4:5], v11 offset:1824
ds_read_b64_tr_b16 a[6:7], v11 offset:5408
v_or3_b32 v36, v36, v37, v38
v_accvgpr_read_b32 v37, a220
v_bitop3_b32 v36, v36, v37, 1 bitop3:0xa8
v_mfma_f32_32x32x16_bf16 v[128:143], a[24:27], a[184:187], v[128:143]
ds_read_b64_tr_b16 a[248:249], v12 offset:34816
ds_read_b64_tr_b16 a[250:251], v12 offset:35840
ds_read_b64_tr_b16 a[8:9], v11 offset:7200
ds_read_b64_tr_b16 a[10:11], v11 offset:10784
v_cmp_ne_u32 vcc, 0, v36
v_mfma_f32_32x32x16_bf16 v[144:159], a[28:31], a[184:187], v[144:159]
buffer_load_dwordx4 v25, s[12:15], s29 offen offset:3072 lds
ds_read_b64_tr_b16 a[252:253], v13 offset:34816
ds_read_b64_tr_b16 a[254:255], v13 offset:35840
ds_read_b64_tr_b16 a[12:13], v11 offset:8992
ds_read_b64_tr_b16 a[14:15], v11 offset:12576
s_cbranch_vccnz RT2_5
RT2_5_B:
v_mfma_f32_32x32x16_bf16 v[160:175], a[32:35], a[184:187], v[160:175]
ds_read_b64_tr_b16 v[188:189], v12 offset:36864
ds_read_b64_tr_b16 v[190:191], v12 offset:37888
ds_read_b64_tr_b16 a[16:17], v10 offset:32800
ds_read_b64_tr_b16 a[18:19], v10 offset:36384
v_mfma_f32_32x32x16_bf16 v[64:79], a[36:39], a[188:191], v[64:79]
ds_read_b64_tr_b16 v[48:49], v13 offset:36864
ds_read_b64_tr_b16 v[50:51], v13 offset:37888
ds_read_b64_tr_b16 a[20:21], v10 offset:34592
ds_read_b64_tr_b16 a[22:23], v10 offset:38176
v_mfma_f32_32x32x16_bf16 v[80:95], a[40:43], a[188:191], v[80:95]
ds_read_b64_tr_b16 v[52:53], v12 offset:38912
ds_read_b64_tr_b16 v[54:55], v12 offset:39936
ds_read_b64_tr_b16 a[24:25], v10 offset:39968
ds_read_b64_tr_b16 a[26:27], v10 offset:43552
v_accvgpr_read_b32 v36, a224
v_accvgpr_read_b32 v37, a228
v_accvgpr_read_b32 v38, a232
v_mfma_f32_32x32x16_bf16 v[96:111], a[44:47], a[188:191], v[96:111]
ds_read_b64_tr_b16 v[56:57], v13 offset:38912
ds_read_b64_tr_b16 v[58:59], v13 offset:39936
ds_read_b64_tr_b16 a[28:29], v10 offset:41760
ds_read_b64_tr_b16 a[30:31], v10 offset:45344
v_or3_b32 v36, v36, v37, v38
v_accvgpr_read_b32 v37, a236
v_bitop3_b32 v36, v36, v37, 1 bitop3:0xa8
v_mfma_f32_32x32x16_bf16 v[112:127], a[48:51], a[188:191], v[112:127]
ds_read_b64_tr_b16 a[32:33], v10 offset:64
ds_read_b64_tr_b16 a[34:35], v10 offset:3648
v_cmp_ne_u32 vcc, 0, v36
v_mfma_f32_32x32x16_bf16 v[128:143], a[52:55], a[188:191], v[128:143]
ds_read_b64_tr_b16 a[36:37], v10 offset:1856
ds_read_b64_tr_b16 a[38:39], v10 offset:5440
s_cbranch_vccnz RT2_6
RT2_6_B:
v_mfma_f32_32x32x16_bf16 v[144:159], a[56:59], a[188:191], v[144:159]
s_mov_b32 s29, 57344
ds_read_b64_tr_b16 a[40:41], v10 offset:7232
ds_read_b64_tr_b16 a[42:43], v10 offset:10816
v_mfma_f32_32x32x16_bf16 v[160:175], a[60:63], a[188:191], v[160:175]
s_add_u32 m0, s24, 32768
ds_read_b64_tr_b16 a[44:45], v10 offset:9024
ds_read_b64_tr_b16 a[46:47], v10 offset:12608
s_waitcnt lgkmcnt(4)
v_mfma_f32_32x32x16_bf16 v[64:79], a[64:67], a[192:195], v[64:79]
buffer_load_dwordx4 v8, s[12:15], s29 offen lds
ds_read_b64_tr_b16 a[48:49], v11 offset:64
ds_read_b64_tr_b16 a[50:51], v11 offset:3648
v_mfma_f32_32x32x16_bf16 v[64:79], a[68:71], a[196:199], v[64:79]
ds_read_b64_tr_b16 a[52:53], v11 offset:1856
ds_read_b64_tr_b16 a[54:55], v11 offset:5440
v_mfma_f32_32x32x16_bf16 v[64:79], a[72:75], a[200:203], v[64:79]
buffer_load_dwordx4 v19, s[12:15], s29 offen offset:1024 lds
ds_read_b64_tr_b16 a[56:57], v11 offset:7232
ds_read_b64_tr_b16 a[58:59], v11 offset:10816
v_mfma_f32_32x32x16_bf16 v[64:79], a[76:79], a[204:207], v[64:79]
ds_read_b64_tr_b16 a[60:61], v11 offset:9024
ds_read_b64_tr_b16 a[62:63], v11 offset:12608
v_mfma_f32_32x32x16_bf16 v[64:79], a[80:83], a[208:211], v[64:79]
buffer_load_dwordx4 v23, s[12:15], s29 offen offset:2048 lds
ds_read_b64_tr_b16 a[64:65], v10 offset:32832
ds_read_b64_tr_b16 a[66:67], v10 offset:36416
v_mfma_f32_32x32x16_bf16 v[64:79], a[84:87], a[212:215], v[64:79]
ds_read_b64_tr_b16 a[68:69], v10 offset:34624
ds_read_b64_tr_b16 a[70:71], v10 offset:38208
v_mfma_f32_32x32x16_bf16 v[64:79], a[88:91], a[216:219], v[64:79]
buffer_load_dwordx4 v25, s[12:15], s29 offen offset:3072 lds
s_mov_b32 s29, 258048
ds_read_b64_tr_b16 a[72:73], v10 offset:40000
ds_read_b64_tr_b16 a[74:75], v10 offset:43584
v_mfma_f32_32x32x16_bf16 v[64:79], a[92:95], a[220:223], v[64:79]
s_add_u32 m0, s24, 36864
ds_read_b64_tr_b16 a[76:77], v10 offset:41792
ds_read_b64_tr_b16 a[78:79], v10 offset:45376
v_mfma_f32_32x32x16_bf16 v[64:79], a[96:99], a[224:227], v[64:79]
buffer_load_dwordx4 v8, s[12:15], s29 offen lds
s_waitcnt vmcnt(5)
ds_read_b64_tr_b16 a[128:129], v12 offset:0
ds_read_b64_tr_b16 a[130:131], v12 offset:1024
ds_read_b64_tr_b16 a[80:81], v10 offset:96
ds_read_b64_tr_b16 a[82:83], v10 offset:3680
v_mfma_f32_32x32x16_bf16 v[64:79], a[100:103], a[228:231], v[64:79]
ds_read_b64_tr_b16 a[132:133], v13 offset:0
ds_read_b64_tr_b16 a[134:135], v13 offset:1024
ds_read_b64_tr_b16 a[84:85], v10 offset:1888
ds_read_b64_tr_b16 a[86:87], v10 offset:5472
v_mfma_f32_32x32x16_bf16 v[64:79], a[104:107], a[232:235], v[64:79]
buffer_load_dwordx4 v19, s[12:15], s29 offen offset:1024 lds
ds_read_b64_tr_b16 a[136:137], v12 offset:2048
ds_read_b64_tr_b16 a[138:139], v12 offset:3072
ds_read_b64_tr_b16 a[88:89], v10 offset:7264
ds_read_b64_tr_b16 a[90:91], v10 offset:10848
v_mfma_f32_32x32x16_bf16 v[64:79], a[108:111], a[236:239], v[64:79]
ds_read_b64_tr_b16 a[140:141], v13 offset:2048
ds_read_b64_tr_b16 a[142:143], v13 offset:3072
ds_read_b64_tr_b16 a[92:93], v10 offset:9056
ds_read_b64_tr_b16 a[94:95], v10 offset:12640
v_mfma_f32_32x32x16_bf16 v[80:95], a[112:115], a[192:195], v[80:95]
buffer_load_dwordx4 v23, s[12:15], s29 offen offset:2048 lds
ds_read_b64_tr_b16 a[144:145], v12 offset:4096
ds_read_b64_tr_b16 a[146:147], v12 offset:5120
ds_read_b64_tr_b16 a[96:97], v11 offset:96
ds_read_b64_tr_b16 a[98:99], v11 offset:3680
v_mfma_f32_32x32x16_bf16 v[80:95], a[116:119], a[196:199], v[80:95]
ds_read_b64_tr_b16 a[148:149], v13 offset:4096
ds_read_b64_tr_b16 a[150:151], v13 offset:5120
ds_read_b64_tr_b16 a[100:101], v11 offset:1888
ds_read_b64_tr_b16 a[102:103], v11 offset:5472
v_mfma_f32_32x32x16_bf16 v[80:95], a[120:123], a[200:203], v[80:95]
buffer_load_dwordx4 v25, s[12:15], s29 offen offset:3072 lds
ds_read_b64_tr_b16 a[152:153], v12 offset:6144
ds_read_b64_tr_b16 a[154:155], v12 offset:7168
ds_read_b64_tr_b16 a[104:105], v11 offset:7264
ds_read_b64_tr_b16 a[106:107], v11 offset:10848
v_mfma_f32_32x32x16_bf16 v[80:95], a[124:127], a[204:207], v[80:95]
ds_read_b64_tr_b16 a[156:157], v13 offset:6144
ds_read_b64_tr_b16 a[158:159], v13 offset:7168
ds_read_b64_tr_b16 a[108:109], v11 offset:9056
ds_read_b64_tr_b16 a[110:111], v11 offset:12640
v_mul_f32 v176, v64, v64
v_mul_f32 v177, v65, v65
v_mul_f32 v178, v66, v66
v_mul_f32 v179, v67, v67
v_fma_f32 v176, v176, s59, v180
v_fma_f32 v177, v177, s59, v180
v_mfma_f32_32x32x16_bf16 v[80:95], a[0:3], a[208:211], v[80:95]
ds_read_b64_tr_b16 a[112:113], v10 offset:32864
ds_read_b64_tr_b16 a[114:115], v10 offset:36448
v_fma_f32 v178, v178, s59, v180
v_fma_f32 v179, v179, s59, v180
v_mul_f32 v176, v176, v64
v_mul_f32 v177, v177, v65
v_mul_f32 v178, v178, v66
v_mul_f32 v179, v179, v67
v_exp_f32 v176, v176
v_mfma_f32_32x32x16_bf16 v[80:95], a[4:7], a[212:215], v[80:95]
ds_read_b64_tr_b16 a[116:117], v10 offset:34656
ds_read_b64_tr_b16 a[118:119], v10 offset:38240
v_mul_f32 v64, v64, v72
v_exp_f32 v177, v177
v_mul_f32 v65, v65, v73
v_exp_f32 v178, v178
v_mul_f32 v66, v66, v74
v_mfma_f32_32x32x16_bf16 v[80:95], a[8:11], a[216:219], v[80:95]
s_mov_b32 s29, 71680
ds_read_b64_tr_b16 a[120:121], v10 offset:40032
ds_read_b64_tr_b16 a[122:123], v10 offset:43616
v_exp_f32 v179, v179
v_mul_f32 v67, v67, v75
v_add_f32 v176, 1.0, v176
v_add_f32 v177, 1.0, v177
v_add_f32 v178, 1.0, v178
v_add_f32 v179, 1.0, v179
v_mfma_f32_32x32x16_bf16 v[80:95], a[12:15], a[220:223], v[80:95]
s_add_u32 m0, s24, 0
ds_read_b64_tr_b16 a[124:125], v10 offset:41824
ds_read_b64_tr_b16 a[126:127], v10 offset:45408
v_rcp_f32 v176, v176
v_rcp_f32 v177, v177
v_rcp_f32 v178, v178
v_mfma_f32_32x32x16_bf16 v[80:95], a[16:19], a[224:227], v[80:95]
s_waitcnt lgkmcnt(10)
buffer_load_dwordx4 v8, s[12:15], s29 offen lds
ds_read_b64_tr_b16 a[0:1], v10 offset:128
ds_read_b64_tr_b16 a[2:3], v10 offset:3712
v_rcp_f32 v179, v179
v_mul_f32 v64, v64, v176
v_mul_f32 v65, v65, v177
v_mul_f32 v66, v66, v178
v_mul_f32 v67, v67, v179
v_cvt_pk_bf16_f32 v40, v64, v65
v_mfma_f32_32x32x16_bf16 v[80:95], a[20:23], a[228:231], v[80:95]
ds_read_b64_tr_b16 a[4:5], v10 offset:1920
ds_read_b64_tr_b16 a[6:7], v10 offset:5504
v_cvt_pk_bf16_f32 v41, v66, v67
v_and_b32 v40, -2, v40
v_mul_f32 v184, v68, v68
v_mul_f32 v185, v69, v69
v_mul_f32 v186, v70, v70
v_mul_f32 v187, v71, v71
v_fma_f32 v184, v184, s59, v180
v_fma_f32 v185, v185, s59, v180
v_mfma_f32_32x32x16_bf16 v[80:95], a[24:27], a[232:235], v[80:95]
buffer_load_dwordx4 v19, s[12:15], s29 offen offset:1024 lds
ds_read_b64_tr_b16 a[8:9], v10 offset:7296
ds_read_b64_tr_b16 a[10:11], v10 offset:10880
v_fma_f32 v186, v186, s59, v180
v_fma_f32 v187, v187, s59, v180
v_mul_f32 v184, v184, v68
v_mul_f32 v185, v185, v69
v_mul_f32 v186, v186, v70
v_mul_f32 v187, v187, v71
v_mfma_f32_32x32x16_bf16 v[80:95], a[28:31], a[236:239], v[80:95]
ds_read_b64_tr_b16 a[12:13], v10 offset:9088
ds_read_b64_tr_b16 a[14:15], v10 offset:12672
v_exp_f32 v184, v184
v_mul_f32 v68, v68, v76
v_exp_f32 v185, v185
v_mul_f32 v69, v69, v77
v_exp_f32 v186, v186
v_mfma_f32_32x32x16_bf16 v[96:111], a[32:35], a[192:195], v[96:111]
buffer_load_dwordx4 v23, s[12:15], s29 offen offset:2048 lds
ds_read_b64_tr_b16 a[16:17], v11 offset:128
ds_read_b64_tr_b16 a[18:19], v11 offset:3712
v_mul_f32 v70, v70, v78
v_exp_f32 v187, v187
v_mul_f32 v71, v71, v79
v_add_f32 v184, 1.0, v184
v_add_f32 v185, 1.0, v185
v_add_f32 v186, 1.0, v186
v_mfma_f32_32x32x16_bf16 v[96:111], a[36:39], a[196:199], v[96:111]
ds_read_b64_tr_b16 a[20:21], v11 offset:1920
ds_read_b64_tr_b16 a[22:23], v11 offset:5504
v_add_f32 v187, 1.0, v187
v_rcp_f32 v184, v184
v_rcp_f32 v185, v185
v_rcp_f32 v186, v186
v_mfma_f32_32x32x16_bf16 v[96:111], a[40:43], a[200:203], v[96:111]
buffer_load_dwordx4 v25, s[12:15], s29 offen offset:3072 lds
s_mov_b32 s29, 272384
ds_read_b64_tr_b16 a[24:25], v11 offset:7296
ds_read_b64_tr_b16 a[26:27], v11 offset:10880
v_rcp_f32 v187, v187
v_mul_f32 v68, v68, v184
v_mul_f32 v69, v69, v185
v_mul_f32 v70, v70, v186
v_mul_f32 v71, v71, v187
v_mfma_f32_32x32x16_bf16 v[96:111], a[44:47], a[204:207], v[96:111]
s_add_u32 m0, s24, 4096
ds_read_b64_tr_b16 a[28:29], v11 offset:9088
ds_read_b64_tr_b16 a[30:31], v11 offset:12672
v_cvt_pk_bf16_f32 v42, v68, v69
v_cvt_pk_bf16_f32 v43, v70, v71
buffer_store_dwordx4 v[40:43], v31, s[20:23], s10 offen sc1
v_mul_f32 v176, v80, v80
v_mul_f32 v177, v81, v81
v_mul_f32 v178, v82, v82
v_mul_f32 v179, v83, v83
v_mfma_f32_32x32x16_bf16 v[96:111], a[48:51], a[208:211], v[96:111]
buffer_load_dwordx4 v8, s[12:15], s29 offen lds
ds_read_b64_tr_b16 a[32:33], v10 offset:32896
ds_read_b64_tr_b16 a[34:35], v10 offset:36480
v_fma_f32 v176, v176, s59, v180
v_fma_f32 v177, v177, s59, v180
v_fma_f32 v178, v178, s59, v180
v_fma_f32 v179, v179, s59, v180
v_mul_f32 v176, v176, v80
v_mul_f32 v177, v177, v81
v_mul_f32 v178, v178, v82
v_mfma_f32_32x32x16_bf16 v[96:111], a[52:55], a[212:215], v[96:111]
ds_read_b64_tr_b16 a[36:37], v10 offset:34688
ds_read_b64_tr_b16 a[38:39], v10 offset:38272
v_mul_f32 v179, v179, v83
v_exp_f32 v176, v176
v_mul_f32 v80, v80, v88
v_exp_f32 v177, v177
v_mul_f32 v81, v81, v89
v_mfma_f32_32x32x16_bf16 v[96:111], a[56:59], a[216:219], v[96:111]
buffer_load_dwordx4 v19, s[12:15], s29 offen offset:1024 lds
ds_read_b64_tr_b16 a[40:41], v10 offset:40064
ds_read_b64_tr_b16 a[42:43], v10 offset:43648
v_exp_f32 v178, v178
v_mul_f32 v82, v82, v90
v_exp_f32 v179, v179
v_mul_f32 v83, v83, v91
v_add_f32 v176, 1.0, v176
v_mfma_f32_32x32x16_bf16 v[96:111], a[60:63], a[220:223], v[96:111]
ds_read_b64_tr_b16 a[44:45], v10 offset:41856
ds_read_b64_tr_b16 a[46:47], v10 offset:45440
v_add_f32 v177, 1.0, v177
v_add_f32 v178, 1.0, v178
v_add_f32 v179, 1.0, v179
v_rcp_f32 v176, v176
v_rcp_f32 v177, v177
v_mfma_f32_32x32x16_bf16 v[96:111], a[64:67], a[224:227], v[96:111]
buffer_load_dwordx4 v23, s[12:15], s29 offen offset:2048 lds
ds_read_b64_tr_b16 a[48:49], v10 offset:160
ds_read_b64_tr_b16 a[50:51], v10 offset:3744
v_rcp_f32 v178, v178
v_rcp_f32 v179, v179
v_mul_f32 v80, v80, v176
v_mul_f32 v81, v81, v177
v_mul_f32 v82, v82, v178
v_mfma_f32_32x32x16_bf16 v[96:111], a[68:71], a[228:231], v[96:111]
ds_read_b64_tr_b16 a[52:53], v10 offset:1952
ds_read_b64_tr_b16 a[54:55], v10 offset:5536
v_mul_f32 v83, v83, v179
v_cvt_pk_bf16_f32 v44, v80, v81
v_cvt_pk_bf16_f32 v45, v82, v83
v_and_b32 v44, -2, v44
v_mul_f32 v184, v84, v84
v_mul_f32 v185, v85, v85
v_mul_f32 v186, v86, v86
v_mul_f32 v187, v87, v87
v_mfma_f32_32x32x16_bf16 v[96:111], a[72:75], a[232:235], v[96:111]
buffer_load_dwordx4 v25, s[12:15], s29 offen offset:3072 lds
ds_read_b64_tr_b16 a[56:57], v10 offset:7328
ds_read_b64_tr_b16 a[58:59], v10 offset:10912
v_fma_f32 v184, v184, s59, v180
v_fma_f32 v185, v185, s59, v180
v_fma_f32 v186, v186, s59, v180
v_fma_f32 v187, v187, s59, v180
v_mul_f32 v184, v184, v84
v_mul_f32 v185, v185, v85
v_mul_f32 v186, v186, v86
v_mfma_f32_32x32x16_bf16 v[96:111], a[76:79], a[236:239], v[96:111]
ds_read_b64_tr_b16 a[60:61], v10 offset:9120
ds_read_b64_tr_b16 a[62:63], v10 offset:12704
v_mul_f32 v187, v187, v87
v_exp_f32 v184, v184
v_mul_f32 v84, v84, v92
v_exp_f32 v185, v185
v_mul_f32 v85, v85, v93
v_mfma_f32_32x32x16_bf16 v[112:127], a[80:83], a[192:195], v[112:127]
ds_read_b64_tr_b16 a[64:65], v11 offset:160
ds_read_b64_tr_b16 a[66:67], v11 offset:3744
v_exp_f32 v186, v186
v_mul_f32 v86, v86, v94
v_exp_f32 v187, v187
v_mul_f32 v87, v87, v95
v_add_f32 v184, 1.0, v184
v_add_f32 v185, 1.0, v185
v_mfma_f32_32x32x16_bf16 v[112:127], a[84:87], a[196:199], v[112:127]
ds_read_b64_tr_b16 a[68:69], v11 offset:1952
ds_read_b64_tr_b16 a[70:71], v11 offset:5536
v_add_f32 v186, 1.0, v186
v_add_f32 v187, 1.0, v187
v_rcp_f32 v184, v184
v_rcp_f32 v185, v185
v_rcp_f32 v186, v186
v_mfma_f32_32x32x16_bf16 v[112:127], a[88:91], a[200:203], v[112:127]
ds_read_b64_tr_b16 a[72:73], v11 offset:7328
ds_read_b64_tr_b16 a[74:75], v11 offset:10912
buffer_load_dword v32, v21, s[20:23], s26 offen sc1
v_rcp_f32 v187, v187
v_mul_f32 v84, v84, v184
v_mul_f32 v85, v85, v185
v_mul_f32 v86, v86, v186
v_mul_f32 v87, v87, v187
v_cvt_pk_bf16_f32 v46, v84, v85
v_mfma_f32_32x32x16_bf16 v[112:127], a[92:95], a[204:207], v[112:127]
ds_read_b64_tr_b16 a[76:77], v11 offset:9120
ds_read_b64_tr_b16 a[78:79], v11 offset:12704
v_cvt_pk_bf16_f32 v47, v86, v87
buffer_store_dwordx4 v[44:47], v31, s[20:23], s10 offen offset:1024 sc1
v_mul_f32 v176, v96, v96
v_mul_f32 v177, v97, v97
v_mul_f32 v178, v98, v98
v_mul_f32 v179, v99, v99
v_fma_f32 v176, v176, s59, v180
v_fma_f32 v177, v177, s59, v180
v_mfma_f32_32x32x16_bf16 v[112:127], a[96:99], a[208:211], v[112:127]
ds_read_b64_tr_b16 a[80:81], v10 offset:32928
ds_read_b64_tr_b16 a[82:83], v10 offset:36512
v_fma_f32 v178, v178, s59, v180
v_fma_f32 v179, v179, s59, v180
v_mul_f32 v176, v176, v96
v_mul_f32 v177, v177, v97
v_mul_f32 v178, v178, v98
v_mul_f32 v179, v179, v99
v_exp_f32 v176, v176
v_mfma_f32_32x32x16_bf16 v[112:127], a[100:103], a[212:215], v[112:127]
ds_read_b64_tr_b16 a[84:85], v10 offset:34720
ds_read_b64_tr_b16 a[86:87], v10 offset:38304
v_mul_f32 v96, v96, v104
v_exp_f32 v177, v177
v_mul_f32 v97, v97, v105
v_exp_f32 v178, v178
v_mul_f32 v98, v98, v106
v_mfma_f32_32x32x16_bf16 v[112:127], a[104:107], a[216:219], v[112:127]
ds_read_b64_tr_b16 a[88:89], v10 offset:40096
ds_read_b64_tr_b16 a[90:91], v10 offset:43680
v_exp_f32 v179, v179
v_mul_f32 v99, v99, v107
v_add_f32 v176, 1.0, v176
v_add_f32 v177, 1.0, v177
v_add_f32 v178, 1.0, v178
v_add_f32 v179, 1.0, v179
s_waitcnt lgkmcnt(4)
v_mfma_f32_32x32x16_bf16 v[112:127], a[108:111], a[220:223], v[112:127]
ds_read_b64_tr_b16 a[92:93], v10 offset:41888
ds_read_b64_tr_b16 a[94:95], v10 offset:45472
v_rcp_f32 v176, v176
v_rcp_f32 v177, v177
v_rcp_f32 v178, v178
v_rcp_f32 v179, v179
v_mfma_f32_32x32x16_bf16 v[112:127], a[112:115], a[224:227], v[112:127]
ds_read_b64_tr_b16 a[96:97], v10 offset:192
ds_read_b64_tr_b16 a[98:99], v10 offset:3776
v_mul_f32 v96, v96, v176
v_mul_f32 v97, v97, v177
v_mul_f32 v98, v98, v178
v_mul_f32 v99, v99, v179
v_cvt_pk_bf16_f32 v40, v96, v97
v_cvt_pk_bf16_f32 v41, v98, v99
v_and_b32 v40, -2, v40
v_mul_f32 v184, v100, v100
v_mfma_f32_32x32x16_bf16 v[112:127], a[116:119], a[228:231], v[112:127]
ds_read_b64_tr_b16 a[100:101], v10 offset:1984
ds_read_b64_tr_b16 a[102:103], v10 offset:5568
v_mul_f32 v185, v101, v101
v_mul_f32 v186, v102, v102
v_mul_f32 v187, v103, v103
v_fma_f32 v184, v184, s59, v180
v_fma_f32 v185, v185, s59, v180
v_fma_f32 v186, v186, s59, v180
v_fma_f32 v187, v187, s59, v180
v_mul_f32 v184, v184, v100
v_mfma_f32_32x32x16_bf16 v[112:127], a[120:123], a[232:235], v[112:127]
ds_read_b64_tr_b16 a[104:105], v10 offset:7360
ds_read_b64_tr_b16 a[106:107], v10 offset:10944
v_mul_f32 v185, v185, v101
v_mul_f32 v186, v186, v102
v_mul_f32 v187, v187, v103
v_exp_f32 v184, v184
v_mul_f32 v100, v100, v108
v_exp_f32 v185, v185
v_mfma_f32_32x32x16_bf16 v[112:127], a[124:127], a[236:239], v[112:127]
ds_read_b64_tr_b16 a[108:109], v10 offset:9152
ds_read_b64_tr_b16 a[110:111], v10 offset:12736
v_mul_f32 v101, v101, v109
v_exp_f32 v186, v186
v_mul_f32 v102, v102, v110
v_exp_f32 v187, v187
v_mul_f32 v103, v103, v111
v_add_f32 v184, 1.0, v184
v_mfma_f32_32x32x16_bf16 v[128:143], a[0:3], a[192:195], v[128:143]
ds_read_b64_tr_b16 a[112:113], v11 offset:192
ds_read_b64_tr_b16 a[114:115], v11 offset:3776
v_add_f32 v185, 1.0, v185
v_add_f32 v186, 1.0, v186
v_add_f32 v187, 1.0, v187
v_rcp_f32 v184, v184
v_rcp_f32 v185, v185
v_mfma_f32_32x32x16_bf16 v[128:143], a[4:7], a[196:199], v[128:143]
ds_read_b64_tr_b16 a[116:117], v11 offset:1984
ds_read_b64_tr_b16 a[118:119], v11 offset:5568
v_rcp_f32 v186, v186
v_rcp_f32 v187, v187
v_mul_f32 v100, v100, v184
v_mul_f32 v101, v101, v185
v_mul_f32 v102, v102, v186
v_mul_f32 v103, v103, v187
v_mfma_f32_32x32x16_bf16 v[128:143], a[8:11], a[200:203], v[128:143]
ds_read_b64_tr_b16 a[120:121], v11 offset:7360
ds_read_b64_tr_b16 a[122:123], v11 offset:10944
v_cvt_pk_bf16_f32 v42, v100, v101
v_cvt_pk_bf16_f32 v43, v102, v103
buffer_store_dwordx4 v[40:43], v31, s[20:23], s10 offen offset:2048 sc1
v_mfma_f32_32x32x16_bf16 v[128:143], a[12:15], a[204:207], v[128:143]
ds_read_b64_tr_b16 a[124:125], v11 offset:9152
ds_read_b64_tr_b16 a[126:127], v11 offset:12736
v_mul_f32 v176, v112, v112
v_mul_f32 v177, v113, v113
v_mul_f32 v178, v114, v114
v_mul_f32 v179, v115, v115
v_fma_f32 v176, v176, s59, v180
v_fma_f32 v177, v177, s59, v180
v_fma_f32 v178, v178, s59, v180
v_fma_f32 v179, v179, s59, v180
v_mfma_f32_32x32x16_bf16 v[128:143], a[16:19], a[208:211], v[128:143]
ds_read_b64_tr_b16 a[0:1], v10 offset:32960
ds_read_b64_tr_b16 a[2:3], v10 offset:36544
v_mul_f32 v176, v176, v112
v_mul_f32 v177, v177, v113
v_mul_f32 v178, v178, v114
v_mul_f32 v179, v179, v115
v_exp_f32 v176, v176
v_mul_f32 v112, v112, v120
v_mfma_f32_32x32x16_bf16 v[128:143], a[20:23], a[212:215], v[128:143]
ds_read_b64_tr_b16 a[4:5], v10 offset:34752
ds_read_b64_tr_b16 a[6:7], v10 offset:38336
v_exp_f32 v177, v177
v_mul_f32 v113, v113, v121
v_exp_f32 v178, v178
v_mul_f32 v114, v114, v122
v_exp_f32 v179, v179
v_mfma_f32_32x32x16_bf16 v[128:143], a[24:27], a[216:219], v[128:143]
ds_read_b64_tr_b16 a[8:9], v10 offset:40128
ds_read_b64_tr_b16 a[10:11], v10 offset:43712
v_mul_f32 v115, v115, v123
v_add_f32 v176, 1.0, v176
v_add_f32 v177, 1.0, v177
v_add_f32 v178, 1.0, v178
v_add_f32 v179, 1.0, v179
v_rcp_f32 v176, v176
v_mfma_f32_32x32x16_bf16 v[128:143], a[28:31], a[220:223], v[128:143]
ds_read_b64_tr_b16 a[12:13], v10 offset:41920
ds_read_b64_tr_b16 a[14:15], v10 offset:45504
v_rcp_f32 v177, v177
v_rcp_f32 v178, v178
v_rcp_f32 v179, v179
v_mul_f32 v112, v112, v176
v_mul_f32 v113, v113, v177
v_mfma_f32_32x32x16_bf16 v[128:143], a[32:35], a[224:227], v[128:143]
v_mul_f32 v114, v114, v178
v_mul_f32 v115, v115, v179
v_cvt_pk_bf16_f32 v44, v112, v113
v_cvt_pk_bf16_f32 v45, v114, v115
v_and_b32 v44, -2, v44
v_mul_f32 v184, v116, v116
v_mul_f32 v185, v117, v117
v_mul_f32 v186, v118, v118
v_mul_f32 v187, v119, v119
v_fma_f32 v184, v184, s59, v180
v_mfma_f32_32x32x16_bf16 v[128:143], a[36:39], a[228:231], v[128:143]
v_fma_f32 v185, v185, s59, v180
v_fma_f32 v186, v186, s59, v180
v_fma_f32 v187, v187, s59, v180
v_mul_f32 v184, v184, v116
v_mul_f32 v185, v185, v117
v_mul_f32 v186, v186, v118
v_mul_f32 v187, v187, v119
v_exp_f32 v184, v184
v_mul_f32 v116, v116, v124
v_mfma_f32_32x32x16_bf16 v[128:143], a[40:43], a[232:235], v[128:143]
s_waitcnt lgkmcnt(0)
s_barrier
v_exp_f32 v185, v185
v_mul_f32 v117, v117, v125
v_exp_f32 v186, v186
v_mul_f32 v118, v118, v126
v_exp_f32 v187, v187
v_mfma_f32_32x32x16_bf16 v[128:143], a[44:47], a[236:239], v[128:143]
s_add_u32 m0, s24, 65536
s_mov_b32 s29, 86016
buffer_load_dwordx4 v8, s[12:15], s29 offen lds
v_mul_f32 v119, v119, v127
v_add_f32 v184, 1.0, v184
v_add_f32 v185, 1.0, v185
v_add_f32 v186, 1.0, v186
v_add_f32 v187, 1.0, v187
v_rcp_f32 v184, v184
v_mfma_f32_32x32x16_bf16 v[144:159], a[48:51], a[192:195], v[144:159]
buffer_load_dwordx4 v19, s[12:15], s29 offen offset:1024 lds
v_rcp_f32 v185, v185
v_rcp_f32 v186, v186
v_rcp_f32 v187, v187
v_mul_f32 v116, v116, v184
v_mul_f32 v117, v117, v185
v_mul_f32 v118, v118, v186
v_mfma_f32_32x32x16_bf16 v[144:159], a[52:55], a[196:199], v[144:159]
buffer_load_dwordx4 v23, s[12:15], s29 offen offset:2048 lds
v_mul_f32 v119, v119, v187
v_cvt_pk_bf16_f32 v46, v116, v117
v_cvt_pk_bf16_f32 v47, v118, v119
buffer_store_dwordx4 v[44:47], v31, s[20:23], s10 offen offset:3072 sc1
v_mfma_f32_32x32x16_bf16 v[144:159], a[56:59], a[200:203], v[144:159]
buffer_load_dwordx4 v25, s[12:15], s29 offen offset:3072 lds
v_mfma_f32_32x32x16_bf16 v[144:159], a[60:63], a[204:207], v[144:159]
v_mul_f32 v176, v128, v128
v_mul_f32 v177, v129, v129
v_mul_f32 v178, v130, v130
v_mul_f32 v179, v131, v131
v_fma_f32 v176, v176, s59, v180
v_fma_f32 v177, v177, s59, v180
v_fma_f32 v178, v178, s59, v180
v_fma_f32 v179, v179, s59, v180
v_mul_f32 v176, v176, v128
v_mul_f32 v177, v177, v129
v_mfma_f32_32x32x16_bf16 v[144:159], a[64:67], a[208:211], v[144:159]
s_add_u32 m0, s24, 69632
s_mov_b32 s29, 286720
buffer_load_dwordx4 v8, s[12:15], s29 offen lds
v_mul_f32 v178, v178, v130
v_mul_f32 v179, v179, v131
v_exp_f32 v176, v176
v_mul_f32 v128, v128, v136
v_exp_f32 v177, v177
v_mfma_f32_32x32x16_bf16 v[144:159], a[68:71], a[212:215], v[144:159]
buffer_load_dwordx4 v19, s[12:15], s29 offen offset:1024 lds
v_mul_f32 v129, v129, v137
v_exp_f32 v178, v178
v_mul_f32 v130, v130, v138
v_exp_f32 v179, v179
v_mul_f32 v131, v131, v139
v_add_f32 v176, 1.0, v176
v_add_f32 v177, 1.0, v177
v_mfma_f32_32x32x16_bf16 v[144:159], a[72:75], a[216:219], v[144:159]
buffer_load_dwordx4 v23, s[12:15], s29 offen offset:2048 lds
v_add_f32 v178, 1.0, v178
v_add_f32 v179, 1.0, v179
v_rcp_f32 v176, v176
v_rcp_f32 v177, v177
v_rcp_f32 v178, v178
v_mfma_f32_32x32x16_bf16 v[144:159], a[76:79], a[220:223], v[144:159]
v_rcp_f32 v179, v179
v_mul_f32 v128, v128, v176
v_mul_f32 v129, v129, v177
v_mul_f32 v130, v130, v178
v_mul_f32 v131, v131, v179
v_cvt_pk_bf16_f32 v40, v128, v129
v_cvt_pk_bf16_f32 v41, v130, v131
v_and_b32 v40, -2, v40
v_mul_f32 v184, v132, v132
v_mfma_f32_32x32x16_bf16 v[144:159], a[80:83], a[224:227], v[144:159]
buffer_load_dwordx4 v25, s[12:15], s29 offen offset:3072 lds
v_mul_f32 v185, v133, v133
v_mul_f32 v186, v134, v134
v_mul_f32 v187, v135, v135
v_fma_f32 v184, v184, s59, v180
v_fma_f32 v185, v185, s59, v180
v_fma_f32 v186, v186, s59, v180
v_fma_f32 v187, v187, s59, v180
v_mul_f32 v184, v184, v132
v_mul_f32 v185, v185, v133
v_mfma_f32_32x32x16_bf16 v[144:159], a[84:87], a[228:231], v[144:159]
v_mul_f32 v186, v186, v134
v_mul_f32 v187, v187, v135
v_exp_f32 v184, v184
v_mul_f32 v132, v132, v140
v_exp_f32 v185, v185
v_mul_f32 v133, v133, v141
v_exp_f32 v186, v186
v_mfma_f32_32x32x16_bf16 v[144:159], a[88:91], a[232:235], v[144:159]
s_waitcnt vmcnt(11)
v_cmp_gt_u32 vcc, v27, v32
v_mul_f32 v134, v134, v142
v_exp_f32 v187, v187
v_mul_f32 v135, v135, v143
v_add_f32 v184, 1.0, v184
v_add_f32 v185, 1.0, v185
v_add_f32 v186, 1.0, v186
v_add_f32 v187, 1.0, v187
v_mfma_f32_32x32x16_bf16 v[144:159], a[92:95], a[236:239], v[144:159]
v_rcp_f32 v184, v184
v_rcp_f32 v185, v185
v_rcp_f32 v186, v186
v_rcp_f32 v187, v187
v_mul_f32 v132, v132, v184
s_cbranch_vccnz POLL3
POLL3_B:
v_mfma_f32_32x32x16_bf16 v[160:175], a[96:99], a[192:195], v[160:175]
buffer_load_dwordx4 a[16:19], v31, s[20:23], s32 offen sc1
v_mul_f32 v133, v133, v185
v_mul_f32 v134, v134, v186
v_mul_f32 v135, v135, v187
v_cvt_pk_bf16_f32 v42, v132, v133
v_cvt_pk_bf16_f32 v43, v134, v135
buffer_store_dwordx4 v[40:43], v31, s[20:23], s11 offen sc1
v_mfma_f32_32x32x16_bf16 v[160:175], a[100:103], a[196:199], v[160:175]
v_mfma_f32_32x32x16_bf16 v[160:175], a[104:107], a[200:203], v[160:175]
buffer_load_dwordx4 a[20:23], v31, s[20:23], s33 offen sc1
v_mfma_f32_32x32x16_bf16 v[160:175], a[108:111], a[204:207], v[160:175]
buffer_load_dwordx4 a[24:27], v33, s[20:23], s32 offen sc1
v_mul_f32 v176, v144, v144
v_mul_f32 v177, v145, v145
v_mul_f32 v178, v146, v146
v_mul_f32 v179, v147, v147
v_fma_f32 v176, v176, s59, v180
v_fma_f32 v177, v177, s59, v180
v_fma_f32 v178, v178, s59, v180
v_fma_f32 v179, v179, s59, v180
v_mul_f32 v176, v176, v144
v_mfma_f32_32x32x16_bf16 v[160:175], a[112:115], a[208:211], v[160:175]
buffer_load_dwordx4 a[28:31], v33, s[20:23], s33 offen sc1
v_mul_f32 v177, v177, v145
v_mul_f32 v178, v178, v146
v_mul_f32 v179, v179, v147
v_exp_f32 v176, v176
v_mul_f32 v144, v144, v152
v_exp_f32 v177, v177
v_mul_f32 v145, v145, v153
v_mfma_f32_32x32x16_bf16 v[160:175], a[116:119], a[212:215], v[160:175]
v_exp_f32 v178, v178
v_mul_f32 v146, v146, v154
v_exp_f32 v179, v179
v_mul_f32 v147, v147, v155
v_add_f32 v176, 1.0, v176
v_add_f32 v177, 1.0, v177
v_add_f32 v178, 1.0, v178
v_add_f32 v179, 1.0, v179
v_mfma_f32_32x32x16_bf16 v[160:175], a[120:123], a[216:219], v[160:175]
buffer_load_dwordx4 a[32:35], v34, s[20:23], s32 offen sc1
v_rcp_f32 v176, v176
v_rcp_f32 v177, v177
v_rcp_f32 v178, v178
v_rcp_f32 v179, v179
v_mul_f32 v144, v144, v176
v_mfma_f32_32x32x16_bf16 v[160:175], a[124:127], a[220:223], v[160:175]
buffer_load_dwordx4 a[36:39], v34, s[20:23], s33 offen sc1
v_mul_f32 v145, v145, v177
v_mul_f32 v146, v146, v178
v_mul_f32 v147, v147, v179
v_cvt_pk_bf16_f32 v44, v144, v145
v_cvt_pk_bf16_f32 v45, v146, v147
v_and_b32 v44, -2, v44
v_mul_f32 v184, v148, v148
v_mul_f32 v185, v149, v149
v_mul_f32 v186, v150, v150
v_mfma_f32_32x32x16_bf16 v[160:175], a[0:3], a[224:227], v[160:175]
v_mul_f32 v187, v151, v151
v_fma_f32 v184, v184, s59, v180
v_fma_f32 v185, v185, s59, v180
v_fma_f32 v186, v186, s59, v180
v_fma_f32 v187, v187, s59, v180
v_mul_f32 v184, v184, v148
v_mul_f32 v185, v185, v149
v_mul_f32 v186, v186, v150
v_mul_f32 v187, v187, v151
v_mfma_f32_32x32x16_bf16 v[160:175], a[4:7], a[228:231], v[160:175]
buffer_load_dwordx4 a[40:43], v35, s[20:23], s32 offen sc1
v_exp_f32 v184, v184
v_mul_f32 v148, v148, v156
v_exp_f32 v185, v185
v_mul_f32 v149, v149, v157
v_exp_f32 v186, v186
v_mul_f32 v150, v150, v158
v_mfma_f32_32x32x16_bf16 v[160:175], a[8:11], a[232:235], v[160:175]
buffer_load_dwordx4 a[44:47], v35, s[20:23], s33 offen sc1
v_exp_f32 v187, v187
v_mul_f32 v151, v151, v159
v_add_f32 v184, 1.0, v184
v_add_f32 v185, 1.0, v185
v_add_f32 v186, 1.0, v186
v_add_f32 v187, 1.0, v187
v_rcp_f32 v184, v184
v_mfma_f32_32x32x16_bf16 v[160:175], a[12:15], a[236:239], v[160:175]
buffer_load_dwordx4 a[48:51], v31, s[20:23], s32 offen offset:1024 sc1
v_rcp_f32 v185, v185
v_rcp_f32 v186, v186
v_rcp_f32 v187, v187
v_mul_f32 v148, v148, v184
v_mul_f32 v149, v149, v185
v_mul_f32 v150, v150, v186
v_mul_f32 v151, v151, v187
v_cvt_pk_bf16_f32 v46, v148, v149
v_cvt_pk_bf16_f32 v47, v150, v151
buffer_store_dwordx4 v[44:47], v31, s[20:23], s11 offen offset:1024 sc1
s_nop 0
v_mul_f32 v176, v160, v160
v_mul_f32 v177, v161, v161
buffer_load_dwordx4 a[52:55], v31, s[20:23], s33 offen offset:1024 sc1
v_mul_f32 v178, v162, v162
v_mul_f32 v179, v163, v163
v_fma_f32 v176, v176, s59, v180
v_fma_f32 v177, v177, s59, v180
v_fma_f32 v178, v178, s59, v180
v_fma_f32 v179, v179, s59, v180
v_mul_f32 v176, v176, v160
v_mul_f32 v177, v177, v161
v_mul_f32 v178, v178, v162
v_mul_f32 v179, v179, v163
v_exp_f32 v176, v176
v_mul_f32 v160, v160, v168
buffer_load_dwordx4 a[56:59], v33, s[20:23], s32 offen offset:1024 sc1
v_exp_f32 v177, v177
v_mul_f32 v161, v161, v169
v_exp_f32 v178, v178
v_mul_f32 v162, v162, v170
v_exp_f32 v179, v179
v_mul_f32 v163, v163, v171
v_add_f32 v176, 1.0, v176
v_add_f32 v177, 1.0, v177
v_add_f32 v178, 1.0, v178
v_add_f32 v179, 1.0, v179
v_rcp_f32 v176, v176
v_rcp_f32 v177, v177
buffer_load_dwordx4 a[60:63], v33, s[20:23], s33 offen offset:1024 sc1
v_rcp_f32 v178, v178
v_rcp_f32 v179, v179
v_mul_f32 v160, v160, v176
v_mul_f32 v161, v161, v177
v_mul_f32 v162, v162, v178
v_mul_f32 v163, v163, v179
v_cvt_pk_bf16_f32 v40, v160, v161
v_cvt_pk_bf16_f32 v41, v162, v163
v_and_b32 v40, -2, v40
v_mul_f32 v184, v164, v164
v_mul_f32 v185, v165, v165
v_mul_f32 v186, v166, v166
buffer_load_dwordx4 a[160:163], v34, s[20:23], s32 offen offset:1024 sc1
v_mul_f32 v187, v167, v167
v_fma_f32 v184, v184, s59, v180
v_fma_f32 v185, v185, s59, v180
v_fma_f32 v186, v186, s59, v180
v_fma_f32 v187, v187, s59, v180
v_mul_f32 v184, v184, v164
v_mul_f32 v185, v185, v165
v_mul_f32 v186, v186, v166
v_mul_f32 v187, v187, v167
v_exp_f32 v184, v184
v_mul_f32 v164, v164, v172
v_exp_f32 v185, v185
buffer_load_dwordx4 a[164:167], v34, s[20:23], s33 offen offset:1024 sc1
v_mul_f32 v165, v165, v173
v_exp_f32 v186, v186
v_mul_f32 v166, v166, v174
v_exp_f32 v187, v187
v_mul_f32 v167, v167, v175
v_add_f32 v184, 1.0, v184
v_add_f32 v185, 1.0, v185
v_add_f32 v186, 1.0, v186
v_add_f32 v187, 1.0, v187
v_rcp_f32 v184, v184
v_rcp_f32 v185, v185
v_rcp_f32 v186, v186
v_rcp_f32 v187, v187
v_mul_f32 v164, v164, v184
v_mul_f32 v165, v165, v185
v_mul_f32 v166, v166, v186
v_mul_f32 v167, v167, v187
v_cvt_pk_bf16_f32 v42, v164, v165
v_cvt_pk_bf16_f32 v43, v166, v167
buffer_store_dwordx4 v[40:43], v31, s[20:23], s11 offen offset:2048 sc1
s_cmp_ge_u32 s93, 14
s_cbranch_scc1 K_FIN
s_waitcnt vmcnt(14)
v_accvgpr_read_b32 v36, a16
v_accvgpr_read_b32 v37, a20
v_bitop3_b32 v36, v36, v37, 1 bitop3:0xa8
v_cmp_ne_u32 vcc, 0, v36
s_nop 0
s_cbranch_vccnz RT3_0
RT3_0_B:
v_mfma_f32_32x32x16_bf16 a[80:95], v[196:199], a[16:19], 0
buffer_load_dwordx4 a[168:171], v35, s[20:23], s32 offen offset:1024 sc1
v_mfma_f32_32x32x16_bf16 a[96:111], v[192:195], a[20:23], 0
s_waitcnt vmcnt(13)
v_accvgpr_read_b32 v36, a24
v_accvgpr_read_b32 v37, a28
v_mfma_f32_32x32x16_bf16 a[112:127], v[196:199], a[20:23], 0
buffer_load_dwordx4 a[172:175], v35, s[20:23], s33 offen offset:1024 sc1
v_bitop3_b32 v36, v36, v37, 1 bitop3:0xa8
v_cmp_ne_u32 vcc, 0, v36
v_mfma_f32_32x32x16_bf16 a[64:79], v[192:195], a[16:19], 0
s_cbranch_vccnz RT3_1
RT3_1_B:
v_mfma_f32_32x32x16_bf16 a[80:95], v[204:207], a[24:27], a[80:95]
buffer_load_dwordx4 a[176:179], v31, s[20:23], s32 offen offset:2048 sc1
v_mfma_f32_32x32x16_bf16 a[96:111], v[200:203], a[28:31], a[96:111]
s_waitcnt vmcnt(13)
v_accvgpr_read_b32 v36, a32
v_accvgpr_read_b32 v37, a36
v_mfma_f32_32x32x16_bf16 a[112:127], v[204:207], a[28:31], a[112:127]
buffer_load_dwordx4 a[180:183], v31, s[20:23], s33 offen offset:2048 sc1
v_bitop3_b32 v36, v36, v37, 1 bitop3:0xa8
v_cmp_ne_u32 vcc, 0, v36
v_mfma_f32_32x32x16_bf16 a[64:79], v[200:203], a[24:27], a[64:79]
s_cbranch_vccnz RT3_2
RT3_2_B:
v_mfma_f32_32x32x16_bf16 a[80:95], v[212:215], a[32:35], a[80:95]
buffer_load_dwordx4 a[184:187], v33, s[20:23], s32 offen offset:2048 sc1
v_mfma_f32_32x32x16_bf16 a[96:111], v[208:211], a[36:39], a[96:111]
s_waitcnt vmcnt(13)
v_accvgpr_read_b32 v36, a40
v_accvgpr_read_b32 v37, a44
v_mfma_f32_32x32x16_bf16 a[112:127], v[212:215], a[36:39], a[112:127]
buffer_load_dwordx4 a[188:191], v33, s[20:23], s33 offen offset:2048 sc1
v_bitop3_b32 v36, v36, v37, 1 bitop3:0xa8
v_cmp_ne_u32 vcc, 0, v36
v_mfma_f32_32x32x16_bf16 a[64:79], v[208:211], a[32:35], a[64:79]
s_cbranch_vccnz RT3_3
RT3_3_B:
v_mfma_f32_32x32x16_bf16 a[80:95], v[220:223], a[40:43], a[80:95]
buffer_load_dwordx4 a[192:195], v34, s[20:23], s32 offen offset:2048 sc1
v_mfma_f32_32x32x16_bf16 a[96:111], v[216:219], a[44:47], a[96:111]
s_waitcnt vmcnt(12)
v_accvgpr_read_b32 v36, a48
v_accvgpr_read_b32 v37, a52
v_mfma_f32_32x32x16_bf16 a[112:127], v[220:223], a[44:47], a[112:127]
buffer_load_dwordx4 a[196:199], v34, s[20:23], s33 offen offset:2048 sc1
v_bitop3_b32 v36, v36, v37, 1 bitop3:0xa8
v_cmp_ne_u32 vcc, 0, v36
v_mfma_f32_32x32x16_bf16 a[64:79], v[216:219], a[40:43], a[64:79]
s_cbranch_vccnz RT3_4
RT3_4_B:
v_mfma_f32_32x32x16_bf16 a[80:95], v[228:231], a[48:51], a[80:95]
buffer_load_dwordx4 a[200:203], v35, s[20:23], s32 offen offset:2048 sc1
v_mfma_f32_32x32x16_bf16 a[96:111], v[224:227], a[52:55], a[96:111]
s_waitcnt vmcnt(12)
v_accvgpr_read_b32 v36, a56
v_accvgpr_read_b32 v37, a60
v_mfma_f32_32x32x16_bf16 a[112:127], v[228:231], a[52:55], a[112:127]
buffer_load_dwordx4 a[204:207], v35, s[20:23], s33 offen offset:2048 sc1
v_bitop3_b32 v36, v36, v37, 1 bitop3:0xa8
v_cmp_ne_u32 vcc, 0, v36
v_mfma_f32_32x32x16_bf16 a[64:79], v[224:227], a[48:51], a[64:79]
s_cbranch_vccnz RT3_5
RT3_5_B:
v_mfma_f32_32x32x16_bf16 a[80:95], v[236:239], a[56:59], a[80:95]
buffer_load_dwordx4 a[208:211], v31, s[20:23], s32 offen offset:3072 sc1
v_mfma_f32_32x32x16_bf16 a[96:111], v[232:235], a[60:63], a[96:111]
s_waitcnt vmcnt(12)
v_accvgpr_read_b32 v36, a160
v_accvgpr_read_b32 v37, a164
v_mfma_f32_32x32x16_bf16 a[112:127], v[236:239], a[60:63], a[112:127]
buffer_load_dwordx4 a[212:215], v31, s[20:23], s33 offen offset:3072 sc1
v_bitop3_b32 v36, v36, v37, 1 bitop3:0xa8
v_cmp_ne_u32 vcc, 0, v36
v_mfma_f32_32x32x16_bf16 a[64:79], v[232:235], a[56:59], a[64:79]
s_cbranch_vccnz RT3_6
RT3_6_B:
v_mfma_f32_32x32x16_bf16 a[80:95], v[244:247], a[160:163], a[80:95]
buffer_load_dwordx4 a[216:219], v33, s[20:23], s32 offen offset:3072 sc1
v_mfma_f32_32x32x16_bf16 a[96:111], v[240:243], a[164:167], a[96:111]
s_waitcnt vmcnt(11)
v_accvgpr_read_b32 v36, a168
v_accvgpr_read_b32 v37, a172
v_mfma_f32_32x32x16_bf16 a[112:127], v[244:247], a[164:167], a[112:127]
buffer_load_dwordx4 a[220:223], v33, s[20:23], s33 offen offset:3072 sc1
v_bitop3_b32 v36, v36, v37, 1 bitop3:0xa8
v_cmp_ne_u32 vcc, 0, v36
v_mfma_f32_32x32x16_bf16 a[64:79], v[240:243], a[160:163], a[64:79]
s_cbranch_vccnz RT3_7
RT3_7_B:
v_mfma_f32_32x32x16_bf16 a[80:95], v[252:255], a[168:171], a[80:95]
buffer_load_dwordx4 a[224:227], v34, s[20:23], s32 offen offset:3072 sc1
v_mfma_f32_32x32x16_bf16 a[96:111], v[248:251], a[172:175], a[96:111]
s_waitcnt vmcnt(11)
v_accvgpr_read_b32 v36, a176
v_accvgpr_read_b32 v37, a180
v_mfma_f32_32x32x16_bf16 a[112:127], v[252:255], a[172:175], a[112:127]
buffer_load_dwordx4 a[228:231], v34, s[20:23], s33 offen offset:3072 sc1
v_bitop3_b32 v36, v36, v37, 1 bitop3:0xa8
v_cmp_ne_u32 vcc, 0, v36
v_mfma_f32_32x32x16_bf16 a[64:79], v[248:251], a[168:171], a[64:79]
s_cbranch_vccnz RT3_8
RT3_8_B:
v_mfma_f32_32x32x16_bf16 a[80:95], a[244:247], a[176:179], a[80:95]
buffer_load_dwordx4 a[232:235], v35, s[20:23], s32 offen offset:3072 sc1
v_mfma_f32_32x32x16_bf16 a[96:111], a[240:243], a[180:183], a[96:111]
ds_read_b64_tr_b16 v[64:65], v12 offset:32768
ds_read_b64_tr_b16 v[66:67], v12 offset:33792
s_waitcnt vmcnt(11)
v_accvgpr_read_b32 v36, a184
v_accvgpr_read_b32 v37, a188
v_mfma_f32_32x32x16_bf16 a[112:127], a[244:247], a[180:183], a[112:127]
buffer_load_dwordx4 a[236:239], v35, s[20:23], s33 offen offset:3072 sc1
v_bitop3_b32 v36, v36, v37, 1 bitop3:0xa8
v_cmp_ne_u32 vcc, 0, v36
v_mfma_f32_32x32x16_bf16 a[64:79], a[240:243], a[176:179], a[64:79]
ds_read_b64_tr_b16 v[68:69], v13 offset:32768
ds_read_b64_tr_b16 v[70:71], v13 offset:33792
s_cbranch_vccnz RT3_9
RT3_9_B:
v_mfma_f32_32x32x16_bf16 a[80:95], a[252:255], a[184:187], a[80:95]
buffer_load_dwordx4 a[0:3], v31, s[20:23], s68 offen sc1
v_mfma_f32_32x32x16_bf16 a[96:111], a[248:251], a[188:191], a[96:111]
ds_read_b64_tr_b16 v[72:73], v12 offset:34816
ds_read_b64_tr_b16 v[74:75], v12 offset:35840
s_waitcnt vmcnt(11)
v_accvgpr_read_b32 v36, a192
v_accvgpr_read_b32 v37, a196
v_mfma_f32_32x32x16_bf16 a[112:127], a[252:255], a[188:191], a[112:127]
buffer_load_dwordx4 a[4:7], v31, s[20:23], s69 offen sc1
v_bitop3_b32 v36, v36, v37, 1 bitop3:0xa8
v_cmp_ne_u32 vcc, 0, v36
v_mfma_f32_32x32x16_bf16 a[64:79], a[248:251], a[184:187], a[64:79]
ds_read_b64_tr_b16 v[76:77], v13 offset:34816
ds_read_b64_tr_b16 v[78:79], v13 offset:35840
s_cbranch_vccnz RT3_10
RT3_10_B:
v_mfma_f32_32x32x16_bf16 a[80:95], v[48:51], a[192:195], a[80:95]
buffer_load_dwordx4 a[8:11], v33, s[20:23], s68 offen sc1
v_mfma_f32_32x32x16_bf16 a[96:111], v[188:191], a[196:199], a[96:111]
ds_read_b64_tr_b16 v[80:81], v12 offset:36864
ds_read_b64_tr_b16 v[82:83], v12 offset:37888
s_waitcnt vmcnt(11)
v_accvgpr_read_b32 v36, a200
v_accvgpr_read_b32 v37, a204
v_mfma_f32_32x32x16_bf16 a[112:127], v[48:51], a[196:199], a[112:127]
buffer_load_dwordx4 a[12:15], v33, s[20:23], s69 offen sc1
v_bitop3_b32 v36, v36, v37, 1 bitop3:0xa8
v_cmp_ne_u32 vcc, 0, v36
v_mfma_f32_32x32x16_bf16 a[64:79], v[188:191], a[192:195], a[64:79]
ds_read_b64_tr_b16 v[84:85], v13 offset:36864
ds_read_b64_tr_b16 v[86:87], v13 offset:37888
s_cbranch_vccnz RT3_11
RT3_11_B:
v_mfma_f32_32x32x16_bf16 a[80:95], v[56:59], a[200:203], a[80:95]
buffer_load_dwordx4 a[16:19], v34, s[20:23], s68 offen sc1
v_mfma_f32_32x32x16_bf16 a[96:111], v[52:55], a[204:207], a[96:111]
ds_read_b64_tr_b16 v[88:89], v12 offset:38912
ds_read_b64_tr_b16 v[90:91], v12 offset:39936
s_waitcnt vmcnt(11)
v_accvgpr_read_b32 v36, a208
v_accvgpr_read_b32 v37, a212
v_mfma_f32_32x32x16_bf16 a[112:127], v[56:59], a[204:207], a[112:127]
buffer_load_dwordx4 a[20:23], v34, s[20:23], s69 offen sc1
v_bitop3_b32 v36, v36, v37, 1 bitop3:0xa8
v_cmp_ne_u32 vcc, 0, v36
v_mfma_f32_32x32x16_bf16 a[64:79], v[52:55], a[200:203], a[64:79]
ds_read_b64_tr_b16 v[92:93], v13 offset:38912
ds_read_b64_tr_b16 v[94:95], v13 offset:39936
s_cbranch_vccnz RT3_12
RT3_12_B:
v_mfma_f32_32x32x16_bf16 a[80:95], a[132:135], a[208:211], a[80:95]
buffer_load_dwordx4 a[24:27], v35, s[20:23], s68 offen sc1
v_mfma_f32_32x32x16_bf16 a[96:111], a[128:131], a[212:215], a[96:111]
ds_read_b64_tr_b16 v[96:97], v12 offset:0
ds_read_b64_tr_b16 v[98:99], v12 offset:1024
s_waitcnt vmcnt(11)
v_accvgpr_read_b32 v36, a216
v_accvgpr_read_b32 v37, a220
v_mfma_f32_32x32x16_bf16 a[112:127], a[132:135], a[212:215], a[112:127]
buffer_load_dwordx4 a[28:31], v35, s[20:23], s69 offen sc1
v_bitop3_b32 v36, v36, v37, 1 bitop3:0xa8
v_cmp_ne_u32 vcc, 0, v36
v_mfma_f32_32x32x16_bf16 a[64:79], a[128:131], a[208:211], a[64:79]
ds_read_b64_tr_b16 v[100:101], v13 offset:0
ds_read_b64_tr_b16 v[102:103], v13 offset:1024
s_cbranch_vccnz RT3_13
RT3_13_B:
v_mfma_f32_32x32x16_bf16 a[80:95], a[140:143], a[216:219], a[80:95]
buffer_load_dwordx4 a[32:35], v31, s[20:23], s68 offen offset:1024 sc1
v_mfma_f32_32x32x16_bf16 a[96:111], a[136:139], a[220:223], a[96:111]
ds_read_b64_tr_b16 v[104:105], v12 offset:2048
ds_read_b64_tr_b16 v[106:107], v12 offset:3072
s_waitcnt vmcnt(11)
v_accvgpr_read_b32 v36, a224
v_accvgpr_read_b32 v37, a228
v_mfma_f32_32x32x16_bf16 a[112:127], a[140:143], a[220:223], a[112:127]
buffer_load_dwordx4 a[36:39], v31, s[20:23], s69 offen offset:1024 sc1
v_bitop3_b32 v36, v36, v37, 1 bitop3:0xa8
v_cmp_ne_u32 vcc, 0, v36
v_mfma_f32_32x32x16_bf16 a[64:79], a[136:139], a[216:219], a[64:79]
ds_read_b64_tr_b16 v[108:109], v13 offset:2048
ds_read_b64_tr_b16 v[110:111], v13 offset:3072
s_cbranch_vccnz RT3_14
RT3_14_B:
v_mfma_f32_32x32x16_bf16 a[80:95], a[148:151], a[224:227], a[80:95]
buffer_load_dwordx4 a[40:43], v33, s[20:23], s68 offen offset:1024 sc1
v_mfma_f32_32x32x16_bf16 a[96:111], a[144:147], a[228:231], a[96:111]
s_waitcnt vmcnt(11)
v_accvgpr_read_b32 v36, a232
v_accvgpr_read_b32 v37, a236
v_mfma_f32_32x32x16_bf16 a[112:127], a[148:151], a[228:231], a[112:127]
buffer_load_dwordx4 a[44:47], v33, s[20:23], s69 offen offset:1024 sc1
v_bitop3_b32 v36, v36, v37, 1 bitop3:0xa8
v_cmp_ne_u32 vcc, 0, v36
v_mfma_f32_32x32x16_bf16 a[64:79], a[144:147], a[224:227], a[64:79]
s_cbranch_vccnz RT3_15
RT3_15_B:
v_mfma_f32_32x32x16_bf16 a[80:95], a[156:159], a[232:235], a[80:95]
buffer_load_dwordx4 a[48:51], v34, s[20:23], s68 offen offset:1024 sc1
v_mfma_f32_32x32x16_bf16 a[96:111], a[152:155], a[236:239], a[96:111]
s_waitcnt vmcnt(11)
v_accvgpr_read_b32 v36, a0
v_accvgpr_read_b32 v37, a4
v_mfma_f32_32x32x16_bf16 a[112:127], a[156:159], a[236:239], a[112:127]
buffer_load_dwordx4 a[52:55], v34, s[20:23], s69 offen offset:1024 sc1
v_bitop3_b32 v36, v36, v37, 1 bitop3:0xa8
v_cmp_ne_u32 vcc, 0, v36
v_mfma_f32_32x32x16_bf16 a[64:79], a[152:155], a[232:235], a[64:79]
s_cbranch_vccnz RT3_16
RT3_16_B:
s_waitcnt lgkmcnt(0)
v_mfma_f32_32x32x16_bf16 a[80:95], v[68:71], a[0:3], a[80:95]
buffer_load_dwordx4 a[56:59], v35, s[20:23], s68 offen offset:1024 sc1
v_mfma_f32_32x32x16_bf16 a[96:111], v[64:67], a[4:7], a[96:111]
s_waitcnt vmcnt(11)
v_accvgpr_read_b32 v36, a8
v_accvgpr_read_b32 v37, a12
v_mfma_f32_32x32x16_bf16 a[112:127], v[68:71], a[4:7], a[112:127]
buffer_load_dwordx4 a[60:63], v35, s[20:23], s69 offen offset:1024 sc1
v_bitop3_b32 v36, v36, v37, 1 bitop3:0xa8
v_cmp_ne_u32 vcc, 0, v36
v_mfma_f32_32x32x16_bf16 a[64:79], v[64:67], a[0:3], a[64:79]
s_cbranch_vccnz RT3_17
RT3_17_B:
v_mfma_f32_32x32x16_bf16 a[80:95], v[76:79], a[8:11], a[80:95]
buffer_load_dwordx4 a[160:163], v31, s[20:23], s68 offen offset:2048 sc1
v_mfma_f32_32x32x16_bf16 a[96:111], v[72:75], a[12:15], a[96:111]
ds_read_b64_tr_b16 v[64:65], v12 offset:4096
ds_read_b64_tr_b16 v[66:67], v12 offset:5120
s_waitcnt vmcnt(11)
v_accvgpr_read_b32 v36, a16
v_accvgpr_read_b32 v37, a20
v_mfma_f32_32x32x16_bf16 a[112:127], v[76:79], a[12:15], a[112:127]
buffer_load_dwordx4 a[164:167], v31, s[20:23], s69 offen offset:2048 sc1
v_bitop3_b32 v36, v36, v37, 1 bitop3:0xa8
v_cmp_ne_u32 vcc, 0, v36
v_mfma_f32_32x32x16_bf16 a[64:79], v[72:75], a[8:11], a[64:79]
ds_read_b64_tr_b16 v[68:69], v13 offset:4096
ds_read_b64_tr_b16 v[70:71], v13 offset:5120
s_cbranch_vccnz RT3_18
RT3_18_B:
v_mfma_f32_32x32x16_bf16 a[80:95], v[84:87], a[16:19], a[80:95]
buffer_load_dwordx4 a[168:171], v33, s[20:23], s68 offen offset:2048 sc1
v_mfma_f32_32x32x16_bf16 a[96:111], v[80:83], a[20:23], a[96:111]
ds_read_b64_tr_b16 v[72:73], v12 offset:6144
ds_read_b64_tr_b16 v[74:75], v12 offset:7168
s_waitcnt vmcnt(11)
v_accvgpr_read_b32 v36, a24
v_accvgpr_read_b32 v37, a28
v_mfma_f32_32x32x16_bf16 a[112:127], v[84:87], a[20:23], a[112:127]
buffer_load_dwordx4 a[172:175], v33, s[20:23], s69 offen offset:2048 sc1
v_bitop3_b32 v36, v36, v37, 1 bitop3:0xa8
v_cmp_ne_u32 vcc, 0, v36
v_mfma_f32_32x32x16_bf16 a[64:79], v[80:83], a[16:19], a[64:79]
ds_read_b64_tr_b16 v[76:77], v13 offset:6144
ds_read_b64_tr_b16 v[78:79], v13 offset:7168
s_cbranch_vccnz RT3_19
RT3_19_B:
v_mfma_f32_32x32x16_bf16 a[80:95], v[92:95], a[24:27], a[80:95]
buffer_load_dwordx4 a[176:179], v34, s[20:23], s68 offen offset:2048 sc1
v_mfma_f32_32x32x16_bf16 a[96:111], v[88:91], a[28:31], a[96:111]
ds_read_b64_tr_b16 v[80:81], v14 offset:0
ds_read_b64_tr_b16 v[82:83], v14 offset:1024
s_waitcnt vmcnt(11)
v_accvgpr_read_b32 v36, a32
v_accvgpr_read_b32 v37, a36
v_mfma_f32_32x32x16_bf16 a[112:127], v[92:95], a[28:31], a[112:127]
buffer_load_dwordx4 a[180:183], v34, s[20:23], s69 offen offset:2048 sc1
v_bitop3_b32 v36, v36, v37, 1 bitop3:0xa8
v_cmp_ne_u32 vcc, 0, v36
v_mfma_f32_32x32x16_bf16 a[64:79], v[88:91], a[24:27], a[64:79]
ds_read_b64_tr_b16 v[84:85], v15 offset:0
ds_read_b64_tr_b16 v[86:87], v15 offset:1024
s_cbranch_vccnz RT3_20
RT3_20_B:
v_mfma_f32_32x32x16_bf16 a[80:95], v[100:103], a[32:35], a[80:95]
buffer_load_dwordx4 a[184:187], v35, s[20:23], s68 offen offset:2048 sc1
v_mfma_f32_32x32x16_bf16 a[96:111], v[96:99], a[36:39], a[96:111]
ds_read_b64_tr_b16 v[88:89], v14 offset:2048
ds_read_b64_tr_b16 v[90:91], v14 offset:3072
s_waitcnt vmcnt(11)
v_accvgpr_read_b32 v36, a40
v_accvgpr_read_b32 v37, a44
v_mfma_f32_32x32x16_bf16 a[112:127], v[100:103], a[36:39], a[112:127]
buffer_load_dwordx4 a[188:191], v35, s[20:23], s69 offen offset:2048 sc1
v_bitop3_b32 v36, v36, v37, 1 bitop3:0xa8
v_cmp_ne_u32 vcc, 0, v36
v_mfma_f32_32x32x16_bf16 a[64:79], v[96:99], a[32:35], a[64:79]
ds_read_b64_tr_b16 v[92:93], v15 offset:2048
ds_read_b64_tr_b16 v[94:95], v15 offset:3072
s_cbranch_vccnz RT3_21
RT3_21_B:
v_mfma_f32_32x32x16_bf16 a[80:95], v[108:111], a[40:43], a[80:95]
buffer_load_dwordx4 v[40:43], v31, s[20:23], s27 offen sc1
v_mfma_f32_32x32x16_bf16 a[96:111], v[104:107], a[44:47], a[96:111]
ds_read_b64_tr_b16 v[96:97], v14 offset:4096
ds_read_b64_tr_b16 v[98:99], v14 offset:5120
s_waitcnt vmcnt(11)
v_accvgpr_read_b32 v36, a48
v_accvgpr_read_b32 v37, a52
v_mfma_f32_32x32x16_bf16 a[112:127], v[108:111], a[44:47], a[112:127]
buffer_load_dwordx4 v[44:47], v31, s[20:23], s27 offen offset:1024 sc1
v_bitop3_b32 v36, v36, v37, 1 bitop3:0xa8
v_cmp_ne_u32 vcc, 0, v36
v_mfma_f32_32x32x16_bf16 a[64:79], v[104:107], a[40:43], a[64:79]
ds_read_b64_tr_b16 v[100:101], v15 offset:4096
ds_read_b64_tr_b16 v[102:103], v15 offset:5120
s_cbranch_vccnz RT3_22
RT3_22_B:
s_waitcnt lgkmcnt(2)
v_mfma_f32_32x32x16_bf16 a[80:95], v[68:71], a[48:51], a[80:95]
buffer_load_dwordx4 v[48:51], v31, s[20:23], s27 offen offset:2048 sc1
v_mfma_f32_32x32x16_bf16 a[96:111], v[64:67], a[52:55], a[96:111]
ds_read_b64_tr_b16 v[104:105], v14 offset:6144
ds_read_b64_tr_b16 v[106:107], v14 offset:7168
s_waitcnt vmcnt(11)
v_accvgpr_read_b32 v36, a56
v_accvgpr_read_b32 v37, a60
v_mfma_f32_32x32x16_bf16 a[112:127], v[68:71], a[52:55], a[112:127]
buffer_load_dwordx4 v[52:55], v31, s[20:23], s27 offen offset:3072 sc1
v_bitop3_b32 v36, v36, v37, 1 bitop3:0xa8
v_cmp_ne_u32 vcc, 0, v36
v_mfma_f32_32x32x16_bf16 a[64:79], v[64:67], a[48:51], a[64:79]
ds_read_b64_tr_b16 v[108:109], v15 offset:6144
ds_read_b64_tr_b16 v[110:111], v15 offset:7168
s_cbranch_vccnz RT3_23
RT3_23_B:
v_mfma_f32_32x32x16_bf16 a[80:95], v[76:79], a[56:59], a[80:95]
buffer_load_dwordx4 v[176:179], v1, s[20:23], s67 offen sc1
v_mfma_f32_32x32x16_bf16 a[96:111], v[72:75], a[60:63], a[96:111]
s_waitcnt vmcnt(11)
v_accvgpr_read_b32 v36, a160
v_accvgpr_read_b32 v37, a164
v_mfma_f32_32x32x16_bf16 a[112:127], v[76:79], a[60:63], a[112:127]
buffer_load_dwordx4 v[180:183], v1, s[20:23], s67 offen offset:32 sc1
v_bitop3_b32 v36, v36, v37, 1 bitop3:0xa8
v_cmp_ne_u32 vcc, 0, v36
v_mfma_f32_32x32x16_bf16 a[64:79], v[72:75], a[56:59], a[64:79]
s_cbranch_vccnz RT3_24
RT3_24_B:
v_mfma_f32_32x32x16_bf16 a[80:95], v[84:87], a[160:163], a[80:95]
buffer_load_dwordx4 v[184:187], v1, s[20:23], s67 offen offset:64 sc1
v_mfma_f32_32x32x16_bf16 a[96:111], v[80:83], a[164:167], a[96:111]
s_waitcnt vmcnt(11)
v_accvgpr_read_b32 v36, a168
v_accvgpr_read_b32 v37, a172
v_mfma_f32_32x32x16_bf16 a[112:127], v[84:87], a[164:167], a[112:127]
buffer_load_dwordx4 v[188:191], v1, s[20:23], s67 offen offset:96 sc1
v_bitop3_b32 v36, v36, v37, 1 bitop3:0xa8
v_cmp_ne_u32 vcc, 0, v36
v_mfma_f32_32x32x16_bf16 a[64:79], v[80:83], a[160:163], a[64:79]
s_cbranch_vccnz RT3_25
RT3_25_B:
v_mfma_f32_32x32x16_bf16 a[80:95], v[92:95], a[168:171], a[80:95]
v_mfma_f32_32x32x16_bf16 a[96:111], v[88:91], a[172:175], a[96:111]
s_waitcnt vmcnt(8)
v_accvgpr_read_b32 v36, a176
v_accvgpr_read_b32 v37, a180
v_accvgpr_read_b32 v38, a184
v_or3_b32 v36, v36, v37, v38
v_mfma_f32_32x32x16_bf16 a[112:127], v[92:95], a[172:175], a[112:127]
v_accvgpr_read_b32 v37, a188
v_bitop3_b32 v36, v36, v37, 1 bitop3:0xa8
v_cmp_ne_u32 vcc, 0, v36
v_mfma_f32_32x32x16_bf16 a[64:79], v[88:91], a[168:171], a[64:79]
s_cbranch_vccnz RT3_26
RT3_26_B:
s_waitcnt lgkmcnt(0)
v_mfma_f32_32x32x16_bf16 a[80:95], v[100:103], a[176:179], a[80:95]
v_mfma_f32_32x32x16_bf16 a[80:95], v[108:111], a[184:187], a[80:95]
s_nop 5
v_mfma_f32_32x32x16_bf16 a[96:111], v[96:99], a[180:183], a[96:111]
s_nop 4
v_mfma_f32_32x32x16_bf16 a[96:111], v[104:107], a[188:191], a[96:111]
ds_write_b128 v3, a[80:83] offset:0
ds_write_b128 v3, a[84:87] offset:1024
s_nop 3
v_mfma_f32_32x32x16_bf16 a[112:127], v[100:103], a[180:183], a[112:127]
ds_write_b128 v3, a[88:91] offset:2048
ds_write_b128 v3, a[92:95] offset:3072
s_nop 2
v_mfma_f32_32x32x16_bf16 a[112:127], v[108:111], a[188:191], a[112:127]
ds_write_b128 v3, a[96:99] offset:4096
ds_write_b128 v3, a[100:103] offset:5120
s_nop 3
v_mfma_f32_32x32x16_bf16 a[64:79], v[96:99], a[176:179], a[64:79]
ds_write_b128 v3, a[104:107] offset:6144
ds_write_b128 v3, a[108:111] offset:7168
s_nop 2
v_mfma_f32_32x32x16_bf16 a[64:79], v[104:107], a[184:187], a[64:79]
ds_write_b128 v3, a[112:115] offset:32768
ds_write_b128 v3, a[116:119] offset:33792
ds_write_b128 v3, a[120:123] offset:34816
ds_write_b128 v3, a[124:127] offset:35840
s_waitcnt lgkmcnt(0)
s_barrier
ds_read_b128 v[80:83], v4 offset:0
ds_read_b128 v[84:87], v4 offset:1024
ds_read_b128 v[88:91], v4 offset:2048
ds_read_b128 v[92:95], v4 offset:3072
ds_read_b128 v[96:99], v18 offset:4096
ds_read_b128 v[100:103], v18 offset:5120
ds_read_b128 v[104:107], v18 offset:6144
ds_read_b128 v[108:111], v18 offset:7168
ds_read_b128 v[112:115], v20 offset:32768
ds_read_b128 v[116:119], v20 offset:33792
ds_read_b128 v[120:123], v20 offset:34816
ds_read_b128 v[124:127], v20 offset:35840
v_accvgpr_read_b32 v64, a64
v_accvgpr_read_b32 v65, a65
v_accvgpr_read_b32 v66, a66
v_accvgpr_read_b32 v67, a67
v_accvgpr_read_b32 v68, a68
v_accvgpr_read_b32 v69, a69
v_accvgpr_read_b32 v70, a70
v_accvgpr_read_b32 v71, a71
v_accvgpr_read_b32 v72, a72
v_accvgpr_read_b32 v73, a73
v_accvgpr_read_b32 v74, a74
v_accvgpr_read_b32 v75, a75
v_accvgpr_read_b32 v76, a76
v_accvgpr_read_b32 v77, a77
v_accvgpr_read_b32 v78, a78
v_accvgpr_read_b32 v79, a79
s_waitcnt vmcnt(0)
v_pk_fma_f32 v[64:65], v[64:65], v[176:177], v[40:41]
v_pk_fma_f32 v[66:67], v[66:67], v[178:179], v[42:43]
v_pk_fma_f32 v[68:69], v[68:69], v[180:181], v[44:45]
v_pk_fma_f32 v[70:71], v[70:71], v[182:183], v[46:47]
v_pk_fma_f32 v[72:73], v[72:73], v[184:185], v[48:49]
v_pk_fma_f32 v[74:75], v[74:75], v[186:187], v[50:51]
v_pk_fma_f32 v[76:77], v[76:77], v[188:189], v[52:53]
v_pk_fma_f32 v[78:79], v[78:79], v[190:191], v[54:55]
s_waitcnt lgkmcnt(4)
v_pk_add_f32 v[80:81], v[80:81], v[96:97]
v_pk_add_f32 v[82:83], v[82:83], v[98:99]
v_pk_add_f32 v[84:85], v[84:85], v[100:101]
v_pk_add_f32 v[86:87], v[86:87], v[102:103]
v_pk_add_f32 v[88:89], v[88:89], v[104:105]
v_pk_add_f32 v[90:91], v[90:91], v[106:107]
v_pk_add_f32 v[92:93], v[92:93], v[108:109]
v_pk_add_f32 v[94:95], v[94:95], v[110:111]
s_waitcnt lgkmcnt(0)
v_pk_add_f32 v[80:81], v[80:81], v[112:113]
v_pk_add_f32 v[82:83], v[82:83], v[114:115]
v_pk_add_f32 v[84:85], v[84:85], v[116:117]
v_pk_add_f32 v[86:87], v[86:87], v[118:119]
v_pk_add_f32 v[88:89], v[88:89], v[120:121]
v_pk_add_f32 v[90:91], v[90:91], v[122:123]
v_pk_add_f32 v[92:93], v[92:93], v[124:125]
v_pk_add_f32 v[94:95], v[94:95], v[126:127]
v_pk_fma_f32 v[64:65], v[80:81], v[176:177], v[64:65]
v_pk_fma_f32 v[66:67], v[82:83], v[178:179], v[66:67]
v_pk_fma_f32 v[68:69], v[84:85], v[180:181], v[68:69]
v_pk_fma_f32 v[70:71], v[86:87], v[182:183], v[70:71]
v_pk_fma_f32 v[72:73], v[88:89], v[184:185], v[72:73]
v_pk_fma_f32 v[74:75], v[90:91], v[186:187], v[74:75]
v_pk_fma_f32 v[76:77], v[92:93], v[188:189], v[76:77]
v_pk_fma_f32 v[78:79], v[94:95], v[190:191], v[78:79]
v_cvt_pk_bf16_f32 v80, v64, v65
v_cvt_pk_bf16_f32 v81, v66, v67
v_cvt_pk_bf16_f32 v82, v68, v69
v_cvt_pk_bf16_f32 v83, v70, v71
v_cvt_pk_bf16_f32 v84, v72, v73
v_cvt_pk_bf16_f32 v85, v74, v75
v_cvt_pk_bf16_f32 v86, v76, v77
v_cvt_pk_bf16_f32 v87, v78, v79
s_nop 1
v_permlane32_swap_b32 v80, v82
v_permlane32_swap_b32 v81, v83
v_permlane32_swap_b32 v84, v86
v_permlane32_swap_b32 v85, v87
buffer_store_dwordx4 v[80:83], v2, s[48:51], s28 offen
buffer_store_dwordx4 v[84:87], v2, s[48:51], s28 offen offset:32
K_FIN:
K_END:
s_endpgm
POLL3:
s_cmp_eq_u32 s62, 0
s_cbranch_scc1 POLL3_B
s_sub_u32 s62, s62, 1
s_sleep 4
buffer_load_dword v32, v21, s[20:23], s26 offen sc1
s_waitcnt vmcnt(0)
v_cmp_gt_u32 vcc, v27, v32
s_nop 0
s_cbranch_vccnz POLL3
s_branch POLL3_B
RT3_26:
s_cmp_eq_u32 s62, 0
s_cbranch_scc1 RT3_26_X
s_sub_u32 s62, s62, 1
s_sleep 4
buffer_load_dwordx4 a[176:179], v34, s[20:23], s68 offen offset:2048 sc1
buffer_load_dwordx4 a[180:183], v34, s[20:23], s69 offen offset:2048 sc1
buffer_load_dwordx4 a[184:187], v35, s[20:23], s68 offen offset:2048 sc1
buffer_load_dwordx4 a[188:191], v35, s[20:23], s69 offen offset:2048 sc1
s_waitcnt vmcnt(0)
v_accvgpr_read_b32 v36, a176
v_accvgpr_read_b32 v37, a180
v_accvgpr_read_b32 v38, a184
v_or3_b32 v36, v36, v37, v38
v_accvgpr_read_b32 v37, a188
v_bitop3_b32 v36, v36, v37, 1 bitop3:0xa8
v_cmp_ne_u32 vcc, 0, v36
s_nop 0
s_cbranch_vccnz RT3_26
RT3_26_X:
s_branch RT3_26_B
RT3_0:
s_cmp_eq_u32 s62, 0
s_cbranch_scc1 RT3_0_X
s_sub_u32 s62, s62, 1
s_sleep 4
buffer_load_dwordx4 a[16:19], v31, s[20:23], s32 offen sc1
buffer_load_dwordx4 a[20:23], v31, s[20:23], s33 offen sc1
buffer_load_dwordx4 a[48:51], v31, s[20:23], s32 offen offset:1024 sc1
buffer_load_dwordx4 a[52:55], v31, s[20:23], s33 offen offset:1024 sc1
s_waitcnt vmcnt(0)
v_accvgpr_read_b32 v36, a16
v_accvgpr_read_b32 v37, a20
v_bitop3_b32 v36, v36, v37, 1 bitop3:0xa8
v_cmp_ne_u32 vcc, 0, v36
s_nop 0
s_cbranch_vccnz RT3_0
RT3_0_X:
s_branch RT3_0_B
RT3_1:
s_cmp_eq_u32 s62, 0
s_cbranch_scc1 RT3_1_X
s_sub_u32 s62, s62, 1
s_sleep 4
buffer_load_dwordx4 a[24:27], v33, s[20:23], s32 offen sc1
buffer_load_dwordx4 a[28:31], v33, s[20:23], s33 offen sc1
buffer_load_dwordx4 a[56:59], v33, s[20:23], s32 offen offset:1024 sc1
buffer_load_dwordx4 a[60:63], v33, s[20:23], s33 offen offset:1024 sc1
s_waitcnt vmcnt(0)
v_accvgpr_read_b32 v36, a24
v_accvgpr_read_b32 v37, a28
v_bitop3_b32 v36, v36, v37, 1 bitop3:0xa8
v_cmp_ne_u32 vcc, 0, v36
s_nop 0
s_cbranch_vccnz RT3_1
RT3_1_X:
s_branch RT3_1_B
RT3_2:
s_cmp_eq_u32 s62, 0
s_cbranch_scc1 RT3_2_X
s_sub_u32 s62, s62, 1
s_sleep 4
buffer_load_dwordx4 a[32:35], v34, s[20:23], s32 offen sc1
buffer_load_dwordx4 a[36:39], v34, s[20:23], s33 offen sc1
buffer_load_dwordx4 a[160:163], v34, s[20:23], s32 offen offset:1024 sc1
buffer_load_dwordx4 a[164:167], v34, s[20:23], s33 offen offset:1024 sc1
s_waitcnt vmcnt(0)
v_accvgpr_read_b32 v36, a32
v_accvgpr_read_b32 v37, a36
v_bitop3_b32 v36, v36, v37, 1 bitop3:0xa8
v_cmp_ne_u32 vcc, 0, v36
s_nop 0
s_cbranch_vccnz RT3_2
RT3_2_X:
s_branch RT3_2_B
RT3_3:
s_cmp_eq_u32 s62, 0
s_cbranch_scc1 RT3_3_X
s_sub_u32 s62, s62, 1
s_sleep 4
buffer_load_dwordx4 a[40:43], v35, s[20:23], s32 offen sc1
buffer_load_dwordx4 a[44:47], v35, s[20:23], s33 offen sc1
buffer_load_dwordx4 a[168:171], v35, s[20:23], s32 offen offset:1024 sc1
buffer_load_dwordx4 a[172:175], v35, s[20:23], s33 offen offset:1024 sc1
s_waitcnt vmcnt(0)
v_accvgpr_read_b32 v36, a40
v_accvgpr_read_b32 v37, a44
v_bitop3_b32 v36, v36, v37, 1 bitop3:0xa8
v_cmp_ne_u32 vcc, 0, v36
s_nop 0
s_cbranch_vccnz RT3_3
RT3_3_X:
s_branch RT3_3_B
RT3_4:
s_cmp_eq_u32 s62, 0
s_cbranch_scc1 RT3_4_X
s_sub_u32 s62, s62, 1
s_sleep 4
buffer_load_dwordx4 a[48:51], v31, s[20:23], s32 offen offset:1024 sc1
buffer_load_dwordx4 a[52:55], v31, s[20:23], s33 offen offset:1024 sc1
buffer_load_dwordx4 a[176:179], v31, s[20:23], s32 offen offset:2048 sc1
buffer_load_dwordx4 a[180:183], v31, s[20:23], s33 offen offset:2048 sc1
s_waitcnt vmcnt(0)
v_accvgpr_read_b32 v36, a48
v_accvgpr_read_b32 v37, a52
v_bitop3_b32 v36, v36, v37, 1 bitop3:0xa8
v_cmp_ne_u32 vcc, 0, v36
s_nop 0
s_cbranch_vccnz RT3_4
RT3_4_X:
s_branch RT3_4_B
RT3_5:
s_cmp_eq_u32 s62, 0
s_cbranch_scc1 RT3_5_X
s_sub_u32 s62, s62, 1
s_sleep 4
buffer_load_dwordx4 a[56:59], v33, s[20:23], s32 offen offset:1024 sc1
buffer_load_dwordx4 a[60:63], v33, s[20:23], s33 offen offset:1024 sc1
buffer_load_dwordx4 a[184:187], v33, s[20:23], s32 offen offset:2048 sc1
buffer_load_dwordx4 a[188:191], v33, s[20:23], s33 offen offset:2048 sc1
s_waitcnt vmcnt(0)
v_accvgpr_read_b32 v36, a56
v_accvgpr_read_b32 v37, a60
v_bitop3_b32 v36, v36, v37, 1 bitop3:0xa8
v_cmp_ne_u32 vcc, 0, v36
s_nop 0
s_cbranch_vccnz RT3_5
RT3_5_X:
s_branch RT3_5_B
RT3_6:
s_cmp_eq_u32 s62, 0
s_cbranch_scc1 RT3_6_X
s_sub_u32 s62, s62, 1
s_sleep 4
buffer_load_dwordx4 a[160:163], v34, s[20:23], s32 offen offset:1024 sc1
buffer_load_dwordx4 a[164:167], v34, s[20:23], s33 offen offset:1024 sc1
buffer_load_dwordx4 a[192:195], v34, s[20:23], s32 offen offset:2048 sc1
buffer_load_dwordx4 a[196:199], v34, s[20:23], s33 offen offset:2048 sc1
s_waitcnt vmcnt(0)
v_accvgpr_read_b32 v36, a160
v_accvgpr_read_b32 v37, a164
v_bitop3_b32 v36, v36, v37, 1 bitop3:0xa8
v_cmp_ne_u32 vcc, 0, v36
s_nop 0
s_cbranch_vccnz RT3_6
RT3_6_X:
s_branch RT3_6_B
RT3_7:
s_cmp_eq_u32 s62, 0
s_cbranch_scc1 RT3_7_X
s_sub_u32 s62, s62, 1
s_sleep 4
buffer_load_dwordx4 a[168:171], v35, s[20:23], s32 offen offset:1024 sc1
buffer_load_dwordx4 a[172:175], v35, s[20:23], s33 offen offset:1024 sc1
buffer_load_dwordx4 a[200:203], v35, s[20:23], s32 offen offset:2048 sc1
buffer_load_dwordx4 a[204:207], v35, s[20:23], s33 offen offset:2048 sc1
s_waitcnt vmcnt(0)
v_accvgpr_read_b32 v36, a168
v_accvgpr_read_b32 v37, a172
v_bitop3_b32 v36, v36, v37, 1 bitop3:0xa8
v_cmp_ne_u32 vcc, 0, v36
s_nop 0
s_cbranch_vccnz RT3_7
RT3_7_X:
s_branch RT3_7_B
RT3_8:
s_cmp_eq_u32 s62, 0
s_cbranch_scc1 RT3_8_X
s_sub_u32 s62, s62, 1
s_sleep 4
buffer_load_dwordx4 a[176:179], v31, s[20:23], s32 offen offset:2048 sc1
buffer_load_dwordx4 a[180:183], v31, s[20:23], s33 offen offset:2048 sc1
buffer_load_dwordx4 a[208:211], v31, s[20:23], s32 offen offset:3072 sc1
buffer_load_dwordx4 a[212:215], v31, s[20:23], s33 offen offset:3072 sc1
s_waitcnt vmcnt(0)
v_accvgpr_read_b32 v36, a176
v_accvgpr_read_b32 v37, a180
v_bitop3_b32 v36, v36, v37, 1 bitop3:0xa8
v_cmp_ne_u32 vcc, 0, v36
s_nop 0
s_cbranch_vccnz RT3_8
RT3_8_X:
s_branch RT3_8_B
RT3_9:
s_cmp_eq_u32 s62, 0
s_cbranch_scc1 RT3_9_X
s_sub_u32 s62, s62, 1
s_sleep 4
buffer_load_dwordx4 a[184:187], v33, s[20:23], s32 offen offset:2048 sc1
buffer_load_dwordx4 a[188:191], v33, s[20:23], s33 offen offset:2048 sc1
buffer_load_dwordx4 a[216:219], v33, s[20:23], s32 offen offset:3072 sc1
buffer_load_dwordx4 a[220:223], v33, s[20:23], s33 offen offset:3072 sc1
s_waitcnt vmcnt(0)
v_accvgpr_read_b32 v36, a184
v_accvgpr_read_b32 v37, a188
v_bitop3_b32 v36, v36, v37, 1 bitop3:0xa8
v_cmp_ne_u32 vcc, 0, v36
s_nop 0
s_cbranch_vccnz RT3_9
RT3_9_X:
s_branch RT3_9_B
RT3_10:
s_cmp_eq_u32 s62, 0
s_cbranch_scc1 RT3_10_X
s_sub_u32 s62, s62, 1
s_sleep 4
buffer_load_dwordx4 a[192:195], v34, s[20:23], s32 offen offset:2048 sc1
buffer_load_dwordx4 a[196:199], v34, s[20:23], s33 offen offset:2048 sc1
buffer_load_dwordx4 a[224:227], v34, s[20:23], s32 offen offset:3072 sc1
buffer_load_dwordx4 a[228:231], v34, s[20:23], s33 offen offset:3072 sc1
s_waitcnt vmcnt(0)
v_accvgpr_read_b32 v36, a192
v_accvgpr_read_b32 v37, a196
v_bitop3_b32 v36, v36, v37, 1 bitop3:0xa8
v_cmp_ne_u32 vcc, 0, v36
s_nop 0
s_cbranch_vccnz RT3_10
RT3_10_X:
s_branch RT3_10_B
RT3_11:
s_cmp_eq_u32 s62, 0
s_cbranch_scc1 RT3_11_X
s_sub_u32 s62, s62, 1
s_sleep 4
buffer_load_dwordx4 a[200:203], v35, s[20:23], s32 offen offset:2048 sc1
buffer_load_dwordx4 a[204:207], v35, s[20:23], s33 offen offset:2048 sc1
buffer_load_dwordx4 a[232:235], v35, s[20:23], s32 offen offset:3072 sc1
buffer_load_dwordx4 a[236:239], v35, s[20:23], s33 offen offset:3072 sc1
s_waitcnt vmcnt(0)
v_accvgpr_read_b32 v36, a200
v_accvgpr_read_b32 v37, a204
v_bitop3_b32 v36, v36, v37, 1 bitop3:0xa8
v_cmp_ne_u32 vcc, 0, v36
s_nop 0
s_cbranch_vccnz RT3_11
RT3_11_X:
s_branch RT3_11_B
RT3_12:
s_cmp_eq_u32 s62, 0
s_cbranch_scc1 RT3_12_X
s_sub_u32 s62, s62, 1
s_sleep 4
buffer_load_dwordx4 a[208:211], v31, s[20:23], s32 offen offset:3072 sc1
buffer_load_dwordx4 a[212:215], v31, s[20:23], s33 offen offset:3072 sc1
buffer_load_dwordx4 a[0:3], v31, s[20:23], s68 offen sc1
buffer_load_dwordx4 a[4:7], v31, s[20:23], s69 offen sc1
s_waitcnt vmcnt(0)
v_accvgpr_read_b32 v36, a208
v_accvgpr_read_b32 v37, a212
v_bitop3_b32 v36, v36, v37, 1 bitop3:0xa8
v_cmp_ne_u32 vcc, 0, v36
s_nop 0
s_cbranch_vccnz RT3_12
RT3_12_X:
s_branch RT3_12_B
RT3_13:
s_cmp_eq_u32 s62, 0
s_cbranch_scc1 RT3_13_X
s_sub_u32 s62, s62, 1
s_sleep 4
buffer_load_dwordx4 a[216:219], v33, s[20:23], s32 offen offset:3072 sc1
buffer_load_dwordx4 a[220:223], v33, s[20:23], s33 offen offset:3072 sc1
buffer_load_dwordx4 a[8:11], v33, s[20:23], s68 offen sc1
buffer_load_dwordx4 a[12:15], v33, s[20:23], s69 offen sc1
s_waitcnt vmcnt(0)
v_accvgpr_read_b32 v36, a216
v_accvgpr_read_b32 v37, a220
v_bitop3_b32 v36, v36, v37, 1 bitop3:0xa8
v_cmp_ne_u32 vcc, 0, v36
s_nop 0
s_cbranch_vccnz RT3_13
RT3_13_X:
s_branch RT3_13_B
RT3_14:
s_cmp_eq_u32 s62, 0
s_cbranch_scc1 RT3_14_X
s_sub_u32 s62, s62, 1
s_sleep 4
buffer_load_dwordx4 a[224:227], v34, s[20:23], s32 offen offset:3072 sc1
buffer_load_dwordx4 a[228:231], v34, s[20:23], s33 offen offset:3072 sc1
buffer_load_dwordx4 a[16:19], v34, s[20:23], s68 offen sc1
buffer_load_dwordx4 a[20:23], v34, s[20:23], s69 offen sc1
s_waitcnt vmcnt(0)
v_accvgpr_read_b32 v36, a224
v_accvgpr_read_b32 v37, a228
v_bitop3_b32 v36, v36, v37, 1 bitop3:0xa8
v_cmp_ne_u32 vcc, 0, v36
s_nop 0
s_cbranch_vccnz RT3_14
RT3_14_X:
s_branch RT3_14_B
RT3_15:
s_cmp_eq_u32 s62, 0
s_cbranch_scc1 RT3_15_X
s_sub_u32 s62, s62, 1
s_sleep 4
buffer_load_dwordx4 a[232:235], v35, s[20:23], s32 offen offset:3072 sc1
buffer_load_dwordx4 a[236:239], v35, s[20:23], s33 offen offset:3072 sc1
buffer_load_dwordx4 a[24:27], v35, s[20:23], s68 offen sc1
buffer_load_dwordx4 a[28:31], v35, s[20:23], s69 offen sc1
s_waitcnt vmcnt(0)
v_accvgpr_read_b32 v36, a232
v_accvgpr_read_b32 v37, a236
v_bitop3_b32 v36, v36, v37, 1 bitop3:0xa8
v_cmp_ne_u32 vcc, 0, v36
s_nop 0
s_cbranch_vccnz RT3_15
RT3_15_X:
s_branch RT3_15_B
RT3_16:
s_cmp_eq_u32 s62, 0
s_cbranch_scc1 RT3_16_X
s_sub_u32 s62, s62, 1
s_sleep 4
buffer_load_dwordx4 a[0:3], v31, s[20:23], s68 offen sc1
buffer_load_dwordx4 a[4:7], v31, s[20:23], s69 offen sc1
buffer_load_dwordx4 a[32:35], v31, s[20:23], s68 offen offset:1024 sc1
buffer_load_dwordx4 a[36:39], v31, s[20:23], s69 offen offset:1024 sc1
s_waitcnt vmcnt(0)
v_accvgpr_read_b32 v36, a0
v_accvgpr_read_b32 v37, a4
v_bitop3_b32 v36, v36, v37, 1 bitop3:0xa8
v_cmp_ne_u32 vcc, 0, v36
s_nop 0
s_cbranch_vccnz RT3_16
RT3_16_X:
s_branch RT3_16_B
RT3_17:
s_cmp_eq_u32 s62, 0
s_cbranch_scc1 RT3_17_X
s_sub_u32 s62, s62, 1
s_sleep 4
buffer_load_dwordx4 a[8:11], v33, s[20:23], s68 offen sc1
buffer_load_dwordx4 a[12:15], v33, s[20:23], s69 offen sc1
buffer_load_dwordx4 a[40:43], v33, s[20:23], s68 offen offset:1024 sc1
buffer_load_dwordx4 a[44:47], v33, s[20:23], s69 offen offset:1024 sc1
s_waitcnt vmcnt(0)
v_accvgpr_read_b32 v36, a8
v_accvgpr_read_b32 v37, a12
v_bitop3_b32 v36, v36, v37, 1 bitop3:0xa8
v_cmp_ne_u32 vcc, 0, v36
s_nop 0
s_cbranch_vccnz RT3_17
RT3_17_X:
s_branch RT3_17_B
RT3_18:
s_cmp_eq_u32 s62, 0
s_cbranch_scc1 RT3_18_X
s_sub_u32 s62, s62, 1
s_sleep 4
buffer_load_dwordx4 a[16:19], v34, s[20:23], s68 offen sc1
buffer_load_dwordx4 a[20:23], v34, s[20:23], s69 offen sc1
buffer_load_dwordx4 a[48:51], v34, s[20:23], s68 offen offset:1024 sc1
buffer_load_dwordx4 a[52:55], v34, s[20:23], s69 offen offset:1024 sc1
s_waitcnt vmcnt(0)
v_accvgpr_read_b32 v36, a16
v_accvgpr_read_b32 v37, a20
v_bitop3_b32 v36, v36, v37, 1 bitop3:0xa8
v_cmp_ne_u32 vcc, 0, v36
s_nop 0
s_cbranch_vccnz RT3_18
RT3_18_X:
s_branch RT3_18_B
RT3_19:
s_cmp_eq_u32 s62, 0
s_cbranch_scc1 RT3_19_X
s_sub_u32 s62, s62, 1
s_sleep 4
buffer_load_dwordx4 a[24:27], v35, s[20:23], s68 offen sc1
buffer_load_dwordx4 a[28:31], v35, s[20:23], s69 offen sc1
buffer_load_dwordx4 a[56:59], v35, s[20:23], s68 offen offset:1024 sc1
buffer_load_dwordx4 a[60:63], v35, s[20:23], s69 offen offset:1024 sc1
s_waitcnt vmcnt(0)
v_accvgpr_read_b32 v36, a24
v_accvgpr_read_b32 v37, a28
v_bitop3_b32 v36, v36, v37, 1 bitop3:0xa8
v_cmp_ne_u32 vcc, 0, v36
s_nop 0
s_cbranch_vccnz RT3_19
RT3_19_X:
s_branch RT3_19_B
RT3_20:
s_cmp_eq_u32 s62, 0
s_cbranch_scc1 RT3_20_X
s_sub_u32 s62, s62, 1
s_sleep 4
buffer_load_dwordx4 a[32:35], v31, s[20:23], s68 offen offset:1024 sc1
buffer_load_dwordx4 a[36:39], v31, s[20:23], s69 offen offset:1024 sc1
buffer_load_dwordx4 a[160:163], v31, s[20:23], s68 offen offset:2048 sc1
buffer_load_dwordx4 a[164:167], v31, s[20:23], s69 offen offset:2048 sc1
s_waitcnt vmcnt(0)
v_accvgpr_read_b32 v36, a32
v_accvgpr_read_b32 v37, a36
v_bitop3_b32 v36, v36, v37, 1 bitop3:0xa8
v_cmp_ne_u32 vcc, 0, v36
s_nop 0
s_cbranch_vccnz RT3_20
RT3_20_X:
s_branch RT3_20_B
RT3_21:
s_cmp_eq_u32 s62, 0
s_cbranch_scc1 RT3_21_X
s_sub_u32 s62, s62, 1
s_sleep 4
buffer_load_dwordx4 a[40:43], v33, s[20:23], s68 offen offset:1024 sc1
buffer_load_dwordx4 a[44:47], v33, s[20:23], s69 offen offset:1024 sc1
buffer_load_dwordx4 a[168:171], v33, s[20:23], s68 offen offset:2048 sc1
buffer_load_dwordx4 a[172:175], v33, s[20:23], s69 offen offset:2048 sc1
s_waitcnt vmcnt(0)
v_accvgpr_read_b32 v36, a40
v_accvgpr_read_b32 v37, a44
v_bitop3_b32 v36, v36, v37, 1 bitop3:0xa8
v_cmp_ne_u32 vcc, 0, v36
s_nop 0
s_cbranch_vccnz RT3_21
RT3_21_X:
s_branch RT3_21_B
RT3_22:
s_cmp_eq_u32 s62, 0
s_cbranch_scc1 RT3_22_X
s_sub_u32 s62, s62, 1
s_sleep 4
buffer_load_dwordx4 a[48:51], v34, s[20:23], s68 offen offset:1024 sc1
buffer_load_dwordx4 a[52:55], v34, s[20:23], s69 offen offset:1024 sc1
buffer_load_dwordx4 a[176:179], v34, s[20:23], s68 offen offset:2048 sc1
buffer_load_dwordx4 a[180:183], v34, s[20:23], s69 offen offset:2048 sc1
s_waitcnt vmcnt(0)
v_accvgpr_read_b32 v36, a48
v_accvgpr_read_b32 v37, a52
v_bitop3_b32 v36, v36, v37, 1 bitop3:0xa8
v_cmp_ne_u32 vcc, 0, v36
s_nop 0
s_cbranch_vccnz RT3_22
RT3_22_X:
s_branch RT3_22_B
RT3_23:
s_cmp_eq_u32 s62, 0
s_cbranch_scc1 RT3_23_X
s_sub_u32 s62, s62, 1
s_sleep 4
buffer_load_dwordx4 a[56:59], v35, s[20:23], s68 offen offset:1024 sc1
buffer_load_dwordx4 a[60:63], v35, s[20:23], s69 offen offset:1024 sc1
buffer_load_dwordx4 a[184:187], v35, s[20:23], s68 offen offset:2048 sc1
buffer_load_dwordx4 a[188:191], v35, s[20:23], s69 offen offset:2048 sc1
s_waitcnt vmcnt(0)
v_accvgpr_read_b32 v36, a56
v_accvgpr_read_b32 v37, a60
v_bitop3_b32 v36, v36, v37, 1 bitop3:0xa8
v_cmp_ne_u32 vcc, 0, v36
s_nop 0
s_cbranch_vccnz RT3_23
RT3_23_X:
s_branch RT3_23_B
RT3_24:
s_cmp_eq_u32 s62, 0
s_cbranch_scc1 RT3_24_X
s_sub_u32 s62, s62, 1
s_sleep 4
buffer_load_dwordx4 a[160:163], v31, s[20:23], s68 offen offset:2048 sc1
buffer_load_dwordx4 a[164:167], v31, s[20:23], s69 offen offset:2048 sc1
s_waitcnt vmcnt(0)
v_accvgpr_read_b32 v36, a160
v_accvgpr_read_b32 v37, a164
v_bitop3_b32 v36, v36, v37, 1 bitop3:0xa8
v_cmp_ne_u32 vcc, 0, v36
s_nop 0
s_cbranch_vccnz RT3_24
RT3_24_X:
s_branch RT3_24_B
RT3_25:
s_cmp_eq_u32 s62, 0
s_cbranch_scc1 RT3_25_X
s_sub_u32 s62, s62, 1
s_sleep 4
buffer_load_dwordx4 a[168:171], v33, s[20:23], s68 offen offset:2048 sc1
buffer_load_dwordx4 a[172:175], v33, s[20:23], s69 offen offset:2048 sc1
s_waitcnt vmcnt(0)
v_accvgpr_read_b32 v36, a168
v_accvgpr_read_b32 v37, a172
v_bitop3_b32 v36, v36, v37, 1 bitop3:0xa8
v_cmp_ne_u32 vcc, 0, v36
s_nop 0
s_cbranch_vccnz RT3_25
RT3_25_X:
s_branch RT3_25_B
RT2_0:
s_cmp_eq_u32 s62, 0
s_cbranch_scc1 RT2_0_X
s_sub_u32 s62, s62, 1
s_sleep 2
buffer_load_dwordx4 a[128:131], v6, s[20:23], s61 offen sc1
buffer_load_dwordx4 a[132:135], v6, s[20:23], s61 offen offset:512 sc1
buffer_load_dwordx4 a[136:139], v6, s[20:23], s61 offen offset:1024 sc1
buffer_load_dwordx4 a[140:143], v6, s[20:23], s61 offen offset:1536 sc1
s_waitcnt vmcnt(0)
v_accvgpr_read_b32 v36, a128
v_accvgpr_read_b32 v37, a132
v_accvgpr_read_b32 v38, a136
v_or3_b32 v36, v36, v37, v38
v_accvgpr_read_b32 v37, a140
v_bitop3_b32 v36, v36, v37, 1 bitop3:0xa8
v_cmp_ne_u32 vcc, 0, v36
s_nop 0
s_cbranch_vccnz RT2_0
RT2_0_X:
s_branch RT2_0_B
RT2_1:
s_cmp_eq_u32 s62, 0
s_cbranch_scc1 RT2_1_X
s_sub_u32 s62, s62, 1
s_sleep 2
buffer_load_dwordx4 a[144:147], v6, s[20:23], s4 offen sc1
buffer_load_dwordx4 a[148:151], v6, s[20:23], s4 offen offset:512 sc1
buffer_load_dwordx4 a[152:155], v6, s[20:23], s4 offen offset:1024 sc1
buffer_load_dwordx4 a[156:159], v6, s[20:23], s4 offen offset:1536 sc1
s_waitcnt vmcnt(0)
v_accvgpr_read_b32 v36, a144
v_accvgpr_read_b32 v37, a148
v_accvgpr_read_b32 v38, a152
v_or3_b32 v36, v36, v37, v38
v_accvgpr_read_b32 v37, a156
v_bitop3_b32 v36, v36, v37, 1 bitop3:0xa8
v_cmp_ne_u32 vcc, 0, v36
s_nop 0
s_cbranch_vccnz RT2_1
RT2_1_X:
s_branch RT2_1_B
RT2_2:
s_cmp_eq_u32 s62, 0
s_cbranch_scc1 RT2_2_X
s_sub_u32 s62, s62, 1
s_sleep 2
buffer_load_dwordx4 a[160:163], v6, s[20:23], s5 offen sc1
buffer_load_dwordx4 a[164:167], v6, s[20:23], s5 offen offset:512 sc1
buffer_load_dwordx4 a[168:171], v6, s[20:23], s5 offen offset:1024 sc1
buffer_load_dwordx4 a[172:175], v6, s[20:23], s5 offen offset:1536 sc1
s_waitcnt vmcnt(0)
v_accvgpr_read_b32 v36, a160
v_accvgpr_read_b32 v37, a164
v_accvgpr_read_b32 v38, a168
v_or3_b32 v36, v36, v37, v38
v_accvgpr_read_b32 v37, a172
v_bitop3_b32 v36, v36, v37, 1 bitop3:0xa8
v_cmp_ne_u32 vcc, 0, v36
s_nop 0
s_cbranch_vccnz RT2_2
RT2_2_X:
s_branch RT2_2_B
RT2_3:
s_cmp_eq_u32 s62, 0
s_cbranch_scc1 RT2_3_X
s_sub_u32 s62, s62, 1
s_sleep 2
buffer_load_dwordx4 a[176:179], v6, s[20:23], s6 offen sc1
buffer_load_dwordx4 a[180:183], v6, s[20:23], s6 offen offset:512 sc1
buffer_load_dwordx4 a[184:187], v6, s[20:23], s6 offen offset:1024 sc1
buffer_load_dwordx4 a[188:191], v6, s[20:23], s6 offen offset:1536 sc1
s_waitcnt vmcnt(0)
v_accvgpr_read_b32 v36, a176
v_accvgpr_read_b32 v37, a180
v_accvgpr_read_b32 v38, a184
v_or3_b32 v36, v36, v37, v38
v_accvgpr_read_b32 v37, a188
v_bitop3_b32 v36, v36, v37, 1 bitop3:0xa8
v_cmp_ne_u32 vcc, 0, v36
s_nop 0
s_cbranch_vccnz RT2_3
RT2_3_X:
s_branch RT2_3_B
RT2_4:
s_cmp_eq_u32 s62, 0
s_cbranch_scc1 RT2_4_X
s_sub_u32 s62, s62, 1
s_sleep 2
buffer_load_dwordx4 a[192:195], v6, s[20:23], s7 offen sc1
buffer_load_dwordx4 a[196:199], v6, s[20:23], s7 offen offset:512 sc1
buffer_load_dwordx4 a[200:203], v6, s[20:23], s7 offen offset:1024 sc1
buffer_load_dwordx4 a[204:207], v6, s[20:23], s7 offen offset:1536 sc1
s_waitcnt vmcnt(0)
v_accvgpr_read_b32 v36, a192
v_accvgpr_read_b32 v37, a196
v_accvgpr_read_b32 v38, a200
v_or3_b32 v36, v36, v37, v38
v_accvgpr_read_b32 v37, a204
v_bitop3_b32 v36, v36, v37, 1 bitop3:0xa8
v_cmp_ne_u32 vcc, 0, v36
s_nop 0
s_cbranch_vccnz RT2_4
RT2_4_X:
s_branch RT2_4_B
RT2_5:
s_cmp_eq_u32 s62, 0
s_cbranch_scc1 RT2_5_X
s_sub_u32 s62, s62, 1
s_sleep 2
buffer_load_dwordx4 a[208:211], v6, s[20:23], s8 offen sc1
buffer_load_dwordx4 a[212:215], v6, s[20:23], s8 offen offset:512 sc1
buffer_load_dwordx4 a[216:219], v6, s[20:23], s8 offen offset:1024 sc1
buffer_load_dwordx4 a[220:223], v6, s[20:23], s8 offen offset:1536 sc1
s_waitcnt vmcnt(0)
v_accvgpr_read_b32 v36, a208
v_accvgpr_read_b32 v37, a212
v_accvgpr_read_b32 v38, a216
v_or3_b32 v36, v36, v37, v38
v_accvgpr_read_b32 v37, a220
v_bitop3_b32 v36, v36, v37, 1 bitop3:0xa8
v_cmp_ne_u32 vcc, 0, v36
s_nop 0
s_cbranch_vccnz RT2_5
RT2_5_X:
s_branch RT2_5_B
RT2_6:
s_cmp_eq_u32 s62, 0
s_cbranch_scc1 RT2_6_X
s_sub_u32 s62, s62, 1
s_sleep 2
buffer_load_dwordx4 a[224:227], v6, s[20:23], s9 offen sc1
buffer_load_dwordx4 a[228:231], v6, s[20:23], s9 offen offset:512 sc1
buffer_load_dwordx4 a[232:235], v6, s[20:23], s9 offen offset:1024 sc1
buffer_load_dwordx4 a[236:239], v6, s[20:23], s9 offen offset:1536 sc1
s_waitcnt vmcnt(0)
v_accvgpr_read_b32 v36, a224
v_accvgpr_read_b32 v37, a228
v_accvgpr_read_b32 v38, a232
v_or3_b32 v36, v36, v37, v38
v_accvgpr_read_b32 v37, a236
v_bitop3_b32 v36, v36, v37, 1 bitop3:0xa8
v_cmp_ne_u32 vcc, 0, v36
s_nop 0
s_cbranch_vccnz RT2_6
RT2_6_X:
s_branch RT2_6_B
PROD:
s_mov_b32 s61, 0xbfb8aa3b
s_mov_b32 s59, 0xffff0000
v_and_b32 v98, 3, v30
v_lshrrev_b32 v99, 4, v30
v_lshl_add_u32 v98, v98, 2, v99
v_lshlrev_b32 v99, 7, v29
v_lshl_add_u32 v121, v98, 3, v99
v_add_u32 v121, 147456, v121
v_mov_b32 v80, 0
v_mov_b32 v81, 0
v_mov_b32 v82, 0
v_mov_b32 v83, 0
v_mov_b32 v84, 0
v_mov_b32 v85, 0
v_mov_b32 v86, 0
v_mov_b32 v87, 0
s_cmp_lt_u32 s2, 28
s_cbranch_scc1 PROD1
s_waitcnt vmcnt(8)
PROD1:
s_waitcnt vmcnt(17)
v_lshlrev_b32 v64, 16, v124
v_and_b32 v65, s59, v124
v_lshlrev_b32 v66, 16, v125
v_and_b32 v67, s59, v125
v_lshlrev_b32 v68, 16, v126
v_and_b32 v69, s59, v126
v_lshlrev_b32 v70, 16, v127
v_and_b32 v71, s59, v127
v_mul_f32 v88, s61, v64
v_mul_f32 v89, s61, v65
v_mul_f32 v90, s61, v66
v_mul_f32 v91, s61, v67
v_mul_f32 v92, s61, v68
v_mul_f32 v93, s61, v69
v_mul_f32 v94, s61, v70
v_mul_f32 v95, s61, v71
v_exp_f32 v88, v88
v_exp_f32 v89, v89
v_exp_f32 v90, v90
v_exp_f32 v91, v91
v_exp_f32 v92, v92
v_exp_f32 v93, v93
v_exp_f32 v94, v94
v_exp_f32 v95, v95
v_add_f32 v88, 1.0, v88
v_add_f32 v89, 1.0, v89
v_add_f32 v90, 1.0, v90
v_add_f32 v91, 1.0, v91
v_add_f32 v92, 1.0, v92
v_add_f32 v93, 1.0, v93
v_add_f32 v94, 1.0, v94
v_add_f32 v95, 1.0, v95
v_rcp_f32 v88, v88
v_rcp_f32 v89, v89
v_rcp_f32 v90, v90
v_rcp_f32 v91, v91
v_rcp_f32 v92, v92
v_rcp_f32 v93, v93
v_rcp_f32 v94, v94
v_rcp_f32 v95, v95
v_mul_f32 v88, v64, v88
v_mul_f32 v89, v65, v89
v_mul_f32 v90, v66, v90
v_mul_f32 v91, v67, v91
v_mul_f32 v92, v68, v92
v_mul_f32 v93, v69, v93
v_mul_f32 v94, v70, v94
v_mul_f32 v95, v71, v95
v_cvt_pk_bf16_f32 v64, v88, 0
v_cvt_pk_bf16_f32 v65, v89, 0
v_cvt_pk_bf16_f32 v66, v90, 0
v_cvt_pk_bf16_f32 v67, v91, 0
v_cvt_pk_bf16_f32 v68, v92, 0
v_cvt_pk_bf16_f32 v69, v93, 0
v_cvt_pk_bf16_f32 v70, v94, 0
v_cvt_pk_bf16_f32 v71, v95, 0
v_cvt_pk_bf16_f32 v72, 0, v88
v_cvt_pk_bf16_f32 v73, 0, v89
v_cvt_pk_bf16_f32 v74, 0, v90
v_cvt_pk_bf16_f32 v75, 0, v91
v_cvt_pk_bf16_f32 v76, 0, v92
v_cvt_pk_bf16_f32 v77, 0, v93
v_cvt_pk_bf16_f32 v78, 0, v94
v_cvt_pk_bf16_f32 v79, 0, v95
s_cbranch_scc0 PRO_B
s_waitcnt vmcnt(16)
v_lshlrev_b32 v122, v122, 1
v_and_b32 v98, 0xcf, v0
v_lshrrev_b32 v99, 4, v0
v_or_b32_dpp v122, v122, v122 row_ror:1 row_mask:0xf bank_mask:0xf
s_nop 1
v_or_b32_dpp v122, v122, v122 row_ror:2 row_mask:0xf bank_mask:0xf
s_nop 1
v_or_b32_dpp v122, v122, v122 row_ror:4 row_mask:0xf bank_mask:0xf
s_nop 1
v_or_b32_dpp v122, v122, v122 row_ror:8 row_mask:0xf bank_mask:0xf
s_nop 1
v_not_b32 v122, v122
v_lshl_add_u32 v98, v98, 20, v99
v_ffbl_b32 v122, v122
s_lshl_b32 s61, s2, 2
v_add_u32 v122, 32, v122
buffer_store_byte v122, v98, s[40:43], s61 offen sc1
s_waitcnt vmcnt(16)
v_dot2c_f32_bf16 v80, v32, v64
v_dot2c_f32_bf16 v81, v32, v72
v_dot2c_f32_bf16 v82, v33, v64
v_dot2c_f32_bf16 v83, v33, v72
v_dot2c_f32_bf16 v84, v34, v64
v_dot2c_f32_bf16 v85, v34, v72
v_dot2c_f32_bf16 v86, v35, v64
v_dot2c_f32_bf16 v87, v35, v72
s_waitcnt vmcnt(15)
v_dot2c_f32_bf16 v80, v36, v65
v_dot2c_f32_bf16 v81, v36, v73
v_dot2c_f32_bf16 v82, v37, v65
v_dot2c_f32_bf16 v83, v37, v73
v_dot2c_f32_bf16 v84, v38, v65
v_dot2c_f32_bf16 v85, v38, v73
v_dot2c_f32_bf16 v86, v39, v65
v_dot2c_f32_bf16 v87, v39, v73
s_waitcnt vmcnt(14)
v_dot2c_f32_bf16 v80, v40, v66
v_dot2c_f32_bf16 v81, v40, v74
v_dot2c_f32_bf16 v82, v41, v66
v_dot2c_f32_bf16 v83, v41, v74
v_dot2c_f32_bf16 v84, v42, v66
v_dot2c_f32_bf16 v85, v42, v74
v_dot2c_f32_bf16 v86, v43, v66
v_dot2c_f32_bf16 v87, v43, v74
s_waitcnt vmcnt(13)
v_dot2c_f32_bf16 v80, v44, v67
v_dot2c_f32_bf16 v81, v44, v75
v_dot2c_f32_bf16 v82, v45, v67
v_dot2c_f32_bf16 v83, v45, v75
v_dot2c_f32_bf16 v84, v46, v67
v_dot2c_f32_bf16 v85, v46, v75
v_dot2c_f32_bf16 v86, v47, v67
v_dot2c_f32_bf16 v87, v47, v75
s_waitcnt vmcnt(12)
v_dot2c_f32_bf16 v80, v48, v68
v_dot2c_f32_bf16 v81, v48, v76
v_dot2c_f32_bf16 v82, v49, v68
v_dot2c_f32_bf16 v83, v49, v76
v_dot2c_f32_bf16 v84, v50, v68
v_dot2c_f32_bf16 v85, v50, v76
v_dot2c_f32_bf16 v86, v51, v68
v_dot2c_f32_bf16 v87, v51, v76
s_waitcnt vmcnt(11)
v_dot2c_f32_bf16 v80, v52, v69
v_dot2c_f32_bf16 v81, v52, v77
v_dot2c_f32_bf16 v82, v53, v69
v_dot2c_f32_bf16 v83, v53, v77
v_dot2c_f32_bf16 v84, v54, v69
v_dot2c_f32_bf16 v85, v54, v77
v_dot2c_f32_bf16 v86, v55, v69
v_dot2c_f32_bf16 v87, v55, v77
s_waitcnt vmcnt(10)
v_dot2c_f32_bf16 v80, v56, v70
v_dot2c_f32_bf16 v81, v56, v78
v_dot2c_f32_bf16 v82, v57, v70
v_dot2c_f32_bf16 v83, v57, v78
v_dot2c_f32_bf16 v84, v58, v70
v_dot2c_f32_bf16 v85, v58, v78
v_dot2c_f32_bf16 v86, v59, v70
v_dot2c_f32_bf16 v87, v59, v78
s_waitcnt vmcnt(9)
v_dot2c_f32_bf16 v80, v60, v71
v_dot2c_f32_bf16 v81, v60, v79
v_dot2c_f32_bf16 v82, v61, v71
v_dot2c_f32_bf16 v83, v61, v79
v_dot2c_f32_bf16 v84, v62, v71
v_dot2c_f32_bf16 v85, v62, v79
v_dot2c_f32_bf16 v86, v63, v71
v_dot2c_f32_bf16 v87, v63, v79
s_nop 0
v_permlane32_swap_b32 v80, v84
v_permlane32_swap_b32 v81, v85
v_permlane32_swap_b32 v82, v86
v_permlane32_swap_b32 v83, v87
v_add_f32 v80, v80, v84
v_add_f32 v81, v81, v85
v_add_f32 v82, v82, v86
v_add_f32 v83, v83, v87
s_nop 0
v_permlane16_swap_b32 v80, v82
v_permlane16_swap_b32 v81, v83
v_add_f32 v80, v80, v82
v_add_f32 v81, v81, v83
s_nop 0
v_add_f32_dpp v80, v80, v80 row_ror:4 row_mask:0xf bank_mask:0xf
v_add_f32_dpp v81, v81, v81 row_ror:4 row_mask:0xf bank_mask:0xf
s_nop 0
v_add_f32_dpp v80, v80, v80 row_ror:8 row_mask:0xf bank_mask:0xf
v_add_f32_dpp v81, v81, v81 row_ror:8 row_mask:0xf bank_mask:0xf
ds_write_b64 v121, v[80:81]
s_cmp_lg_u32 s56, 0
s_waitcnt lgkmcnt(0)
s_barrier
s_cbranch_scc1 PRO_B
v_and_b32 v40, 15, v0
v_lshlrev_b32 v40, 3, v40
v_add_u32 v41, 147456, v40
ds_read_b64 v[32:33], v41 offset:0
ds_read_b64 v[34:35], v41 offset:128
ds_read_b64 v[36:37], v41 offset:256
ds_read_b64 v[38:39], v41 offset:384
s_mul_i32 s60, s2, 4682
s_lshr_b32 s60, s60, 16
s_cmp_eq_u32 s60, 1
s_cselect_b32 s59, 1.0, 0
s_cmp_eq_u32 s60, 4
s_cselect_b32 s59, 1.0, s59
v_lshrrev_b32 v41, 4, v0
v_lshl_add_u32 v41, v41, 29, v40
v_mov_b32 v43, v122
s_waitcnt lgkmcnt(0)
v_add_f32 v32, v32, v34
v_add_f32 v33, v33, v35
v_add_f32 v36, v36, v38
v_add_f32 v37, v37, v39
v_add_f32 v32, v32, v36
v_add_f32 v33, v33, v37
v_cvt_pk_bf16_f32 v32, 0, v32
v_cvt_pk_bf16_f32 v33, 0, v33
v_add_f32 v32, s59, v32
v_add_f32 v33, s59, v33
v_cvt_pk_bf16_f32 v42, v32, v33
buffer_store_dwordx2 v[42:43], v123, s[20:23], s62 offen sc1
s_branch PRO_B
LATE:
s_waitcnt vmcnt(9)
v_dot2c_f32_bf16 v80, v32, v64
v_dot2c_f32_bf16 v81, v32, v72
v_dot2c_f32_bf16 v82, v33, v64
v_dot2c_f32_bf16 v83, v33, v72
v_dot2c_f32_bf16 v84, v34, v64
v_dot2c_f32_bf16 v85, v34, v72
v_dot2c_f32_bf16 v86, v35, v64
v_dot2c_f32_bf16 v87, v35, v72
s_waitcnt vmcnt(8)
v_dot2c_f32_bf16 v80, v36, v65
v_dot2c_f32_bf16 v81, v36, v73
v_dot2c_f32_bf16 v82, v37, v65
v_dot2c_f32_bf16 v83, v37, v73
v_dot2c_f32_bf16 v84, v38, v65
v_dot2c_f32_bf16 v85, v38, v73
v_dot2c_f32_bf16 v86, v39, v65
v_dot2c_f32_bf16 v87, v39, v73
s_waitcnt vmcnt(7)
v_dot2c_f32_bf16 v80, v40, v66
v_dot2c_f32_bf16 v81, v40, v74
v_dot2c_f32_bf16 v82, v41, v66
v_dot2c_f32_bf16 v83, v41, v74
v_dot2c_f32_bf16 v84, v42, v66
v_dot2c_f32_bf16 v85, v42, v74
v_dot2c_f32_bf16 v86, v43, v66
v_dot2c_f32_bf16 v87, v43, v74
s_waitcnt vmcnt(6)
v_dot2c_f32_bf16 v80, v44, v67
v_dot2c_f32_bf16 v81, v44, v75
v_dot2c_f32_bf16 v82, v45, v67
v_dot2c_f32_bf16 v83, v45, v75
v_dot2c_f32_bf16 v84, v46, v67
v_dot2c_f32_bf16 v85, v46, v75
v_dot2c_f32_bf16 v86, v47, v67
v_dot2c_f32_bf16 v87, v47, v75
s_waitcnt vmcnt(5)
v_dot2c_f32_bf16 v80, v48, v68
v_dot2c_f32_bf16 v81, v48, v76
v_dot2c_f32_bf16 v82, v49, v68
v_dot2c_f32_bf16 v83, v49, v76
v_dot2c_f32_bf16 v84, v50, v68
v_dot2c_f32_bf16 v85, v50, v76
v_dot2c_f32_bf16 v86, v51, v68
v_dot2c_f32_bf16 v87, v51, v76
s_waitcnt vmcnt(4)
v_dot2c_f32_bf16 v80, v52, v69
v_dot2c_f32_bf16 v81, v52, v77
v_dot2c_f32_bf16 v82, v53, v69
v_dot2c_f32_bf16 v83, v53, v77
v_dot2c_f32_bf16 v84, v54, v69
v_dot2c_f32_bf16 v85, v54, v77
v_dot2c_f32_bf16 v86, v55, v69
v_dot2c_f32_bf16 v87, v55, v77
s_waitcnt vmcnt(3)
v_dot2c_f32_bf16 v80, v56, v70
v_dot2c_f32_bf16 v81, v56, v78
v_dot2c_f32_bf16 v82, v57, v70
v_dot2c_f32_bf16 v83, v57, v78
v_dot2c_f32_bf16 v84, v58, v70
v_dot2c_f32_bf16 v85, v58, v78
v_dot2c_f32_bf16 v86, v59, v70
v_dot2c_f32_bf16 v87, v59, v78
s_waitcnt vmcnt(2)
v_dot2c_f32_bf16 v80, v60, v71
v_dot2c_f32_bf16 v81, v60, v79
v_dot2c_f32_bf16 v82, v61, v71
v_dot2c_f32_bf16 v83, v61, v79
v_dot2c_f32_bf16 v84, v62, v71
v_dot2c_f32_bf16 v85, v62, v79
v_dot2c_f32_bf16 v86, v63, v71
v_dot2c_f32_bf16 v87, v63, v79
s_nop 0
v_permlane32_swap_b32 v80, v84
v_permlane32_swap_b32 v81, v85
v_permlane32_swap_b32 v82, v86
v_permlane32_swap_b32 v83, v87
v_add_f32 v80, v80, v84
v_add_f32 v81, v81, v85
v_add_f32 v82, v82, v86
v_add_f32 v83, v83, v87
s_nop 0
v_permlane16_swap_b32 v80, v82
v_permlane16_swap_b32 v81, v83
v_add_f32 v80, v80, v82
v_add_f32 v81, v81, v83
s_nop 0
v_add_f32_dpp v80, v80, v80 row_ror:4 row_mask:0xf bank_mask:0xf
v_add_f32_dpp v81, v81, v81 row_ror:4 row_mask:0xf bank_mask:0xf
s_nop 0
v_add_f32_dpp v80, v80, v80 row_ror:8 row_mask:0xf bank_mask:0xf
v_add_f32_dpp v81, v81, v81 row_ror:8 row_mask:0xf bank_mask:0xf
ds_write_b64 v252, v[80:81]
s_branch PRO_E
LATE_F:
v_and_b32 v56, 15, v0
v_lshlrev_b32 v56, 3, v56
v_add_u32 v57, 147456, v56
ds_read_b64 v[48:49], v57 offset:0
ds_read_b64 v[50:51], v57 offset:128
ds_read_b64 v[52:53], v57 offset:256
ds_read_b64 v[54:55], v57 offset:384
s_mul_i32 s60, s2, 4682
s_lshr_b32 s60, s60, 16
s_cmp_eq_u32 s60, 1
s_cselect_b32 s59, 1.0, 0
s_cmp_eq_u32 s60, 4
s_cselect_b32 s59, 1.0, s59
v_lshrrev_b32 v57, 4, v0
v_lshl_add_u32 v57, v57, 29, v56
s_lshl_b32 s62, s2, 7
s_waitcnt lgkmcnt(0)
v_add_f32 v48, v48, v50
v_add_f32 v49, v49, v51
v_add_f32 v52, v52, v54
v_add_f32 v53, v53, v55
v_add_f32 v48, v48, v52
v_add_f32 v49, v49, v53
v_cvt_pk_bf16_f32 v48, 0, v48
v_cvt_pk_bf16_f32 v49, 0, v49
v_add_f32 v48, s59, v48
v_add_f32 v49, s59, v49
v_cvt_pk_bf16_f32 v48, 0, v48
v_cvt_pk_bf16_f32 v49, 0, v49
buffer_store_dwordx2 v[48:49], v57, s[20:23], s62 offen offset:512 sc1
s_branch LATE_FB
K_STUB1:
s_call_b64 s[30:31], K_RARE0
s_branch K_BACK1
K_STUB2:
s_call_b64 s[30:31], K_RARE1
s_branch K_BACK2
K_STUB3:
s_call_b64 s[30:31], K_RARE0
s_branch K_BACK3
K_STUB4:
s_call_b64 s[30:31], K_RARE1
s_branch K_BACK4
K_STUB5:
s_call_b64 s[30:31], K_RARE0
s_branch K_BACK5
K_STUB6:
s_call_b64 s[30:31], K_RARE1
s_branch K_BACK6
K_STUB7:
s_call_b64 s[30:31], K_RARE0
s_branch K_BACK7
K_STUB8:
s_call_b64 s[30:31], K_RARE1
s_branch K_BACK8
CHK_SLOW:
s_mov_b32 s62, 16384
POLLC_L:
buffer_load_dword v242, v240, s[40:43], 0 offen offset:128 sc1
s_waitcnt vmcnt(0)
v_cmp_le_u32 vcc, v241, v242
s_sub_u32 s62, s62, 1
s_cbranch_scc1 POLLC_D
s_cmp_eq_u64 vcc, -1
s_cbranch_scc1 POLLC_D
s_sleep 1
s_branch POLLC_L
POLLC_D:
s_branch CHK_BACK
K_RARE0:
s_nop 15
v_max3_f32 v33, v128, v129, v130
v_max3_f32 v33, v33, v131, v136
v_max3_f32 v33, v33, v137, v138
v_max3_f32 v33, v33, v139, v144
v_max3_f32 v33, v33, v145, v146
v_max3_f32 v33, v33, v147, v152
v_max3_f32 v33, v33, v153, v154
v_max_f32 v33, v33, v155
v_max3_f32 v34, v132, v133, v134
v_max3_f32 v34, v34, v135, v140
v_max3_f32 v34, v34, v141, v142
v_max3_f32 v34, v34, v143, v148
v_max3_f32 v34, v34, v149, v150
v_max3_f32 v34, v34, v151, v156
v_max3_f32 v34, v34, v157, v158
v_max_f32 v34, v34, v159
v_mov_b32 v35, v33
s_nop 1
v_permlane32_swap_b32 v33, v35
v_max_f32 v33, v33, v35
v_mov_b32 v35, v33
s_nop 1
v_permlane16_swap_b32 v33, v35
v_max_f32 v33, v33, v35
v_max_f32 v33, 0, v33
v_mov_b32 v35, v34
s_nop 1
v_permlane32_swap_b32 v34, v35
v_max_f32 v34, v34, v35
v_mov_b32 v35, v34
s_nop 1
v_permlane16_swap_b32 v34, v35
v_max_f32 v34, v34, v35
v_max_f32 v34, 0, v34
v_sub_f32 v35, 0, v33
v_exp_f32 v35, v35
v_sub_f32 v36, 0, v34
v_exp_f32 v36, v36
v_sub_f32 v128, v128, v33
v_sub_f32 v129, v129, v33
v_sub_f32 v130, v130, v33
v_sub_f32 v131, v131, v33
v_sub_f32 v136, v136, v33
v_sub_f32 v137, v137, v33
v_sub_f32 v138, v138, v33
v_sub_f32 v139, v139, v33
v_sub_f32 v144, v144, v33
v_sub_f32 v145, v145, v33
v_sub_f32 v146, v146, v33
v_sub_f32 v147, v147, v33
v_sub_f32 v152, v152, v33
v_sub_f32 v153, v153, v33
v_sub_f32 v154, v154, v33
v_sub_f32 v155, v155, v33
v_sub_f32 v160, v160, v33
v_sub_f32 v161, v161, v33
v_sub_f32 v162, v162, v33
v_sub_f32 v163, v163, v33
v_sub_f32 v168, v168, v33
v_sub_f32 v169, v169, v33
v_sub_f32 v170, v170, v33
v_sub_f32 v171, v171, v33
v_sub_f32 v176, v176, v33
v_sub_f32 v177, v177, v33
v_sub_f32 v178, v178, v33
v_sub_f32 v179, v179, v33
v_sub_f32 v184, v184, v33
v_sub_f32 v185, v185, v33
v_sub_f32 v186, v186, v33
v_sub_f32 v187, v187, v33
v_sub_f32 v48, v48, v33
v_sub_f32 v49, v49, v33
v_sub_f32 v50, v50, v33
v_sub_f32 v51, v51, v33
v_mul_f32 v29, v29, v35
v_sub_f32 v132, v132, v34
v_sub_f32 v133, v133, v34
v_sub_f32 v134, v134, v34
v_sub_f32 v135, v135, v34
v_sub_f32 v140, v140, v34
v_sub_f32 v141, v141, v34
v_sub_f32 v142, v142, v34
v_sub_f32 v143, v143, v34
v_sub_f32 v148, v148, v34
v_sub_f32 v149, v149, v34
v_sub_f32 v150, v150, v34
v_sub_f32 v151, v151, v34
v_sub_f32 v156, v156, v34
v_sub_f32 v157, v157, v34
v_sub_f32 v158, v158, v34
v_sub_f32 v159, v159, v34
v_sub_f32 v164, v164, v34
v_sub_f32 v165, v165, v34
v_sub_f32 v166, v166, v34
v_sub_f32 v167, v167, v34
v_sub_f32 v172, v172, v34
v_sub_f32 v173, v173, v34
v_sub_f32 v174, v174, v34
v_sub_f32 v175, v175, v34
v_sub_f32 v180, v180, v34
v_sub_f32 v181, v181, v34
v_sub_f32 v182, v182, v34
v_sub_f32 v183, v183, v34
v_sub_f32 v188, v188, v34
v_sub_f32 v189, v189, v34
v_sub_f32 v190, v190, v34
v_sub_f32 v191, v191, v34
v_sub_f32 v52, v52, v34
v_sub_f32 v53, v53, v34
v_sub_f32 v54, v54, v34
v_sub_f32 v55, v55, v34
v_mul_f32 v30, v30, v36
v_accvgpr_read_b32 v40, a0
v_accvgpr_read_b32 v41, a1
v_accvgpr_read_b32 v42, a2
v_accvgpr_read_b32 v43, a3
v_accvgpr_read_b32 v44, a4
v_accvgpr_read_b32 v45, a5
v_accvgpr_read_b32 v46, a6
v_accvgpr_read_b32 v47, a7
v_mul_f32 v40, v40, v35
v_mul_f32 v41, v41, v35
v_mul_f32 v42, v42, v35
v_mul_f32 v43, v43, v35
v_mul_f32 v44, v44, v36
v_mul_f32 v45, v45, v36
v_mul_f32 v46, v46, v36
v_mul_f32 v47, v47, v36
v_accvgpr_write_b32 a0, v40
v_accvgpr_write_b32 a1, v41
v_accvgpr_write_b32 a2, v42
v_accvgpr_write_b32 a3, v43
v_accvgpr_write_b32 a4, v44
v_accvgpr_write_b32 a5, v45
v_accvgpr_write_b32 a6, v46
v_accvgpr_write_b32 a7, v47
v_accvgpr_read_b32 v40, a8
v_accvgpr_read_b32 v41, a9
v_accvgpr_read_b32 v42, a10
v_accvgpr_read_b32 v43, a11
v_accvgpr_read_b32 v44, a12
v_accvgpr_read_b32 v45, a13
v_accvgpr_read_b32 v46, a14
v_accvgpr_read_b32 v47, a15
v_mul_f32 v40, v40, v35
v_mul_f32 v41, v41, v35
v_mul_f32 v42, v42, v35
v_mul_f32 v43, v43, v35
v_mul_f32 v44, v44, v36
v_mul_f32 v45, v45, v36
v_mul_f32 v46, v46, v36
v_mul_f32 v47, v47, v36
v_accvgpr_write_b32 a8, v40
v_accvgpr_write_b32 a9, v41
v_accvgpr_write_b32 a10, v42
v_accvgpr_write_b32 a11, v43
v_accvgpr_write_b32 a12, v44
v_accvgpr_write_b32 a13, v45
v_accvgpr_write_b32 a14, v46
v_accvgpr_write_b32 a15, v47
v_accvgpr_read_b32 v40, a16
v_accvgpr_read_b32 v41, a17
v_accvgpr_read_b32 v42, a18
v_accvgpr_read_b32 v43, a19
v_accvgpr_read_b32 v44, a20
v_accvgpr_read_b32 v45, a21
v_accvgpr_read_b32 v46, a22
v_accvgpr_read_b32 v47, a23
v_mul_f32 v40, v40, v35
v_mul_f32 v41, v41, v35
v_mul_f32 v42, v42, v35
v_mul_f32 v43, v43, v35
v_mul_f32 v44, v44, v36
v_mul_f32 v45, v45, v36
v_mul_f32 v46, v46, v36
v_mul_f32 v47, v47, v36
v_accvgpr_write_b32 a16, v40
v_accvgpr_write_b32 a17, v41
v_accvgpr_write_b32 a18, v42
v_accvgpr_write_b32 a19, v43
v_accvgpr_write_b32 a20, v44
v_accvgpr_write_b32 a21, v45
v_accvgpr_write_b32 a22, v46
v_accvgpr_write_b32 a23, v47
v_accvgpr_read_b32 v40, a24
v_accvgpr_read_b32 v41, a25
v_accvgpr_read_b32 v42, a26
v_accvgpr_read_b32 v43, a27
v_accvgpr_read_b32 v44, a28
v_accvgpr_read_b32 v45, a29
v_accvgpr_read_b32 v46, a30
v_accvgpr_read_b32 v47, a31
v_mul_f32 v40, v40, v35
v_mul_f32 v41, v41, v35
v_mul_f32 v42, v42, v35
v_mul_f32 v43, v43, v35
v_mul_f32 v44, v44, v36
v_mul_f32 v45, v45, v36
v_mul_f32 v46, v46, v36
v_mul_f32 v47, v47, v36
v_accvgpr_write_b32 a24, v40
v_accvgpr_write_b32 a25, v41
v_accvgpr_write_b32 a26, v42
v_accvgpr_write_b32 a27, v43
v_accvgpr_write_b32 a28, v44
v_accvgpr_write_b32 a29, v45
v_accvgpr_write_b32 a30, v46
v_accvgpr_write_b32 a31, v47
v_accvgpr_read_b32 v40, a32
v_accvgpr_read_b32 v41, a33
v_accvgpr_read_b32 v42, a34
v_accvgpr_read_b32 v43, a35
v_accvgpr_read_b32 v44, a36
v_accvgpr_read_b32 v45, a37
v_accvgpr_read_b32 v46, a38
v_accvgpr_read_b32 v47, a39
v_mul_f32 v40, v40, v35
v_mul_f32 v41, v41, v35
v_mul_f32 v42, v42, v35
v_mul_f32 v43, v43, v35
v_mul_f32 v44, v44, v36
v_mul_f32 v45, v45, v36
v_mul_f32 v46, v46, v36
v_mul_f32 v47, v47, v36
v_accvgpr_write_b32 a32, v40
v_accvgpr_write_b32 a33, v41
v_accvgpr_write_b32 a34, v42
v_accvgpr_write_b32 a35, v43
v_accvgpr_write_b32 a36, v44
v_accvgpr_write_b32 a37, v45
v_accvgpr_write_b32 a38, v46
v_accvgpr_write_b32 a39, v47
v_accvgpr_read_b32 v40, a40
v_accvgpr_read_b32 v41, a41
v_accvgpr_read_b32 v42, a42
v_accvgpr_read_b32 v43, a43
v_accvgpr_read_b32 v44, a44
v_accvgpr_read_b32 v45, a45
v_accvgpr_read_b32 v46, a46
v_accvgpr_read_b32 v47, a47
v_mul_f32 v40, v40, v35
v_mul_f32 v41, v41, v35
v_mul_f32 v42, v42, v35
v_mul_f32 v43, v43, v35
v_mul_f32 v44, v44, v36
v_mul_f32 v45, v45, v36
v_mul_f32 v46, v46, v36
v_mul_f32 v47, v47, v36
v_accvgpr_write_b32 a40, v40
v_accvgpr_write_b32 a41, v41
v_accvgpr_write_b32 a42, v42
v_accvgpr_write_b32 a43, v43
v_accvgpr_write_b32 a44, v44
v_accvgpr_write_b32 a45, v45
v_accvgpr_write_b32 a46, v46
v_accvgpr_write_b32 a47, v47
v_accvgpr_read_b32 v40, a48
v_accvgpr_read_b32 v41, a49
v_accvgpr_read_b32 v42, a50
v_accvgpr_read_b32 v43, a51
v_accvgpr_read_b32 v44, a52
v_accvgpr_read_b32 v45, a53
v_accvgpr_read_b32 v46, a54
v_accvgpr_read_b32 v47, a55
v_mul_f32 v40, v40, v35
v_mul_f32 v41, v41, v35
v_mul_f32 v42, v42, v35
v_mul_f32 v43, v43, v35
v_mul_f32 v44, v44, v36
v_mul_f32 v45, v45, v36
v_mul_f32 v46, v46, v36
v_mul_f32 v47, v47, v36
v_accvgpr_write_b32 a48, v40
v_accvgpr_write_b32 a49, v41
v_accvgpr_write_b32 a50, v42
v_accvgpr_write_b32 a51, v43
v_accvgpr_write_b32 a52, v44
v_accvgpr_write_b32 a53, v45
v_accvgpr_write_b32 a54, v46
v_accvgpr_write_b32 a55, v47
v_accvgpr_read_b32 v40, a56
v_accvgpr_read_b32 v41, a57
v_accvgpr_read_b32 v42, a58
v_accvgpr_read_b32 v43, a59
v_accvgpr_read_b32 v44, a60
v_accvgpr_read_b32 v45, a61
v_accvgpr_read_b32 v46, a62
v_accvgpr_read_b32 v47, a63
v_mul_f32 v40, v40, v35
v_mul_f32 v41, v41, v35
v_mul_f32 v42, v42, v35
v_mul_f32 v43, v43, v35
v_mul_f32 v44, v44, v36
v_mul_f32 v45, v45, v36
v_mul_f32 v46, v46, v36
v_mul_f32 v47, v47, v36
v_accvgpr_write_b32 a56, v40
v_accvgpr_write_b32 a57, v41
v_accvgpr_write_b32 a58, v42
v_accvgpr_write_b32 a59, v43
v_accvgpr_write_b32 a60, v44
v_accvgpr_write_b32 a61, v45
v_accvgpr_write_b32 a62, v46
v_accvgpr_write_b32 a63, v47
v_accvgpr_read_b32 v40, a64
v_accvgpr_read_b32 v41, a65
v_accvgpr_read_b32 v42, a66
v_accvgpr_read_b32 v43, a67
v_accvgpr_read_b32 v44, a68
v_accvgpr_read_b32 v45, a69
v_accvgpr_read_b32 v46, a70
v_accvgpr_read_b32 v47, a71
v_mul_f32 v40, v40, v35
v_mul_f32 v41, v41, v35
v_mul_f32 v42, v42, v35
v_mul_f32 v43, v43, v35
v_mul_f32 v44, v44, v36
v_mul_f32 v45, v45, v36
v_mul_f32 v46, v46, v36
v_mul_f32 v47, v47, v36
v_accvgpr_write_b32 a64, v40
v_accvgpr_write_b32 a65, v41
v_accvgpr_write_b32 a66, v42
v_accvgpr_write_b32 a67, v43
v_accvgpr_write_b32 a68, v44
v_accvgpr_write_b32 a69, v45
v_accvgpr_write_b32 a70, v46
v_accvgpr_write_b32 a71, v47
v_accvgpr_read_b32 v40, a72
v_accvgpr_read_b32 v41, a73
v_accvgpr_read_b32 v42, a74
v_accvgpr_read_b32 v43, a75
v_accvgpr_read_b32 v44, a76
v_accvgpr_read_b32 v45, a77
v_accvgpr_read_b32 v46, a78
v_accvgpr_read_b32 v47, a79
v_mul_f32 v40, v40, v35
v_mul_f32 v41, v41, v35
v_mul_f32 v42, v42, v35
v_mul_f32 v43, v43, v35
v_mul_f32 v44, v44, v36
v_mul_f32 v45, v45, v36
v_mul_f32 v46, v46, v36
v_mul_f32 v47, v47, v36
v_accvgpr_write_b32 a72, v40
v_accvgpr_write_b32 a73, v41
v_accvgpr_write_b32 a74, v42
v_accvgpr_write_b32 a75, v43
v_accvgpr_write_b32 a76, v44
v_accvgpr_write_b32 a77, v45
v_accvgpr_write_b32 a78, v46
v_accvgpr_write_b32 a79, v47
v_accvgpr_read_b32 v40, a80
v_accvgpr_read_b32 v41, a81
v_accvgpr_read_b32 v42, a82
v_accvgpr_read_b32 v43, a83
v_accvgpr_read_b32 v44, a84
v_accvgpr_read_b32 v45, a85
v_accvgpr_read_b32 v46, a86
v_accvgpr_read_b32 v47, a87
v_mul_f32 v40, v40, v35
v_mul_f32 v41, v41, v35
v_mul_f32 v42, v42, v35
v_mul_f32 v43, v43, v35
v_mul_f32 v44, v44, v36
v_mul_f32 v45, v45, v36
v_mul_f32 v46, v46, v36
v_mul_f32 v47, v47, v36
v_accvgpr_write_b32 a80, v40
v_accvgpr_write_b32 a81, v41
v_accvgpr_write_b32 a82, v42
v_accvgpr_write_b32 a83, v43
v_accvgpr_write_b32 a84, v44
v_accvgpr_write_b32 a85, v45
v_accvgpr_write_b32 a86, v46
v_accvgpr_write_b32 a87, v47
v_accvgpr_read_b32 v40, a88
v_accvgpr_read_b32 v41, a89
v_accvgpr_read_b32 v42, a90
v_accvgpr_read_b32 v43, a91
v_accvgpr_read_b32 v44, a92
v_accvgpr_read_b32 v45, a93
v_accvgpr_read_b32 v46, a94
v_accvgpr_read_b32 v47, a95
v_mul_f32 v40, v40, v35
v_mul_f32 v41, v41, v35
v_mul_f32 v42, v42, v35
v_mul_f32 v43, v43, v35
v_mul_f32 v44, v44, v36
v_mul_f32 v45, v45, v36
v_mul_f32 v46, v46, v36
v_mul_f32 v47, v47, v36
v_accvgpr_write_b32 a88, v40
v_accvgpr_write_b32 a89, v41
v_accvgpr_write_b32 a90, v42
v_accvgpr_write_b32 a91, v43
v_accvgpr_write_b32 a92, v44
v_accvgpr_write_b32 a93, v45
v_accvgpr_write_b32 a94, v46
v_accvgpr_write_b32 a95, v47
v_accvgpr_read_b32 v40, a96
v_accvgpr_read_b32 v41, a97
v_accvgpr_read_b32 v42, a98
v_accvgpr_read_b32 v43, a99
v_accvgpr_read_b32 v44, a100
v_accvgpr_read_b32 v45, a101
v_accvgpr_read_b32 v46, a102
v_accvgpr_read_b32 v47, a103
v_mul_f32 v40, v40, v35
v_mul_f32 v41, v41, v35
v_mul_f32 v42, v42, v35
v_mul_f32 v43, v43, v35
v_mul_f32 v44, v44, v36
v_mul_f32 v45, v45, v36
v_mul_f32 v46, v46, v36
v_mul_f32 v47, v47, v36
v_accvgpr_write_b32 a96, v40
v_accvgpr_write_b32 a97, v41
v_accvgpr_write_b32 a98, v42
v_accvgpr_write_b32 a99, v43
v_accvgpr_write_b32 a100, v44
v_accvgpr_write_b32 a101, v45
v_accvgpr_write_b32 a102, v46
v_accvgpr_write_b32 a103, v47
v_accvgpr_read_b32 v40, a104
v_accvgpr_read_b32 v41, a105
v_accvgpr_read_b32 v42, a106
v_accvgpr_read_b32 v43, a107
v_accvgpr_read_b32 v44, a108
v_accvgpr_read_b32 v45, a109
v_accvgpr_read_b32 v46, a110
v_accvgpr_read_b32 v47, a111
v_mul_f32 v40, v40, v35
v_mul_f32 v41, v41, v35
v_mul_f32 v42, v42, v35
v_mul_f32 v43, v43, v35
v_mul_f32 v44, v44, v36
v_mul_f32 v45, v45, v36
v_mul_f32 v46, v46, v36
v_mul_f32 v47, v47, v36
v_accvgpr_write_b32 a104, v40
v_accvgpr_write_b32 a105, v41
v_accvgpr_write_b32 a106, v42
v_accvgpr_write_b32 a107, v43
v_accvgpr_write_b32 a108, v44
v_accvgpr_write_b32 a109, v45
v_accvgpr_write_b32 a110, v46
v_accvgpr_write_b32 a111, v47
v_accvgpr_read_b32 v40, a112
v_accvgpr_read_b32 v41, a113
v_accvgpr_read_b32 v42, a114
v_accvgpr_read_b32 v43, a115
v_accvgpr_read_b32 v44, a116
v_accvgpr_read_b32 v45, a117
v_accvgpr_read_b32 v46, a118
v_accvgpr_read_b32 v47, a119
v_mul_f32 v40, v40, v35
v_mul_f32 v41, v41, v35
v_mul_f32 v42, v42, v35
v_mul_f32 v43, v43, v35
v_mul_f32 v44, v44, v36
v_mul_f32 v45, v45, v36
v_mul_f32 v46, v46, v36
v_mul_f32 v47, v47, v36
v_accvgpr_write_b32 a112, v40
v_accvgpr_write_b32 a113, v41
v_accvgpr_write_b32 a114, v42
v_accvgpr_write_b32 a115, v43
v_accvgpr_write_b32 a116, v44
v_accvgpr_write_b32 a117, v45
v_accvgpr_write_b32 a118, v46
v_accvgpr_write_b32 a119, v47
v_accvgpr_read_b32 v40, a120
v_accvgpr_read_b32 v41, a121
v_accvgpr_read_b32 v42, a122
v_accvgpr_read_b32 v43, a123
v_accvgpr_read_b32 v44, a124
v_accvgpr_read_b32 v45, a125
v_accvgpr_read_b32 v46, a126
v_accvgpr_read_b32 v47, a127
v_mul_f32 v40, v40, v35
v_mul_f32 v41, v41, v35
v_mul_f32 v42, v42, v35
v_mul_f32 v43, v43, v35
v_mul_f32 v44, v44, v36
v_mul_f32 v45, v45, v36
v_mul_f32 v46, v46, v36
v_mul_f32 v47, v47, v36
v_accvgpr_write_b32 a120, v40
v_accvgpr_write_b32 a121, v41
v_accvgpr_write_b32 a122, v42
v_accvgpr_write_b32 a123, v43
v_accvgpr_write_b32 a124, v44
v_accvgpr_write_b32 a125, v45
v_accvgpr_write_b32 a126, v46
v_accvgpr_write_b32 a127, v47
v_exp_f32 v40, v128
v_exp_f32 v41, v129
v_exp_f32 v42, v130
v_add_f32 v31, v40, v41
v_exp_f32 v43, v131
v_cvt_pk_bf16_f32 v192, v40, v41
v_exp_f32 v44, v132
v_add_f32 v31, v42, v31
v_exp_f32 v45, v133
v_cvt_pk_bf16_f32 v193, v42, v43
v_add_f32 v31, v43, v31
v_exp_f32 v46, v134
v_add_f32 v32, v44, v45
v_exp_f32 v47, v135
v_cvt_pk_bf16_f32 v200, v44, v45
v_exp_f32 v40, v136
v_add_f32 v32, v46, v32
v_exp_f32 v41, v137
v_cvt_pk_bf16_f32 v201, v46, v47
v_add_f32 v32, v47, v32
v_exp_f32 v42, v138
v_add_f32 v31, v40, v31
v_exp_f32 v43, v139
v_cvt_pk_bf16_f32 v194, v40, v41
v_add_f32 v31, v41, v31
v_exp_f32 v44, v140
v_add_f32 v31, v42, v31
v_exp_f32 v45, v141
v_cvt_pk_bf16_f32 v195, v42, v43
v_add_f32 v31, v43, v31
v_exp_f32 v46, v142
v_add_f32 v32, v44, v32
v_exp_f32 v47, v143
v_cvt_pk_bf16_f32 v202, v44, v45
v_add_f32 v32, v45, v32
v_exp_f32 v40, v144
v_add_f32 v32, v46, v32
v_exp_f32 v41, v145
v_cvt_pk_bf16_f32 v203, v46, v47
v_add_f32 v32, v47, v32
v_exp_f32 v42, v146
v_add_f32 v31, v40, v31
v_exp_f32 v43, v147
v_cvt_pk_bf16_f32 v196, v40, v41
v_add_f32 v31, v41, v31
v_exp_f32 v44, v148
v_add_f32 v31, v42, v31
v_exp_f32 v45, v149
v_cvt_pk_bf16_f32 v197, v42, v43
v_add_f32 v31, v43, v31
v_exp_f32 v46, v150
v_add_f32 v32, v44, v32
v_exp_f32 v47, v151
v_cvt_pk_bf16_f32 v204, v44, v45
v_add_f32 v32, v45, v32
v_exp_f32 v40, v152
v_add_f32 v32, v46, v32
v_exp_f32 v41, v153
v_cvt_pk_bf16_f32 v205, v46, v47
v_add_f32 v32, v47, v32
v_exp_f32 v42, v154
v_add_f32 v31, v40, v31
v_exp_f32 v43, v155
v_cvt_pk_bf16_f32 v198, v40, v41
v_add_f32 v31, v41, v31
v_exp_f32 v44, v156
v_add_f32 v31, v42, v31
v_exp_f32 v45, v157
v_cvt_pk_bf16_f32 v199, v42, v43
v_add_f32 v31, v43, v31
v_exp_f32 v46, v158
v_add_f32 v32, v44, v32
v_exp_f32 v47, v159
v_cvt_pk_bf16_f32 v206, v44, v45
v_add_f32 v32, v45, v32
v_add_f32 v32, v46, v32
v_cvt_pk_bf16_f32 v207, v46, v47
v_add_f32 v32, v47, v32
s_nop 4
s_setpc_b64 s[30:31]
K_RARE1:
s_nop 15
v_max3_f32 v33, v160, v161, v162
v_max3_f32 v33, v33, v163, v168
v_max3_f32 v33, v33, v169, v170
v_max3_f32 v33, v33, v171, v176
v_max3_f32 v33, v33, v177, v178
v_max3_f32 v33, v33, v179, v184
v_max3_f32 v33, v33, v185, v186
v_max_f32 v33, v33, v187
v_max3_f32 v34, v164, v165, v166
v_max3_f32 v34, v34, v167, v172
v_max3_f32 v34, v34, v173, v174
v_max3_f32 v34, v34, v175, v180
v_max3_f32 v34, v34, v181, v182
v_max3_f32 v34, v34, v183, v188
v_max3_f32 v34, v34, v189, v190
v_max_f32 v34, v34, v191
v_mov_b32 v35, v33
s_nop 1
v_permlane32_swap_b32 v33, v35
v_max_f32 v33, v33, v35
v_mov_b32 v35, v33
s_nop 1
v_permlane16_swap_b32 v33, v35
v_max_f32 v33, v33, v35
v_max_f32 v33, 0, v33
v_mov_b32 v35, v34
s_nop 1
v_permlane32_swap_b32 v34, v35
v_max_f32 v34, v34, v35
v_mov_b32 v35, v34
s_nop 1
v_permlane16_swap_b32 v34, v35
v_max_f32 v34, v34, v35
v_max_f32 v34, 0, v34
v_sub_f32 v35, 0, v33
v_exp_f32 v35, v35
v_sub_f32 v36, 0, v34
v_exp_f32 v36, v36
v_sub_f32 v128, v128, v33
v_sub_f32 v129, v129, v33
v_sub_f32 v130, v130, v33
v_sub_f32 v131, v131, v33
v_sub_f32 v136, v136, v33
v_sub_f32 v137, v137, v33
v_sub_f32 v138, v138, v33
v_sub_f32 v139, v139, v33
v_sub_f32 v144, v144, v33
v_sub_f32 v145, v145, v33
v_sub_f32 v146, v146, v33
v_sub_f32 v147, v147, v33
v_sub_f32 v152, v152, v33
v_sub_f32 v153, v153, v33
v_sub_f32 v154, v154, v33
v_sub_f32 v155, v155, v33
v_sub_f32 v160, v160, v33
v_sub_f32 v161, v161, v33
v_sub_f32 v162, v162, v33
v_sub_f32 v163, v163, v33
v_sub_f32 v168, v168, v33
v_sub_f32 v169, v169, v33
v_sub_f32 v170, v170, v33
v_sub_f32 v171, v171, v33
v_sub_f32 v176, v176, v33
v_sub_f32 v177, v177, v33
v_sub_f32 v178, v178, v33
v_sub_f32 v179, v179, v33
v_sub_f32 v184, v184, v33
v_sub_f32 v185, v185, v33
v_sub_f32 v186, v186, v33
v_sub_f32 v187, v187, v33
v_sub_f32 v48, v48, v33
v_sub_f32 v49, v49, v33
v_sub_f32 v50, v50, v33
v_sub_f32 v51, v51, v33
v_mul_f32 v29, v29, v35
v_sub_f32 v132, v132, v34
v_sub_f32 v133, v133, v34
v_sub_f32 v134, v134, v34
v_sub_f32 v135, v135, v34
v_sub_f32 v140, v140, v34
v_sub_f32 v141, v141, v34
v_sub_f32 v142, v142, v34
v_sub_f32 v143, v143, v34
v_sub_f32 v148, v148, v34
v_sub_f32 v149, v149, v34
v_sub_f32 v150, v150, v34
v_sub_f32 v151, v151, v34
v_sub_f32 v156, v156, v34
v_sub_f32 v157, v157, v34
v_sub_f32 v158, v158, v34
v_sub_f32 v159, v159, v34
v_sub_f32 v164, v164, v34
v_sub_f32 v165, v165, v34
v_sub_f32 v166, v166, v34
v_sub_f32 v167, v167, v34
v_sub_f32 v172, v172, v34
v_sub_f32 v173, v173, v34
v_sub_f32 v174, v174, v34
v_sub_f32 v175, v175, v34
v_sub_f32 v180, v180, v34
v_sub_f32 v181, v181, v34
v_sub_f32 v182, v182, v34
v_sub_f32 v183, v183, v34
v_sub_f32 v188, v188, v34
v_sub_f32 v189, v189, v34
v_sub_f32 v190, v190, v34
v_sub_f32 v191, v191, v34
v_sub_f32 v52, v52, v34
v_sub_f32 v53, v53, v34
v_sub_f32 v54, v54, v34
v_sub_f32 v55, v55, v34
v_mul_f32 v30, v30, v36
v_accvgpr_read_b32 v40, a0
v_accvgpr_read_b32 v41, a1
v_accvgpr_read_b32 v42, a2
v_accvgpr_read_b32 v43, a3
v_accvgpr_read_b32 v44, a4
v_accvgpr_read_b32 v45, a5
v_accvgpr_read_b32 v46, a6
v_accvgpr_read_b32 v47, a7
v_mul_f32 v40, v40, v35
v_mul_f32 v41, v41, v35
v_mul_f32 v42, v42, v35
v_mul_f32 v43, v43, v35
v_mul_f32 v44, v44, v36
v_mul_f32 v45, v45, v36
v_mul_f32 v46, v46, v36
v_mul_f32 v47, v47, v36
v_accvgpr_write_b32 a0, v40
v_accvgpr_write_b32 a1, v41
v_accvgpr_write_b32 a2, v42
v_accvgpr_write_b32 a3, v43
v_accvgpr_write_b32 a4, v44
v_accvgpr_write_b32 a5, v45
v_accvgpr_write_b32 a6, v46
v_accvgpr_write_b32 a7, v47
v_accvgpr_read_b32 v40, a8
v_accvgpr_read_b32 v41, a9
v_accvgpr_read_b32 v42, a10
v_accvgpr_read_b32 v43, a11
v_accvgpr_read_b32 v44, a12
v_accvgpr_read_b32 v45, a13
v_accvgpr_read_b32 v46, a14
v_accvgpr_read_b32 v47, a15
v_mul_f32 v40, v40, v35
v_mul_f32 v41, v41, v35
v_mul_f32 v42, v42, v35
v_mul_f32 v43, v43, v35
v_mul_f32 v44, v44, v36
v_mul_f32 v45, v45, v36
v_mul_f32 v46, v46, v36
v_mul_f32 v47, v47, v36
v_accvgpr_write_b32 a8, v40
v_accvgpr_write_b32 a9, v41
v_accvgpr_write_b32 a10, v42
v_accvgpr_write_b32 a11, v43
v_accvgpr_write_b32 a12, v44
v_accvgpr_write_b32 a13, v45
v_accvgpr_write_b32 a14, v46
v_accvgpr_write_b32 a15, v47
v_accvgpr_read_b32 v40, a16
v_accvgpr_read_b32 v41, a17
v_accvgpr_read_b32 v42, a18
v_accvgpr_read_b32 v43, a19
v_accvgpr_read_b32 v44, a20
v_accvgpr_read_b32 v45, a21
v_accvgpr_read_b32 v46, a22
v_accvgpr_read_b32 v47, a23
v_mul_f32 v40, v40, v35
v_mul_f32 v41, v41, v35
v_mul_f32 v42, v42, v35
v_mul_f32 v43, v43, v35
v_mul_f32 v44, v44, v36
v_mul_f32 v45, v45, v36
v_mul_f32 v46, v46, v36
v_mul_f32 v47, v47, v36
v_accvgpr_write_b32 a16, v40
v_accvgpr_write_b32 a17, v41
v_accvgpr_write_b32 a18, v42
v_accvgpr_write_b32 a19, v43
v_accvgpr_write_b32 a20, v44
v_accvgpr_write_b32 a21, v45
v_accvgpr_write_b32 a22, v46
v_accvgpr_write_b32 a23, v47
v_accvgpr_read_b32 v40, a24
v_accvgpr_read_b32 v41, a25
v_accvgpr_read_b32 v42, a26
v_accvgpr_read_b32 v43, a27
v_accvgpr_read_b32 v44, a28
v_accvgpr_read_b32 v45, a29
v_accvgpr_read_b32 v46, a30
v_accvgpr_read_b32 v47, a31
v_mul_f32 v40, v40, v35
v_mul_f32 v41, v41, v35
v_mul_f32 v42, v42, v35
v_mul_f32 v43, v43, v35
v_mul_f32 v44, v44, v36
v_mul_f32 v45, v45, v36
v_mul_f32 v46, v46, v36
v_mul_f32 v47, v47, v36
v_accvgpr_write_b32 a24, v40
v_accvgpr_write_b32 a25, v41
v_accvgpr_write_b32 a26, v42
v_accvgpr_write_b32 a27, v43
v_accvgpr_write_b32 a28, v44
v_accvgpr_write_b32 a29, v45
v_accvgpr_write_b32 a30, v46
v_accvgpr_write_b32 a31, v47
v_accvgpr_read_b32 v40, a32
v_accvgpr_read_b32 v41, a33
v_accvgpr_read_b32 v42, a34
v_accvgpr_read_b32 v43, a35
v_accvgpr_read_b32 v44, a36
v_accvgpr_read_b32 v45, a37
v_accvgpr_read_b32 v46, a38
v_accvgpr_read_b32 v47, a39
v_mul_f32 v40, v40, v35
v_mul_f32 v41, v41, v35
v_mul_f32 v42, v42, v35
v_mul_f32 v43, v43, v35
v_mul_f32 v44, v44, v36
v_mul_f32 v45, v45, v36
v_mul_f32 v46, v46, v36
v_mul_f32 v47, v47, v36
v_accvgpr_write_b32 a32, v40
v_accvgpr_write_b32 a33, v41
v_accvgpr_write_b32 a34, v42
v_accvgpr_write_b32 a35, v43
v_accvgpr_write_b32 a36, v44
v_accvgpr_write_b32 a37, v45
v_accvgpr_write_b32 a38, v46
v_accvgpr_write_b32 a39, v47
v_accvgpr_read_b32 v40, a40
v_accvgpr_read_b32 v41, a41
v_accvgpr_read_b32 v42, a42
v_accvgpr_read_b32 v43, a43
v_accvgpr_read_b32 v44, a44
v_accvgpr_read_b32 v45, a45
v_accvgpr_read_b32 v46, a46
v_accvgpr_read_b32 v47, a47
v_mul_f32 v40, v40, v35
v_mul_f32 v41, v41, v35
v_mul_f32 v42, v42, v35
v_mul_f32 v43, v43, v35
v_mul_f32 v44, v44, v36
v_mul_f32 v45, v45, v36
v_mul_f32 v46, v46, v36
v_mul_f32 v47, v47, v36
v_accvgpr_write_b32 a40, v40
v_accvgpr_write_b32 a41, v41
v_accvgpr_write_b32 a42, v42
v_accvgpr_write_b32 a43, v43
v_accvgpr_write_b32 a44, v44
v_accvgpr_write_b32 a45, v45
v_accvgpr_write_b32 a46, v46
v_accvgpr_write_b32 a47, v47
v_accvgpr_read_b32 v40, a48
v_accvgpr_read_b32 v41, a49
v_accvgpr_read_b32 v42, a50
v_accvgpr_read_b32 v43, a51
v_accvgpr_read_b32 v44, a52
v_accvgpr_read_b32 v45, a53
v_accvgpr_read_b32 v46, a54
v_accvgpr_read_b32 v47, a55
v_mul_f32 v40, v40, v35
v_mul_f32 v41, v41, v35
v_mul_f32 v42, v42, v35
v_mul_f32 v43, v43, v35
v_mul_f32 v44, v44, v36
v_mul_f32 v45, v45, v36
v_mul_f32 v46, v46, v36
v_mul_f32 v47, v47, v36
v_accvgpr_write_b32 a48, v40
v_accvgpr_write_b32 a49, v41
v_accvgpr_write_b32 a50, v42
v_accvgpr_write_b32 a51, v43
v_accvgpr_write_b32 a52, v44
v_accvgpr_write_b32 a53, v45
v_accvgpr_write_b32 a54, v46
v_accvgpr_write_b32 a55, v47
v_accvgpr_read_b32 v40, a56
v_accvgpr_read_b32 v41, a57
v_accvgpr_read_b32 v42, a58
v_accvgpr_read_b32 v43, a59
v_accvgpr_read_b32 v44, a60
v_accvgpr_read_b32 v45, a61
v_accvgpr_read_b32 v46, a62
v_accvgpr_read_b32 v47, a63
v_mul_f32 v40, v40, v35
v_mul_f32 v41, v41, v35
v_mul_f32 v42, v42, v35
v_mul_f32 v43, v43, v35
v_mul_f32 v44, v44, v36
v_mul_f32 v45, v45, v36
v_mul_f32 v46, v46, v36
v_mul_f32 v47, v47, v36
v_accvgpr_write_b32 a56, v40
v_accvgpr_write_b32 a57, v41
v_accvgpr_write_b32 a58, v42
v_accvgpr_write_b32 a59, v43
v_accvgpr_write_b32 a60, v44
v_accvgpr_write_b32 a61, v45
v_accvgpr_write_b32 a62, v46
v_accvgpr_write_b32 a63, v47
v_accvgpr_read_b32 v40, a64
v_accvgpr_read_b32 v41, a65
v_accvgpr_read_b32 v42, a66
v_accvgpr_read_b32 v43, a67
v_accvgpr_read_b32 v44, a68
v_accvgpr_read_b32 v45, a69
v_accvgpr_read_b32 v46, a70
v_accvgpr_read_b32 v47, a71
v_mul_f32 v40, v40, v35
v_mul_f32 v41, v41, v35
v_mul_f32 v42, v42, v35
v_mul_f32 v43, v43, v35
v_mul_f32 v44, v44, v36
v_mul_f32 v45, v45, v36
v_mul_f32 v46, v46, v36
v_mul_f32 v47, v47, v36
v_accvgpr_write_b32 a64, v40
v_accvgpr_write_b32 a65, v41
v_accvgpr_write_b32 a66, v42
v_accvgpr_write_b32 a67, v43
v_accvgpr_write_b32 a68, v44
v_accvgpr_write_b32 a69, v45
v_accvgpr_write_b32 a70, v46
v_accvgpr_write_b32 a71, v47
v_accvgpr_read_b32 v40, a72
v_accvgpr_read_b32 v41, a73
v_accvgpr_read_b32 v42, a74
v_accvgpr_read_b32 v43, a75
v_accvgpr_read_b32 v44, a76
v_accvgpr_read_b32 v45, a77
v_accvgpr_read_b32 v46, a78
v_accvgpr_read_b32 v47, a79
v_mul_f32 v40, v40, v35
v_mul_f32 v41, v41, v35
v_mul_f32 v42, v42, v35
v_mul_f32 v43, v43, v35
v_mul_f32 v44, v44, v36
v_mul_f32 v45, v45, v36
v_mul_f32 v46, v46, v36
v_mul_f32 v47, v47, v36
v_accvgpr_write_b32 a72, v40
v_accvgpr_write_b32 a73, v41
v_accvgpr_write_b32 a74, v42
v_accvgpr_write_b32 a75, v43
v_accvgpr_write_b32 a76, v44
v_accvgpr_write_b32 a77, v45
v_accvgpr_write_b32 a78, v46
v_accvgpr_write_b32 a79, v47
v_accvgpr_read_b32 v40, a80
v_accvgpr_read_b32 v41, a81
v_accvgpr_read_b32 v42, a82
v_accvgpr_read_b32 v43, a83
v_accvgpr_read_b32 v44, a84
v_accvgpr_read_b32 v45, a85
v_accvgpr_read_b32 v46, a86
v_accvgpr_read_b32 v47, a87
v_mul_f32 v40, v40, v35
v_mul_f32 v41, v41, v35
v_mul_f32 v42, v42, v35
v_mul_f32 v43, v43, v35
v_mul_f32 v44, v44, v36
v_mul_f32 v45, v45, v36
v_mul_f32 v46, v46, v36
v_mul_f32 v47, v47, v36
v_accvgpr_write_b32 a80, v40
v_accvgpr_write_b32 a81, v41
v_accvgpr_write_b32 a82, v42
v_accvgpr_write_b32 a83, v43
v_accvgpr_write_b32 a84, v44
v_accvgpr_write_b32 a85, v45
v_accvgpr_write_b32 a86, v46
v_accvgpr_write_b32 a87, v47
v_accvgpr_read_b32 v40, a88
v_accvgpr_read_b32 v41, a89
v_accvgpr_read_b32 v42, a90
v_accvgpr_read_b32 v43, a91
v_accvgpr_read_b32 v44, a92
v_accvgpr_read_b32 v45, a93
v_accvgpr_read_b32 v46, a94
v_accvgpr_read_b32 v47, a95
v_mul_f32 v40, v40, v35
v_mul_f32 v41, v41, v35
v_mul_f32 v42, v42, v35
v_mul_f32 v43, v43, v35
v_mul_f32 v44, v44, v36
v_mul_f32 v45, v45, v36
v_mul_f32 v46, v46, v36
v_mul_f32 v47, v47, v36
v_accvgpr_write_b32 a88, v40
v_accvgpr_write_b32 a89, v41
v_accvgpr_write_b32 a90, v42
v_accvgpr_write_b32 a91, v43
v_accvgpr_write_b32 a92, v44
v_accvgpr_write_b32 a93, v45
v_accvgpr_write_b32 a94, v46
v_accvgpr_write_b32 a95, v47
v_accvgpr_read_b32 v40, a96
v_accvgpr_read_b32 v41, a97
v_accvgpr_read_b32 v42, a98
v_accvgpr_read_b32 v43, a99
v_accvgpr_read_b32 v44, a100
v_accvgpr_read_b32 v45, a101
v_accvgpr_read_b32 v46, a102
v_accvgpr_read_b32 v47, a103
v_mul_f32 v40, v40, v35
v_mul_f32 v41, v41, v35
v_mul_f32 v42, v42, v35
v_mul_f32 v43, v43, v35
v_mul_f32 v44, v44, v36
v_mul_f32 v45, v45, v36
v_mul_f32 v46, v46, v36
v_mul_f32 v47, v47, v36
v_accvgpr_write_b32 a96, v40
v_accvgpr_write_b32 a97, v41
v_accvgpr_write_b32 a98, v42
v_accvgpr_write_b32 a99, v43
v_accvgpr_write_b32 a100, v44
v_accvgpr_write_b32 a101, v45
v_accvgpr_write_b32 a102, v46
v_accvgpr_write_b32 a103, v47
v_accvgpr_read_b32 v40, a104
v_accvgpr_read_b32 v41, a105
v_accvgpr_read_b32 v42, a106
v_accvgpr_read_b32 v43, a107
v_accvgpr_read_b32 v44, a108
v_accvgpr_read_b32 v45, a109
v_accvgpr_read_b32 v46, a110
v_accvgpr_read_b32 v47, a111
v_mul_f32 v40, v40, v35
v_mul_f32 v41, v41, v35
v_mul_f32 v42, v42, v35
v_mul_f32 v43, v43, v35
v_mul_f32 v44, v44, v36
v_mul_f32 v45, v45, v36
v_mul_f32 v46, v46, v36
v_mul_f32 v47, v47, v36
v_accvgpr_write_b32 a104, v40
v_accvgpr_write_b32 a105, v41
v_accvgpr_write_b32 a106, v42
v_accvgpr_write_b32 a107, v43
v_accvgpr_write_b32 a108, v44
v_accvgpr_write_b32 a109, v45
v_accvgpr_write_b32 a110, v46
v_accvgpr_write_b32 a111, v47
v_accvgpr_read_b32 v40, a112
v_accvgpr_read_b32 v41, a113
v_accvgpr_read_b32 v42, a114
v_accvgpr_read_b32 v43, a115
v_accvgpr_read_b32 v44, a116
v_accvgpr_read_b32 v45, a117
v_accvgpr_read_b32 v46, a118
v_accvgpr_read_b32 v47, a119
v_mul_f32 v40, v40, v35
v_mul_f32 v41, v41, v35
v_mul_f32 v42, v42, v35
v_mul_f32 v43, v43, v35
v_mul_f32 v44, v44, v36
v_mul_f32 v45, v45, v36
v_mul_f32 v46, v46, v36
v_mul_f32 v47, v47, v36
v_accvgpr_write_b32 a112, v40
v_accvgpr_write_b32 a113, v41
v_accvgpr_write_b32 a114, v42
v_accvgpr_write_b32 a115, v43
v_accvgpr_write_b32 a116, v44
v_accvgpr_write_b32 a117, v45
v_accvgpr_write_b32 a118, v46
v_accvgpr_write_b32 a119, v47
v_accvgpr_read_b32 v40, a120
v_accvgpr_read_b32 v41, a121
v_accvgpr_read_b32 v42, a122
v_accvgpr_read_b32 v43, a123
v_accvgpr_read_b32 v44, a124
v_accvgpr_read_b32 v45, a125
v_accvgpr_read_b32 v46, a126
v_accvgpr_read_b32 v47, a127
v_mul_f32 v40, v40, v35
v_mul_f32 v41, v41, v35
v_mul_f32 v42, v42, v35
v_mul_f32 v43, v43, v35
v_mul_f32 v44, v44, v36
v_mul_f32 v45, v45, v36
v_mul_f32 v46, v46, v36
v_mul_f32 v47, v47, v36
v_accvgpr_write_b32 a120, v40
v_accvgpr_write_b32 a121, v41
v_accvgpr_write_b32 a122, v42
v_accvgpr_write_b32 a123, v43
v_accvgpr_write_b32 a124, v44
v_accvgpr_write_b32 a125, v45
v_accvgpr_write_b32 a126, v46
v_accvgpr_write_b32 a127, v47
v_exp_f32 v40, v160
v_exp_f32 v41, v161
v_exp_f32 v42, v162
v_add_f32 v31, v40, v41
v_exp_f32 v43, v163
v_cvt_pk_bf16_f32 v208, v40, v41
v_exp_f32 v44, v164
v_add_f32 v31, v42, v31
v_exp_f32 v45, v165
v_cvt_pk_bf16_f32 v209, v42, v43
v_add_f32 v31, v43, v31
v_exp_f32 v46, v166
v_add_f32 v32, v44, v45
v_exp_f32 v47, v167
v_cvt_pk_bf16_f32 v216, v44, v45
v_exp_f32 v40, v168
v_add_f32 v32, v46, v32
v_exp_f32 v41, v169
v_cvt_pk_bf16_f32 v217, v46, v47
v_add_f32 v32, v47, v32
v_exp_f32 v42, v170
v_add_f32 v31, v40, v31
v_exp_f32 v43, v171
v_cvt_pk_bf16_f32 v210, v40, v41
v_add_f32 v31, v41, v31
v_exp_f32 v44, v172
v_add_f32 v31, v42, v31
v_exp_f32 v45, v173
v_cvt_pk_bf16_f32 v211, v42, v43
v_add_f32 v31, v43, v31
v_exp_f32 v46, v174
v_add_f32 v32, v44, v32
v_exp_f32 v47, v175
v_cvt_pk_bf16_f32 v218, v44, v45
v_add_f32 v32, v45, v32
v_exp_f32 v40, v176
v_add_f32 v32, v46, v32
v_exp_f32 v41, v177
v_cvt_pk_bf16_f32 v219, v46, v47
v_add_f32 v32, v47, v32
v_exp_f32 v42, v178
v_add_f32 v31, v40, v31
v_exp_f32 v43, v179
v_cvt_pk_bf16_f32 v212, v40, v41
v_add_f32 v31, v41, v31
v_exp_f32 v44, v180
v_add_f32 v31, v42, v31
v_exp_f32 v45, v181
v_cvt_pk_bf16_f32 v213, v42, v43
v_add_f32 v31, v43, v31
v_exp_f32 v46, v182
v_add_f32 v32, v44, v32
v_exp_f32 v47, v183
v_cvt_pk_bf16_f32 v220, v44, v45
v_add_f32 v32, v45, v32
v_exp_f32 v40, v184
v_add_f32 v32, v46, v32
v_exp_f32 v41, v185
v_cvt_pk_bf16_f32 v221, v46, v47
v_add_f32 v32, v47, v32
v_exp_f32 v42, v186
v_add_f32 v31, v40, v31
v_exp_f32 v43, v187
v_cvt_pk_bf16_f32 v214, v40, v41
v_add_f32 v31, v41, v31
v_exp_f32 v44, v188
v_add_f32 v31, v42, v31
v_exp_f32 v45, v189
v_cvt_pk_bf16_f32 v215, v42, v43
v_add_f32 v31, v43, v31
v_exp_f32 v46, v190
v_add_f32 v32, v44, v32
v_exp_f32 v47, v191
v_cvt_pk_bf16_f32 v222, v44, v45
v_add_f32 v32, v45, v32
v_add_f32 v32, v46, v32
v_cvt_pk_bf16_f32 v223, v46, v47
v_add_f32 v32, v47, v32
s_nop 4
s_setpc_b64 s[30:31]
.section .rodata,"a"
.p2align 6
.amdhsa_kernel adaLN_cond__mha_block_cached__glu_gated_geglu__prompt_kernel
  .amdhsa_next_free_vgpr 512
  .amdhsa_next_free_sgpr 102
  .amdhsa_accum_offset 256
  .amdhsa_group_segment_fixed_size 0
  .amdhsa_kernarg_size 112
  .amdhsa_user_sgpr_count 2
  .amdhsa_user_sgpr_kernarg_segment_ptr 1
  .amdhsa_system_sgpr_workgroup_id_x 1
  .amdhsa_float_denorm_mode_32 3
.end_amdhsa_kernel
```
